```python
import torch

def _softmax(x, axis=-1):
    return torch.softmax(x, dim=axis)
def _gelu(x):
    return torch.nn.functional.gelu(x, approximate="tanh")
def _silu(x):
    return torch.nn.functional.silu(x)
def _sigmoid(x):
    return torch.sigmoid(x)
def _layernorm(x, axis=-1, eps=1e-5):
    m = x.mean(dim=axis, keepdim=True)
    v = x.var(dim=axis, keepdim=True, unbiased=False)
    return (x - m) / torch.sqrt(v + eps)
def _scatter_add(tgt, idx, src, axis=0):
    return tgt.clone().index_add_(axis, idx, src)
def _segment_sum(src, seg, n):
    out = torch.zeros((n,) + src.shape[1:], dtype=src.dtype)
    return out.index_add_(0, seg, src)
def _pad(x, pw):
    flat = tuple(v for pair in reversed(pw) for v in pair)
    return torch.nn.functional.pad(x, flat)

kernel_name = 'parallel_sum__compressed_kv_cla__dense_activation_silu__prompt'

def setup_inputs():

    _w = (lambda a: (lambda t: t.to(torch.bfloat16) if t.is_floating_point() else t)(torch.as_tensor(a)))
    def _A_setup():
        B, H, Sq, Sk, D, M = 1, 32, 2048, 2048, 128, 640
        Dc = 4 * D
        return {
            "x": _w((lambda *s: torch.randn(*s, dtype=torch.bfloat16) * 0.05)(B, Sq, M)),
            "c_kv": _w((lambda *s: torch.randn(*s, dtype=torch.bfloat16) * 0.4)(B, Sk, Dc)),
            "w_q": _w((lambda *s: torch.randn(*s, dtype=torch.bfloat16) * 3.2)(M, H, D) * (M ** -0.5)),
            "w_uk": _w((lambda *s: torch.randn(*s, dtype=torch.bfloat16) * 3.2)(Dc, H, D) * (Dc ** -0.5)),
            "w_uv": _w((lambda *s: torch.randn(*s, dtype=torch.bfloat16) * 0.4)(Dc, H, D) * (Dc ** -0.5)),
            "w_o": _w((lambda *s: torch.randn(*s, dtype=torch.bfloat16) * 0.4)(H, D, M) * ((H * D) ** -0.5)),
        }
    _A_in = _A_setup()

    def _B_setup():
        B, S, D, F = 1, 2048, 640, 1728
        return {
            "x": _w((lambda *s: torch.randn(*s, dtype=torch.bfloat16) * 0.05)(B, S, D)),
            "w1": _w((lambda *s: torch.randn(*s, dtype=torch.bfloat16) * 0.8)(D, F) * (D ** -0.5)),
            "w2": _w((lambda *s: torch.randn(*s, dtype=torch.bfloat16) * 0.1)(F, D) * (F ** -0.5)),
        }
    _B_in = _B_setup()

    return {
        "A_x": _A_in["x"],
        "A_c_kv": _A_in["c_kv"],
        "A_w_q": _A_in["w_q"],
        "A_w_uk": _A_in["w_uk"],
        "A_w_uv": _A_in["w_uv"],
        "A_w_o": _A_in["w_o"],
        "B_x": _B_in["x"],
        "B_w1": _B_in["w1"],
        "B_w2": _B_in["w2"],
    }

def reference(A_x, A_c_kv, A_w_q, A_w_uk, A_w_uv, A_w_o, B_x, B_w1, B_w2):
    def _A_ref(x, c_kv, w_q, w_uk, w_uv, w_o):
        B, Sq, M = x.shape[0], x.shape[1], x.shape[2]
        Sk = c_kv.shape[1]
        H, D = w_q.shape[1], w_q.shape[2]
        q = torch.einsum("bqm,mhd->bhqd", x, w_q)
        k = torch.einsum("bkc,chd->bhkd", c_kv, w_uk)
        v = torch.einsum("bkc,chd->bhkd", c_kv, w_uv)
        scores = torch.einsum("bhqd,bhkd->bhqk", q, k) * (D ** -0.5)
        off = Sk - Sq
        qi = torch.arange(Sq)[:, None]
        kj = torch.arange(Sk)[None, :]
        cmask = kj <= (qi + off)
        scores = torch.where(cmask[None, None], scores, -1e9)
        p = _softmax(scores, axis=-1)
        ctx = torch.einsum("bhqk,bhkd->bhqd", p, v)
        return torch.einsum("bhqd,hdm->bqm", ctx, w_o)

    def _B_ref(x, w1, w2):
        h = torch.einsum("bsd,df->bsf", x, w1)
        h = _silu(h)
        out = torch.einsum("bsf,fd->bsd", h, w2)
        return out

    x = A_x
    xn = _layernorm(x, axis=-1)
    return x + _A_ref(xn, A_c_kv, A_w_q, A_w_uk, A_w_uv, A_w_o) + _B_ref(xn, B_w1, B_w2)
```

```asm
; @launch grid=(256,1,1) block=(256,1,1) lds=163840
.amdgcn_target "amdgcn-amd-amdhsa--gfx950"
.text
.globl parallel_sum__compressed_kv_cla__dense_activation_silu__prompt_kernel
.p2align 8
.type parallel_sum__compressed_kv_cla__dense_activation_silu__prompt_kernel,@function
parallel_sum__compressed_kv_cla__dense_activation_silu__prompt_kernel:
  s_cmp_ge_u32 s2, 256
  s_cbranch_scc1 L_end
  s_load_dwordx16 s[64:79], s[0:1], 0
  s_load_dwordx8 s[80:87], s[0:1], 64
  s_getpc_b64 s[96:97]
L_pc:
  v_lshrrev_b32 v1, 6, v0
  s_and_b32 s28, s2, 7
  s_lshr_b32 s6, s28, 1
  v_readfirstlane_b32 s3, v1
  s_and_b32 s28, s28, 1
  s_lshr_b32 s29, s2, 3
  s_and_b32 s7, s29, 7
  s_lshr_b32 s29, s29, 3
  s_lshl_b32 s4, s6, 3
  s_add_u32 s4, s4, s7
  s_lshl_b32 s30, s28, 2
  s_add_u32 s5, s29, s30
  v_bfe_u32 v7, v0, 3, 3
  v_and_b32 v8, 6, v7
  v_and_b32 v11, 7, v0
  v_xor_b32 v8, v8, v11
  v_lshlrev_b32 v8, 4, v8
  v_lshl_add_u32 v5, v7, 10, v8
  v_mul_u32_u24 v9, 0x500, v11
  v_lshl_add_u32 v9, v7, 4, v9
  s_lshl_b32 s32, s5, 18
  s_lshl_b32 s28, s3, 16
  s_add_u32 s32, s32, s28
  s_lshl_b32 s34, s3, 13
  s_mul_i32 s29, s2, 10240
  s_lshl_b32 s28, s3, 7
  s_add_u32 s29, s29, s28
  s_lshl_b32 s28, s3, 10
  s_add_u32 s30, s28, 133120
  s_mov_b32 s26, 2621440
  s_mov_b32 s27, 0x20000
  s_mov_b32 s14, 2097152
  s_mov_b32 s15, 0x20000
  s_waitcnt lgkmcnt(0)
  s_mov_b32 s24, s64
  s_and_b32 s25, s65, 0xffff
  s_mov_b32 s12, s66
  s_and_b32 s13, s67, 0xffff
  s_add_u32 m0, s30, 0
  s_add_u32 s28, s29, 0
  buffer_load_dwordx4 v9, s[24:27], s28 offen lds
  s_add_u32 m0, s30, 4096
  s_add_u32 s28, s29, 512
  buffer_load_dwordx4 v9, s[24:27], s28 offen lds
  s_cmp_ge_u32 s3, 2
  s_cbranch_scc1 L_x2
  s_add_u32 m0, s30, 8192
  s_add_u32 s28, s29, 1024
  buffer_load_dwordx4 v9, s[24:27], s28 offen lds
L_x2:
  s_add_u32 m0, s34, 0
  s_add_u32 s28, s32, 0
  buffer_load_dwordx4 v5, s[12:15], s28 offen lds
  s_add_u32 m0, s34, 1024
  s_add_u32 s28, s32, 8192
  buffer_load_dwordx4 v5, s[12:15], s28 offen lds
  s_add_u32 m0, s34, 2048
  s_add_u32 s28, s32, 16384
  buffer_load_dwordx4 v5, s[12:15], s28 offen lds
  s_add_u32 m0, s34, 3072
  s_add_u32 s28, s32, 24576
  buffer_load_dwordx4 v5, s[12:15], s28 offen lds
  s_add_u32 m0, s34, 4096
  s_add_u32 s28, s32, 32768
  buffer_load_dwordx4 v5, s[12:15], s28 offen lds
  s_add_u32 m0, s34, 5120
  s_add_u32 s28, s32, 40960
  buffer_load_dwordx4 v5, s[12:15], s28 offen lds
  s_add_u32 m0, s34, 6144
  s_add_u32 s28, s32, 49152
  buffer_load_dwordx4 v5, s[12:15], s28 offen lds
  s_add_u32 m0, s34, 7168
  s_add_u32 s28, s32, 57344
  buffer_load_dwordx4 v5, s[12:15], s28 offen lds
  v_lshlrev_b32 v14, 4, v11
  v_lshl_add_u32 v14, v7, 8, v14
  s_lshr_b32 s28, s2, 3
  s_lshl_b32 s28, s28, 2
  s_add_u32 s28, s28, s3
  s_mul_i32 s28, s28, 768
  v_lshlrev_b32 v7, 7, v11
  v_add_u32 v7, s28, v7
  v_min_u32 v7, L_end-L_pc, v7
  global_load_dword v10, v7, s[96:97]
  v_bfe_u32 v7, v0, 4, 2
  v_and_b32 v8, 15, v0
  v_lshlrev_b32 v11, 4, v8
  v_lshl_add_u32 v6, v7, 17, v11
  s_and_b32 s28, s3, 1
  s_lshl_b32 s28, s28, 3
  s_lshr_b32 s29, s3, 1
  s_lshl_b32 s29, s29, 2
  s_add_u32 s28, s28, s29
  s_lshl_b32 s33, s28, 13
  s_lshl_b32 s28, s4, 8
  s_add_u32 s33, s33, s28
  s_mul_i32 s42, s3, 4224
  s_add_u32 s35, s42, 65536
  s_mov_b32 s16, s70
  s_and_b32 s17, s71, 0xffff
  s_mov_b32 s18, 4194304
  s_mov_b32 s19, 0x20000
  s_mov_b32 s20, s72
  s_and_b32 s21, s73, 0xffff
  s_mov_b32 s22, 4194304
  s_mov_b32 s23, 0x20000
  s_add_u32 m0, s35, 0
  s_add_u32 s29, s33, 0
  buffer_load_dwordx4 v6, s[16:19], s29 offen lds
  s_add_u32 m0, s35, 1056
  s_add_u32 s29, s33, 8192
  buffer_load_dwordx4 v6, s[16:19], s29 offen lds
  s_add_u32 m0, s35, 2112
  s_add_u32 s29, s33, 16384
  buffer_load_dwordx4 v6, s[16:19], s29 offen lds
  s_add_u32 m0, s35, 3168
  s_add_u32 s29, s33, 24576
  buffer_load_dwordx4 v6, s[16:19], s29 offen lds
  s_add_u32 m0, s35, 16896
  s_add_u32 s29, s33, 0
  buffer_load_dwordx4 v6, s[20:23], s29 offen lds
  s_add_u32 m0, s35, 17952
  s_add_u32 s29, s33, 8192
  buffer_load_dwordx4 v6, s[20:23], s29 offen lds
  s_add_u32 m0, s35, 19008
  s_add_u32 s29, s33, 16384
  buffer_load_dwordx4 v6, s[20:23], s29 offen lds
  s_add_u32 m0, s35, 20064
  s_add_u32 s29, s33, 24576
  buffer_load_dwordx4 v6, s[20:23], s29 offen lds
  v_and_b32 v16, 63, v0
  s_lshl_b32 s94, s2, 2
  s_add_u32 s94, s94, s3
  s_lshl_b32 s28, s94, 11
  s_add_u32 s28, s28, 128
  v_lshlrev_b32 v17, 10, v16
  v_add_u32 v17, s28, v17
  v_mov_b32 v26, s66
  v_mov_b32 v27, s67
  v_mov_b32 v25, 0x80
  s_mul_i32 s28, s94, 512
  s_add_u32 s28, s28, 524032
  v_min_u32 v18, 21, v16
  v_lshlrev_b32 v18, 7, v18
  v_add_u32 v18, s28, v18
  v_cmp_le_u32 vcc, 2, v16
  v_mov_b32 v22, s70
  v_mov_b32 v23, s71
  v_mov_b32 v24, 524288
  v_cndmask_b32 v17, v17, v18, vcc
  v_cndmask_b32 v26, v26, v22, vcc
  v_cndmask_b32 v27, v27, v23, vcc
  v_cndmask_b32 v25, v25, v24, vcc
  s_mul_i32 s28, s94, 512
  s_add_u32 s28, s28, 523520
  v_min_u32 v18, 21, v16
  v_lshlrev_b32 v18, 7, v18
  v_add_u32 v18, s28, v18
  v_cmp_le_u32 vcc, 6, v16
  v_mov_b32 v22, s72
  v_mov_b32 v23, s73
  v_mov_b32 v24, 524288
  v_cndmask_b32 v17, v17, v18, vcc
  v_cndmask_b32 v26, v26, v22, vcc
  v_cndmask_b32 v27, v27, v23, vcc
  v_cndmask_b32 v25, v25, v24, vcc
  s_mul_i32 s28, s94, 1024
  s_add_u32 s28, s28, 4294966016
  v_min_u32 v18, 21, v16
  v_lshlrev_b32 v18, 7, v18
  v_add_u32 v18, s28, v18
  v_cmp_le_u32 vcc, 10, v16
  v_mov_b32 v22, s68
  v_mov_b32 v23, s69
  v_mov_b32 v24, 1048576
  v_cndmask_b32 v17, v17, v18, vcc
  v_cndmask_b32 v26, v26, v22, vcc
  v_cndmask_b32 v27, v27, v23, vcc
  v_cndmask_b32 v25, v25, v24, vcc
  s_mul_i32 s28, s94, 432
  s_and_b32 s28, s28, 0xffffff80
  s_min_u32 s28, s28, 441856
  s_add_u32 s28, s28, 4294964992
  v_min_u32 v18, 21, v16
  v_lshlrev_b32 v18, 7, v18
  v_add_u32 v18, s28, v18
  v_cmp_le_u32 vcc, 18, v16
  v_mov_b32 v22, s78
  v_mov_b32 v23, s79
  v_mov_b32 v24, 442368
  v_cndmask_b32 v17, v17, v18, vcc
  v_cndmask_b32 v26, v26, v22, vcc
  v_cndmask_b32 v27, v27, v23, vcc
  v_cndmask_b32 v25, v25, v24, vcc
  v_add_co_u32 v26, vcc, v26, v17
  s_nop 1
  v_addc_co_u32 v27, vcc, 0, v27, vcc
  s_mov_b64 exec, 0x3ff
  global_load_dword v10, v[26:27], off
  v_add_co_u32 v26, vcc, v26, v25
  s_nop 1
  v_addc_co_u32 v27, vcc, 0, v27, vcc
  global_load_dword v10, v[26:27], off
  v_add_co_u32 v26, vcc, v26, v25
  s_nop 1
  v_addc_co_u32 v27, vcc, 0, v27, vcc
  s_mov_b64 exec, -1
  v_and_b32 v1, 63, v0
  v_cmp_eq_u32 vcc, 0, v1
  v_mov_b32 v13, 2.0
  v_lshlrev_b32 v1, 4, v1
  v_cndmask_b32 v12, v13, 0, vcc
  v_mov_b32 v13, 1
  v_and_b32 v11, 6, v8
  v_xor_b32 v11, v11, v7
  v_lshlrev_b32 v11, 4, v11
  v_lshl_add_u32 v2, v8, 7, v11
  s_and_b32 s28, s3, 1
  s_lshl_b32 s28, s28, 14
  v_add_u32 v2, s28, v2
  v_xor_b32 v3, 64, v2
  v_bfe_u32 v8, v0, 2, 2
  v_and_b32 v11, 1, v7
  v_lshl_add_u32 v8, v11, 2, v8
  v_mul_u32_u24 v8, 0x420, v8
  v_lshrrev_b32 v11, 1, v7
  v_lshl_add_u32 v8, v11, 8, v8
  v_and_b32 v11, 3, v0
  v_lshl_add_u32 v8, v11, 3, v8
  s_lshr_b32 s28, s3, 1
  s_mul_i32 s28, s28, 16896
  s_add_u32 s31, s28, 65536
  v_add_u32 v4, s31, v8
  s_add_u32 s91, s31, 33792
  s_mov_b32 s40, s33
  s_mov_b32 s36, 4294933504
  s_mov_b32 s37, 33792
  s_cmp_eq_u32 s3, 0
  s_cselect_b32 s39, 1, -1
  s_mov_b32 s8, s86
  s_and_b32 s9, s87, 0xffff
  s_mov_b32 s10, 268435456
  s_mov_b32 s11, 0x20000
  s_add_u32 s60, s86, 65536
  s_addc_u32 s61, s87, 0
  s_and_b32 s61, s61, 0xffff
  s_mov_b32 s62, 2621440
  s_mov_b32 s63, 0x20000
  v_mov_b32 v7, v25
  v_mov_b32 v8, v26
  v_mov_b32 v9, v27
  s_mul_i32 s28, s3, 3
  s_min_u32 s28, s28, 7
  s_lshl_b32 s88, s28, 11
  s_lshl_b32 s28, s28, 10
  v_add_u32 v11, 133120, v1
  v_add_u32 v64, s28, v11
  s_waitcnt vmcnt(19)
  s_barrier
  ds_read_b128 v[16:19], v11 offset:0
  ds_read_b128 v[20:23], v11 offset:1024
  ds_read_b128 v[24:27], v11 offset:2048
  ds_read_b128 v[28:31], v11 offset:3072
  ds_read_b128 v[32:35], v11 offset:4096
  ds_read_b128 v[36:39], v11 offset:5120
  ds_read_b128 v[40:43], v11 offset:6144
  ds_read_b128 v[44:47], v11 offset:7168
  ds_read_b128 v[48:51], v11 offset:8192
  ds_read_b128 v[52:55], v11 offset:9216
  ds_read_b128 v[68:71], v64 offset:0
  ds_read_b128 v[72:75], v64 offset:1024
  ds_read_b128 v[76:79], v64 offset:2048
  s_mov_b32 s28, 0x3f803f80
  v_mov_b32 v60, 0
  v_mov_b32 v61, 0
  v_mov_b32 v62, 0
  v_mov_b32 v63, 0
  s_waitcnt lgkmcnt(12)
  v_dot2_f32_bf16 v60, v16, s28, v60
  v_dot2_f32_bf16 v62, v16, v16, v62
  v_dot2_f32_bf16 v61, v17, s28, v61
  v_dot2_f32_bf16 v63, v17, v17, v63
  v_dot2_f32_bf16 v60, v18, s28, v60
  v_dot2_f32_bf16 v62, v18, v18, v62
  v_dot2_f32_bf16 v61, v19, s28, v61
  v_dot2_f32_bf16 v63, v19, v19, v63
  s_waitcnt lgkmcnt(11)
  v_dot2_f32_bf16 v60, v20, s28, v60
  v_dot2_f32_bf16 v62, v20, v20, v62
  v_dot2_f32_bf16 v61, v21, s28, v61
  v_dot2_f32_bf16 v63, v21, v21, v63
  v_dot2_f32_bf16 v60, v22, s28, v60
  v_dot2_f32_bf16 v62, v22, v22, v62
  v_dot2_f32_bf16 v61, v23, s28, v61
  v_dot2_f32_bf16 v63, v23, v23, v63
  s_waitcnt lgkmcnt(10)
  v_dot2_f32_bf16 v60, v24, s28, v60
  v_dot2_f32_bf16 v62, v24, v24, v62
  v_dot2_f32_bf16 v61, v25, s28, v61
  v_dot2_f32_bf16 v63, v25, v25, v63
  v_dot2_f32_bf16 v60, v26, s28, v60
  v_dot2_f32_bf16 v62, v26, v26, v62
  v_dot2_f32_bf16 v61, v27, s28, v61
  v_dot2_f32_bf16 v63, v27, v27, v63
  s_waitcnt lgkmcnt(9)
  v_dot2_f32_bf16 v60, v28, s28, v60
  v_dot2_f32_bf16 v62, v28, v28, v62
  v_dot2_f32_bf16 v61, v29, s28, v61
  v_dot2_f32_bf16 v63, v29, v29, v63
  v_dot2_f32_bf16 v60, v30, s28, v60
  v_dot2_f32_bf16 v62, v30, v30, v62
  v_dot2_f32_bf16 v61, v31, s28, v61
  v_dot2_f32_bf16 v63, v31, v31, v63
  s_waitcnt lgkmcnt(8)
  v_dot2_f32_bf16 v60, v32, s28, v60
  v_dot2_f32_bf16 v62, v32, v32, v62
  v_dot2_f32_bf16 v61, v33, s28, v61
  v_dot2_f32_bf16 v63, v33, v33, v63
  v_dot2_f32_bf16 v60, v34, s28, v60
  v_dot2_f32_bf16 v62, v34, v34, v62
  v_dot2_f32_bf16 v61, v35, s28, v61
  v_dot2_f32_bf16 v63, v35, v35, v63
  s_waitcnt lgkmcnt(7)
  v_dot2_f32_bf16 v60, v36, s28, v60
  v_dot2_f32_bf16 v62, v36, v36, v62
  v_dot2_f32_bf16 v61, v37, s28, v61
  v_dot2_f32_bf16 v63, v37, v37, v63
  v_dot2_f32_bf16 v60, v38, s28, v60
  v_dot2_f32_bf16 v62, v38, v38, v62
  v_dot2_f32_bf16 v61, v39, s28, v61
  v_dot2_f32_bf16 v63, v39, v39, v63
  s_waitcnt lgkmcnt(6)
  v_dot2_f32_bf16 v60, v40, s28, v60
  v_dot2_f32_bf16 v62, v40, v40, v62
  v_dot2_f32_bf16 v61, v41, s28, v61
  v_dot2_f32_bf16 v63, v41, v41, v63
  v_dot2_f32_bf16 v60, v42, s28, v60
  v_dot2_f32_bf16 v62, v42, v42, v62
  v_dot2_f32_bf16 v61, v43, s28, v61
  v_dot2_f32_bf16 v63, v43, v43, v63
  s_waitcnt lgkmcnt(5)
  v_dot2_f32_bf16 v60, v44, s28, v60
  v_dot2_f32_bf16 v62, v44, v44, v62
  v_dot2_f32_bf16 v61, v45, s28, v61
  v_dot2_f32_bf16 v63, v45, v45, v63
  v_dot2_f32_bf16 v60, v46, s28, v60
  v_dot2_f32_bf16 v62, v46, v46, v62
  v_dot2_f32_bf16 v61, v47, s28, v61
  v_dot2_f32_bf16 v63, v47, v47, v63
  s_waitcnt lgkmcnt(4)
  v_dot2_f32_bf16 v60, v48, s28, v60
  v_dot2_f32_bf16 v62, v48, v48, v62
  v_dot2_f32_bf16 v61, v49, s28, v61
  v_dot2_f32_bf16 v63, v49, v49, v63
  v_dot2_f32_bf16 v60, v50, s28, v60
  v_dot2_f32_bf16 v62, v50, v50, v62
  v_dot2_f32_bf16 v61, v51, s28, v61
  v_dot2_f32_bf16 v63, v51, v51, v63
  s_waitcnt lgkmcnt(3)
  v_dot2_f32_bf16 v60, v52, s28, v60
  v_dot2_f32_bf16 v62, v52, v52, v62
  v_dot2_f32_bf16 v61, v53, s28, v61
  v_dot2_f32_bf16 v63, v53, v53, v63
  v_dot2_f32_bf16 v60, v54, s28, v60
  v_dot2_f32_bf16 v62, v54, v54, v62
  v_dot2_f32_bf16 v61, v55, s28, v61
  v_dot2_f32_bf16 v63, v55, v55, v63
  s_nop 1
  v_add_f32 v60, v60, v61
  v_add_f32 v62, v62, v63
  s_nop 0
  v_add_f32_dpp v60, v60, v60 row_ror:8 row_mask:0xf bank_mask:0xf
  v_add_f32_dpp v62, v62, v62 row_ror:8 row_mask:0xf bank_mask:0xf
  v_mov_b32 v61, v60
  v_mov_b32 v63, v62
  s_nop 0
  v_permlane16_swap_b32 v60, v61
  v_permlane16_swap_b32 v62, v63
  v_add_f32 v60, v60, v61
  v_add_f32 v62, v62, v63
  v_mov_b32 v61, v60
  v_mov_b32 v63, v62
  s_nop 0
  v_permlane32_swap_b32 v60, v61
  v_permlane32_swap_b32 v62, v63
  v_add_f32 v60, v60, v61
  v_add_f32 v62, v62, v63
  s_mov_b32 s28, 0x3acccccd
  v_mul_f32 v60, s28, v60
  v_mul_f32 v62, s28, v62
  v_fma_f32 v62, -v60, v60, v62
  v_max_f32 v62, 0, v62
  v_cvt_pk_bf16_f32 v61, v60, v62
  v_lshlrev_b32 v60, 16, v61
  v_and_b32 v62, 0xffff0000, v61
  v_add_f32 v62, 0x3727c5ac, v62
  v_cvt_pk_bf16_f32 v62, v62, v62
  v_and_b32 v62, 0xffff0000, v62
  v_sqrt_f32 v62, v62
  s_nop 0
  v_cvt_pk_bf16_f32 v62, v62, v62
  v_and_b32 v62, 0xffff0000, v62
  v_rcp_f32 v62, v62
  s_lshr_b32 s28, s2, 1
  s_mul_i32 s28, s28, 20480
  s_and_b32 s29, s2, 1
  s_lshl_b32 s29, s29, 7
  s_add_u32 s28, s28, s29
  s_add_u32 s88, s28, s88
  s_add_u32 m0, s34, 32768
  s_add_u32 s28, s32, 128
  buffer_load_dwordx4 v5, s[12:15], s28 offen lds
  s_add_u32 m0, s34, 33792
  s_add_u32 s28, s32, 8320
  buffer_load_dwordx4 v5, s[12:15], s28 offen lds
  s_add_u32 m0, s34, 34816
  s_add_u32 s28, s32, 16512
  buffer_load_dwordx4 v5, s[12:15], s28 offen lds
  s_add_u32 m0, s34, 35840
  s_add_u32 s28, s32, 24704
  buffer_load_dwordx4 v5, s[12:15], s28 offen lds
  s_add_u32 m0, s34, 36864
  s_add_u32 s28, s32, 32896
  buffer_load_dwordx4 v5, s[12:15], s28 offen lds
  s_add_u32 m0, s34, 37888
  s_add_u32 s28, s32, 41088
  buffer_load_dwordx4 v5, s[12:15], s28 offen lds
  s_add_u32 m0, s34, 38912
  s_add_u32 s28, s32, 49280
  buffer_load_dwordx4 v5, s[12:15], s28 offen lds
  s_add_u32 m0, s34, 39936
  s_add_u32 s28, s32, 57472
  buffer_load_dwordx4 v5, s[12:15], s28 offen lds
  s_waitcnt lgkmcnt(2)
  v_lshlrev_b32 v64, 16, v68
  v_and_b32 v65, 0xffff0000, v68
  v_sub_f32 v64, v64, v60
  v_sub_f32 v65, v65, v60
  v_cvt_pk_bf16_f32 v64, v64, v65
  v_and_b32 v65, 0xffff0000, v64
  v_lshlrev_b32 v64, 16, v64
  v_mul_f32 v64, v64, v62
  v_mul_f32 v65, v65, v62
  v_cvt_pk_bf16_f32 v64, v64, v65
  v_accvgpr_write_b32 a96, v64
  v_lshlrev_b32 v64, 16, v69
  v_and_b32 v65, 0xffff0000, v69
  v_sub_f32 v64, v64, v60
  v_sub_f32 v65, v65, v60
  v_cvt_pk_bf16_f32 v64, v64, v65
  v_and_b32 v65, 0xffff0000, v64
  v_lshlrev_b32 v64, 16, v64
  v_mul_f32 v64, v64, v62
  v_mul_f32 v65, v65, v62
  v_cvt_pk_bf16_f32 v64, v64, v65
  v_accvgpr_write_b32 a97, v64
  v_lshlrev_b32 v64, 16, v70
  v_and_b32 v65, 0xffff0000, v70
  v_sub_f32 v64, v64, v60
  v_sub_f32 v65, v65, v60
  v_cvt_pk_bf16_f32 v64, v64, v65
  v_and_b32 v65, 0xffff0000, v64
  v_lshlrev_b32 v64, 16, v64
  v_mul_f32 v64, v64, v62
  v_mul_f32 v65, v65, v62
  v_cvt_pk_bf16_f32 v64, v64, v65
  v_accvgpr_write_b32 a98, v64
  v_lshlrev_b32 v64, 16, v71
  v_and_b32 v65, 0xffff0000, v71
  v_sub_f32 v64, v64, v60
  v_sub_f32 v65, v65, v60
  v_cvt_pk_bf16_f32 v64, v64, v65
  v_and_b32 v65, 0xffff0000, v64
  v_lshlrev_b32 v64, 16, v64
  v_mul_f32 v64, v64, v62
  v_mul_f32 v65, v65, v62
  v_cvt_pk_bf16_f32 v64, v64, v65
  v_accvgpr_write_b32 a99, v64
  s_waitcnt lgkmcnt(1)
  v_lshlrev_b32 v64, 16, v72
  v_and_b32 v65, 0xffff0000, v72
  v_sub_f32 v64, v64, v60
  v_sub_f32 v65, v65, v60
  v_cvt_pk_bf16_f32 v64, v64, v65
  v_and_b32 v65, 0xffff0000, v64
  v_lshlrev_b32 v64, 16, v64
  v_mul_f32 v64, v64, v62
  v_mul_f32 v65, v65, v62
  v_cvt_pk_bf16_f32 v64, v64, v65
  v_accvgpr_write_b32 a100, v64
  v_lshlrev_b32 v64, 16, v73
  v_and_b32 v65, 0xffff0000, v73
  v_sub_f32 v64, v64, v60
  v_sub_f32 v65, v65, v60
  v_cvt_pk_bf16_f32 v64, v64, v65
  v_and_b32 v65, 0xffff0000, v64
  v_lshlrev_b32 v64, 16, v64
  v_mul_f32 v64, v64, v62
  v_mul_f32 v65, v65, v62
  v_cvt_pk_bf16_f32 v64, v64, v65
  v_accvgpr_write_b32 a101, v64
  v_lshlrev_b32 v64, 16, v74
  v_and_b32 v65, 0xffff0000, v74
  v_sub_f32 v64, v64, v60
  v_sub_f32 v65, v65, v60
  v_cvt_pk_bf16_f32 v64, v64, v65
  v_and_b32 v65, 0xffff0000, v64
  v_lshlrev_b32 v64, 16, v64
  v_mul_f32 v64, v64, v62
  v_mul_f32 v65, v65, v62
  v_cvt_pk_bf16_f32 v64, v64, v65
  v_accvgpr_write_b32 a102, v64
  v_lshlrev_b32 v64, 16, v75
  v_and_b32 v65, 0xffff0000, v75
  v_sub_f32 v64, v64, v60
  v_sub_f32 v65, v65, v60
  v_cvt_pk_bf16_f32 v64, v64, v65
  v_and_b32 v65, 0xffff0000, v64
  v_lshlrev_b32 v64, 16, v64
  v_mul_f32 v64, v64, v62
  v_mul_f32 v65, v65, v62
  v_cvt_pk_bf16_f32 v64, v64, v65
  v_accvgpr_write_b32 a103, v64
  s_waitcnt lgkmcnt(0)
  v_lshlrev_b32 v64, 16, v76
  v_and_b32 v65, 0xffff0000, v76
  v_sub_f32 v64, v64, v60
  v_sub_f32 v65, v65, v60
  v_cvt_pk_bf16_f32 v64, v64, v65
  v_and_b32 v65, 0xffff0000, v64
  v_lshlrev_b32 v64, 16, v64
  v_mul_f32 v64, v64, v62
  v_mul_f32 v65, v65, v62
  v_cvt_pk_bf16_f32 v64, v64, v65
  v_accvgpr_write_b32 a104, v64
  v_lshlrev_b32 v64, 16, v77
  v_and_b32 v65, 0xffff0000, v77
  v_sub_f32 v64, v64, v60
  v_sub_f32 v65, v65, v60
  v_cvt_pk_bf16_f32 v64, v64, v65
  v_and_b32 v65, 0xffff0000, v64
  v_lshlrev_b32 v64, 16, v64
  v_mul_f32 v64, v64, v62
  v_mul_f32 v65, v65, v62
  v_cvt_pk_bf16_f32 v64, v64, v65
  v_accvgpr_write_b32 a105, v64
  v_lshlrev_b32 v64, 16, v78
  v_and_b32 v65, 0xffff0000, v78
  v_sub_f32 v64, v64, v60
  v_sub_f32 v65, v65, v60
  v_cvt_pk_bf16_f32 v64, v64, v65
  v_and_b32 v65, 0xffff0000, v64
  v_lshlrev_b32 v64, 16, v64
  v_mul_f32 v64, v64, v62
  v_mul_f32 v65, v65, v62
  v_cvt_pk_bf16_f32 v64, v64, v65
  v_accvgpr_write_b32 a106, v64
  v_lshlrev_b32 v64, 16, v79
  v_and_b32 v65, 0xffff0000, v79
  v_sub_f32 v64, v64, v60
  v_sub_f32 v65, v65, v60
  v_cvt_pk_bf16_f32 v64, v64, v65
  v_and_b32 v65, 0xffff0000, v64
  v_lshlrev_b32 v64, 16, v64
  v_mul_f32 v64, v64, v62
  v_mul_f32 v65, v65, v62
  v_cvt_pk_bf16_f32 v64, v64, v65
  v_accvgpr_write_b32 a107, v64
  v_accvgpr_write_b32 a108, 0
  s_lshl_b32 s89, s2, 7
  s_cmp_eq_u32 s3, 0
  s_cselect_b32 s89, s89, 536870912
  v_lshrrev_b32 v11, 2, v1
  v_and_b32 v11, 0x7f, v11
  s_add_u32 s33, s33, 524288
  s_add_u32 s35, s35, 33792
  s_add_u32 s32, s32, 256
  s_and_b32 s95, s2, 63
  s_lshl_b32 s95, s95, 2
  s_mov_b32 s38, 1
  s_mov_b32 s24, s84
  s_and_b32 s25, s85, 0xffff
  s_mov_b32 s26, 256
  s_mov_b32 s27, 0x20000
  s_waitcnt vmcnt(10)
  s_barrier
  ds_read_b64_tr_b16 a[64:65], v4 offset:0
  ds_read_b64_tr_b16 a[66:67], v4 offset:8448
  ds_read_b64_tr_b16 a[68:69], v4 offset:512
  ds_read_b64_tr_b16 a[70:71], v4 offset:8960
  ds_read_b128 a[0:3], v2 offset:0
  ds_read_b128 a[4:7], v3 offset:0
  ds_read_b128 a[8:11], v2 offset:2048
  ds_read_b128 a[12:15], v3 offset:2048
  ds_read_b128 a[16:19], v2 offset:4096
  ds_read_b128 a[20:23], v3 offset:4096
  ds_read_b128 a[24:27], v2 offset:6144
  ds_read_b128 a[28:31], v3 offset:6144
  ds_read_b128 a[32:35], v2 offset:8192
  ds_read_b128 a[36:39], v3 offset:8192
  ds_read_b128 a[40:43], v2 offset:10240
  s_waitcnt lgkmcnt(14)
  ds_read_b128 a[44:47], v3 offset:10240
  s_cmp_ge_u32 s3, 2
  s_cbranch_scc1 L_p1_vw
  s_waitcnt lgkmcnt(11)
  v_mfma_f32_16x16x32_bf16 a[80:83], a[64:67], a[0:3], 0
  s_waitcnt lgkmcnt(10)
  ds_read_b128 a[48:51], v2 offset:12288
  ds_read_b128 a[52:55], v3 offset:12288
  v_mfma_f32_16x16x32_bf16 a[80:83], a[68:71], a[4:7], a[80:83]
  s_waitcnt lgkmcnt(10)
  ds_read_b128 a[56:59], v2 offset:14336
  ds_read_b128 a[60:63], v3 offset:14336
  v_mfma_f32_16x16x32_bf16 v[32:35], a[68:71], a[12:15], 0
  s_add_u32 m0, s35, 0
  v_mfma_f32_16x16x32_bf16 v[32:35], a[64:67], a[8:11], v[32:35]
  s_waitcnt lgkmcnt(11)
  s_add_u32 s28, s33, 0
  v_mfma_f32_16x16x32_bf16 v[64:67], a[64:67], a[16:19], 0
  s_waitcnt lgkmcnt(10)
  buffer_load_dwordx4 v6, s[16:19], s28 offen lds
  v_mfma_f32_16x16x32_bf16 v[64:67], a[68:71], a[20:23], v[64:67]
  s_waitcnt lgkmcnt(8)
  ds_read_b64_tr_b16 a[72:73], v4 offset:32
  ds_read_b64_tr_b16 a[74:75], v4 offset:8480
  v_mfma_f32_16x16x32_bf16 v[96:99], a[68:71], a[28:31], 0
  ds_read_b64_tr_b16 a[76:77], v4 offset:544
  ds_read_b64_tr_b16 a[78:79], v4 offset:8992
  v_mfma_f32_16x16x32_bf16 v[96:99], a[64:67], a[24:27], v[96:99]
  s_waitcnt lgkmcnt(11)
  s_add_u32 m0, s35, 1056
  v_mfma_f32_16x16x32_bf16 v[128:131], a[64:67], a[32:35], 0
  s_waitcnt lgkmcnt(10)
  s_add_u32 s28, s33, 8192
  v_mfma_f32_16x16x32_bf16 v[128:131], a[68:71], a[36:39], v[128:131]
  s_waitcnt lgkmcnt(8)
  buffer_load_dwordx4 v6, s[16:19], s28 offen lds
  v_mfma_f32_16x16x32_bf16 v[160:163], a[68:71], a[44:47], 0
  v_mfma_f32_16x16x32_bf16 v[160:163], a[64:67], a[40:43], v[160:163]
  s_waitcnt lgkmcnt(7)
  v_mfma_f32_16x16x32_bf16 v[192:195], a[64:67], a[48:51], 0
  s_waitcnt lgkmcnt(0)
  s_add_u32 m0, s35, 2112
  v_mfma_f32_16x16x32_bf16 v[192:195], a[68:71], a[52:55], v[192:195]
  s_barrier
  s_add_u32 s28, s33, 16384
  v_mfma_f32_16x16x32_bf16 v[224:227], a[68:71], a[60:63], 0
  buffer_load_dwordx4 v6, s[16:19], s28 offen lds
  v_mfma_f32_16x16x32_bf16 v[224:227], a[64:67], a[56:59], v[224:227]
  v_mfma_f32_16x16x32_bf16 a[84:87], a[72:75], a[0:3], 0
  v_mfma_f32_16x16x32_bf16 a[84:87], a[76:79], a[4:7], a[84:87]
  s_add_u32 m0, s35, 3168
  ds_read_b64_tr_b16 a[64:65], v4 offset:64
  ds_read_b64_tr_b16 a[66:67], v4 offset:8512
  v_mfma_f32_16x16x32_bf16 v[36:39], a[76:79], a[12:15], 0
  s_add_u32 s28, s33, 24576
  ds_read_b64_tr_b16 a[68:69], v4 offset:576
  ds_read_b64_tr_b16 a[70:71], v4 offset:9024
  v_mfma_f32_16x16x32_bf16 v[36:39], a[72:75], a[8:11], v[36:39]
  buffer_load_dwordx4 v6, s[16:19], s28 offen lds
  v_mfma_f32_16x16x32_bf16 v[68:71], a[72:75], a[16:19], 0
  v_xor_b32 v2, 0x8000, v2
  v_xor_b32 v3, 0x8000, v3
  v_mfma_f32_16x16x32_bf16 v[68:71], a[76:79], a[20:23], v[68:71]
  v_mfma_f32_16x16x32_bf16 v[100:103], a[76:79], a[28:31], 0
  s_add_u32 m0, s35, 16896
  v_mfma_f32_16x16x32_bf16 v[100:103], a[72:75], a[24:27], v[100:103]
  s_add_u32 s28, s33, 0
  v_mfma_f32_16x16x32_bf16 v[132:135], a[72:75], a[32:35], 0
  buffer_load_dwordx4 v6, s[20:23], s28 offen lds
  v_mfma_f32_16x16x32_bf16 v[132:135], a[76:79], a[36:39], v[132:135]
  v_mfma_f32_16x16x32_bf16 v[164:167], a[76:79], a[44:47], 0
  v_mfma_f32_16x16x32_bf16 v[164:167], a[72:75], a[40:43], v[164:167]
  s_add_u32 m0, s35, 17952
  v_mfma_f32_16x16x32_bf16 v[196:199], a[72:75], a[48:51], 0
  s_add_u32 s28, s33, 8192
  v_mfma_f32_16x16x32_bf16 v[196:199], a[76:79], a[52:55], v[196:199]
  buffer_load_dwordx4 v6, s[20:23], s28 offen lds
  v_mfma_f32_16x16x32_bf16 v[228:231], a[76:79], a[60:63], 0
  v_mfma_f32_16x16x32_bf16 v[228:231], a[72:75], a[56:59], v[228:231]
  s_waitcnt lgkmcnt(2)
  v_mfma_f32_16x16x32_bf16 a[88:91], a[64:67], a[0:3], 0
  s_waitcnt lgkmcnt(0)
  s_add_u32 m0, s35, 19008
  v_mfma_f32_16x16x32_bf16 a[88:91], a[68:71], a[4:7], a[88:91]
  s_add_u32 s28, s33, 16384
  ds_read_b64_tr_b16 a[72:73], v4 offset:96
  ds_read_b64_tr_b16 a[74:75], v4 offset:8544
  v_mfma_f32_16x16x32_bf16 v[40:43], a[68:71], a[12:15], 0
  buffer_load_dwordx4 v6, s[20:23], s28 offen lds
  v_mfma_f32_16x16x32_bf16 v[40:43], a[64:67], a[8:11], v[40:43]
  ds_read_b64_tr_b16 a[76:77], v4 offset:608
  ds_read_b64_tr_b16 a[78:79], v4 offset:9056
  v_mfma_f32_16x16x32_bf16 v[72:75], a[64:67], a[16:19], 0
  v_mfma_f32_16x16x32_bf16 v[72:75], a[68:71], a[20:23], v[72:75]
  s_add_u32 m0, s35, 20064
  v_mfma_f32_16x16x32_bf16 v[104:107], a[68:71], a[28:31], 0
  s_add_u32 s28, s33, 24576
  v_mfma_f32_16x16x32_bf16 v[104:107], a[64:67], a[24:27], v[104:107]
  buffer_load_dwordx4 v6, s[20:23], s28 offen lds
  v_mfma_f32_16x16x32_bf16 v[136:139], a[64:67], a[32:35], 0
  v_mfma_f32_16x16x32_bf16 v[136:139], a[68:71], a[36:39], v[136:139]
  v_mfma_f32_16x16x32_bf16 v[168:171], a[68:71], a[44:47], 0
  v_mfma_f32_16x16x32_bf16 v[168:171], a[64:67], a[40:43], v[168:171]
  s_add_u32 s33, s33, 524288
  s_add_u32 s35, s35, s36
  v_mfma_f32_16x16x32_bf16 v[200:203], a[64:67], a[48:51], 0
  s_sub_u32 s36, 0, s36
  buffer_store_dwordx4 a[96:99], v14, s[60:63], s88 offen offset:0 sc1
  v_mfma_f32_16x16x32_bf16 v[200:203], a[68:71], a[52:55], v[200:203]
  s_add_u32 m0, s34, 0
  global_load_dword v10, v[8:9], off
  v_mfma_f32_16x16x32_bf16 v[232:235], a[68:71], a[60:63], 0
  s_add_u32 s28, s32, 0
  v_mfma_f32_16x16x32_bf16 v[232:235], a[64:67], a[56:59], v[232:235]
  s_waitcnt lgkmcnt(2)
  buffer_load_dwordx4 v5, s[12:15], s28 offen lds
  v_mfma_f32_16x16x32_bf16 a[92:95], a[72:75], a[0:3], 0
  s_waitcnt lgkmcnt(0)
  buffer_store_dwordx4 a[100:103], v14, s[60:63], s88 offen offset:2048 sc1
  v_mfma_f32_16x16x32_bf16 a[92:95], a[76:79], a[4:7], a[92:95]
  s_add_u32 m0, s34, 1024
  ds_read_b64_tr_b16 a[64:65], v4 offset:128
  v_add_co_u32 v8, vcc, v8, v7
  v_mfma_f32_16x16x32_bf16 v[44:47], a[76:79], a[12:15], 0
  s_add_u32 s28, s32, 8192
  ds_read_b64_tr_b16 a[66:67], v4 offset:8576
  ds_read_b64_tr_b16 a[68:69], v4 offset:640
  v_mfma_f32_16x16x32_bf16 v[44:47], a[72:75], a[8:11], v[44:47]
  s_add_u32 s88, s88, 4096
  buffer_store_dwordx4 a[104:107], v14, s[60:63], s88 offen offset:0 sc1
  v_mfma_f32_16x16x32_bf16 v[76:79], a[72:75], a[16:19], 0
  buffer_load_dwordx4 v5, s[12:15], s28 offen lds
  v_mfma_f32_16x16x32_bf16 v[76:79], a[76:79], a[20:23], v[76:79]
  s_add_u32 m0, s34, 2048
  ds_read_b64_tr_b16 a[70:71], v4 offset:9088
  v_addc_co_u32 v9, vcc, 0, v9, vcc
  v_mfma_f32_16x16x32_bf16 v[108:111], a[76:79], a[28:31], 0
  s_add_u32 s28, s32, 16384
  buffer_store_dword a108, v11, s[8:11], s89 offen sc1
  v_mfma_f32_16x16x32_bf16 v[108:111], a[72:75], a[24:27], v[108:111]
  buffer_load_dwordx4 v5, s[12:15], s28 offen lds
  v_mfma_f32_16x16x32_bf16 v[140:143], a[72:75], a[32:35], 0
  v_mfma_f32_16x16x32_bf16 v[140:143], a[76:79], a[36:39], v[140:143]
  s_add_u32 m0, s34, 3072
  v_mfma_f32_16x16x32_bf16 v[172:175], a[76:79], a[44:47], 0
  s_add_u32 s28, s32, 24576
  v_mfma_f32_16x16x32_bf16 v[172:175], a[72:75], a[40:43], v[172:175]
  buffer_load_dwordx4 v5, s[12:15], s28 offen lds
  v_mfma_f32_16x16x32_bf16 v[204:207], a[72:75], a[48:51], 0
  v_mfma_f32_16x16x32_bf16 v[204:207], a[76:79], a[52:55], v[204:207]
  s_add_u32 m0, s34, 4096
  v_mfma_f32_16x16x32_bf16 v[236:239], a[76:79], a[60:63], 0
  s_add_u32 s28, s32, 32768
  v_mfma_f32_16x16x32_bf16 v[236:239], a[72:75], a[56:59], v[236:239]
  s_waitcnt lgkmcnt(2)
  buffer_load_dwordx4 v5, s[12:15], s28 offen lds
  v_mfma_f32_16x16x32_bf16 v[16:19], a[64:67], a[0:3], 0
  s_waitcnt lgkmcnt(0)
  v_mfma_f32_16x16x32_bf16 v[16:19], a[68:71], a[4:7], v[16:19]
  s_add_u32 m0, s34, 5120
  ds_read_b64_tr_b16 a[72:73], v4 offset:160
  ds_read_b64_tr_b16 a[74:75], v4 offset:8608
  v_mfma_f32_16x16x32_bf16 v[48:51], a[68:71], a[12:15], 0
  s_add_u32 s28, s32, 40960
  ds_read_b64_tr_b16 a[76:77], v4 offset:672
  ds_read_b64_tr_b16 a[78:79], v4 offset:9120
  v_mfma_f32_16x16x32_bf16 v[48:51], a[64:67], a[8:11], v[48:51]
  buffer_load_dwordx4 v5, s[12:15], s28 offen lds
  v_mfma_f32_16x16x32_bf16 v[80:83], a[64:67], a[16:19], 0
  v_mfma_f32_16x16x32_bf16 v[80:83], a[68:71], a[20:23], v[80:83]
  s_add_u32 m0, s34, 6144
  v_mfma_f32_16x16x32_bf16 v[112:115], a[68:71], a[28:31], 0
  s_add_u32 s28, s32, 49152
  v_mfma_f32_16x16x32_bf16 v[112:115], a[64:67], a[24:27], v[112:115]
  buffer_load_dwordx4 v5, s[12:15], s28 offen lds
  v_mfma_f32_16x16x32_bf16 v[144:147], a[64:67], a[32:35], 0
  v_mfma_f32_16x16x32_bf16 v[144:147], a[68:71], a[36:39], v[144:147]
  s_add_u32 m0, s34, 7168
  v_mfma_f32_16x16x32_bf16 v[176:179], a[68:71], a[44:47], 0
  s_add_u32 s28, s32, 57344
  v_mfma_f32_16x16x32_bf16 v[176:179], a[64:67], a[40:43], v[176:179]
  buffer_load_dwordx4 v5, s[12:15], s28 offen lds
  v_mfma_f32_16x16x32_bf16 v[208:211], a[64:67], a[48:51], 0
  v_mfma_f32_16x16x32_bf16 v[208:211], a[68:71], a[52:55], v[208:211]
  v_mfma_f32_16x16x32_bf16 v[240:243], a[68:71], a[60:63], 0
  s_add_u32 s32, s32, 128
  s_xor_b32 s34, s34, 0x8000
  v_mfma_f32_16x16x32_bf16 v[240:243], a[64:67], a[56:59], v[240:243]
  s_waitcnt lgkmcnt(2)
  v_mfma_f32_16x16x32_bf16 v[20:23], a[72:75], a[0:3], 0
  s_waitcnt lgkmcnt(0)
  v_mfma_f32_16x16x32_bf16 v[20:23], a[76:79], a[4:7], v[20:23]
  ds_read_b64_tr_b16 a[64:65], v4 offset:192
  ds_read_b64_tr_b16 a[66:67], v4 offset:8640
  v_mfma_f32_16x16x32_bf16 v[52:55], a[76:79], a[12:15], 0
  ds_read_b64_tr_b16 a[68:69], v4 offset:704
  ds_read_b64_tr_b16 a[70:71], v4 offset:9152
  v_mfma_f32_16x16x32_bf16 v[52:55], a[72:75], a[8:11], v[52:55]
  v_mfma_f32_16x16x32_bf16 v[84:87], a[72:75], a[16:19], 0
  v_mfma_f32_16x16x32_bf16 v[84:87], a[76:79], a[20:23], v[84:87]
  v_mfma_f32_16x16x32_bf16 v[116:119], a[76:79], a[28:31], 0
  v_mfma_f32_16x16x32_bf16 v[116:119], a[72:75], a[24:27], v[116:119]
  v_mfma_f32_16x16x32_bf16 v[148:151], a[72:75], a[32:35], 0
  v_mfma_f32_16x16x32_bf16 v[148:151], a[76:79], a[36:39], v[148:151]
  v_mfma_f32_16x16x32_bf16 v[180:183], a[76:79], a[44:47], 0
  v_mfma_f32_16x16x32_bf16 v[180:183], a[72:75], a[40:43], v[180:183]
  v_mfma_f32_16x16x32_bf16 v[212:215], a[72:75], a[48:51], 0
  v_mfma_f32_16x16x32_bf16 v[212:215], a[76:79], a[52:55], v[212:215]
  v_mfma_f32_16x16x32_bf16 v[244:247], a[76:79], a[60:63], 0
  v_mfma_f32_16x16x32_bf16 v[244:247], a[72:75], a[56:59], v[244:247]
  s_waitcnt lgkmcnt(2)
  v_mfma_f32_16x16x32_bf16 v[24:27], a[64:67], a[0:3], 0
  s_waitcnt lgkmcnt(0)
  v_mfma_f32_16x16x32_bf16 v[24:27], a[68:71], a[4:7], v[24:27]
  ds_read_b64_tr_b16 a[72:73], v4 offset:224
  ds_read_b64_tr_b16 a[74:75], v4 offset:8672
  v_mfma_f32_16x16x32_bf16 v[56:59], a[68:71], a[12:15], 0
  ds_read_b64_tr_b16 a[76:77], v4 offset:736
  ds_read_b64_tr_b16 a[78:79], v4 offset:9184
  v_mfma_f32_16x16x32_bf16 v[56:59], a[64:67], a[8:11], v[56:59]
  v_mfma_f32_16x16x32_bf16 v[88:91], a[64:67], a[16:19], 0
  v_mfma_f32_16x16x32_bf16 v[88:91], a[68:71], a[20:23], v[88:91]
  v_mfma_f32_16x16x32_bf16 v[120:123], a[68:71], a[28:31], 0
  v_mfma_f32_16x16x32_bf16 v[120:123], a[64:67], a[24:27], v[120:123]
  v_mfma_f32_16x16x32_bf16 v[152:155], a[64:67], a[32:35], 0
  v_mfma_f32_16x16x32_bf16 v[152:155], a[68:71], a[36:39], v[152:155]
  v_mfma_f32_16x16x32_bf16 v[184:187], a[68:71], a[44:47], 0
  v_add_u32 v4, s37, v4
  v_mfma_f32_16x16x32_bf16 v[184:187], a[64:67], a[40:43], v[184:187]
  v_mfma_f32_16x16x32_bf16 v[216:219], a[64:67], a[48:51], 0
  v_mfma_f32_16x16x32_bf16 v[216:219], a[68:71], a[52:55], v[216:219]
  v_mfma_f32_16x16x32_bf16 v[248:251], a[68:71], a[60:63], 0
  s_waitcnt vmcnt(13)
  s_waitcnt lgkmcnt(0)
  s_sub_u32 s37, 0, s37
  v_mfma_f32_16x16x32_bf16 v[248:251], a[64:67], a[56:59], v[248:251]
  s_barrier
  v_mfma_f32_16x16x32_bf16 v[28:31], a[72:75], a[0:3], 0
  v_mfma_f32_16x16x32_bf16 v[28:31], a[76:79], a[4:7], v[28:31]
  ds_read_b64_tr_b16 a[64:65], v4 offset:0
  ds_read_b64_tr_b16 a[66:67], v4 offset:8448
  v_mfma_f32_16x16x32_bf16 v[60:63], a[76:79], a[12:15], 0
  ds_read_b64_tr_b16 a[68:69], v4 offset:512
  ds_read_b64_tr_b16 a[70:71], v4 offset:8960
  v_mfma_f32_16x16x32_bf16 v[60:63], a[72:75], a[8:11], v[60:63]
  ds_read_b128 a[0:3], v2 offset:0
  ds_read_b128 a[4:7], v3 offset:0
  v_mfma_f32_16x16x32_bf16 v[92:95], a[72:75], a[16:19], 0
  ds_read_b128 a[8:11], v2 offset:2048
  ds_read_b128 a[12:15], v3 offset:2048
  v_mfma_f32_16x16x32_bf16 v[92:95], a[76:79], a[20:23], v[92:95]
  ds_read_b128 a[16:19], v2 offset:4096
  v_mfma_f32_16x16x32_bf16 v[124:127], a[76:79], a[28:31], 0
  ds_read_b128 a[20:23], v3 offset:4096
  v_mfma_f32_16x16x32_bf16 v[124:127], a[72:75], a[24:27], v[124:127]
  ds_read_b128 a[24:27], v2 offset:6144
  v_mfma_f32_16x16x32_bf16 v[156:159], a[72:75], a[32:35], 0
  ds_read_b128 a[28:31], v3 offset:6144
  v_mfma_f32_16x16x32_bf16 v[156:159], a[76:79], a[36:39], v[156:159]
  ds_read_b128 a[32:35], v2 offset:8192
  v_mfma_f32_16x16x32_bf16 v[188:191], a[76:79], a[44:47], 0
  ds_read_b128 a[36:39], v3 offset:8192
  v_mfma_f32_16x16x32_bf16 v[188:191], a[72:75], a[40:43], v[188:191]
  ds_read_b128 a[40:43], v2 offset:10240
  v_mfma_f32_16x16x32_bf16 v[220:223], a[72:75], a[48:51], 0
  s_waitcnt lgkmcnt(14)
  ds_read_b128 a[44:47], v3 offset:10240
  v_mfma_f32_16x16x32_bf16 v[220:223], a[76:79], a[52:55], v[220:223]
  v_mfma_f32_16x16x32_bf16 v[252:255], a[76:79], a[60:63], 0
  v_mfma_f32_16x16x32_bf16 v[252:255], a[72:75], a[56:59], v[252:255]
.p2align 3
L_p1_k:
  s_waitcnt lgkmcnt(11)
  v_mfma_f32_16x16x32_bf16 a[80:83], a[64:67], a[0:3], a[80:83]
  s_waitcnt lgkmcnt(10)
  ds_read_b128 a[48:51], v2 offset:12288
  ds_read_b128 a[52:55], v3 offset:12288
  v_mfma_f32_16x16x32_bf16 a[80:83], a[68:71], a[4:7], a[80:83]
  s_waitcnt lgkmcnt(10)
  ds_read_b128 a[56:59], v2 offset:14336
  ds_read_b128 a[60:63], v3 offset:14336
  v_mfma_f32_16x16x32_bf16 v[32:35], a[68:71], a[12:15], v[32:35]
  s_add_u32 m0, s35, 0
  v_mfma_f32_16x16x32_bf16 v[32:35], a[64:67], a[8:11], v[32:35]
  s_waitcnt lgkmcnt(11)
  s_add_u32 s28, s33, 0
  v_mfma_f32_16x16x32_bf16 v[64:67], a[64:67], a[16:19], v[64:67]
  s_waitcnt lgkmcnt(10)
  buffer_load_dwordx4 v6, s[16:19], s28 offen lds
  v_mfma_f32_16x16x32_bf16 v[64:67], a[68:71], a[20:23], v[64:67]
  s_waitcnt lgkmcnt(8)
  ds_read_b64_tr_b16 a[72:73], v4 offset:32
  ds_read_b64_tr_b16 a[74:75], v4 offset:8480
  v_mfma_f32_16x16x32_bf16 v[96:99], a[68:71], a[28:31], v[96:99]
  ds_read_b64_tr_b16 a[76:77], v4 offset:544
  ds_read_b64_tr_b16 a[78:79], v4 offset:8992
  v_mfma_f32_16x16x32_bf16 v[96:99], a[64:67], a[24:27], v[96:99]
  s_waitcnt lgkmcnt(11)
  s_add_u32 m0, s35, 1056
  v_mfma_f32_16x16x32_bf16 v[128:131], a[64:67], a[32:35], v[128:131]
  s_waitcnt lgkmcnt(10)
  s_add_u32 s28, s33, 8192
  v_mfma_f32_16x16x32_bf16 v[128:131], a[68:71], a[36:39], v[128:131]
  s_waitcnt lgkmcnt(8)
  buffer_load_dwordx4 v6, s[16:19], s28 offen lds
  v_mfma_f32_16x16x32_bf16 v[160:163], a[68:71], a[44:47], v[160:163]
  v_mfma_f32_16x16x32_bf16 v[160:163], a[64:67], a[40:43], v[160:163]
  s_waitcnt lgkmcnt(7)
  v_mfma_f32_16x16x32_bf16 v[192:195], a[64:67], a[48:51], v[192:195]
  s_waitcnt lgkmcnt(0)
  s_add_u32 m0, s35, 2112
  v_mfma_f32_16x16x32_bf16 v[192:195], a[68:71], a[52:55], v[192:195]
  s_barrier
  s_add_u32 s28, s33, 16384
  v_mfma_f32_16x16x32_bf16 v[224:227], a[68:71], a[60:63], v[224:227]
  buffer_load_dwordx4 v6, s[16:19], s28 offen lds
  v_mfma_f32_16x16x32_bf16 v[224:227], a[64:67], a[56:59], v[224:227]
  v_mfma_f32_16x16x32_bf16 a[84:87], a[72:75], a[0:3], a[84:87]
  v_mfma_f32_16x16x32_bf16 a[84:87], a[76:79], a[4:7], a[84:87]
  s_add_u32 m0, s35, 3168
  ds_read_b64_tr_b16 a[64:65], v4 offset:64
  ds_read_b64_tr_b16 a[66:67], v4 offset:8512
  v_mfma_f32_16x16x32_bf16 v[36:39], a[76:79], a[12:15], v[36:39]
  s_add_u32 s28, s33, 24576
  ds_read_b64_tr_b16 a[68:69], v4 offset:576
  ds_read_b64_tr_b16 a[70:71], v4 offset:9024
  v_mfma_f32_16x16x32_bf16 v[36:39], a[72:75], a[8:11], v[36:39]
  buffer_load_dwordx4 v6, s[16:19], s28 offen lds
  v_mfma_f32_16x16x32_bf16 v[68:71], a[72:75], a[16:19], v[68:71]
  v_xor_b32 v2, 0x8000, v2
  v_xor_b32 v3, 0x8000, v3
  v_mfma_f32_16x16x32_bf16 v[68:71], a[76:79], a[20:23], v[68:71]
  v_mfma_f32_16x16x32_bf16 v[100:103], a[76:79], a[28:31], v[100:103]
  s_add_u32 m0, s35, 16896
  v_mfma_f32_16x16x32_bf16 v[100:103], a[72:75], a[24:27], v[100:103]
  s_add_u32 s28, s33, 0
  v_mfma_f32_16x16x32_bf16 v[132:135], a[72:75], a[32:35], v[132:135]
  buffer_load_dwordx4 v6, s[20:23], s28 offen lds
  v_mfma_f32_16x16x32_bf16 v[132:135], a[76:79], a[36:39], v[132:135]
  v_mfma_f32_16x16x32_bf16 v[164:167], a[76:79], a[44:47], v[164:167]
  v_mfma_f32_16x16x32_bf16 v[164:167], a[72:75], a[40:43], v[164:167]
  s_add_u32 m0, s35, 17952
  v_mfma_f32_16x16x32_bf16 v[196:199], a[72:75], a[48:51], v[196:199]
  s_add_u32 s28, s33, 8192
  v_mfma_f32_16x16x32_bf16 v[196:199], a[76:79], a[52:55], v[196:199]
  buffer_load_dwordx4 v6, s[20:23], s28 offen lds
  v_mfma_f32_16x16x32_bf16 v[228:231], a[76:79], a[60:63], v[228:231]
  v_mfma_f32_16x16x32_bf16 v[228:231], a[72:75], a[56:59], v[228:231]
  s_waitcnt lgkmcnt(2)
  v_mfma_f32_16x16x32_bf16 a[88:91], a[64:67], a[0:3], a[88:91]
  s_waitcnt lgkmcnt(0)
  s_add_u32 m0, s35, 19008
  v_mfma_f32_16x16x32_bf16 a[88:91], a[68:71], a[4:7], a[88:91]
  s_add_u32 s28, s33, 16384
  ds_read_b64_tr_b16 a[72:73], v4 offset:96
  ds_read_b64_tr_b16 a[74:75], v4 offset:8544
  v_mfma_f32_16x16x32_bf16 v[40:43], a[68:71], a[12:15], v[40:43]
  buffer_load_dwordx4 v6, s[20:23], s28 offen lds
  v_mfma_f32_16x16x32_bf16 v[40:43], a[64:67], a[8:11], v[40:43]
  ds_read_b64_tr_b16 a[76:77], v4 offset:608
  ds_read_b64_tr_b16 a[78:79], v4 offset:9056
  v_mfma_f32_16x16x32_bf16 v[72:75], a[64:67], a[16:19], v[72:75]
  v_mfma_f32_16x16x32_bf16 v[72:75], a[68:71], a[20:23], v[72:75]
  s_add_u32 m0, s35, 20064
  v_mfma_f32_16x16x32_bf16 v[104:107], a[68:71], a[28:31], v[104:107]
  s_add_u32 s28, s33, 24576
  v_mfma_f32_16x16x32_bf16 v[104:107], a[64:67], a[24:27], v[104:107]
  buffer_load_dwordx4 v6, s[20:23], s28 offen lds
  v_mfma_f32_16x16x32_bf16 v[136:139], a[64:67], a[32:35], v[136:139]
  v_mfma_f32_16x16x32_bf16 v[136:139], a[68:71], a[36:39], v[136:139]
  v_mfma_f32_16x16x32_bf16 v[168:171], a[68:71], a[44:47], v[168:171]
  v_mfma_f32_16x16x32_bf16 v[168:171], a[64:67], a[40:43], v[168:171]
  s_add_u32 s33, s33, 524288
  s_add_u32 s35, s35, s36
  v_mfma_f32_16x16x32_bf16 v[200:203], a[64:67], a[48:51], v[200:203]
  s_sub_u32 s36, 0, s36
  v_mfma_f32_16x16x32_bf16 v[200:203], a[68:71], a[52:55], v[200:203]
  global_load_dword v10, v[8:9], off
  v_mfma_f32_16x16x32_bf16 v[232:235], a[68:71], a[60:63], v[232:235]
  v_mfma_f32_16x16x32_bf16 v[232:235], a[64:67], a[56:59], v[232:235]
  s_waitcnt lgkmcnt(2)
  v_add_co_u32 v8, vcc, v8, v7
  v_mfma_f32_16x16x32_bf16 a[92:95], a[72:75], a[0:3], a[92:95]
  s_waitcnt lgkmcnt(0)
  v_mfma_f32_16x16x32_bf16 a[92:95], a[76:79], a[4:7], a[92:95]
  ds_read_b64_tr_b16 a[64:65], v4 offset:128
  v_addc_co_u32 v9, vcc, 0, v9, vcc
  v_mfma_f32_16x16x32_bf16 v[44:47], a[76:79], a[12:15], v[44:47]
  ds_read_b64_tr_b16 a[66:67], v4 offset:8576
  ds_read_b64_tr_b16 a[68:69], v4 offset:640
  v_mfma_f32_16x16x32_bf16 v[44:47], a[72:75], a[8:11], v[44:47]
  s_add_u32 m0, s34, 0
  ds_read_b64_tr_b16 a[70:71], v4 offset:9088
  v_mfma_f32_16x16x32_bf16 v[76:79], a[72:75], a[16:19], v[76:79]
  s_add_u32 s28, s32, 0
  v_mfma_f32_16x16x32_bf16 v[76:79], a[76:79], a[20:23], v[76:79]
  buffer_load_dwordx4 v5, s[12:15], s28 offen lds
  v_mfma_f32_16x16x32_bf16 v[108:111], a[76:79], a[28:31], v[108:111]
  v_mfma_f32_16x16x32_bf16 v[108:111], a[72:75], a[24:27], v[108:111]
  v_mfma_f32_16x16x32_bf16 v[140:143], a[72:75], a[32:35], v[140:143]
  v_mfma_f32_16x16x32_bf16 v[140:143], a[76:79], a[36:39], v[140:143]
  v_mfma_f32_16x16x32_bf16 v[172:175], a[76:79], a[44:47], v[172:175]
  s_add_u32 m0, s34, 1024
  v_mfma_f32_16x16x32_bf16 v[172:175], a[72:75], a[40:43], v[172:175]
  s_add_u32 s28, s32, 8192
  v_mfma_f32_16x16x32_bf16 v[204:207], a[72:75], a[48:51], v[204:207]
  buffer_load_dwordx4 v5, s[12:15], s28 offen lds
  v_mfma_f32_16x16x32_bf16 v[204:207], a[76:79], a[52:55], v[204:207]
  v_mfma_f32_16x16x32_bf16 v[236:239], a[76:79], a[60:63], v[236:239]
  v_mfma_f32_16x16x32_bf16 v[236:239], a[72:75], a[56:59], v[236:239]
  s_waitcnt lgkmcnt(2)
  v_mfma_f32_16x16x32_bf16 v[16:19], a[64:67], a[0:3], v[16:19]
  s_waitcnt lgkmcnt(0)
  v_mfma_f32_16x16x32_bf16 v[16:19], a[68:71], a[4:7], v[16:19]
  s_add_u32 m0, s34, 2048
  ds_read_b64_tr_b16 a[72:73], v4 offset:160
  ds_read_b64_tr_b16 a[74:75], v4 offset:8608
  v_mfma_f32_16x16x32_bf16 v[48:51], a[68:71], a[12:15], v[48:51]
  s_add_u32 s28, s32, 16384
  ds_read_b64_tr_b16 a[76:77], v4 offset:672
  ds_read_b64_tr_b16 a[78:79], v4 offset:9120
  v_mfma_f32_16x16x32_bf16 v[48:51], a[64:67], a[8:11], v[48:51]
  buffer_load_dwordx4 v5, s[12:15], s28 offen lds
  v_mfma_f32_16x16x32_bf16 v[80:83], a[64:67], a[16:19], v[80:83]
  v_mfma_f32_16x16x32_bf16 v[80:83], a[68:71], a[20:23], v[80:83]
  v_mfma_f32_16x16x32_bf16 v[112:115], a[68:71], a[28:31], v[112:115]
  v_mfma_f32_16x16x32_bf16 v[112:115], a[64:67], a[24:27], v[112:115]
  v_mfma_f32_16x16x32_bf16 v[144:147], a[64:67], a[32:35], v[144:147]
  s_add_u32 m0, s34, 3072
  v_mfma_f32_16x16x32_bf16 v[144:147], a[68:71], a[36:39], v[144:147]
  s_add_u32 s28, s32, 24576
  v_mfma_f32_16x16x32_bf16 v[176:179], a[68:71], a[44:47], v[176:179]
  buffer_load_dwordx4 v5, s[12:15], s28 offen lds
  v_mfma_f32_16x16x32_bf16 v[176:179], a[64:67], a[40:43], v[176:179]
  v_mfma_f32_16x16x32_bf16 v[208:211], a[64:67], a[48:51], v[208:211]
  v_mfma_f32_16x16x32_bf16 v[208:211], a[68:71], a[52:55], v[208:211]
  v_mfma_f32_16x16x32_bf16 v[240:243], a[68:71], a[60:63], v[240:243]
  v_mfma_f32_16x16x32_bf16 v[240:243], a[64:67], a[56:59], v[240:243]
  s_waitcnt lgkmcnt(2)
  s_add_u32 m0, s34, 4096
  v_mfma_f32_16x16x32_bf16 v[20:23], a[72:75], a[0:3], v[20:23]
  s_waitcnt lgkmcnt(0)
  s_add_u32 s28, s32, 32768
  v_mfma_f32_16x16x32_bf16 v[20:23], a[76:79], a[4:7], v[20:23]
  buffer_load_dwordx4 v5, s[12:15], s28 offen lds
  v_mfma_f32_16x16x32_bf16 v[52:55], a[76:79], a[12:15], v[52:55]
  ds_read_b64_tr_b16 a[64:65], v4 offset:192
  ds_read_b64_tr_b16 a[66:67], v4 offset:8640
  v_mfma_f32_16x16x32_bf16 v[52:55], a[72:75], a[8:11], v[52:55]
  ds_read_b64_tr_b16 a[68:69], v4 offset:704
  ds_read_b64_tr_b16 a[70:71], v4 offset:9152
  v_mfma_f32_16x16x32_bf16 v[84:87], a[72:75], a[16:19], v[84:87]
  v_mfma_f32_16x16x32_bf16 v[84:87], a[76:79], a[20:23], v[84:87]
  v_mfma_f32_16x16x32_bf16 v[116:119], a[76:79], a[28:31], v[116:119]
  s_add_u32 m0, s34, 5120
  v_mfma_f32_16x16x32_bf16 v[116:119], a[72:75], a[24:27], v[116:119]
  s_add_u32 s28, s32, 40960
  v_mfma_f32_16x16x32_bf16 v[148:151], a[72:75], a[32:35], v[148:151]
  buffer_load_dwordx4 v5, s[12:15], s28 offen lds
  v_mfma_f32_16x16x32_bf16 v[148:151], a[76:79], a[36:39], v[148:151]
  v_mfma_f32_16x16x32_bf16 v[180:183], a[76:79], a[44:47], v[180:183]
  v_mfma_f32_16x16x32_bf16 v[180:183], a[72:75], a[40:43], v[180:183]
  v_mfma_f32_16x16x32_bf16 v[212:215], a[72:75], a[48:51], v[212:215]
  v_mfma_f32_16x16x32_bf16 v[212:215], a[76:79], a[52:55], v[212:215]
  s_add_u32 m0, s34, 6144
  v_mfma_f32_16x16x32_bf16 v[244:247], a[76:79], a[60:63], v[244:247]
  s_add_u32 s28, s32, 49152
  v_mfma_f32_16x16x32_bf16 v[244:247], a[72:75], a[56:59], v[244:247]
  s_waitcnt lgkmcnt(2)
  buffer_load_dwordx4 v5, s[12:15], s28 offen lds
  v_mfma_f32_16x16x32_bf16 v[24:27], a[64:67], a[0:3], v[24:27]
  s_waitcnt lgkmcnt(0)
  v_mfma_f32_16x16x32_bf16 v[24:27], a[68:71], a[4:7], v[24:27]
  ds_read_b64_tr_b16 a[72:73], v4 offset:224
  ds_read_b64_tr_b16 a[74:75], v4 offset:8672
  v_mfma_f32_16x16x32_bf16 v[56:59], a[68:71], a[12:15], v[56:59]
  ds_read_b64_tr_b16 a[76:77], v4 offset:736
  ds_read_b64_tr_b16 a[78:79], v4 offset:9184
  v_mfma_f32_16x16x32_bf16 v[56:59], a[64:67], a[8:11], v[56:59]
  v_mfma_f32_16x16x32_bf16 v[88:91], a[64:67], a[16:19], v[88:91]
  s_add_u32 m0, s34, 7168
  v_mfma_f32_16x16x32_bf16 v[88:91], a[68:71], a[20:23], v[88:91]
  s_add_u32 s28, s32, 57344
  v_mfma_f32_16x16x32_bf16 v[120:123], a[68:71], a[28:31], v[120:123]
  buffer_load_dwordx4 v5, s[12:15], s28 offen lds
  v_mfma_f32_16x16x32_bf16 v[120:123], a[64:67], a[24:27], v[120:123]
  v_mfma_f32_16x16x32_bf16 v[152:155], a[64:67], a[32:35], v[152:155]
  v_mfma_f32_16x16x32_bf16 v[152:155], a[68:71], a[36:39], v[152:155]
  v_mfma_f32_16x16x32_bf16 v[184:187], a[68:71], a[44:47], v[184:187]
  v_add_u32 v4, s37, v4
  v_mfma_f32_16x16x32_bf16 v[184:187], a[64:67], a[40:43], v[184:187]
  v_mfma_f32_16x16x32_bf16 v[216:219], a[64:67], a[48:51], v[216:219]
  s_add_u32 s32, s32, 128
  s_xor_b32 s34, s34, 0x8000
  v_mfma_f32_16x16x32_bf16 v[216:219], a[68:71], a[52:55], v[216:219]
  v_mfma_f32_16x16x32_bf16 v[248:251], a[68:71], a[60:63], v[248:251]
  s_waitcnt vmcnt(9)
  s_waitcnt lgkmcnt(0)
  s_sub_u32 s37, 0, s37
  v_mfma_f32_16x16x32_bf16 v[248:251], a[64:67], a[56:59], v[248:251]
  s_barrier
  v_mfma_f32_16x16x32_bf16 v[28:31], a[72:75], a[0:3], v[28:31]
  s_cmp_eq_u32 s38, s39
  s_cbranch_scc1 L_s1_k
L_s1b_k:
  v_mfma_f32_16x16x32_bf16 v[28:31], a[76:79], a[4:7], v[28:31]
  ds_read_b64_tr_b16 a[64:65], v4 offset:0
  ds_read_b64_tr_b16 a[66:67], v4 offset:8448
  v_mfma_f32_16x16x32_bf16 v[60:63], a[76:79], a[12:15], v[60:63]
  ds_read_b64_tr_b16 a[68:69], v4 offset:512
  ds_read_b64_tr_b16 a[70:71], v4 offset:8960
  v_mfma_f32_16x16x32_bf16 v[60:63], a[72:75], a[8:11], v[60:63]
  ds_read_b128 a[0:3], v2 offset:0
  ds_read_b128 a[4:7], v3 offset:0
  v_mfma_f32_16x16x32_bf16 v[92:95], a[72:75], a[16:19], v[92:95]
  ds_read_b128 a[8:11], v2 offset:2048
  ds_read_b128 a[12:15], v3 offset:2048
  v_mfma_f32_16x16x32_bf16 v[92:95], a[76:79], a[20:23], v[92:95]
  ds_read_b128 a[16:19], v2 offset:4096
  v_mfma_f32_16x16x32_bf16 v[124:127], a[76:79], a[28:31], v[124:127]
  ds_read_b128 a[20:23], v3 offset:4096
  v_mfma_f32_16x16x32_bf16 v[124:127], a[72:75], a[24:27], v[124:127]
  ds_read_b128 a[24:27], v2 offset:6144
  v_mfma_f32_16x16x32_bf16 v[156:159], a[72:75], a[32:35], v[156:159]
  ds_read_b128 a[28:31], v3 offset:6144
  v_mfma_f32_16x16x32_bf16 v[156:159], a[76:79], a[36:39], v[156:159]
  ds_read_b128 a[32:35], v2 offset:8192
  v_mfma_f32_16x16x32_bf16 v[188:191], a[76:79], a[44:47], v[188:191]
  s_add_u32 s38, s38, 1
  ds_read_b128 a[36:39], v3 offset:8192
  v_mfma_f32_16x16x32_bf16 v[188:191], a[72:75], a[40:43], v[188:191]
  ds_read_b128 a[40:43], v2 offset:10240
  v_mfma_f32_16x16x32_bf16 v[220:223], a[72:75], a[48:51], v[220:223]
  s_waitcnt lgkmcnt(14)
  ds_read_b128 a[44:47], v3 offset:10240
  v_mfma_f32_16x16x32_bf16 v[220:223], a[76:79], a[52:55], v[220:223]
  v_mfma_f32_16x16x32_bf16 v[252:255], a[76:79], a[60:63], v[252:255]
  s_cmp_lt_u32 s38, 5
  v_mfma_f32_16x16x32_bf16 v[252:255], a[72:75], a[56:59], v[252:255]
  s_cbranch_scc1 L_p1_k
  v_lshrrev_b32 v14, 2, v1
  s_waitcnt lgkmcnt(11)
  v_mfma_f32_16x16x32_bf16 a[80:83], a[64:67], a[0:3], a[80:83]
  s_waitcnt lgkmcnt(10)
  s_mov_b32 s52, s68
  buffer_load_dword v11, v14, s[24:27], 0 offen sc1
  v_mfma_f32_16x16x32_bf16 a[80:83], a[68:71], a[4:7], a[80:83]
  s_waitcnt lgkmcnt(8)
  s_and_b32 s53, s69, 0xffff
  ds_read_b128 a[48:51], v2 offset:12288
  ds_read_b128 a[52:55], v3 offset:12288
  v_mfma_f32_16x16x32_bf16 v[32:35], a[68:71], a[12:15], v[32:35]
  s_add_u32 m0, s35, 0
  ds_read_b128 a[56:59], v2 offset:14336
  ds_read_b128 a[60:63], v3 offset:14336
  v_mfma_f32_16x16x32_bf16 v[32:35], a[64:67], a[8:11], v[32:35]
  s_waitcnt lgkmcnt(11)
  s_add_u32 s28, s33, 0
  s_mov_b32 s54, 5242880
  s_mov_b32 s55, 0x20000
  v_mfma_f32_16x16x32_bf16 v[64:67], a[64:67], a[16:19], v[64:67]
  s_waitcnt lgkmcnt(10)
  s_mov_b32 s56, s78
  buffer_load_dwordx4 v6, s[16:19], s28 offen lds
  v_mfma_f32_16x16x32_bf16 v[64:67], a[68:71], a[20:23], v[64:67]
  s_waitcnt lgkmcnt(8)
  s_and_b32 s57, s79, 0xffff
  s_mov_b32 s58, 2211840
  ds_read_b64_tr_b16 a[72:73], v4 offset:32
  v_mfma_f32_16x16x32_bf16 v[96:99], a[68:71], a[28:31], v[96:99]
  s_mov_b32 s59, 0x20000
  ds_read_b64_tr_b16 a[74:75], v4 offset:8480
  ds_read_b64_tr_b16 a[76:77], v4 offset:544
  v_mfma_f32_16x16x32_bf16 v[96:99], a[64:67], a[24:27], v[96:99]
  s_waitcnt lgkmcnt(10)
  s_add_u32 m0, s35, 1056
  s_and_b32 s0, s3, 1
  ds_read_b64_tr_b16 a[78:79], v4 offset:8992
  v_mfma_f32_16x16x32_bf16 v[128:131], a[64:67], a[32:35], v[128:131]
  s_waitcnt lgkmcnt(10)
  s_add_u32 s28, s33, 8192
  s_lshl_b32 s0, s0, 1
  s_lshr_b32 s1, s3, 1
  v_mfma_f32_16x16x32_bf16 v[128:131], a[68:71], a[36:39], v[128:131]
  s_waitcnt lgkmcnt(8)
  s_lshl_b32 s1, s1, 3
  buffer_load_dwordx4 v6, s[16:19], s28 offen lds
  v_mfma_f32_16x16x32_bf16 v[160:163], a[68:71], a[44:47], v[160:163]
  s_add_u32 s0, s0, s1
  s_mul_i32 s41, s0, 3456
  s_mul_i32 s0, s6, 7
  v_mfma_f32_16x16x32_bf16 v[160:163], a[64:67], a[40:43], v[160:163]
  s_waitcnt lgkmcnt(7)
  s_add_u32 s0, s0, s7
  s_min_u32 s92, s0, 26
  s_lshl_b32 s0, s92, 7
  v_mfma_f32_16x16x32_bf16 v[192:195], a[64:67], a[48:51], v[192:195]
  s_waitcnt lgkmcnt(0)
  s_add_u32 m0, s35, 2112
  s_add_u32 s41, s41, s0
  v_mfma_f32_16x16x32_bf16 v[192:195], a[68:71], a[52:55], v[192:195]
  s_barrier
  s_add_u32 s28, s33, 16384
  s_mul_i32 s43, s3, 2112
  v_mfma_f32_16x16x32_bf16 v[224:227], a[68:71], a[60:63], v[224:227]
  s_add_u32 s43, s43, 16896
  buffer_load_dwordx4 v6, s[16:19], s28 offen lds
  v_mfma_f32_16x16x32_bf16 v[224:227], a[64:67], a[56:59], v[224:227]
  s_sub_u32 s0, 15, s5
  s_lshl_b32 s0, s0, 3
  s_add_u32 s0, s0, s3
  v_mfma_f32_16x16x32_bf16 a[84:87], a[72:75], a[0:3], a[84:87]
  s_mul_i32 s0, s0, 20480
  s_add_u32 s44, s0, 0
  s_sub_u32 s0, 15, s5
  v_mfma_f32_16x16x32_bf16 a[84:87], a[76:79], a[4:7], a[84:87]
  s_add_u32 m0, s35, 3168
  s_lshl_b32 s0, s0, 3
  s_add_u32 s0, s0, 7
  v_mfma_f32_16x16x32_bf16 v[36:39], a[76:79], a[12:15], v[36:39]
  s_add_u32 s28, s33, 24576
  s_sub_u32 s0, s0, s3
  s_mul_i32 s0, s0, 20480
  v_mfma_f32_16x16x32_bf16 v[36:39], a[72:75], a[8:11], v[36:39]
  s_add_u32 s45, s0, 0
  buffer_load_dwordx4 v6, s[16:19], s28 offen lds
  v_mfma_f32_16x16x32_bf16 v[68:71], a[72:75], a[16:19], v[68:71]
  s_mov_b32 s0, s5
  s_lshl_b32 s0, s0, 3
  ds_read_b64_tr_b16 a[64:65], v4 offset:64
  v_mfma_f32_16x16x32_bf16 v[68:71], a[76:79], a[20:23], v[68:71]
  s_add_u32 s0, s0, s3
  ds_read_b64_tr_b16 a[66:67], v4 offset:8512
  ds_read_b64_tr_b16 a[68:69], v4 offset:576
  v_mfma_f32_16x16x32_bf16 v[100:103], a[76:79], a[28:31], v[100:103]
  s_add_u32 m0, s35, 16896
  s_mul_i32 s0, s0, 20480
  ds_read_b64_tr_b16 a[70:71], v4 offset:9024
  v_mfma_f32_16x16x32_bf16 v[100:103], a[72:75], a[24:27], v[100:103]
  s_add_u32 s28, s33, 0
  s_add_u32 s46, s0, 0
  s_mov_b32 s0, s5
  v_mfma_f32_16x16x32_bf16 v[132:135], a[72:75], a[32:35], v[132:135]
  s_lshl_b32 s0, s0, 3
  buffer_load_dwordx4 v6, s[20:23], s28 offen lds
  v_mfma_f32_16x16x32_bf16 v[132:135], a[76:79], a[36:39], v[132:135]
  s_add_u32 s0, s0, 7
  s_sub_u32 s0, s0, s3
  s_mul_i32 s0, s0, 20480
  v_mfma_f32_16x16x32_bf16 v[164:167], a[76:79], a[44:47], v[164:167]
  s_add_u32 s47, s0, 0
  s_mul_i32 s1, s6, 47104
  s_add_u32 s1, s1, 38797312
  v_mfma_f32_16x16x32_bf16 v[164:167], a[72:75], a[40:43], v[164:167]
  s_add_u32 m0, s35, 17952
  s_sub_u32 s0, 15, s5
  s_lshl_b32 s0, s0, 3
  v_mfma_f32_16x16x32_bf16 v[196:199], a[72:75], a[48:51], v[196:199]
  s_add_u32 s28, s33, 8192
  s_add_u32 s0, s0, s3
  s_mul_i32 s0, s0, 188416
  v_mfma_f32_16x16x32_bf16 v[196:199], a[76:79], a[52:55], v[196:199]
  s_add_u32 s48, s0, s1
  buffer_load_dwordx4 v6, s[20:23], s28 offen lds
  v_mfma_f32_16x16x32_bf16 v[228:231], a[76:79], a[60:63], v[228:231]
  s_sub_u32 s0, 15, s5
  s_lshl_b32 s0, s0, 3
  s_add_u32 s0, s0, 7
  v_mfma_f32_16x16x32_bf16 v[228:231], a[72:75], a[56:59], v[228:231]
  s_waitcnt lgkmcnt(2)
  s_sub_u32 s0, s0, s3
  s_mul_i32 s0, s0, 188416
  s_add_u32 s49, s0, s1
  v_mfma_f32_16x16x32_bf16 a[88:91], a[64:67], a[0:3], a[88:91]
  s_waitcnt lgkmcnt(0)
  s_add_u32 m0, s35, 19008
  s_mov_b32 s0, s5
  s_lshl_b32 s0, s0, 3
  v_mfma_f32_16x16x32_bf16 a[88:91], a[68:71], a[4:7], a[88:91]
  s_add_u32 s28, s33, 16384
  s_add_u32 s0, s0, s3
  s_mul_i32 s0, s0, 188416
  v_mfma_f32_16x16x32_bf16 v[40:43], a[68:71], a[12:15], v[40:43]
  s_add_u32 s50, s0, s1
  buffer_load_dwordx4 v6, s[20:23], s28 offen lds
  v_mfma_f32_16x16x32_bf16 v[40:43], a[64:67], a[8:11], v[40:43]
  s_mov_b32 s0, s5
  ds_read_b64_tr_b16 a[72:73], v4 offset:96
  ds_read_b64_tr_b16 a[74:75], v4 offset:8544
  v_mfma_f32_16x16x32_bf16 v[72:75], a[64:67], a[16:19], v[72:75]
  s_lshl_b32 s0, s0, 3
  ds_read_b64_tr_b16 a[76:77], v4 offset:608
  ds_read_b64_tr_b16 a[78:79], v4 offset:9056
  v_mfma_f32_16x16x32_bf16 v[72:75], a[68:71], a[20:23], v[72:75]
  s_add_u32 m0, s35, 20064
  s_add_u32 s0, s0, 7
  s_sub_u32 s0, s0, s3
  v_mfma_f32_16x16x32_bf16 v[104:107], a[68:71], a[28:31], v[104:107]
  s_add_u32 s28, s33, 24576
  s_mul_i32 s0, s0, 188416
  s_add_u32 s51, s0, s1
  v_mfma_f32_16x16x32_bf16 v[104:107], a[64:67], a[24:27], v[104:107]
  s_lshl_b32 s0, s4, 4
  buffer_load_dwordx4 v6, s[20:23], s28 offen lds
  v_mfma_f32_16x16x32_bf16 v[136:139], a[64:67], a[32:35], v[136:139]
  s_lshl_b32 s1, s5, 1
  s_add_u32 s0, s0, s1
  s_and_b32 s1, s3, 1
  v_mfma_f32_16x16x32_bf16 v[136:139], a[68:71], a[36:39], v[136:139]
  s_add_u32 s0, s0, s1
  s_lshl_b32 s0, s0, 1
  s_lshr_b32 s1, s3, 1
  v_mfma_f32_16x16x32_bf16 v[168:171], a[68:71], a[44:47], v[168:171]
  s_add_u32 s0, s0, s1
  s_lshl_b32 s0, s0, 15
  s_waitcnt vmcnt(8)
  v_cmp_gt_u32 vcc, 4, v11
  v_mfma_f32_16x16x32_bf16 v[168:171], a[64:67], a[40:43], v[168:171]
  s_add_u32 s33, s33, 524288
  s_add_u32 s35, s35, s36
  s_mul_i32 s1, s4, 9216
  v_mfma_f32_16x16x32_bf16 v[200:203], a[64:67], a[48:51], v[200:203]
  s_sub_u32 s36, 0, s36
  s_add_u32 s0, s0, s1
  s_add_u32 s93, s0, 4194304
  v_mfma_f32_16x16x32_bf16 v[200:203], a[68:71], a[52:55], v[200:203]
  s_cmp_eq_u32 s6, 3
  s_cselect_b32 s1, 6, 7
  v_xor_b32 v2, 0x8000, v2
  v_mfma_f32_16x16x32_bf16 v[232:235], a[68:71], a[60:63], v[232:235]
  s_cbranch_vccnz L_sl_s1k
L_bk_s1k:
  s_cmp_lt_u32 s7, s1
  s_cselect_b32 s58, 2211840, 0
  v_mfma_f32_16x16x32_bf16 v[232:235], a[64:67], a[56:59], v[232:235]
  s_waitcnt lgkmcnt(2)
  s_add_u32 m0, s34, 0
  v_xor_b32 v3, 0x8000, v3
  v_mfma_f32_16x16x32_bf16 a[92:95], a[72:75], a[0:3], a[92:95]
  s_waitcnt lgkmcnt(0)
  s_add_u32 s28, s32, 0
  v_mfma_f32_16x16x32_bf16 a[92:95], a[76:79], a[4:7], a[92:95]
  buffer_load_dwordx4 v5, s[12:15], s28 offen lds
  v_mfma_f32_16x16x32_bf16 v[44:47], a[76:79], a[12:15], v[44:47]
  ds_read_b64_tr_b16 a[64:65], v4 offset:128
  ds_read_b64_tr_b16 a[66:67], v4 offset:8576
  v_mfma_f32_16x16x32_bf16 v[44:47], a[72:75], a[8:11], v[44:47]
  ds_read_b64_tr_b16 a[68:69], v4 offset:640
  ds_read_b64_tr_b16 a[70:71], v4 offset:9088
  v_mfma_f32_16x16x32_bf16 v[76:79], a[72:75], a[16:19], v[76:79]
  v_mfma_f32_16x16x32_bf16 v[76:79], a[76:79], a[20:23], v[76:79]
  v_mfma_f32_16x16x32_bf16 v[108:111], a[76:79], a[28:31], v[108:111]
  v_mfma_f32_16x16x32_bf16 v[108:111], a[72:75], a[24:27], v[108:111]
  s_add_u32 m0, s34, 1024
  v_mfma_f32_16x16x32_bf16 v[140:143], a[72:75], a[32:35], v[140:143]
  s_add_u32 s28, s32, 8192
  buffer_load_dwordx4 a[96:99], v1, s[60:63], s44 offen offset:0 sc1
  v_mfma_f32_16x16x32_bf16 v[140:143], a[76:79], a[36:39], v[140:143]
  buffer_load_dwordx4 v5, s[12:15], s28 offen lds
  v_mfma_f32_16x16x32_bf16 v[172:175], a[76:79], a[44:47], v[172:175]
  v_mfma_f32_16x16x32_bf16 v[172:175], a[72:75], a[40:43], v[172:175]
  v_mfma_f32_16x16x32_bf16 v[204:207], a[72:75], a[48:51], v[204:207]
  s_lshr_b32 s90, s2, 3
  s_lshl_b32 s90, s90, 2
  s_add_u32 s90, s90, s3
  v_mfma_f32_16x16x32_bf16 v[204:207], a[76:79], a[52:55], v[204:207]
  s_lshl_b32 s90, s90, 8
  buffer_load_dwordx4 a[100:103], v1, s[60:63], s44 offen offset:1024 sc1
  v_mfma_f32_16x16x32_bf16 v[236:239], a[76:79], a[60:63], v[236:239]
  v_and_b32 v7, 1, v0
  v_lshlrev_b32 v7, 7, v7
  v_mfma_f32_16x16x32_bf16 v[236:239], a[72:75], a[56:59], v[236:239]
  s_waitcnt lgkmcnt(2)
  s_add_u32 m0, s34, 2048
  v_add_u32 v7, s90, v7
  v_min_u32 v7, L_att-L_p2, v7
  v_mfma_f32_16x16x32_bf16 v[16:19], a[64:67], a[0:3], v[16:19]
  s_add_u32 s28, s32, 16384
  s_getpc_b64 s[88:89]
L_ct_k:
  v_add_u32 v7, L_p2-L_ct_k, v7
  s_waitcnt lgkmcnt(0)
  v_mfma_f32_16x16x32_bf16 v[16:19], a[68:71], a[4:7], v[16:19]
  buffer_load_dwordx4 v5, s[12:15], s28 offen lds
  v_mfma_f32_16x16x32_bf16 v[48:51], a[68:71], a[12:15], v[48:51]
  ds_read_b64_tr_b16 a[72:73], v4 offset:160
  ds_read_b64_tr_b16 a[74:75], v4 offset:8608
  v_mfma_f32_16x16x32_bf16 v[48:51], a[64:67], a[8:11], v[48:51]
  ds_read_b64_tr_b16 a[76:77], v4 offset:672
  ds_read_b64_tr_b16 a[78:79], v4 offset:9120
  v_mfma_f32_16x16x32_bf16 v[80:83], a[64:67], a[16:19], v[80:83]
  v_mfma_f32_16x16x32_bf16 v[80:83], a[68:71], a[20:23], v[80:83]
  buffer_load_dwordx4 a[104:107], v1, s[60:63], s45 offen offset:0 sc1
  v_mfma_f32_16x16x32_bf16 v[112:115], a[68:71], a[28:31], v[112:115]
  v_mfma_f32_16x16x32_bf16 v[112:115], a[64:67], a[24:27], v[112:115]
  s_add_u32 m0, s34, 3072
  v_mfma_f32_16x16x32_bf16 v[144:147], a[64:67], a[32:35], v[144:147]
  s_add_u32 s28, s32, 24576
  v_mfma_f32_16x16x32_bf16 v[144:147], a[68:71], a[36:39], v[144:147]
  buffer_load_dwordx4 v5, s[12:15], s28 offen lds
  v_mfma_f32_16x16x32_bf16 v[176:179], a[68:71], a[44:47], v[176:179]
  v_mfma_f32_16x16x32_bf16 v[176:179], a[64:67], a[40:43], v[176:179]
  v_mfma_f32_16x16x32_bf16 v[208:211], a[64:67], a[48:51], v[208:211]
  v_mfma_f32_16x16x32_bf16 v[208:211], a[68:71], a[52:55], v[208:211]
  buffer_load_dwordx4 a[108:111], v1, s[60:63], s45 offen offset:1024 sc1
  v_mfma_f32_16x16x32_bf16 v[240:243], a[68:71], a[60:63], v[240:243]
  v_mfma_f32_16x16x32_bf16 v[240:243], a[64:67], a[56:59], v[240:243]
  s_waitcnt lgkmcnt(2)
  s_add_u32 m0, s34, 4096
  v_mfma_f32_16x16x32_bf16 v[20:23], a[72:75], a[0:3], v[20:23]
  s_waitcnt lgkmcnt(0)
  s_add_u32 s28, s32, 32768
  v_mfma_f32_16x16x32_bf16 v[20:23], a[76:79], a[4:7], v[20:23]
  buffer_load_dwordx4 v5, s[12:15], s28 offen lds
  v_mfma_f32_16x16x32_bf16 v[52:55], a[76:79], a[12:15], v[52:55]
  ds_read_b64_tr_b16 a[64:65], v4 offset:192
  ds_read_b64_tr_b16 a[66:67], v4 offset:8640
  v_mfma_f32_16x16x32_bf16 v[52:55], a[72:75], a[8:11], v[52:55]
  ds_read_b64_tr_b16 a[68:69], v4 offset:704
  ds_read_b64_tr_b16 a[70:71], v4 offset:9152
  v_mfma_f32_16x16x32_bf16 v[84:87], a[72:75], a[16:19], v[84:87]
  v_mfma_f32_16x16x32_bf16 v[84:87], a[76:79], a[20:23], v[84:87]
  buffer_load_dwordx4 a[112:115], v1, s[60:63], s46 offen offset:0 sc1
  v_mfma_f32_16x16x32_bf16 v[116:119], a[76:79], a[28:31], v[116:119]
  v_mfma_f32_16x16x32_bf16 v[116:119], a[72:75], a[24:27], v[116:119]
  s_add_u32 m0, s34, 5120
  v_mfma_f32_16x16x32_bf16 v[148:151], a[72:75], a[32:35], v[148:151]
  s_add_u32 s28, s32, 40960
  v_mfma_f32_16x16x32_bf16 v[148:151], a[76:79], a[36:39], v[148:151]
  buffer_load_dwordx4 v5, s[12:15], s28 offen lds
  v_mfma_f32_16x16x32_bf16 v[180:183], a[76:79], a[44:47], v[180:183]
  v_mfma_f32_16x16x32_bf16 v[180:183], a[72:75], a[40:43], v[180:183]
  v_mfma_f32_16x16x32_bf16 v[212:215], a[72:75], a[48:51], v[212:215]
  v_mfma_f32_16x16x32_bf16 v[212:215], a[76:79], a[52:55], v[212:215]
  buffer_load_dwordx4 a[116:119], v1, s[60:63], s46 offen offset:1024 sc1
  v_mfma_f32_16x16x32_bf16 v[244:247], a[76:79], a[60:63], v[244:247]
  v_mfma_f32_16x16x32_bf16 v[244:247], a[72:75], a[56:59], v[244:247]
  s_waitcnt lgkmcnt(2)
  s_add_u32 m0, s34, 6144
  v_mfma_f32_16x16x32_bf16 v[24:27], a[64:67], a[0:3], v[24:27]
  s_waitcnt lgkmcnt(0)
  s_add_u32 s28, s32, 49152
  v_mfma_f32_16x16x32_bf16 v[24:27], a[68:71], a[4:7], v[24:27]
  buffer_load_dwordx4 v5, s[12:15], s28 offen lds
  v_mfma_f32_16x16x32_bf16 v[56:59], a[68:71], a[12:15], v[56:59]
  ds_read_b64_tr_b16 a[72:73], v4 offset:224
  ds_read_b64_tr_b16 a[74:75], v4 offset:8672
  v_mfma_f32_16x16x32_bf16 v[56:59], a[64:67], a[8:11], v[56:59]
  ds_read_b64_tr_b16 a[76:77], v4 offset:736
  ds_read_b64_tr_b16 a[78:79], v4 offset:9184
  v_mfma_f32_16x16x32_bf16 v[88:91], a[64:67], a[16:19], v[88:91]
  v_mfma_f32_16x16x32_bf16 v[88:91], a[68:71], a[20:23], v[88:91]
  buffer_load_dwordx4 a[120:123], v1, s[60:63], s47 offen offset:0 sc1
  v_mfma_f32_16x16x32_bf16 v[120:123], a[68:71], a[28:31], v[120:123]
  v_mfma_f32_16x16x32_bf16 v[120:123], a[64:67], a[24:27], v[120:123]
  s_add_u32 m0, s34, 7168
  v_mfma_f32_16x16x32_bf16 v[152:155], a[64:67], a[32:35], v[152:155]
  s_add_u32 s28, s32, 57344
  v_mfma_f32_16x16x32_bf16 v[152:155], a[68:71], a[36:39], v[152:155]
  buffer_load_dwordx4 v5, s[12:15], s28 offen lds
  v_mfma_f32_16x16x32_bf16 v[184:187], a[68:71], a[44:47], v[184:187]
  v_add_u32 v4, s37, v4
  v_mfma_f32_16x16x32_bf16 v[184:187], a[64:67], a[40:43], v[184:187]
  v_mfma_f32_16x16x32_bf16 v[216:219], a[64:67], a[48:51], v[216:219]
  v_mfma_f32_16x16x32_bf16 v[216:219], a[68:71], a[52:55], v[216:219]
  buffer_load_dwordx4 a[124:127], v1, s[60:63], s47 offen offset:1024 sc1
  v_mfma_f32_16x16x32_bf16 v[248:251], a[68:71], a[60:63], v[248:251]
  s_waitcnt vmcnt(16)
  s_waitcnt lgkmcnt(0)
  s_sub_u32 s37, 0, s37
  v_mfma_f32_16x16x32_bf16 v[248:251], a[64:67], a[56:59], v[248:251]
  s_barrier
  v_mfma_f32_16x16x32_bf16 v[28:31], a[72:75], a[0:3], v[28:31]
  global_load_dword v10, v7, s[88:89]
  v_mfma_f32_16x16x32_bf16 v[28:31], a[76:79], a[4:7], v[28:31]
  ds_read_b64_tr_b16 a[64:65], v4 offset:0
  ds_read_b64_tr_b16 a[66:67], v4 offset:8448
  v_mfma_f32_16x16x32_bf16 v[60:63], a[76:79], a[12:15], v[60:63]
  ds_read_b64_tr_b16 a[68:69], v4 offset:512
  ds_read_b64_tr_b16 a[70:71], v4 offset:8960
  v_mfma_f32_16x16x32_bf16 v[60:63], a[72:75], a[8:11], v[60:63]
  ds_read_b128 a[0:3], v2 offset:0
  ds_read_b128 a[4:7], v3 offset:0
  v_mfma_f32_16x16x32_bf16 v[92:95], a[72:75], a[16:19], v[92:95]
  ds_read_b128 a[8:11], v2 offset:2048
  ds_read_b128 a[12:15], v3 offset:2048
  v_mfma_f32_16x16x32_bf16 v[92:95], a[76:79], a[20:23], v[92:95]
  ds_read_b128 a[16:19], v2 offset:4096
  v_mfma_f32_16x16x32_bf16 v[124:127], a[76:79], a[28:31], v[124:127]
  ds_read_b128 a[20:23], v3 offset:4096
  v_mfma_f32_16x16x32_bf16 v[124:127], a[72:75], a[24:27], v[124:127]
  ds_read_b128 a[24:27], v2 offset:6144
  v_mfma_f32_16x16x32_bf16 v[156:159], a[72:75], a[32:35], v[156:159]
  ds_read_b128 a[28:31], v3 offset:6144
  v_mfma_f32_16x16x32_bf16 v[156:159], a[76:79], a[36:39], v[156:159]
  ds_read_b128 a[32:35], v2 offset:8192
  v_mfma_f32_16x16x32_bf16 v[188:191], a[76:79], a[44:47], v[188:191]
  ds_read_b128 a[36:39], v3 offset:8192
  v_mfma_f32_16x16x32_bf16 v[188:191], a[72:75], a[40:43], v[188:191]
  ds_read_b128 a[40:43], v2 offset:10240
  v_mfma_f32_16x16x32_bf16 v[220:223], a[72:75], a[48:51], v[220:223]
  s_waitcnt lgkmcnt(14)
  ds_read_b128 a[44:47], v3 offset:10240
  v_mfma_f32_16x16x32_bf16 v[220:223], a[76:79], a[52:55], v[220:223]
  v_mfma_f32_16x16x32_bf16 v[252:255], a[76:79], a[60:63], v[252:255]
  v_mfma_f32_16x16x32_bf16 v[252:255], a[72:75], a[56:59], v[252:255]
  s_waitcnt lgkmcnt(11)
  v_mfma_f32_16x16x32_bf16 a[80:83], a[64:67], a[0:3], a[80:83]
  s_waitcnt lgkmcnt(10)
  ds_read_b128 a[48:51], v2 offset:12288
  ds_read_b128 a[52:55], v3 offset:12288
  v_mfma_f32_16x16x32_bf16 a[80:83], a[68:71], a[4:7], a[80:83]
  s_waitcnt lgkmcnt(10)
  ds_read_b128 a[56:59], v2 offset:14336
  ds_read_b128 a[60:63], v3 offset:14336
  v_mfma_f32_16x16x32_bf16 v[32:35], a[68:71], a[12:15], v[32:35]
  s_add_u32 m0, s35, 0
  v_mfma_f32_16x16x32_bf16 v[32:35], a[64:67], a[8:11], v[32:35]
  s_waitcnt lgkmcnt(11)
  s_add_u32 s28, s33, 0
  v_mfma_f32_16x16x32_bf16 v[64:67], a[64:67], a[16:19], v[64:67]
  s_waitcnt lgkmcnt(10)
  buffer_load_dwordx4 v6, s[16:19], s28 offen lds
  v_mfma_f32_16x16x32_bf16 v[64:67], a[68:71], a[20:23], v[64:67]
  s_waitcnt lgkmcnt(8)
  ds_read_b64_tr_b16 a[72:73], v4 offset:32
  ds_read_b64_tr_b16 a[74:75], v4 offset:8480
  v_mfma_f32_16x16x32_bf16 v[96:99], a[68:71], a[28:31], v[96:99]
  ds_read_b64_tr_b16 a[76:77], v4 offset:544
  ds_read_b64_tr_b16 a[78:79], v4 offset:8992
  v_mfma_f32_16x16x32_bf16 v[96:99], a[64:67], a[24:27], v[96:99]
  s_waitcnt lgkmcnt(11)
  s_add_u32 m0, s35, 1056
  v_bfe_u32 v7, v0, 3, 1
  v_bfe_u32 v8, v0, 4, 2
  v_mfma_f32_16x16x32_bf16 v[128:131], a[64:67], a[32:35], v[128:131]
  s_waitcnt lgkmcnt(10)
  s_add_u32 s28, s33, 8192
  v_lshlrev_b32 v8, 2, v8
  v_add_lshl_u32 v7, v7, v8, 2
  v_mfma_f32_16x16x32_bf16 v[128:131], a[68:71], a[36:39], v[128:131]
  s_waitcnt lgkmcnt(8)
  buffer_load_dwordx4 v6, s[16:19], s28 offen lds
  v_mfma_f32_16x16x32_bf16 v[160:163], a[68:71], a[44:47], v[160:163]
  v_mul_u32_u24 v7, 0xd80, v7
  v_and_b32 v8, 7, v0
  v_mfma_f32_16x16x32_bf16 v[160:163], a[64:67], a[40:43], v[160:163]
  s_waitcnt lgkmcnt(7)
  v_lshl_add_u32 v5, v8, 4, v7
  v_mfma_f32_16x16x32_bf16 v[192:195], a[64:67], a[48:51], v[192:195]
  s_waitcnt lgkmcnt(6)
  s_add_u32 m0, s35, 2112
  v_mfma_f32_16x16x32_bf16 v[192:195], a[68:71], a[52:55], v[192:195]
  s_waitcnt lgkmcnt(4)
  s_add_u32 s28, s33, 16384
  v_mfma_f32_16x16x32_bf16 v[224:227], a[68:71], a[60:63], v[224:227]
  buffer_load_dwordx4 v6, s[16:19], s28 offen lds
  v_mfma_f32_16x16x32_bf16 v[224:227], a[64:67], a[56:59], v[224:227]
  s_waitcnt lgkmcnt(2)
  v_mfma_f32_16x16x32_bf16 a[84:87], a[72:75], a[0:3], a[84:87]
  s_waitcnt lgkmcnt(0)
  v_mfma_f32_16x16x32_bf16 a[84:87], a[76:79], a[4:7], a[84:87]
  s_add_u32 m0, s35, 3168
  ds_read_b64_tr_b16 a[64:65], v4 offset:64
  ds_read_b64_tr_b16 a[66:67], v4 offset:8512
  v_mfma_f32_16x16x32_bf16 v[36:39], a[76:79], a[12:15], v[36:39]
  s_add_u32 s28, s33, 24576
  ds_read_b64_tr_b16 a[68:69], v4 offset:576
  ds_read_b64_tr_b16 a[70:71], v4 offset:9024
  v_mfma_f32_16x16x32_bf16 v[36:39], a[72:75], a[8:11], v[36:39]
  buffer_load_dwordx4 v6, s[16:19], s28 offen lds
  v_mfma_f32_16x16x32_bf16 v[68:71], a[72:75], a[16:19], v[68:71]
  v_xor_b32 v2, 0x8000, v2
  v_xor_b32 v3, 0x8000, v3
  v_mfma_f32_16x16x32_bf16 v[68:71], a[76:79], a[20:23], v[68:71]
  v_mfma_f32_16x16x32_bf16 v[100:103], a[76:79], a[28:31], v[100:103]
  s_add_u32 m0, s35, 16896
  v_mfma_f32_16x16x32_bf16 v[100:103], a[72:75], a[24:27], v[100:103]
  s_add_u32 s28, s33, 0
  v_mfma_f32_16x16x32_bf16 v[132:135], a[72:75], a[32:35], v[132:135]
  buffer_load_dwordx4 v6, s[20:23], s28 offen lds
  v_mfma_f32_16x16x32_bf16 v[132:135], a[76:79], a[36:39], v[132:135]
  v_mfma_f32_16x16x32_bf16 v[164:167], a[76:79], a[44:47], v[164:167]
  v_mfma_f32_16x16x32_bf16 v[164:167], a[72:75], a[40:43], v[164:167]
  s_add_u32 m0, s35, 17952
  v_mfma_f32_16x16x32_bf16 v[196:199], a[72:75], a[48:51], v[196:199]
  s_add_u32 s28, s33, 8192
  v_mfma_f32_16x16x32_bf16 v[196:199], a[76:79], a[52:55], v[196:199]
  buffer_load_dwordx4 v6, s[20:23], s28 offen lds
  v_mfma_f32_16x16x32_bf16 v[228:231], a[76:79], a[60:63], v[228:231]
  v_mfma_f32_16x16x32_bf16 v[228:231], a[72:75], a[56:59], v[228:231]
  s_waitcnt lgkmcnt(2)
  v_mfma_f32_16x16x32_bf16 a[88:91], a[64:67], a[0:3], a[88:91]
  s_waitcnt lgkmcnt(0)
  s_add_u32 m0, s35, 19008
  v_mfma_f32_16x16x32_bf16 a[88:91], a[68:71], a[4:7], a[88:91]
  s_add_u32 s28, s33, 16384
  ds_read_b64_tr_b16 a[72:73], v4 offset:96
  ds_read_b64_tr_b16 a[74:75], v4 offset:8544
  v_mfma_f32_16x16x32_bf16 v[40:43], a[68:71], a[12:15], v[40:43]
  buffer_load_dwordx4 v6, s[20:23], s28 offen lds
  v_mfma_f32_16x16x32_bf16 v[40:43], a[64:67], a[8:11], v[40:43]
  ds_read_b64_tr_b16 a[76:77], v4 offset:608
  ds_read_b64_tr_b16 a[78:79], v4 offset:9056
  v_mfma_f32_16x16x32_bf16 v[72:75], a[64:67], a[16:19], v[72:75]
  v_mfma_f32_16x16x32_bf16 v[72:75], a[68:71], a[20:23], v[72:75]
  s_add_u32 m0, s35, 20064
  v_mfma_f32_16x16x32_bf16 v[104:107], a[68:71], a[28:31], v[104:107]
  s_add_u32 s28, s33, 24576
  v_mfma_f32_16x16x32_bf16 v[104:107], a[64:67], a[24:27], v[104:107]
  buffer_load_dwordx4 v6, s[20:23], s28 offen lds
  v_mfma_f32_16x16x32_bf16 v[136:139], a[64:67], a[32:35], v[136:139]
  v_mfma_f32_16x16x32_bf16 v[136:139], a[68:71], a[36:39], v[136:139]
  v_mfma_f32_16x16x32_bf16 v[168:171], a[68:71], a[44:47], v[168:171]
  v_mfma_f32_16x16x32_bf16 v[168:171], a[64:67], a[40:43], v[168:171]
  s_add_u32 s33, s33, 524288
  s_add_u32 s35, s35, s36
  v_mfma_f32_16x16x32_bf16 v[200:203], a[64:67], a[48:51], v[200:203]
  s_add_u32 m0, s42, 133120
  s_add_u32 s28, s40, 0
  s_sub_u32 s36, 0, s36
  v_mfma_f32_16x16x32_bf16 v[200:203], a[68:71], a[52:55], v[200:203]
  v_mfma_f32_16x16x32_bf16 v[232:235], a[68:71], a[60:63], v[232:235]
  buffer_load_dwordx4 v6, s[52:55], s28 offen lds
  v_mfma_f32_16x16x32_bf16 v[232:235], a[64:67], a[56:59], v[232:235]
  s_waitcnt lgkmcnt(2)
  v_mfma_f32_16x16x32_bf16 a[92:95], a[72:75], a[0:3], a[92:95]
  s_waitcnt lgkmcnt(0)
  s_add_u32 m0, s42, 134176
  s_add_u32 s28, s40, 8192
  v_mfma_f32_16x16x32_bf16 a[92:95], a[76:79], a[4:7], a[92:95]
  ds_read_b64_tr_b16 a[64:65], v4 offset:128
  ds_read_b64_tr_b16 a[66:67], v4 offset:8576
  v_mfma_f32_16x16x32_bf16 v[44:47], a[76:79], a[12:15], v[44:47]
  buffer_load_dwordx4 v6, s[52:55], s28 offen lds
  v_mfma_f32_16x16x32_bf16 v[44:47], a[72:75], a[8:11], v[44:47]
  ds_read_b64_tr_b16 a[68:69], v4 offset:640
  ds_read_b64_tr_b16 a[70:71], v4 offset:9088
  v_mfma_f32_16x16x32_bf16 v[76:79], a[72:75], a[16:19], v[76:79]
  v_mfma_f32_16x16x32_bf16 v[76:79], a[76:79], a[20:23], v[76:79]
  s_add_u32 m0, s42, 135232
  s_add_u32 s28, s40, 16384
  v_mfma_f32_16x16x32_bf16 v[108:111], a[76:79], a[28:31], v[108:111]
  v_mfma_f32_16x16x32_bf16 v[108:111], a[72:75], a[24:27], v[108:111]
  buffer_load_dwordx4 v6, s[52:55], s28 offen lds
  v_mfma_f32_16x16x32_bf16 v[140:143], a[72:75], a[32:35], v[140:143]
  v_mfma_f32_16x16x32_bf16 v[140:143], a[76:79], a[36:39], v[140:143]
  v_mfma_f32_16x16x32_bf16 v[172:175], a[76:79], a[44:47], v[172:175]
  s_add_u32 m0, s42, 136288
  s_add_u32 s28, s40, 24576
  v_mfma_f32_16x16x32_bf16 v[172:175], a[72:75], a[40:43], v[172:175]
  v_mfma_f32_16x16x32_bf16 v[204:207], a[72:75], a[48:51], v[204:207]
  buffer_load_dwordx4 v6, s[52:55], s28 offen lds
  v_mfma_f32_16x16x32_bf16 v[204:207], a[76:79], a[52:55], v[204:207]
  v_mfma_f32_16x16x32_bf16 v[236:239], a[76:79], a[60:63], v[236:239]
  s_add_u32 m0, s43, 133120
  s_add_u32 s28, s41, 0
  v_mfma_f32_16x16x32_bf16 v[236:239], a[72:75], a[56:59], v[236:239]
  s_waitcnt lgkmcnt(2)
  v_mfma_f32_16x16x32_bf16 v[16:19], a[64:67], a[0:3], v[16:19]
  s_waitcnt lgkmcnt(0)
  buffer_load_dwordx4 v5, s[56:59], s28 offen lds
  v_mfma_f32_16x16x32_bf16 v[16:19], a[68:71], a[4:7], v[16:19]
  ds_read_b64_tr_b16 a[72:73], v4 offset:160
  ds_read_b64_tr_b16 a[74:75], v4 offset:8608
  v_mfma_f32_16x16x32_bf16 v[48:51], a[68:71], a[12:15], v[48:51]
  ds_read_b64_tr_b16 a[76:77], v4 offset:672
  ds_read_b64_tr_b16 a[78:79], v4 offset:9120
  v_mfma_f32_16x16x32_bf16 v[48:51], a[64:67], a[8:11], v[48:51]
  s_add_u32 m0, s43, 134176
  s_add_u32 s28, s41, 3456
  v_mfma_f32_16x16x32_bf16 v[80:83], a[64:67], a[16:19], v[80:83]
  v_mfma_f32_16x16x32_bf16 v[80:83], a[68:71], a[20:23], v[80:83]
  buffer_load_dwordx4 v5, s[56:59], s28 offen lds
  v_mfma_f32_16x16x32_bf16 v[112:115], a[68:71], a[28:31], v[112:115]
  v_mfma_f32_16x16x32_bf16 v[112:115], a[64:67], a[24:27], v[112:115]
  v_mfma_f32_16x16x32_bf16 v[144:147], a[64:67], a[32:35], v[144:147]
  v_mfma_f32_16x16x32_bf16 v[144:147], a[68:71], a[36:39], v[144:147]
  v_mfma_f32_16x16x32_bf16 v[176:179], a[68:71], a[44:47], v[176:179]
  v_mfma_f32_16x16x32_bf16 v[176:179], a[64:67], a[40:43], v[176:179]
  v_mfma_f32_16x16x32_bf16 v[208:211], a[64:67], a[48:51], v[208:211]
  buffer_load_dwordx4 a[128:131], v1, s[60:63], s44 offen offset:2048 sc1
  v_mfma_f32_16x16x32_bf16 v[208:211], a[68:71], a[52:55], v[208:211]
  v_mfma_f32_16x16x32_bf16 v[240:243], a[68:71], a[60:63], v[240:243]
  v_mfma_f32_16x16x32_bf16 v[240:243], a[64:67], a[56:59], v[240:243]
  s_waitcnt lgkmcnt(2)
  v_mfma_f32_16x16x32_bf16 v[20:23], a[72:75], a[0:3], v[20:23]
  s_waitcnt lgkmcnt(0)
  buffer_load_dwordx4 a[132:135], v1, s[60:63], s44 offen offset:3072 sc1
  v_mfma_f32_16x16x32_bf16 v[20:23], a[76:79], a[4:7], v[20:23]
  s_add_u32 s44, s44, 4096
  ds_read_b64_tr_b16 a[64:65], v4 offset:192
  ds_read_b64_tr_b16 a[66:67], v4 offset:8640
  v_mfma_f32_16x16x32_bf16 v[52:55], a[76:79], a[12:15], v[52:55]
  ds_read_b64_tr_b16 a[68:69], v4 offset:704
  ds_read_b64_tr_b16 a[70:71], v4 offset:9152
  v_mfma_f32_16x16x32_bf16 v[52:55], a[72:75], a[8:11], v[52:55]
  v_mfma_f32_16x16x32_bf16 v[84:87], a[72:75], a[16:19], v[84:87]
  buffer_load_dwordx4 a[136:139], v1, s[60:63], s45 offen offset:2048 sc1
  v_mfma_f32_16x16x32_bf16 v[84:87], a[76:79], a[20:23], v[84:87]
  v_mfma_f32_16x16x32_bf16 v[116:119], a[76:79], a[28:31], v[116:119]
  v_mfma_f32_16x16x32_bf16 v[116:119], a[72:75], a[24:27], v[116:119]
  v_mfma_f32_16x16x32_bf16 v[148:151], a[72:75], a[32:35], v[148:151]
  buffer_load_dwordx4 a[140:143], v1, s[60:63], s45 offen offset:3072 sc1
  v_mfma_f32_16x16x32_bf16 v[148:151], a[76:79], a[36:39], v[148:151]
  s_add_u32 s45, s45, 4096
  v_mfma_f32_16x16x32_bf16 v[180:183], a[76:79], a[44:47], v[180:183]
  v_mfma_f32_16x16x32_bf16 v[180:183], a[72:75], a[40:43], v[180:183]
  v_mfma_f32_16x16x32_bf16 v[212:215], a[72:75], a[48:51], v[212:215]
  buffer_load_dwordx4 a[144:147], v1, s[60:63], s46 offen offset:2048 sc1
  v_mfma_f32_16x16x32_bf16 v[212:215], a[76:79], a[52:55], v[212:215]
  v_mfma_f32_16x16x32_bf16 v[244:247], a[76:79], a[60:63], v[244:247]
  v_mfma_f32_16x16x32_bf16 v[244:247], a[72:75], a[56:59], v[244:247]
  s_waitcnt lgkmcnt(2)
  v_mfma_f32_16x16x32_bf16 v[24:27], a[64:67], a[0:3], v[24:27]
  s_waitcnt lgkmcnt(0)
  buffer_load_dwordx4 a[148:151], v1, s[60:63], s46 offen offset:3072 sc1
  v_mfma_f32_16x16x32_bf16 v[24:27], a[68:71], a[4:7], v[24:27]
  s_add_u32 s46, s46, 4096
  ds_read_b64_tr_b16 a[72:73], v4 offset:224
  ds_read_b64_tr_b16 a[74:75], v4 offset:8672
  v_mfma_f32_16x16x32_bf16 v[56:59], a[68:71], a[12:15], v[56:59]
  ds_read_b64_tr_b16 a[76:77], v4 offset:736
  ds_read_b64_tr_b16 a[78:79], v4 offset:9184
  v_mfma_f32_16x16x32_bf16 v[56:59], a[64:67], a[8:11], v[56:59]
  v_mfma_f32_16x16x32_bf16 v[88:91], a[64:67], a[16:19], v[88:91]
  buffer_load_dwordx4 a[152:155], v1, s[60:63], s47 offen offset:2048 sc1
  v_mfma_f32_16x16x32_bf16 v[88:91], a[68:71], a[20:23], v[88:91]
  v_mfma_f32_16x16x32_bf16 v[120:123], a[68:71], a[28:31], v[120:123]
  v_mfma_f32_16x16x32_bf16 v[120:123], a[64:67], a[24:27], v[120:123]
  v_mfma_f32_16x16x32_bf16 v[152:155], a[64:67], a[32:35], v[152:155]
  buffer_load_dwordx4 a[156:159], v1, s[60:63], s47 offen offset:3072 sc1
  v_mfma_f32_16x16x32_bf16 v[152:155], a[68:71], a[36:39], v[152:155]
  s_add_u32 s47, s47, 4096
  v_mfma_f32_16x16x32_bf16 v[184:187], a[68:71], a[44:47], v[184:187]
  v_add_u32 v4, s37, v4
  v_mfma_f32_16x16x32_bf16 v[184:187], a[64:67], a[40:43], v[184:187]
  v_mfma_f32_16x16x32_bf16 v[216:219], a[64:67], a[48:51], v[216:219]
  v_mfma_f32_16x16x32_bf16 v[216:219], a[68:71], a[52:55], v[216:219]
  v_mfma_f32_16x16x32_bf16 v[248:251], a[68:71], a[60:63], v[248:251]
  s_waitcnt vmcnt(14)
  s_waitcnt lgkmcnt(0)
  s_sub_u32 s37, 0, s37
  v_mfma_f32_16x16x32_bf16 v[248:251], a[64:67], a[56:59], v[248:251]
  s_barrier
  v_mfma_f32_16x16x32_bf16 v[28:31], a[72:75], a[0:3], v[28:31]
  v_mfma_f32_16x16x32_bf16 v[28:31], a[76:79], a[4:7], v[28:31]
  ds_read_b64_tr_b16 a[64:65], v4 offset:0
  ds_read_b64_tr_b16 a[66:67], v4 offset:8448
  v_mfma_f32_16x16x32_bf16 v[60:63], a[76:79], a[12:15], v[60:63]
  ds_read_b64_tr_b16 a[68:69], v4 offset:512
  ds_read_b64_tr_b16 a[70:71], v4 offset:8960
  v_mfma_f32_16x16x32_bf16 v[60:63], a[72:75], a[8:11], v[60:63]
  ds_read_b128 a[0:3], v2 offset:0
  ds_read_b128 a[4:7], v3 offset:0
  v_mfma_f32_16x16x32_bf16 v[92:95], a[72:75], a[16:19], v[92:95]
  ds_read_b128 a[8:11], v2 offset:2048
  ds_read_b128 a[12:15], v3 offset:2048
  v_mfma_f32_16x16x32_bf16 v[92:95], a[76:79], a[20:23], v[92:95]
  ds_read_b128 a[16:19], v2 offset:4096
  v_mfma_f32_16x16x32_bf16 v[124:127], a[76:79], a[28:31], v[124:127]
  ds_read_b128 a[20:23], v3 offset:4096
  v_mfma_f32_16x16x32_bf16 v[124:127], a[72:75], a[24:27], v[124:127]
  ds_read_b128 a[24:27], v2 offset:6144
  v_mfma_f32_16x16x32_bf16 v[156:159], a[72:75], a[32:35], v[156:159]
  ds_read_b128 a[28:31], v3 offset:6144
  v_mfma_f32_16x16x32_bf16 v[156:159], a[76:79], a[36:39], v[156:159]
  ds_read_b128 a[32:35], v2 offset:8192
  v_mfma_f32_16x16x32_bf16 v[188:191], a[76:79], a[44:47], v[188:191]
  ds_read_b128 a[36:39], v3 offset:8192
  v_mfma_f32_16x16x32_bf16 v[188:191], a[72:75], a[40:43], v[188:191]
  ds_read_b128 a[40:43], v2 offset:10240
  v_mfma_f32_16x16x32_bf16 v[220:223], a[72:75], a[48:51], v[220:223]
  s_waitcnt lgkmcnt(14)
  ds_read_b128 a[44:47], v3 offset:10240
  v_mfma_f32_16x16x32_bf16 v[220:223], a[76:79], a[52:55], v[220:223]
  v_mfma_f32_16x16x32_bf16 v[252:255], a[76:79], a[60:63], v[252:255]
  v_mfma_f32_16x16x32_bf16 v[252:255], a[72:75], a[56:59], v[252:255]
  s_waitcnt lgkmcnt(11)
  v_mfma_f32_16x16x32_bf16 a[80:83], a[64:67], a[0:3], a[80:83]
  s_waitcnt lgkmcnt(10)
  ds_read_b128 a[48:51], v2 offset:12288
  ds_read_b128 a[52:55], v3 offset:12288
  v_mfma_f32_16x16x32_bf16 a[80:83], a[68:71], a[4:7], a[80:83]
  s_waitcnt lgkmcnt(10)
  ds_read_b128 a[56:59], v2 offset:14336
  ds_read_b128 a[60:63], v3 offset:14336
  v_mfma_f32_16x16x32_bf16 v[32:35], a[68:71], a[12:15], v[32:35]
  s_add_u32 m0, s42, 73984
  s_add_u32 s28, s40, 524288
  v_mfma_f32_16x16x32_bf16 v[32:35], a[64:67], a[8:11], v[32:35]
  s_waitcnt lgkmcnt(11)
  v_mfma_f32_16x16x32_bf16 v[64:67], a[64:67], a[16:19], v[64:67]
  s_waitcnt lgkmcnt(10)
  buffer_load_dwordx4 v6, s[52:55], s28 offen lds
  v_mfma_f32_16x16x32_bf16 v[64:67], a[68:71], a[20:23], v[64:67]
  s_waitcnt lgkmcnt(8)
  ds_read_b64_tr_b16 a[72:73], v4 offset:32
  ds_read_b64_tr_b16 a[74:75], v4 offset:8480
  v_mfma_f32_16x16x32_bf16 v[96:99], a[68:71], a[28:31], v[96:99]
  ds_read_b64_tr_b16 a[76:77], v4 offset:544
  ds_read_b64_tr_b16 a[78:79], v4 offset:8992
  v_mfma_f32_16x16x32_bf16 v[96:99], a[64:67], a[24:27], v[96:99]
  s_waitcnt lgkmcnt(11)
  s_add_u32 m0, s42, 75040
  s_add_u32 s28, s40, 532480
  v_mfma_f32_16x16x32_bf16 v[128:131], a[64:67], a[32:35], v[128:131]
  s_waitcnt lgkmcnt(10)
  v_subrev_u32 v2, s91, v4
  v_add_u32 v3, 73984, v2
  v_mfma_f32_16x16x32_bf16 v[128:131], a[68:71], a[36:39], v[128:131]
  s_waitcnt lgkmcnt(8)
  buffer_load_dwordx4 v6, s[52:55], s28 offen lds
  v_mfma_f32_16x16x32_bf16 v[160:163], a[68:71], a[44:47], v[160:163]
  v_mfma_f32_16x16x32_bf16 v[160:163], a[64:67], a[40:43], v[160:163]
  s_waitcnt lgkmcnt(7)
  v_mfma_f32_16x16x32_bf16 v[192:195], a[64:67], a[48:51], v[192:195]
  s_waitcnt lgkmcnt(6)
  s_add_u32 m0, s42, 76096
  s_add_u32 s28, s40, 540672
  v_mfma_f32_16x16x32_bf16 v[192:195], a[68:71], a[52:55], v[192:195]
  s_waitcnt lgkmcnt(4)
  v_mfma_f32_16x16x32_bf16 v[224:227], a[68:71], a[60:63], v[224:227]
  buffer_load_dwordx4 v6, s[52:55], s28 offen lds
  v_mfma_f32_16x16x32_bf16 v[224:227], a[64:67], a[56:59], v[224:227]
  s_waitcnt lgkmcnt(2)
  v_mfma_f32_16x16x32_bf16 a[84:87], a[72:75], a[0:3], a[84:87]
  s_waitcnt lgkmcnt(0)
  v_mfma_f32_16x16x32_bf16 a[84:87], a[76:79], a[4:7], a[84:87]
  s_add_u32 m0, s42, 77152
  s_add_u32 s28, s40, 548864
  ds_read_b64_tr_b16 a[64:65], v4 offset:64
  v_mfma_f32_16x16x32_bf16 v[36:39], a[76:79], a[12:15], v[36:39]
  ds_read_b64_tr_b16 a[66:67], v4 offset:8512
  ds_read_b64_tr_b16 a[68:69], v4 offset:576
  v_mfma_f32_16x16x32_bf16 v[36:39], a[72:75], a[8:11], v[36:39]
  buffer_load_dwordx4 v6, s[52:55], s28 offen lds
  v_mfma_f32_16x16x32_bf16 v[68:71], a[72:75], a[16:19], v[68:71]
  ds_read_b64_tr_b16 a[70:71], v4 offset:9024
  v_mfma_f32_16x16x32_bf16 v[68:71], a[76:79], a[20:23], v[68:71]
  v_mfma_f32_16x16x32_bf16 v[100:103], a[76:79], a[28:31], v[100:103]
  s_add_u32 m0, s43, 73984
  s_add_u32 s28, s41, 221184
  v_accvgpr_read_b32 v7, a80
  v_mfma_f32_16x16x32_bf16 v[100:103], a[72:75], a[24:27], v[100:103]
  v_accvgpr_read_b32 v14, a81
  v_cvt_pk_bf16_f32 v8, v7, v14
  v_mfma_f32_16x16x32_bf16 v[132:135], a[72:75], a[32:35], v[132:135]
  buffer_load_dwordx4 v5, s[56:59], s28 offen lds
  v_mfma_f32_16x16x32_bf16 v[132:135], a[76:79], a[36:39], v[132:135]
  v_cvt_pk_bf16_f32 v32, v32, v33
  v_cvt_pk_bf16_f32 v33, v34, v35
  v_mfma_f32_16x16x32_bf16 v[164:167], a[76:79], a[44:47], v[164:167]
  v_cvt_pk_bf16_f32 v34, v36, v37
  v_cvt_pk_bf16_f32 v35, v38, v39
  v_mfma_f32_16x16x32_bf16 v[164:167], a[72:75], a[40:43], v[164:167]
  s_add_u32 m0, s43, 75040
  s_add_u32 s28, s41, 224640
  v_cvt_pk_bf16_f32 v64, v64, v65
  v_mfma_f32_16x16x32_bf16 v[196:199], a[72:75], a[48:51], v[196:199]
  v_cvt_pk_bf16_f32 v65, v66, v67
  v_cvt_pk_bf16_f32 v66, v68, v69
  v_mfma_f32_16x16x32_bf16 v[196:199], a[76:79], a[52:55], v[196:199]
  buffer_load_dwordx4 v5, s[56:59], s28 offen lds
  v_mfma_f32_16x16x32_bf16 v[228:231], a[76:79], a[60:63], v[228:231]
  v_cvt_pk_bf16_f32 v67, v70, v71
  v_cvt_pk_bf16_f32 v96, v96, v97
  v_mfma_f32_16x16x32_bf16 v[228:231], a[72:75], a[56:59], v[228:231]
  s_waitcnt lgkmcnt(2)
  v_cvt_pk_bf16_f32 v97, v98, v99
  v_cvt_pk_bf16_f32 v98, v100, v101
  v_mfma_f32_16x16x32_bf16 a[88:91], a[64:67], a[0:3], a[88:91]
  s_waitcnt lgkmcnt(0)
  v_cvt_pk_bf16_f32 v99, v102, v103
  v_cvt_pk_bf16_f32 v128, v128, v129
  v_mfma_f32_16x16x32_bf16 a[88:91], a[68:71], a[4:7], a[88:91]
  ds_read_b64_tr_b16 a[72:73], v4 offset:96
  ds_read_b64_tr_b16 a[74:75], v4 offset:8544
  v_mfma_f32_16x16x32_bf16 v[40:43], a[68:71], a[12:15], v[40:43]
  ds_read_b64_tr_b16 a[76:77], v4 offset:608
  ds_read_b64_tr_b16 a[78:79], v4 offset:9056
  v_mfma_f32_16x16x32_bf16 v[40:43], a[64:67], a[8:11], v[40:43]
  v_cvt_pk_bf16_f32 v129, v130, v131
  v_cvt_pk_bf16_f32 v130, v132, v133
  v_mfma_f32_16x16x32_bf16 v[72:75], a[64:67], a[16:19], v[72:75]
  buffer_load_dwordx4 a[160:163], v1, s[60:63], s44 offen offset:0 sc1
  v_mfma_f32_16x16x32_bf16 v[72:75], a[68:71], a[20:23], v[72:75]
  v_cvt_pk_bf16_f32 v131, v134, v135
  v_cvt_pk_bf16_f32 v160, v160, v161
  v_mfma_f32_16x16x32_bf16 v[104:107], a[68:71], a[28:31], v[104:107]
  v_cvt_pk_bf16_f32 v161, v162, v163
  v_cvt_pk_bf16_f32 v162, v164, v165
  v_mfma_f32_16x16x32_bf16 v[104:107], a[64:67], a[24:27], v[104:107]
  v_cvt_pk_bf16_f32 v163, v166, v167
  v_cvt_pk_bf16_f32 v192, v192, v193
  v_mfma_f32_16x16x32_bf16 v[136:139], a[64:67], a[32:35], v[136:139]
  s_add_u32 s1, s93, 8192
  buffer_store_dwordx4 v[64:67], v1, s[8:11], s1 offen sc1
  v_mfma_f32_16x16x32_bf16 v[136:139], a[68:71], a[36:39], v[136:139]
  v_cvt_pk_bf16_f32 v193, v194, v195
  v_cvt_pk_bf16_f32 v194, v196, v197
  v_mfma_f32_16x16x32_bf16 v[168:171], a[68:71], a[44:47], v[168:171]
  v_cvt_pk_bf16_f32 v195, v198, v199
  v_cvt_pk_bf16_f32 v224, v224, v225
  v_mfma_f32_16x16x32_bf16 v[168:171], a[64:67], a[40:43], v[168:171]
  v_cvt_pk_bf16_f32 v225, v226, v227
  v_cvt_pk_bf16_f32 v226, v228, v229
  v_mfma_f32_16x16x32_bf16 v[200:203], a[64:67], a[48:51], v[200:203]
  v_cvt_pk_bf16_f32 v227, v230, v231
  v_accvgpr_read_b32 v7, a82
  v_mfma_f32_16x16x32_bf16 v[200:203], a[68:71], a[52:55], v[200:203]
  v_accvgpr_read_b32 v14, a83
  v_cvt_pk_bf16_f32 v9, v7, v14
  v_mfma_f32_16x16x32_bf16 v[232:235], a[68:71], a[60:63], v[232:235]
  buffer_load_dwordx4 a[164:167], v1, s[60:63], s44 offen offset:1024 sc1
  v_mfma_f32_16x16x32_bf16 v[232:235], a[64:67], a[56:59], v[232:235]
  s_waitcnt lgkmcnt(2)
  v_accvgpr_read_b32 v7, a84
  v_accvgpr_read_b32 v14, a85
  v_mfma_f32_16x16x32_bf16 a[92:95], a[72:75], a[0:3], a[92:95]
  s_waitcnt lgkmcnt(0)
  v_cvt_pk_bf16_f32 v10, v7, v14
  v_accvgpr_read_b32 v7, a86
  v_mfma_f32_16x16x32_bf16 a[92:95], a[76:79], a[4:7], a[92:95]
  ds_read_b64_tr_b16 a[64:65], v4 offset:128
  ds_read_b64_tr_b16 a[66:67], v4 offset:8576
  v_mfma_f32_16x16x32_bf16 v[44:47], a[76:79], a[12:15], v[44:47]
  ds_read_b64_tr_b16 a[68:69], v4 offset:640
  ds_read_b64_tr_b16 a[70:71], v4 offset:9088
  v_mfma_f32_16x16x32_bf16 v[44:47], a[72:75], a[8:11], v[44:47]
  s_add_u32 s1, s93, 16384
  buffer_store_dwordx4 v[128:131], v1, s[8:11], s1 offen sc1
  v_mfma_f32_16x16x32_bf16 v[76:79], a[72:75], a[16:19], v[76:79]
  v_accvgpr_read_b32 v14, a87
  v_cvt_pk_bf16_f32 v11, v7, v14
  v_mfma_f32_16x16x32_bf16 v[76:79], a[76:79], a[20:23], v[76:79]
  buffer_store_dwordx4 v[8:11], v1, s[8:11], s93 offen offset:0 sc1
  v_mfma_f32_16x16x32_bf16 v[108:111], a[76:79], a[28:31], v[108:111]
  s_nop 0
  v_accvgpr_read_b32 v7, a88
  v_accvgpr_read_b32 v14, a89
  v_mfma_f32_16x16x32_bf16 v[108:111], a[72:75], a[24:27], v[108:111]
  v_cvt_pk_bf16_f32 v8, v7, v14
  v_accvgpr_read_b32 v7, a90
  v_mfma_f32_16x16x32_bf16 v[140:143], a[72:75], a[32:35], v[140:143]
  buffer_load_dwordx4 a[168:171], v1, s[60:63], s45 offen offset:0 sc1
  v_mfma_f32_16x16x32_bf16 v[140:143], a[76:79], a[36:39], v[140:143]
  v_cvt_pk_bf16_f32 v40, v40, v41
  v_cvt_pk_bf16_f32 v41, v42, v43
  v_mfma_f32_16x16x32_bf16 v[172:175], a[76:79], a[44:47], v[172:175]
  v_cvt_pk_bf16_f32 v42, v44, v45
  v_cvt_pk_bf16_f32 v43, v46, v47
  v_mfma_f32_16x16x32_bf16 v[172:175], a[72:75], a[40:43], v[172:175]
  v_cvt_pk_bf16_f32 v72, v72, v73
  v_cvt_pk_bf16_f32 v73, v74, v75
  v_mfma_f32_16x16x32_bf16 v[204:207], a[72:75], a[48:51], v[204:207]
  v_cvt_pk_bf16_f32 v74, v76, v77
  v_cvt_pk_bf16_f32 v75, v78, v79
  v_mfma_f32_16x16x32_bf16 v[204:207], a[76:79], a[52:55], v[204:207]
  v_cvt_pk_bf16_f32 v104, v104, v105
  v_cvt_pk_bf16_f32 v105, v106, v107
  v_mfma_f32_16x16x32_bf16 v[236:239], a[76:79], a[60:63], v[236:239]
  s_add_u32 s1, s93, 24576
  buffer_store_dwordx4 v[192:195], v1, s[8:11], s1 offen sc1
  v_mfma_f32_16x16x32_bf16 v[236:239], a[72:75], a[56:59], v[236:239]
  s_waitcnt lgkmcnt(2)
  v_cvt_pk_bf16_f32 v106, v108, v109
  v_cvt_pk_bf16_f32 v107, v110, v111
  v_mfma_f32_16x16x32_bf16 v[16:19], a[64:67], a[0:3], v[16:19]
  s_waitcnt lgkmcnt(0)
  v_cvt_pk_bf16_f32 v136, v136, v137
  v_cvt_pk_bf16_f32 v137, v138, v139
  v_mfma_f32_16x16x32_bf16 v[16:19], a[68:71], a[4:7], v[16:19]
  ds_read_b64_tr_b16 a[72:73], v4 offset:160
  ds_read_b64_tr_b16 a[74:75], v4 offset:8608
  v_mfma_f32_16x16x32_bf16 v[48:51], a[68:71], a[12:15], v[48:51]
  buffer_load_dwordx4 a[172:175], v1, s[60:63], s45 offen offset:1024 sc1
  v_mfma_f32_16x16x32_bf16 v[48:51], a[64:67], a[8:11], v[48:51]
  ds_read_b64_tr_b16 a[76:77], v4 offset:672
  ds_read_b64_tr_b16 a[78:79], v4 offset:9120
  v_mfma_f32_16x16x32_bf16 v[80:83], a[64:67], a[16:19], v[80:83]
  v_cvt_pk_bf16_f32 v138, v140, v141
  v_cvt_pk_bf16_f32 v139, v142, v143
  v_mfma_f32_16x16x32_bf16 v[80:83], a[68:71], a[20:23], v[80:83]
  v_cvt_pk_bf16_f32 v168, v168, v169
  v_cvt_pk_bf16_f32 v169, v170, v171
  v_mfma_f32_16x16x32_bf16 v[112:115], a[68:71], a[28:31], v[112:115]
  v_cvt_pk_bf16_f32 v170, v172, v173
  v_cvt_pk_bf16_f32 v171, v174, v175
  v_mfma_f32_16x16x32_bf16 v[112:115], a[64:67], a[24:27], v[112:115]
  v_cvt_pk_bf16_f32 v200, v200, v201
  v_cvt_pk_bf16_f32 v201, v202, v203
  v_mfma_f32_16x16x32_bf16 v[144:147], a[64:67], a[32:35], v[144:147]
  v_cvt_pk_bf16_f32 v202, v204, v205
  v_cvt_pk_bf16_f32 v203, v206, v207
  v_mfma_f32_16x16x32_bf16 v[144:147], a[68:71], a[36:39], v[144:147]
  s_add_u32 s1, s93, 4096
  buffer_store_dwordx4 v[32:35], v1, s[8:11], s1 offen sc1
  v_mfma_f32_16x16x32_bf16 v[176:179], a[68:71], a[44:47], v[176:179]
  v_cvt_pk_bf16_f32 v232, v232, v233
  v_cvt_pk_bf16_f32 v233, v234, v235
  v_mfma_f32_16x16x32_bf16 v[176:179], a[64:67], a[40:43], v[176:179]
  v_cvt_pk_bf16_f32 v234, v236, v237
  v_cvt_pk_bf16_f32 v235, v238, v239
  v_mfma_f32_16x16x32_bf16 v[208:211], a[64:67], a[48:51], v[208:211]
  buffer_load_dwordx4 a[176:179], v1, s[60:63], s46 offen offset:0 sc1
  v_mfma_f32_16x16x32_bf16 v[208:211], a[68:71], a[52:55], v[208:211]
  v_accvgpr_read_b32 v14, a91
  v_cvt_pk_bf16_f32 v9, v7, v14
  v_mfma_f32_16x16x32_bf16 v[240:243], a[68:71], a[60:63], v[240:243]
  v_accvgpr_read_b32 v7, a92
  v_accvgpr_read_b32 v14, a93
  v_mfma_f32_16x16x32_bf16 v[240:243], a[64:67], a[56:59], v[240:243]
  s_waitcnt lgkmcnt(2)
  v_cvt_pk_bf16_f32 v10, v7, v14
  v_accvgpr_read_b32 v7, a94
  v_mfma_f32_16x16x32_bf16 v[20:23], a[72:75], a[0:3], v[20:23]
  s_waitcnt lgkmcnt(0)
  v_accvgpr_read_b32 v14, a95
  v_cvt_pk_bf16_f32 v11, v7, v14
  v_mfma_f32_16x16x32_bf16 v[20:23], a[76:79], a[4:7], v[20:23]
  ds_read_b64_tr_b16 a[64:65], v4 offset:192
  ds_read_b64_tr_b16 a[66:67], v4 offset:8640
  v_mfma_f32_16x16x32_bf16 v[52:55], a[76:79], a[12:15], v[52:55]
  ds_read_b64_tr_b16 a[68:69], v4 offset:704
  ds_read_b64_tr_b16 a[70:71], v4 offset:9152
  v_mfma_f32_16x16x32_bf16 v[52:55], a[72:75], a[8:11], v[52:55]
  buffer_store_dwordx4 v[8:11], v1, s[8:11], s93 offen offset:1024 sc1
  v_mfma_f32_16x16x32_bf16 v[84:87], a[72:75], a[16:19], v[84:87]
  s_nop 0
  v_add_u32 v11, 133120, v2
  v_mfma_f32_16x16x32_bf16 v[84:87], a[76:79], a[20:23], v[84:87]
  s_add_u32 s1, s93, 12288
  buffer_store_dwordx4 v[96:99], v1, s[8:11], s1 offen sc1
  v_mfma_f32_16x16x32_bf16 v[116:119], a[76:79], a[28:31], v[116:119]
  buffer_load_dwordx4 a[180:183], v1, s[60:63], s46 offen offset:1024 sc1
  v_mfma_f32_16x16x32_bf16 v[116:119], a[72:75], a[24:27], v[116:119]
  v_cvt_pk_bf16_f32 v16, v16, v17
  v_cvt_pk_bf16_f32 v17, v18, v19
  v_mfma_f32_16x16x32_bf16 v[148:151], a[72:75], a[32:35], v[148:151]
  v_cvt_pk_bf16_f32 v18, v20, v21
  v_cvt_pk_bf16_f32 v19, v22, v23
  v_mfma_f32_16x16x32_bf16 v[148:151], a[76:79], a[36:39], v[148:151]
  v_cvt_pk_bf16_f32 v48, v48, v49
  v_cvt_pk_bf16_f32 v49, v50, v51
  v_mfma_f32_16x16x32_bf16 v[180:183], a[76:79], a[44:47], v[180:183]
  v_cvt_pk_bf16_f32 v50, v52, v53
  v_cvt_pk_bf16_f32 v51, v54, v55
  v_mfma_f32_16x16x32_bf16 v[180:183], a[72:75], a[40:43], v[180:183]
  v_cvt_pk_bf16_f32 v80, v80, v81
  v_cvt_pk_bf16_f32 v81, v82, v83
  v_mfma_f32_16x16x32_bf16 v[212:215], a[72:75], a[48:51], v[212:215]
  v_cvt_pk_bf16_f32 v82, v84, v85
  v_cvt_pk_bf16_f32 v83, v86, v87
  v_mfma_f32_16x16x32_bf16 v[212:215], a[76:79], a[52:55], v[212:215]
  v_cvt_pk_bf16_f32 v112, v112, v113
  v_cvt_pk_bf16_f32 v113, v114, v115
  v_mfma_f32_16x16x32_bf16 v[244:247], a[76:79], a[60:63], v[244:247]
  v_cvt_pk_bf16_f32 v114, v116, v117
  v_cvt_pk_bf16_f32 v115, v118, v119
  v_mfma_f32_16x16x32_bf16 v[244:247], a[72:75], a[56:59], v[244:247]
  s_waitcnt lgkmcnt(2)
  s_add_u32 s1, s93, 20480
  buffer_store_dwordx4 v[160:163], v1, s[8:11], s1 offen sc1
  v_mfma_f32_16x16x32_bf16 v[24:27], a[64:67], a[0:3], v[24:27]
  s_waitcnt lgkmcnt(0)
  buffer_load_dwordx4 a[184:187], v1, s[60:63], s47 offen offset:0 sc1
  v_mfma_f32_16x16x32_bf16 v[24:27], a[68:71], a[4:7], v[24:27]
  ds_read_b64_tr_b16 a[72:73], v4 offset:224
  ds_read_b64_tr_b16 a[74:75], v4 offset:8672
  v_mfma_f32_16x16x32_bf16 v[56:59], a[68:71], a[12:15], v[56:59]
  ds_read_b64_tr_b16 a[76:77], v4 offset:736
  ds_read_b64_tr_b16 a[78:79], v4 offset:9184
  v_mfma_f32_16x16x32_bf16 v[56:59], a[64:67], a[8:11], v[56:59]
  v_cvt_pk_bf16_f32 v144, v144, v145
  v_cvt_pk_bf16_f32 v145, v146, v147
  v_mfma_f32_16x16x32_bf16 v[88:91], a[64:67], a[16:19], v[88:91]
  v_cvt_pk_bf16_f32 v146, v148, v149
  v_cvt_pk_bf16_f32 v147, v150, v151
  v_mfma_f32_16x16x32_bf16 v[88:91], a[68:71], a[20:23], v[88:91]
  v_cvt_pk_bf16_f32 v176, v176, v177
  v_cvt_pk_bf16_f32 v177, v178, v179
  v_mfma_f32_16x16x32_bf16 v[120:123], a[68:71], a[28:31], v[120:123]
  v_cvt_pk_bf16_f32 v178, v180, v181
  v_cvt_pk_bf16_f32 v179, v182, v183
  v_mfma_f32_16x16x32_bf16 v[120:123], a[64:67], a[24:27], v[120:123]
  v_cvt_pk_bf16_f32 v208, v208, v209
  v_cvt_pk_bf16_f32 v209, v210, v211
  v_mfma_f32_16x16x32_bf16 v[152:155], a[64:67], a[32:35], v[152:155]
  v_cvt_pk_bf16_f32 v210, v212, v213
  v_cvt_pk_bf16_f32 v211, v214, v215
  v_mfma_f32_16x16x32_bf16 v[152:155], a[68:71], a[36:39], v[152:155]
  v_cvt_pk_bf16_f32 v240, v240, v241
  v_cvt_pk_bf16_f32 v241, v242, v243
  v_mfma_f32_16x16x32_bf16 v[184:187], a[68:71], a[44:47], v[184:187]
  buffer_load_dwordx4 a[188:191], v1, s[60:63], s47 offen offset:1024 sc1
  v_mfma_f32_16x16x32_bf16 v[184:187], a[64:67], a[40:43], v[184:187]
  s_add_u32 s1, s93, 28672
  buffer_store_dwordx4 v[224:227], v1, s[8:11], s1 offen sc1
  v_mfma_f32_16x16x32_bf16 v[216:219], a[64:67], a[48:51], v[216:219]
  s_waitcnt vmcnt(31)
  v_cvt_pk_bf16_f32 v242, v244, v245
  v_cvt_pk_bf16_f32 v243, v246, v247
  v_mfma_f32_16x16x32_bf16 v[216:219], a[68:71], a[52:55], v[216:219]
  s_barrier
  v_mfma_f32_16x16x32_bf16 v[248:251], a[68:71], a[60:63], v[248:251]
  v_mfma_f32_16x16x32_bf16 v[248:251], a[64:67], a[56:59], v[248:251]
  s_waitcnt lgkmcnt(2)
  v_mfma_f32_16x16x32_bf16 v[28:31], a[72:75], a[0:3], v[28:31]
  s_waitcnt lgkmcnt(0)
  v_mfma_f32_16x16x32_bf16 v[28:31], a[76:79], a[4:7], v[28:31]
  v_mfma_f32_16x16x32_bf16 v[60:63], a[76:79], a[12:15], v[60:63]
  ds_read_b64_tr_b16 a[0:1], v11 offset:16896
  ds_read_b64_tr_b16 a[2:3], v11 offset:17024
  v_mfma_f32_16x16x32_bf16 v[60:63], a[72:75], a[8:11], v[60:63]
  ds_read_b64_tr_b16 a[4:5], v11 offset:17408
  ds_read_b64_tr_b16 a[6:7], v11 offset:17536
  v_mfma_f32_16x16x32_bf16 v[92:95], a[72:75], a[16:19], v[92:95]
  ds_read_b64_tr_b16 a[8:9], v11 offset:16928
  ds_read_b64_tr_b16 a[10:11], v11 offset:17056
  v_mfma_f32_16x16x32_bf16 v[92:95], a[76:79], a[20:23], v[92:95]
  ds_read_b64_tr_b16 a[12:13], v11 offset:17440
  ds_read_b64_tr_b16 a[14:15], v11 offset:17568
  v_mfma_f32_16x16x32_bf16 v[124:127], a[76:79], a[28:31], v[124:127]
  v_cvt_pk_bf16_f32 v24, v24, v25
  v_cvt_pk_bf16_f32 v25, v26, v27
  v_mfma_f32_16x16x32_bf16 v[124:127], a[72:75], a[24:27], v[124:127]
  v_cvt_pk_bf16_f32 v26, v28, v29
  v_cvt_pk_bf16_f32 v27, v30, v31
  v_mfma_f32_16x16x32_bf16 v[156:159], a[72:75], a[32:35], v[156:159]
  v_cvt_pk_bf16_f32 v56, v56, v57
  v_cvt_pk_bf16_f32 v57, v58, v59
  v_mfma_f32_16x16x32_bf16 v[156:159], a[76:79], a[36:39], v[156:159]
  v_cvt_pk_bf16_f32 v58, v60, v61
  v_cvt_pk_bf16_f32 v59, v62, v63
  v_mfma_f32_16x16x32_bf16 v[188:191], a[76:79], a[44:47], v[188:191]
  v_cvt_pk_bf16_f32 v88, v88, v89
  v_cvt_pk_bf16_f32 v89, v90, v91
  v_mfma_f32_16x16x32_bf16 v[188:191], a[72:75], a[40:43], v[188:191]
  v_cvt_pk_bf16_f32 v90, v92, v93
  v_cvt_pk_bf16_f32 v91, v94, v95
  v_mfma_f32_16x16x32_bf16 v[220:223], a[72:75], a[48:51], v[220:223]
  v_cvt_pk_bf16_f32 v120, v120, v121
  v_cvt_pk_bf16_f32 v121, v122, v123
  v_mfma_f32_16x16x32_bf16 v[220:223], a[76:79], a[52:55], v[220:223]
  v_cvt_pk_bf16_f32 v122, v124, v125
  v_cvt_pk_bf16_f32 v123, v126, v127
  v_mfma_f32_16x16x32_bf16 v[252:255], a[76:79], a[60:63], v[252:255]
  v_cvt_pk_bf16_f32 v152, v152, v153
  v_cvt_pk_bf16_f32 v153, v154, v155
  v_mfma_f32_16x16x32_bf16 v[252:255], a[72:75], a[56:59], v[252:255]
  v_cvt_pk_bf16_f32 v154, v156, v157
  v_cvt_pk_bf16_f32 v155, v158, v159
  v_cvt_pk_bf16_f32 v184, v184, v185
  v_cvt_pk_bf16_f32 v185, v186, v187
  v_cvt_pk_bf16_f32 v186, v188, v189
  v_cvt_pk_bf16_f32 v187, v190, v191
  v_cvt_pk_bf16_f32 v216, v216, v217
  v_cvt_pk_bf16_f32 v217, v218, v219
  v_cvt_pk_bf16_f32 v218, v220, v221
  v_cvt_pk_bf16_f32 v219, v222, v223
  v_cvt_pk_bf16_f32 v248, v248, v249
  v_cvt_pk_bf16_f32 v249, v250, v251
  v_cvt_pk_bf16_f32 v250, v252, v253
  v_cvt_pk_bf16_f32 v251, v254, v255
  s_branch L_p2
L_p1_vw:
  s_waitcnt lgkmcnt(11)
  v_mfma_f32_16x16x32_bf16 a[80:83], a[0:3], a[64:67], 0
  s_waitcnt lgkmcnt(10)
  ds_read_b128 a[48:51], v2 offset:12288
  ds_read_b128 a[52:55], v3 offset:12288
  v_mfma_f32_16x16x32_bf16 a[80:83], a[4:7], a[68:71], a[80:83]
  s_waitcnt lgkmcnt(10)
  ds_read_b128 a[56:59], v2 offset:14336
  ds_read_b128 a[60:63], v3 offset:14336
  v_mfma_f32_16x16x32_bf16 a[84:87], a[12:15], a[68:71], 0
  s_add_u32 m0, s35, 0
  v_mfma_f32_16x16x32_bf16 a[84:87], a[8:11], a[64:67], a[84:87]
  s_waitcnt lgkmcnt(11)
  s_add_u32 s28, s33, 0
  v_mfma_f32_16x16x32_bf16 v[64:67], a[16:19], a[64:67], 0
  s_waitcnt lgkmcnt(10)
  buffer_load_dwordx4 v6, s[16:19], s28 offen lds
  v_mfma_f32_16x16x32_bf16 v[64:67], a[20:23], a[68:71], v[64:67]
  s_waitcnt lgkmcnt(8)
  ds_read_b64_tr_b16 a[72:73], v4 offset:32
  ds_read_b64_tr_b16 a[74:75], v4 offset:8480
  v_mfma_f32_16x16x32_bf16 v[68:71], a[28:31], a[68:71], 0
  ds_read_b64_tr_b16 a[76:77], v4 offset:544
  ds_read_b64_tr_b16 a[78:79], v4 offset:8992
  v_mfma_f32_16x16x32_bf16 v[68:71], a[24:27], a[64:67], v[68:71]
  s_waitcnt lgkmcnt(11)
  s_add_u32 m0, s35, 1056
  v_mfma_f32_16x16x32_bf16 v[128:131], a[32:35], a[64:67], 0
  s_waitcnt lgkmcnt(10)
  s_add_u32 s28, s33, 8192
  v_mfma_f32_16x16x32_bf16 v[128:131], a[36:39], a[68:71], v[128:131]
  s_waitcnt lgkmcnt(8)
  buffer_load_dwordx4 v6, s[16:19], s28 offen lds
  v_mfma_f32_16x16x32_bf16 v[132:135], a[44:47], a[68:71], 0
  v_mfma_f32_16x16x32_bf16 v[132:135], a[40:43], a[64:67], v[132:135]
  s_waitcnt lgkmcnt(7)
  v_mfma_f32_16x16x32_bf16 v[192:195], a[48:51], a[64:67], 0
  s_waitcnt lgkmcnt(0)
  s_add_u32 m0, s35, 2112
  v_mfma_f32_16x16x32_bf16 v[192:195], a[52:55], a[68:71], v[192:195]
  s_barrier
  s_add_u32 s28, s33, 16384
  v_mfma_f32_16x16x32_bf16 v[196:199], a[60:63], a[68:71], 0
  buffer_load_dwordx4 v6, s[16:19], s28 offen lds
  v_mfma_f32_16x16x32_bf16 v[196:199], a[56:59], a[64:67], v[196:199]
  v_mfma_f32_16x16x32_bf16 a[88:91], a[0:3], a[72:75], 0
  v_mfma_f32_16x16x32_bf16 a[88:91], a[4:7], a[76:79], a[88:91]
  s_add_u32 m0, s35, 3168
  ds_read_b64_tr_b16 a[64:65], v4 offset:64
  ds_read_b64_tr_b16 a[66:67], v4 offset:8512
  v_mfma_f32_16x16x32_bf16 a[92:95], a[12:15], a[76:79], 0
  s_add_u32 s28, s33, 24576
  ds_read_b64_tr_b16 a[68:69], v4 offset:576
  ds_read_b64_tr_b16 a[70:71], v4 offset:9024
  v_mfma_f32_16x16x32_bf16 a[92:95], a[8:11], a[72:75], a[92:95]
  buffer_load_dwordx4 v6, s[16:19], s28 offen lds
  v_mfma_f32_16x16x32_bf16 v[72:75], a[16:19], a[72:75], 0
  v_xor_b32 v2, 0x8000, v2
  v_xor_b32 v3, 0x8000, v3
  v_mfma_f32_16x16x32_bf16 v[72:75], a[20:23], a[76:79], v[72:75]
  v_mfma_f32_16x16x32_bf16 v[76:79], a[28:31], a[76:79], 0
  s_add_u32 m0, s35, 16896
  v_mfma_f32_16x16x32_bf16 v[76:79], a[24:27], a[72:75], v[76:79]
  s_add_u32 s28, s33, 0
  v_mfma_f32_16x16x32_bf16 v[136:139], a[32:35], a[72:75], 0
  buffer_load_dwordx4 v6, s[20:23], s28 offen lds
  v_mfma_f32_16x16x32_bf16 v[136:139], a[36:39], a[76:79], v[136:139]
  v_mfma_f32_16x16x32_bf16 v[140:143], a[44:47], a[76:79], 0
  v_mfma_f32_16x16x32_bf16 v[140:143], a[40:43], a[72:75], v[140:143]
  s_add_u32 m0, s35, 17952
  v_mfma_f32_16x16x32_bf16 v[200:203], a[48:51], a[72:75], 0
  s_add_u32 s28, s33, 8192
  v_mfma_f32_16x16x32_bf16 v[200:203], a[52:55], a[76:79], v[200:203]
  buffer_load_dwordx4 v6, s[20:23], s28 offen lds
  v_mfma_f32_16x16x32_bf16 v[204:207], a[60:63], a[76:79], 0
  v_mfma_f32_16x16x32_bf16 v[204:207], a[56:59], a[72:75], v[204:207]
  s_waitcnt lgkmcnt(2)
  v_mfma_f32_16x16x32_bf16 v[16:19], a[0:3], a[64:67], 0
  s_waitcnt lgkmcnt(0)
  s_add_u32 m0, s35, 19008
  v_mfma_f32_16x16x32_bf16 v[16:19], a[4:7], a[68:71], v[16:19]
  s_add_u32 s28, s33, 16384
  ds_read_b64_tr_b16 a[72:73], v4 offset:96
  ds_read_b64_tr_b16 a[74:75], v4 offset:8544
  v_mfma_f32_16x16x32_bf16 v[20:23], a[12:15], a[68:71], 0
  buffer_load_dwordx4 v6, s[20:23], s28 offen lds
  v_mfma_f32_16x16x32_bf16 v[20:23], a[8:11], a[64:67], v[20:23]
  ds_read_b64_tr_b16 a[76:77], v4 offset:608
  ds_read_b64_tr_b16 a[78:79], v4 offset:9056
  v_mfma_f32_16x16x32_bf16 v[80:83], a[16:19], a[64:67], 0
  v_mfma_f32_16x16x32_bf16 v[80:83], a[20:23], a[68:71], v[80:83]
  s_add_u32 m0, s35, 20064
  v_mfma_f32_16x16x32_bf16 v[84:87], a[28:31], a[68:71], 0
  s_add_u32 s28, s33, 24576
  v_mfma_f32_16x16x32_bf16 v[84:87], a[24:27], a[64:67], v[84:87]
  buffer_load_dwordx4 v6, s[20:23], s28 offen lds
  v_mfma_f32_16x16x32_bf16 v[144:147], a[32:35], a[64:67], 0
  v_mfma_f32_16x16x32_bf16 v[144:147], a[36:39], a[68:71], v[144:147]
  v_mfma_f32_16x16x32_bf16 v[148:151], a[44:47], a[68:71], 0
  v_mfma_f32_16x16x32_bf16 v[148:151], a[40:43], a[64:67], v[148:151]
  s_add_u32 s33, s33, 524288
  s_add_u32 s35, s35, s36
  v_mfma_f32_16x16x32_bf16 v[208:211], a[48:51], a[64:67], 0
  s_sub_u32 s36, 0, s36
  buffer_store_dwordx4 a[96:99], v14, s[60:63], s88 offen offset:0 sc1
  v_mfma_f32_16x16x32_bf16 v[208:211], a[52:55], a[68:71], v[208:211]
  s_add_u32 m0, s34, 0
  v_mfma_f32_16x16x32_bf16 v[212:215], a[60:63], a[68:71], 0
  s_add_u32 s28, s32, 0
  v_mfma_f32_16x16x32_bf16 v[212:215], a[56:59], a[64:67], v[212:215]
  s_waitcnt lgkmcnt(2)
  buffer_load_dwordx4 v5, s[12:15], s28 offen lds
  v_mfma_f32_16x16x32_bf16 v[24:27], a[0:3], a[72:75], 0
  s_waitcnt lgkmcnt(0)
  buffer_store_dwordx4 a[100:103], v14, s[60:63], s88 offen offset:2048 sc1
  v_mfma_f32_16x16x32_bf16 v[24:27], a[4:7], a[76:79], v[24:27]
  s_add_u32 m0, s34, 1024
  ds_read_b64_tr_b16 a[64:65], v4 offset:128
  ds_read_b64_tr_b16 a[66:67], v4 offset:8576
  v_mfma_f32_16x16x32_bf16 v[28:31], a[12:15], a[76:79], 0
  s_add_u32 s28, s32, 8192
  ds_read_b64_tr_b16 a[68:69], v4 offset:640
  ds_read_b64_tr_b16 a[70:71], v4 offset:9088
  v_mfma_f32_16x16x32_bf16 v[28:31], a[8:11], a[72:75], v[28:31]
  s_add_u32 s88, s88, 4096
  buffer_store_dwordx4 a[104:107], v14, s[60:63], s88 offen offset:0 sc1
  v_mfma_f32_16x16x32_bf16 v[88:91], a[16:19], a[72:75], 0
  buffer_load_dwordx4 v5, s[12:15], s28 offen lds
  v_mfma_f32_16x16x32_bf16 v[88:91], a[20:23], a[76:79], v[88:91]
  s_add_u32 m0, s34, 2048
  buffer_store_dword a108, v11, s[8:11], s89 offen sc1
  v_mfma_f32_16x16x32_bf16 v[92:95], a[28:31], a[76:79], 0
  s_add_u32 s28, s32, 16384
  v_mfma_f32_16x16x32_bf16 v[92:95], a[24:27], a[72:75], v[92:95]
  buffer_load_dwordx4 v5, s[12:15], s28 offen lds
  v_mfma_f32_16x16x32_bf16 v[152:155], a[32:35], a[72:75], 0
  v_mfma_f32_16x16x32_bf16 v[152:155], a[36:39], a[76:79], v[152:155]
  s_add_u32 m0, s34, 3072
  v_mfma_f32_16x16x32_bf16 v[156:159], a[44:47], a[76:79], 0
  s_add_u32 s28, s32, 24576
  v_mfma_f32_16x16x32_bf16 v[156:159], a[40:43], a[72:75], v[156:159]
  buffer_load_dwordx4 v5, s[12:15], s28 offen lds
  v_mfma_f32_16x16x32_bf16 v[216:219], a[48:51], a[72:75], 0
  v_mfma_f32_16x16x32_bf16 v[216:219], a[52:55], a[76:79], v[216:219]
  s_add_u32 m0, s34, 4096
  v_mfma_f32_16x16x32_bf16 v[220:223], a[60:63], a[76:79], 0
  s_add_u32 s28, s32, 32768
  v_mfma_f32_16x16x32_bf16 v[220:223], a[56:59], a[72:75], v[220:223]
  s_waitcnt lgkmcnt(2)
  buffer_load_dwordx4 v5, s[12:15], s28 offen lds
  v_mfma_f32_16x16x32_bf16 v[32:35], a[0:3], a[64:67], 0
  s_waitcnt lgkmcnt(0)
  v_mfma_f32_16x16x32_bf16 v[32:35], a[4:7], a[68:71], v[32:35]
  s_add_u32 m0, s34, 5120
  ds_read_b64_tr_b16 a[72:73], v4 offset:160
  ds_read_b64_tr_b16 a[74:75], v4 offset:8608
  v_mfma_f32_16x16x32_bf16 v[36:39], a[12:15], a[68:71], 0
  s_add_u32 s28, s32, 40960
  ds_read_b64_tr_b16 a[76:77], v4 offset:672
  ds_read_b64_tr_b16 a[78:79], v4 offset:9120
  v_mfma_f32_16x16x32_bf16 v[36:39], a[8:11], a[64:67], v[36:39]
  buffer_load_dwordx4 v5, s[12:15], s28 offen lds
  v_mfma_f32_16x16x32_bf16 v[96:99], a[16:19], a[64:67], 0
  v_mfma_f32_16x16x32_bf16 v[96:99], a[20:23], a[68:71], v[96:99]
  s_add_u32 m0, s34, 6144
  v_mfma_f32_16x16x32_bf16 v[100:103], a[28:31], a[68:71], 0
  s_add_u32 s28, s32, 49152
  v_mfma_f32_16x16x32_bf16 v[100:103], a[24:27], a[64:67], v[100:103]
  buffer_load_dwordx4 v5, s[12:15], s28 offen lds
  v_mfma_f32_16x16x32_bf16 v[160:163], a[32:35], a[64:67], 0
  v_mfma_f32_16x16x32_bf16 v[160:163], a[36:39], a[68:71], v[160:163]
  s_add_u32 m0, s34, 7168
  v_mfma_f32_16x16x32_bf16 v[164:167], a[44:47], a[68:71], 0
  s_add_u32 s28, s32, 57344
  v_mfma_f32_16x16x32_bf16 v[164:167], a[40:43], a[64:67], v[164:167]
  buffer_load_dwordx4 v5, s[12:15], s28 offen lds
  v_mfma_f32_16x16x32_bf16 v[224:227], a[48:51], a[64:67], 0
  global_load_dword v10, v[8:9], off
  v_mfma_f32_16x16x32_bf16 v[224:227], a[52:55], a[68:71], v[224:227]
  v_mfma_f32_16x16x32_bf16 v[228:231], a[60:63], a[68:71], 0
  s_add_u32 s32, s32, 128
  s_xor_b32 s34, s34, 0x8000
  v_add_co_u32 v8, vcc, v8, v7
  v_mfma_f32_16x16x32_bf16 v[228:231], a[56:59], a[64:67], v[228:231]
  s_waitcnt lgkmcnt(2)
  v_mfma_f32_16x16x32_bf16 v[40:43], a[0:3], a[72:75], 0
  s_waitcnt lgkmcnt(0)
  v_addc_co_u32 v9, vcc, 0, v9, vcc
  v_mfma_f32_16x16x32_bf16 v[40:43], a[4:7], a[76:79], v[40:43]
  ds_read_b64_tr_b16 a[64:65], v4 offset:192
  ds_read_b64_tr_b16 a[66:67], v4 offset:8640
  v_mfma_f32_16x16x32_bf16 v[44:47], a[12:15], a[76:79], 0
  ds_read_b64_tr_b16 a[68:69], v4 offset:704
  ds_read_b64_tr_b16 a[70:71], v4 offset:9152
  v_mfma_f32_16x16x32_bf16 v[44:47], a[8:11], a[72:75], v[44:47]
  v_mfma_f32_16x16x32_bf16 v[104:107], a[16:19], a[72:75], 0
  v_mfma_f32_16x16x32_bf16 v[104:107], a[20:23], a[76:79], v[104:107]
  v_mfma_f32_16x16x32_bf16 v[108:111], a[28:31], a[76:79], 0
  v_mfma_f32_16x16x32_bf16 v[108:111], a[24:27], a[72:75], v[108:111]
  v_mfma_f32_16x16x32_bf16 v[168:171], a[32:35], a[72:75], 0
  v_mfma_f32_16x16x32_bf16 v[168:171], a[36:39], a[76:79], v[168:171]
  v_mfma_f32_16x16x32_bf16 v[172:175], a[44:47], a[76:79], 0
  v_mfma_f32_16x16x32_bf16 v[172:175], a[40:43], a[72:75], v[172:175]
  v_mfma_f32_16x16x32_bf16 v[232:235], a[48:51], a[72:75], 0
  v_mfma_f32_16x16x32_bf16 v[232:235], a[52:55], a[76:79], v[232:235]
  v_mfma_f32_16x16x32_bf16 v[236:239], a[60:63], a[76:79], 0
  v_mfma_f32_16x16x32_bf16 v[236:239], a[56:59], a[72:75], v[236:239]
  s_waitcnt lgkmcnt(2)
  v_mfma_f32_16x16x32_bf16 v[48:51], a[0:3], a[64:67], 0
  s_waitcnt lgkmcnt(0)
  v_mfma_f32_16x16x32_bf16 v[48:51], a[4:7], a[68:71], v[48:51]
  ds_read_b64_tr_b16 a[72:73], v4 offset:224
  ds_read_b64_tr_b16 a[74:75], v4 offset:8672
  v_mfma_f32_16x16x32_bf16 v[52:55], a[12:15], a[68:71], 0
  ds_read_b64_tr_b16 a[76:77], v4 offset:736
  ds_read_b64_tr_b16 a[78:79], v4 offset:9184
  v_mfma_f32_16x16x32_bf16 v[52:55], a[8:11], a[64:67], v[52:55]
  v_mfma_f32_16x16x32_bf16 v[112:115], a[16:19], a[64:67], 0
  v_mfma_f32_16x16x32_bf16 v[112:115], a[20:23], a[68:71], v[112:115]
  v_mfma_f32_16x16x32_bf16 v[116:119], a[28:31], a[68:71], 0
  v_mfma_f32_16x16x32_bf16 v[116:119], a[24:27], a[64:67], v[116:119]
  v_mfma_f32_16x16x32_bf16 v[176:179], a[32:35], a[64:67], 0
  v_mfma_f32_16x16x32_bf16 v[176:179], a[36:39], a[68:71], v[176:179]
  v_mfma_f32_16x16x32_bf16 v[180:183], a[44:47], a[68:71], 0
  v_add_u32 v4, s37, v4
  v_mfma_f32_16x16x32_bf16 v[180:183], a[40:43], a[64:67], v[180:183]
  v_mfma_f32_16x16x32_bf16 v[240:243], a[48:51], a[64:67], 0
  v_mfma_f32_16x16x32_bf16 v[240:243], a[52:55], a[68:71], v[240:243]
  v_mfma_f32_16x16x32_bf16 v[244:247], a[60:63], a[68:71], 0
  s_waitcnt vmcnt(13)
  s_waitcnt lgkmcnt(0)
  s_sub_u32 s37, 0, s37
  v_mfma_f32_16x16x32_bf16 v[244:247], a[56:59], a[64:67], v[244:247]
  s_barrier
  v_mfma_f32_16x16x32_bf16 v[56:59], a[0:3], a[72:75], 0
  v_mfma_f32_16x16x32_bf16 v[56:59], a[4:7], a[76:79], v[56:59]
  ds_read_b64_tr_b16 a[64:65], v4 offset:0
  ds_read_b64_tr_b16 a[66:67], v4 offset:8448
  v_mfma_f32_16x16x32_bf16 v[60:63], a[12:15], a[76:79], 0
  ds_read_b64_tr_b16 a[68:69], v4 offset:512
  ds_read_b64_tr_b16 a[70:71], v4 offset:8960
  v_mfma_f32_16x16x32_bf16 v[60:63], a[8:11], a[72:75], v[60:63]
  ds_read_b128 a[0:3], v2 offset:0
  ds_read_b128 a[4:7], v3 offset:0
  v_mfma_f32_16x16x32_bf16 v[120:123], a[16:19], a[72:75], 0
  ds_read_b128 a[8:11], v2 offset:2048
  ds_read_b128 a[12:15], v3 offset:2048
  v_mfma_f32_16x16x32_bf16 v[120:123], a[20:23], a[76:79], v[120:123]
  ds_read_b128 a[16:19], v2 offset:4096
  v_mfma_f32_16x16x32_bf16 v[124:127], a[28:31], a[76:79], 0
  ds_read_b128 a[20:23], v3 offset:4096
  v_mfma_f32_16x16x32_bf16 v[124:127], a[24:27], a[72:75], v[124:127]
  ds_read_b128 a[24:27], v2 offset:6144
  v_mfma_f32_16x16x32_bf16 v[184:187], a[32:35], a[72:75], 0
  ds_read_b128 a[28:31], v3 offset:6144
  v_mfma_f32_16x16x32_bf16 v[184:187], a[36:39], a[76:79], v[184:187]
  ds_read_b128 a[32:35], v2 offset:8192
  v_mfma_f32_16x16x32_bf16 v[188:191], a[44:47], a[76:79], 0
  ds_read_b128 a[36:39], v3 offset:8192
  v_mfma_f32_16x16x32_bf16 v[188:191], a[40:43], a[72:75], v[188:191]
  ds_read_b128 a[40:43], v2 offset:10240
  v_mfma_f32_16x16x32_bf16 v[248:251], a[48:51], a[72:75], 0
  s_waitcnt lgkmcnt(14)
  ds_read_b128 a[44:47], v3 offset:10240
  v_mfma_f32_16x16x32_bf16 v[248:251], a[52:55], a[76:79], v[248:251]
  v_mfma_f32_16x16x32_bf16 v[252:255], a[60:63], a[76:79], 0
  v_mfma_f32_16x16x32_bf16 v[252:255], a[56:59], a[72:75], v[252:255]
.p2align 3
L_p1_v:
  s_waitcnt lgkmcnt(11)
  v_mfma_f32_16x16x32_bf16 a[80:83], a[0:3], a[64:67], a[80:83]
  s_waitcnt lgkmcnt(10)
  ds_read_b128 a[48:51], v2 offset:12288
  ds_read_b128 a[52:55], v3 offset:12288
  v_mfma_f32_16x16x32_bf16 a[80:83], a[4:7], a[68:71], a[80:83]
  s_waitcnt lgkmcnt(10)
  ds_read_b128 a[56:59], v2 offset:14336
  ds_read_b128 a[60:63], v3 offset:14336
  v_mfma_f32_16x16x32_bf16 a[84:87], a[12:15], a[68:71], a[84:87]
  s_add_u32 m0, s35, 0
  v_mfma_f32_16x16x32_bf16 a[84:87], a[8:11], a[64:67], a[84:87]
  s_waitcnt lgkmcnt(11)
  s_add_u32 s28, s33, 0
  v_mfma_f32_16x16x32_bf16 v[64:67], a[16:19], a[64:67], v[64:67]
  s_waitcnt lgkmcnt(10)
  buffer_load_dwordx4 v6, s[16:19], s28 offen lds
  v_mfma_f32_16x16x32_bf16 v[64:67], a[20:23], a[68:71], v[64:67]
  s_waitcnt lgkmcnt(8)
  ds_read_b64_tr_b16 a[72:73], v4 offset:32
  ds_read_b64_tr_b16 a[74:75], v4 offset:8480
  v_mfma_f32_16x16x32_bf16 v[68:71], a[28:31], a[68:71], v[68:71]
  ds_read_b64_tr_b16 a[76:77], v4 offset:544
  ds_read_b64_tr_b16 a[78:79], v4 offset:8992
  v_mfma_f32_16x16x32_bf16 v[68:71], a[24:27], a[64:67], v[68:71]
  s_waitcnt lgkmcnt(11)
  s_add_u32 m0, s35, 1056
  v_mfma_f32_16x16x32_bf16 v[128:131], a[32:35], a[64:67], v[128:131]
  s_waitcnt lgkmcnt(10)
  s_add_u32 s28, s33, 8192
  v_mfma_f32_16x16x32_bf16 v[128:131], a[36:39], a[68:71], v[128:131]
  s_waitcnt lgkmcnt(8)
  buffer_load_dwordx4 v6, s[16:19], s28 offen lds
  v_mfma_f32_16x16x32_bf16 v[132:135], a[44:47], a[68:71], v[132:135]
  v_mfma_f32_16x16x32_bf16 v[132:135], a[40:43], a[64:67], v[132:135]
  s_waitcnt lgkmcnt(7)
  v_mfma_f32_16x16x32_bf16 v[192:195], a[48:51], a[64:67], v[192:195]
  s_waitcnt lgkmcnt(0)
  s_add_u32 m0, s35, 2112
  v_mfma_f32_16x16x32_bf16 v[192:195], a[52:55], a[68:71], v[192:195]
  s_barrier
  s_add_u32 s28, s33, 16384
  v_mfma_f32_16x16x32_bf16 v[196:199], a[60:63], a[68:71], v[196:199]
  buffer_load_dwordx4 v6, s[16:19], s28 offen lds
  v_mfma_f32_16x16x32_bf16 v[196:199], a[56:59], a[64:67], v[196:199]
  v_mfma_f32_16x16x32_bf16 a[88:91], a[0:3], a[72:75], a[88:91]
  v_mfma_f32_16x16x32_bf16 a[88:91], a[4:7], a[76:79], a[88:91]
  s_add_u32 m0, s35, 3168
  ds_read_b64_tr_b16 a[64:65], v4 offset:64
  ds_read_b64_tr_b16 a[66:67], v4 offset:8512
  v_mfma_f32_16x16x32_bf16 a[92:95], a[12:15], a[76:79], a[92:95]
  s_add_u32 s28, s33, 24576
  ds_read_b64_tr_b16 a[68:69], v4 offset:576
  ds_read_b64_tr_b16 a[70:71], v4 offset:9024
  v_mfma_f32_16x16x32_bf16 a[92:95], a[8:11], a[72:75], a[92:95]
  buffer_load_dwordx4 v6, s[16:19], s28 offen lds
  v_mfma_f32_16x16x32_bf16 v[72:75], a[16:19], a[72:75], v[72:75]
  v_xor_b32 v2, 0x8000, v2
  v_xor_b32 v3, 0x8000, v3
  v_mfma_f32_16x16x32_bf16 v[72:75], a[20:23], a[76:79], v[72:75]
  v_mfma_f32_16x16x32_bf16 v[76:79], a[28:31], a[76:79], v[76:79]
  s_add_u32 m0, s35, 16896
  v_mfma_f32_16x16x32_bf16 v[76:79], a[24:27], a[72:75], v[76:79]
  s_add_u32 s28, s33, 0
  v_mfma_f32_16x16x32_bf16 v[136:139], a[32:35], a[72:75], v[136:139]
  buffer_load_dwordx4 v6, s[20:23], s28 offen lds
  v_mfma_f32_16x16x32_bf16 v[136:139], a[36:39], a[76:79], v[136:139]
  v_mfma_f32_16x16x32_bf16 v[140:143], a[44:47], a[76:79], v[140:143]
  v_mfma_f32_16x16x32_bf16 v[140:143], a[40:43], a[72:75], v[140:143]
  s_add_u32 m0, s35, 17952
  v_mfma_f32_16x16x32_bf16 v[200:203], a[48:51], a[72:75], v[200:203]
  s_add_u32 s28, s33, 8192
  v_mfma_f32_16x16x32_bf16 v[200:203], a[52:55], a[76:79], v[200:203]
  buffer_load_dwordx4 v6, s[20:23], s28 offen lds
  v_mfma_f32_16x16x32_bf16 v[204:207], a[60:63], a[76:79], v[204:207]
  v_mfma_f32_16x16x32_bf16 v[204:207], a[56:59], a[72:75], v[204:207]
  s_waitcnt lgkmcnt(2)
  v_mfma_f32_16x16x32_bf16 v[16:19], a[0:3], a[64:67], v[16:19]
  s_waitcnt lgkmcnt(0)
  s_add_u32 m0, s35, 19008
  v_mfma_f32_16x16x32_bf16 v[16:19], a[4:7], a[68:71], v[16:19]
  s_add_u32 s28, s33, 16384
  ds_read_b64_tr_b16 a[72:73], v4 offset:96
  ds_read_b64_tr_b16 a[74:75], v4 offset:8544
  v_mfma_f32_16x16x32_bf16 v[20:23], a[12:15], a[68:71], v[20:23]
  buffer_load_dwordx4 v6, s[20:23], s28 offen lds
  v_mfma_f32_16x16x32_bf16 v[20:23], a[8:11], a[64:67], v[20:23]
  ds_read_b64_tr_b16 a[76:77], v4 offset:608
  ds_read_b64_tr_b16 a[78:79], v4 offset:9056
  v_mfma_f32_16x16x32_bf16 v[80:83], a[16:19], a[64:67], v[80:83]
  v_mfma_f32_16x16x32_bf16 v[80:83], a[20:23], a[68:71], v[80:83]
  s_add_u32 m0, s35, 20064
  v_mfma_f32_16x16x32_bf16 v[84:87], a[28:31], a[68:71], v[84:87]
  s_add_u32 s28, s33, 24576
  v_mfma_f32_16x16x32_bf16 v[84:87], a[24:27], a[64:67], v[84:87]
  buffer_load_dwordx4 v6, s[20:23], s28 offen lds
  v_mfma_f32_16x16x32_bf16 v[144:147], a[32:35], a[64:67], v[144:147]
  v_mfma_f32_16x16x32_bf16 v[144:147], a[36:39], a[68:71], v[144:147]
  v_mfma_f32_16x16x32_bf16 v[148:151], a[44:47], a[68:71], v[148:151]
  v_mfma_f32_16x16x32_bf16 v[148:151], a[40:43], a[64:67], v[148:151]
  s_add_u32 s33, s33, 524288
  s_add_u32 s35, s35, s36
  v_mfma_f32_16x16x32_bf16 v[208:211], a[48:51], a[64:67], v[208:211]
  s_sub_u32 s36, 0, s36
  v_mfma_f32_16x16x32_bf16 v[208:211], a[52:55], a[68:71], v[208:211]
  v_mfma_f32_16x16x32_bf16 v[212:215], a[60:63], a[68:71], v[212:215]
  v_mfma_f32_16x16x32_bf16 v[212:215], a[56:59], a[64:67], v[212:215]
  s_waitcnt lgkmcnt(2)
  v_mfma_f32_16x16x32_bf16 v[24:27], a[0:3], a[72:75], v[24:27]
  s_waitcnt lgkmcnt(0)
  v_mfma_f32_16x16x32_bf16 v[24:27], a[4:7], a[76:79], v[24:27]
  ds_read_b64_tr_b16 a[64:65], v4 offset:128
  ds_read_b64_tr_b16 a[66:67], v4 offset:8576
  v_mfma_f32_16x16x32_bf16 v[28:31], a[12:15], a[76:79], v[28:31]
  ds_read_b64_tr_b16 a[68:69], v4 offset:640
  ds_read_b64_tr_b16 a[70:71], v4 offset:9088
  v_mfma_f32_16x16x32_bf16 v[28:31], a[8:11], a[72:75], v[28:31]
  s_add_u32 m0, s34, 0
  v_mfma_f32_16x16x32_bf16 v[88:91], a[16:19], a[72:75], v[88:91]
  s_add_u32 s28, s32, 0
  v_mfma_f32_16x16x32_bf16 v[88:91], a[20:23], a[76:79], v[88:91]
  buffer_load_dwordx4 v5, s[12:15], s28 offen lds
  v_mfma_f32_16x16x32_bf16 v[92:95], a[28:31], a[76:79], v[92:95]
  v_mfma_f32_16x16x32_bf16 v[92:95], a[24:27], a[72:75], v[92:95]
  v_mfma_f32_16x16x32_bf16 v[152:155], a[32:35], a[72:75], v[152:155]
  v_mfma_f32_16x16x32_bf16 v[152:155], a[36:39], a[76:79], v[152:155]
  v_mfma_f32_16x16x32_bf16 v[156:159], a[44:47], a[76:79], v[156:159]
  s_add_u32 m0, s34, 1024
  v_mfma_f32_16x16x32_bf16 v[156:159], a[40:43], a[72:75], v[156:159]
  s_add_u32 s28, s32, 8192
  v_mfma_f32_16x16x32_bf16 v[216:219], a[48:51], a[72:75], v[216:219]
  buffer_load_dwordx4 v5, s[12:15], s28 offen lds
  v_mfma_f32_16x16x32_bf16 v[216:219], a[52:55], a[76:79], v[216:219]
  v_mfma_f32_16x16x32_bf16 v[220:223], a[60:63], a[76:79], v[220:223]
  v_mfma_f32_16x16x32_bf16 v[220:223], a[56:59], a[72:75], v[220:223]
  s_waitcnt lgkmcnt(2)
  v_mfma_f32_16x16x32_bf16 v[32:35], a[0:3], a[64:67], v[32:35]
  s_waitcnt lgkmcnt(0)
  v_mfma_f32_16x16x32_bf16 v[32:35], a[4:7], a[68:71], v[32:35]
  s_add_u32 m0, s34, 2048
  ds_read_b64_tr_b16 a[72:73], v4 offset:160
  ds_read_b64_tr_b16 a[74:75], v4 offset:8608
  v_mfma_f32_16x16x32_bf16 v[36:39], a[12:15], a[68:71], v[36:39]
  s_add_u32 s28, s32, 16384
  ds_read_b64_tr_b16 a[76:77], v4 offset:672
  ds_read_b64_tr_b16 a[78:79], v4 offset:9120
  v_mfma_f32_16x16x32_bf16 v[36:39], a[8:11], a[64:67], v[36:39]
  buffer_load_dwordx4 v5, s[12:15], s28 offen lds
  v_mfma_f32_16x16x32_bf16 v[96:99], a[16:19], a[64:67], v[96:99]
  v_mfma_f32_16x16x32_bf16 v[96:99], a[20:23], a[68:71], v[96:99]
  v_mfma_f32_16x16x32_bf16 v[100:103], a[28:31], a[68:71], v[100:103]
  v_mfma_f32_16x16x32_bf16 v[100:103], a[24:27], a[64:67], v[100:103]
  v_mfma_f32_16x16x32_bf16 v[160:163], a[32:35], a[64:67], v[160:163]
  s_add_u32 m0, s34, 3072
  v_mfma_f32_16x16x32_bf16 v[160:163], a[36:39], a[68:71], v[160:163]
  s_add_u32 s28, s32, 24576
  v_mfma_f32_16x16x32_bf16 v[164:167], a[44:47], a[68:71], v[164:167]
  buffer_load_dwordx4 v5, s[12:15], s28 offen lds
  v_mfma_f32_16x16x32_bf16 v[164:167], a[40:43], a[64:67], v[164:167]
  v_mfma_f32_16x16x32_bf16 v[224:227], a[48:51], a[64:67], v[224:227]
  global_load_dword v10, v[8:9], off
  v_mfma_f32_16x16x32_bf16 v[224:227], a[52:55], a[68:71], v[224:227]
  v_mfma_f32_16x16x32_bf16 v[228:231], a[60:63], a[68:71], v[228:231]
  v_add_co_u32 v8, vcc, v8, v7
  v_mfma_f32_16x16x32_bf16 v[228:231], a[56:59], a[64:67], v[228:231]
  s_waitcnt lgkmcnt(2)
  s_add_u32 m0, s34, 4096
  v_mfma_f32_16x16x32_bf16 v[40:43], a[0:3], a[72:75], v[40:43]
  s_waitcnt lgkmcnt(0)
  s_add_u32 s28, s32, 32768
  v_addc_co_u32 v9, vcc, 0, v9, vcc
  v_mfma_f32_16x16x32_bf16 v[40:43], a[4:7], a[76:79], v[40:43]
  buffer_load_dwordx4 v5, s[12:15], s28 offen lds
  v_mfma_f32_16x16x32_bf16 v[44:47], a[12:15], a[76:79], v[44:47]
  ds_read_b64_tr_b16 a[64:65], v4 offset:192
  ds_read_b64_tr_b16 a[66:67], v4 offset:8640
  v_mfma_f32_16x16x32_bf16 v[44:47], a[8:11], a[72:75], v[44:47]
  ds_read_b64_tr_b16 a[68:69], v4 offset:704
  ds_read_b64_tr_b16 a[70:71], v4 offset:9152
  v_mfma_f32_16x16x32_bf16 v[104:107], a[16:19], a[72:75], v[104:107]
  v_mfma_f32_16x16x32_bf16 v[104:107], a[20:23], a[76:79], v[104:107]
  v_mfma_f32_16x16x32_bf16 v[108:111], a[28:31], a[76:79], v[108:111]
  s_add_u32 m0, s34, 5120
  v_mfma_f32_16x16x32_bf16 v[108:111], a[24:27], a[72:75], v[108:111]
  s_add_u32 s28, s32, 40960
  v_mfma_f32_16x16x32_bf16 v[168:171], a[32:35], a[72:75], v[168:171]
  buffer_load_dwordx4 v5, s[12:15], s28 offen lds
  v_mfma_f32_16x16x32_bf16 v[168:171], a[36:39], a[76:79], v[168:171]
  v_mfma_f32_16x16x32_bf16 v[172:175], a[44:47], a[76:79], v[172:175]
  v_mfma_f32_16x16x32_bf16 v[172:175], a[40:43], a[72:75], v[172:175]
  v_mfma_f32_16x16x32_bf16 v[232:235], a[48:51], a[72:75], v[232:235]
  v_mfma_f32_16x16x32_bf16 v[232:235], a[52:55], a[76:79], v[232:235]
  s_add_u32 m0, s34, 6144
  v_mfma_f32_16x16x32_bf16 v[236:239], a[60:63], a[76:79], v[236:239]
  s_add_u32 s28, s32, 49152
  v_mfma_f32_16x16x32_bf16 v[236:239], a[56:59], a[72:75], v[236:239]
  s_waitcnt lgkmcnt(2)
  buffer_load_dwordx4 v5, s[12:15], s28 offen lds
  v_mfma_f32_16x16x32_bf16 v[48:51], a[0:3], a[64:67], v[48:51]
  s_waitcnt lgkmcnt(0)
  v_mfma_f32_16x16x32_bf16 v[48:51], a[4:7], a[68:71], v[48:51]
  ds_read_b64_tr_b16 a[72:73], v4 offset:224
  ds_read_b64_tr_b16 a[74:75], v4 offset:8672
  v_mfma_f32_16x16x32_bf16 v[52:55], a[12:15], a[68:71], v[52:55]
  ds_read_b64_tr_b16 a[76:77], v4 offset:736
  ds_read_b64_tr_b16 a[78:79], v4 offset:9184
  v_mfma_f32_16x16x32_bf16 v[52:55], a[8:11], a[64:67], v[52:55]
  v_mfma_f32_16x16x32_bf16 v[112:115], a[16:19], a[64:67], v[112:115]
  s_add_u32 m0, s34, 7168
  v_mfma_f32_16x16x32_bf16 v[112:115], a[20:23], a[68:71], v[112:115]
  s_add_u32 s28, s32, 57344
  v_mfma_f32_16x16x32_bf16 v[116:119], a[28:31], a[68:71], v[116:119]
  buffer_load_dwordx4 v5, s[12:15], s28 offen lds
  v_mfma_f32_16x16x32_bf16 v[116:119], a[24:27], a[64:67], v[116:119]
  v_mfma_f32_16x16x32_bf16 v[176:179], a[32:35], a[64:67], v[176:179]
  v_mfma_f32_16x16x32_bf16 v[176:179], a[36:39], a[68:71], v[176:179]
  v_mfma_f32_16x16x32_bf16 v[180:183], a[44:47], a[68:71], v[180:183]
  v_add_u32 v4, s37, v4
  v_mfma_f32_16x16x32_bf16 v[180:183], a[40:43], a[64:67], v[180:183]
  v_mfma_f32_16x16x32_bf16 v[240:243], a[48:51], a[64:67], v[240:243]
  s_add_u32 s32, s32, 128
  s_xor_b32 s34, s34, 0x8000
  v_mfma_f32_16x16x32_bf16 v[240:243], a[52:55], a[68:71], v[240:243]
  v_mfma_f32_16x16x32_bf16 v[244:247], a[60:63], a[68:71], v[244:247]
  s_waitcnt vmcnt(9)
  s_waitcnt lgkmcnt(0)
  s_sub_u32 s37, 0, s37
  v_mfma_f32_16x16x32_bf16 v[244:247], a[56:59], a[64:67], v[244:247]
  s_barrier
  v_mfma_f32_16x16x32_bf16 v[56:59], a[0:3], a[72:75], v[56:59]
  s_cmp_eq_u32 s38, s39
  s_cbranch_scc1 L_s1_v
L_s1b_v:
  v_mfma_f32_16x16x32_bf16 v[56:59], a[4:7], a[76:79], v[56:59]
  ds_read_b64_tr_b16 a[64:65], v4 offset:0
  ds_read_b64_tr_b16 a[66:67], v4 offset:8448
  v_mfma_f32_16x16x32_bf16 v[60:63], a[12:15], a[76:79], v[60:63]
  ds_read_b64_tr_b16 a[68:69], v4 offset:512
  ds_read_b64_tr_b16 a[70:71], v4 offset:8960
  v_mfma_f32_16x16x32_bf16 v[60:63], a[8:11], a[72:75], v[60:63]
  ds_read_b128 a[0:3], v2 offset:0
  ds_read_b128 a[4:7], v3 offset:0
  v_mfma_f32_16x16x32_bf16 v[120:123], a[16:19], a[72:75], v[120:123]
  ds_read_b128 a[8:11], v2 offset:2048
  ds_read_b128 a[12:15], v3 offset:2048
  v_mfma_f32_16x16x32_bf16 v[120:123], a[20:23], a[76:79], v[120:123]
  ds_read_b128 a[16:19], v2 offset:4096
  v_mfma_f32_16x16x32_bf16 v[124:127], a[28:31], a[76:79], v[124:127]
  ds_read_b128 a[20:23], v3 offset:4096
  v_mfma_f32_16x16x32_bf16 v[124:127], a[24:27], a[72:75], v[124:127]
  ds_read_b128 a[24:27], v2 offset:6144
  v_mfma_f32_16x16x32_bf16 v[184:187], a[32:35], a[72:75], v[184:187]
  ds_read_b128 a[28:31], v3 offset:6144
  v_mfma_f32_16x16x32_bf16 v[184:187], a[36:39], a[76:79], v[184:187]
  ds_read_b128 a[32:35], v2 offset:8192
  v_mfma_f32_16x16x32_bf16 v[188:191], a[44:47], a[76:79], v[188:191]
  s_add_u32 s38, s38, 1
  ds_read_b128 a[36:39], v3 offset:8192
  v_mfma_f32_16x16x32_bf16 v[188:191], a[40:43], a[72:75], v[188:191]
  ds_read_b128 a[40:43], v2 offset:10240
  v_mfma_f32_16x16x32_bf16 v[248:251], a[48:51], a[72:75], v[248:251]
  s_waitcnt lgkmcnt(14)
  ds_read_b128 a[44:47], v3 offset:10240
  v_mfma_f32_16x16x32_bf16 v[248:251], a[52:55], a[76:79], v[248:251]
  v_mfma_f32_16x16x32_bf16 v[252:255], a[60:63], a[76:79], v[252:255]
  s_cmp_lt_u32 s38, 5
  v_mfma_f32_16x16x32_bf16 v[252:255], a[56:59], a[72:75], v[252:255]
  s_cbranch_scc1 L_p1_v
  v_lshrrev_b32 v14, 2, v1
  s_waitcnt lgkmcnt(11)
  v_mfma_f32_16x16x32_bf16 a[80:83], a[0:3], a[64:67], a[80:83]
  s_waitcnt lgkmcnt(10)
  s_mov_b32 s52, s68
  buffer_load_dword v11, v14, s[24:27], 0 offen sc1
  v_mfma_f32_16x16x32_bf16 a[80:83], a[4:7], a[68:71], a[80:83]
  s_waitcnt lgkmcnt(8)
  s_and_b32 s53, s69, 0xffff
  ds_read_b128 a[48:51], v2 offset:12288
  ds_read_b128 a[52:55], v3 offset:12288
  v_mfma_f32_16x16x32_bf16 a[84:87], a[12:15], a[68:71], a[84:87]
  s_add_u32 m0, s35, 0
  ds_read_b128 a[56:59], v2 offset:14336
  ds_read_b128 a[60:63], v3 offset:14336
  v_mfma_f32_16x16x32_bf16 a[84:87], a[8:11], a[64:67], a[84:87]
  s_waitcnt lgkmcnt(11)
  s_add_u32 s28, s33, 0
  s_mov_b32 s54, 5242880
  s_mov_b32 s55, 0x20000
  v_mfma_f32_16x16x32_bf16 v[64:67], a[16:19], a[64:67], v[64:67]
  s_waitcnt lgkmcnt(10)
  s_mov_b32 s56, s78
  buffer_load_dwordx4 v6, s[16:19], s28 offen lds
  v_mfma_f32_16x16x32_bf16 v[64:67], a[20:23], a[68:71], v[64:67]
  s_waitcnt lgkmcnt(8)
  s_and_b32 s57, s79, 0xffff
  s_mov_b32 s58, 2211840
  ds_read_b64_tr_b16 a[72:73], v4 offset:32
  v_mfma_f32_16x16x32_bf16 v[68:71], a[28:31], a[68:71], v[68:71]
  s_mov_b32 s59, 0x20000
  ds_read_b64_tr_b16 a[74:75], v4 offset:8480
  ds_read_b64_tr_b16 a[76:77], v4 offset:544
  v_mfma_f32_16x16x32_bf16 v[68:71], a[24:27], a[64:67], v[68:71]
  s_waitcnt lgkmcnt(10)
  s_add_u32 m0, s35, 1056
  s_and_b32 s0, s3, 1
  ds_read_b64_tr_b16 a[78:79], v4 offset:8992
  v_mfma_f32_16x16x32_bf16 v[128:131], a[32:35], a[64:67], v[128:131]
  s_waitcnt lgkmcnt(10)
  s_add_u32 s28, s33, 8192
  s_lshl_b32 s0, s0, 1
  s_lshr_b32 s1, s3, 1
  v_mfma_f32_16x16x32_bf16 v[128:131], a[36:39], a[68:71], v[128:131]
  s_waitcnt lgkmcnt(8)
  s_lshl_b32 s1, s1, 3
  buffer_load_dwordx4 v6, s[16:19], s28 offen lds
  v_mfma_f32_16x16x32_bf16 v[132:135], a[44:47], a[68:71], v[132:135]
  s_add_u32 s0, s0, s1
  s_mul_i32 s41, s0, 3456
  s_mul_i32 s0, s6, 7
  v_mfma_f32_16x16x32_bf16 v[132:135], a[40:43], a[64:67], v[132:135]
  s_waitcnt lgkmcnt(7)
  s_add_u32 s0, s0, s7
  s_min_u32 s92, s0, 26
  s_lshl_b32 s0, s92, 7
  v_mfma_f32_16x16x32_bf16 v[192:195], a[48:51], a[64:67], v[192:195]
  s_waitcnt lgkmcnt(0)
  s_add_u32 m0, s35, 2112
  s_add_u32 s41, s41, s0
  v_mfma_f32_16x16x32_bf16 v[192:195], a[52:55], a[68:71], v[192:195]
  s_barrier
  s_add_u32 s28, s33, 16384
  s_mul_i32 s43, s3, 2112
  v_mfma_f32_16x16x32_bf16 v[196:199], a[60:63], a[68:71], v[196:199]
  s_add_u32 s43, s43, 16896
  buffer_load_dwordx4 v6, s[16:19], s28 offen lds
  v_mfma_f32_16x16x32_bf16 v[196:199], a[56:59], a[64:67], v[196:199]
  s_sub_u32 s0, 15, s5
  s_lshl_b32 s0, s0, 3
  s_add_u32 s0, s0, s3
  v_mfma_f32_16x16x32_bf16 a[88:91], a[0:3], a[72:75], a[88:91]
  s_mul_i32 s0, s0, 20480
  s_add_u32 s44, s0, 0
  s_sub_u32 s0, 15, s5
  v_mfma_f32_16x16x32_bf16 a[88:91], a[4:7], a[76:79], a[88:91]
  s_add_u32 m0, s35, 3168
  s_lshl_b32 s0, s0, 3
  s_add_u32 s0, s0, 7
  v_mfma_f32_16x16x32_bf16 a[92:95], a[12:15], a[76:79], a[92:95]
  s_add_u32 s28, s33, 24576
  s_sub_u32 s0, s0, s3
  s_mul_i32 s0, s0, 20480
  v_mfma_f32_16x16x32_bf16 a[92:95], a[8:11], a[72:75], a[92:95]
  s_add_u32 s45, s0, 0
  buffer_load_dwordx4 v6, s[16:19], s28 offen lds
  v_mfma_f32_16x16x32_bf16 v[72:75], a[16:19], a[72:75], v[72:75]
  s_mov_b32 s0, s5
  s_lshl_b32 s0, s0, 3
  ds_read_b64_tr_b16 a[64:65], v4 offset:64
  v_mfma_f32_16x16x32_bf16 v[72:75], a[20:23], a[76:79], v[72:75]
  s_add_u32 s0, s0, s3
  ds_read_b64_tr_b16 a[66:67], v4 offset:8512
  ds_read_b64_tr_b16 a[68:69], v4 offset:576
  v_mfma_f32_16x16x32_bf16 v[76:79], a[28:31], a[76:79], v[76:79]
  s_add_u32 m0, s35, 16896
  s_mul_i32 s0, s0, 20480
  ds_read_b64_tr_b16 a[70:71], v4 offset:9024
  v_mfma_f32_16x16x32_bf16 v[76:79], a[24:27], a[72:75], v[76:79]
  s_add_u32 s28, s33, 0
  s_add_u32 s46, s0, 0
  s_mov_b32 s0, s5
  v_mfma_f32_16x16x32_bf16 v[136:139], a[32:35], a[72:75], v[136:139]
  s_lshl_b32 s0, s0, 3
  buffer_load_dwordx4 v6, s[20:23], s28 offen lds
  v_mfma_f32_16x16x32_bf16 v[136:139], a[36:39], a[76:79], v[136:139]
  s_add_u32 s0, s0, 7
  s_sub_u32 s0, s0, s3
  s_mul_i32 s0, s0, 20480
  v_mfma_f32_16x16x32_bf16 v[140:143], a[44:47], a[76:79], v[140:143]
  s_add_u32 s47, s0, 0
  s_mul_i32 s1, s6, 47104
  s_add_u32 s1, s1, 38797312
  v_mfma_f32_16x16x32_bf16 v[140:143], a[40:43], a[72:75], v[140:143]
  s_add_u32 m0, s35, 17952
  s_sub_u32 s0, 15, s5
  s_lshl_b32 s0, s0, 3
  v_mfma_f32_16x16x32_bf16 v[200:203], a[48:51], a[72:75], v[200:203]
  s_add_u32 s28, s33, 8192
  s_add_u32 s0, s0, s3
  s_mul_i32 s0, s0, 188416
  v_mfma_f32_16x16x32_bf16 v[200:203], a[52:55], a[76:79], v[200:203]
  s_add_u32 s48, s0, s1
  buffer_load_dwordx4 v6, s[20:23], s28 offen lds
  v_mfma_f32_16x16x32_bf16 v[204:207], a[60:63], a[76:79], v[204:207]
  s_sub_u32 s0, 15, s5
  s_lshl_b32 s0, s0, 3
  s_add_u32 s0, s0, 7
  v_mfma_f32_16x16x32_bf16 v[204:207], a[56:59], a[72:75], v[204:207]
  s_waitcnt lgkmcnt(2)
  s_sub_u32 s0, s0, s3
  s_mul_i32 s0, s0, 188416
  s_add_u32 s49, s0, s1
  v_mfma_f32_16x16x32_bf16 v[16:19], a[0:3], a[64:67], v[16:19]
  s_waitcnt lgkmcnt(0)
  s_add_u32 m0, s35, 19008
  s_mov_b32 s0, s5
  s_lshl_b32 s0, s0, 3
  v_mfma_f32_16x16x32_bf16 v[16:19], a[4:7], a[68:71], v[16:19]
  s_add_u32 s28, s33, 16384
  s_add_u32 s0, s0, s3
  s_mul_i32 s0, s0, 188416
  v_mfma_f32_16x16x32_bf16 v[20:23], a[12:15], a[68:71], v[20:23]
  s_add_u32 s50, s0, s1
  buffer_load_dwordx4 v6, s[20:23], s28 offen lds
  v_mfma_f32_16x16x32_bf16 v[20:23], a[8:11], a[64:67], v[20:23]
  s_mov_b32 s0, s5
  ds_read_b64_tr_b16 a[72:73], v4 offset:96
  ds_read_b64_tr_b16 a[74:75], v4 offset:8544
  v_mfma_f32_16x16x32_bf16 v[80:83], a[16:19], a[64:67], v[80:83]
  s_lshl_b32 s0, s0, 3
  ds_read_b64_tr_b16 a[76:77], v4 offset:608
  ds_read_b64_tr_b16 a[78:79], v4 offset:9056
  v_mfma_f32_16x16x32_bf16 v[80:83], a[20:23], a[68:71], v[80:83]
  s_add_u32 m0, s35, 20064
  s_add_u32 s0, s0, 7
  s_sub_u32 s0, s0, s3
  v_mfma_f32_16x16x32_bf16 v[84:87], a[28:31], a[68:71], v[84:87]
  s_add_u32 s28, s33, 24576
  s_mul_i32 s0, s0, 188416
  s_add_u32 s51, s0, s1
  v_mfma_f32_16x16x32_bf16 v[84:87], a[24:27], a[64:67], v[84:87]
  s_lshl_b32 s0, s4, 4
  buffer_load_dwordx4 v6, s[20:23], s28 offen lds
  v_mfma_f32_16x16x32_bf16 v[144:147], a[32:35], a[64:67], v[144:147]
  s_lshl_b32 s1, s5, 1
  s_add_u32 s0, s0, s1
  s_and_b32 s1, s3, 1
  v_mfma_f32_16x16x32_bf16 v[144:147], a[36:39], a[68:71], v[144:147]
  s_add_u32 s0, s0, s1
  s_lshl_b32 s0, s0, 1
  s_lshr_b32 s1, s3, 1
  v_mfma_f32_16x16x32_bf16 v[148:151], a[44:47], a[68:71], v[148:151]
  s_add_u32 s0, s0, s1
  s_lshl_b32 s0, s0, 15
  s_waitcnt vmcnt(8)
  v_cmp_gt_u32 vcc, 4, v11
  v_mfma_f32_16x16x32_bf16 v[148:151], a[40:43], a[64:67], v[148:151]
  s_add_u32 s33, s33, 524288
  s_add_u32 s35, s35, s36
  s_mul_i32 s1, s4, 9216
  v_mfma_f32_16x16x32_bf16 v[208:211], a[48:51], a[64:67], v[208:211]
  s_sub_u32 s36, 0, s36
  s_add_u32 s0, s0, s1
  s_add_u32 s93, s0, 4194304
  v_mfma_f32_16x16x32_bf16 v[208:211], a[52:55], a[68:71], v[208:211]
  s_cmp_eq_u32 s6, 3
  s_cselect_b32 s1, 6, 7
  v_xor_b32 v2, 0x8000, v2
  v_mfma_f32_16x16x32_bf16 v[212:215], a[60:63], a[68:71], v[212:215]
  s_cbranch_vccnz L_sl_s1v
L_bk_s1v:
  s_cmp_lt_u32 s7, s1
  s_cselect_b32 s58, 2211840, 0
  v_mfma_f32_16x16x32_bf16 v[212:215], a[56:59], a[64:67], v[212:215]
  s_waitcnt lgkmcnt(2)
  s_add_u32 m0, s34, 0
  v_xor_b32 v3, 0x8000, v3
  v_mfma_f32_16x16x32_bf16 v[24:27], a[0:3], a[72:75], v[24:27]
  s_waitcnt lgkmcnt(0)
  s_add_u32 s28, s32, 0
  v_mfma_f32_16x16x32_bf16 v[24:27], a[4:7], a[76:79], v[24:27]
  buffer_load_dwordx4 v5, s[12:15], s28 offen lds
  v_mfma_f32_16x16x32_bf16 v[28:31], a[12:15], a[76:79], v[28:31]
  ds_read_b64_tr_b16 a[64:65], v4 offset:128
  ds_read_b64_tr_b16 a[66:67], v4 offset:8576
  v_mfma_f32_16x16x32_bf16 v[28:31], a[8:11], a[72:75], v[28:31]
  ds_read_b64_tr_b16 a[68:69], v4 offset:640
  ds_read_b64_tr_b16 a[70:71], v4 offset:9088
  v_mfma_f32_16x16x32_bf16 v[88:91], a[16:19], a[72:75], v[88:91]
  v_mfma_f32_16x16x32_bf16 v[88:91], a[20:23], a[76:79], v[88:91]
  v_mfma_f32_16x16x32_bf16 v[92:95], a[28:31], a[76:79], v[92:95]
  v_mfma_f32_16x16x32_bf16 v[92:95], a[24:27], a[72:75], v[92:95]
  s_add_u32 m0, s34, 1024
  v_mfma_f32_16x16x32_bf16 v[152:155], a[32:35], a[72:75], v[152:155]
  s_add_u32 s28, s32, 8192
  buffer_load_dwordx4 a[96:99], v1, s[60:63], s44 offen offset:0 sc1
  v_mfma_f32_16x16x32_bf16 v[152:155], a[36:39], a[76:79], v[152:155]
  buffer_load_dwordx4 v5, s[12:15], s28 offen lds
  v_mfma_f32_16x16x32_bf16 v[156:159], a[44:47], a[76:79], v[156:159]
  v_mfma_f32_16x16x32_bf16 v[156:159], a[40:43], a[72:75], v[156:159]
  v_mfma_f32_16x16x32_bf16 v[216:219], a[48:51], a[72:75], v[216:219]
  s_lshr_b32 s90, s2, 3
  s_lshl_b32 s90, s90, 2
  s_add_u32 s90, s90, s3
  v_mfma_f32_16x16x32_bf16 v[216:219], a[52:55], a[76:79], v[216:219]
  s_lshl_b32 s90, s90, 8
  buffer_load_dwordx4 a[100:103], v1, s[60:63], s44 offen offset:1024 sc1
  v_mfma_f32_16x16x32_bf16 v[220:223], a[60:63], a[76:79], v[220:223]
  v_and_b32 v7, 1, v0
  v_lshlrev_b32 v7, 7, v7
  v_mfma_f32_16x16x32_bf16 v[220:223], a[56:59], a[72:75], v[220:223]
  s_waitcnt lgkmcnt(2)
  s_add_u32 m0, s34, 2048
  v_add_u32 v7, s90, v7
  v_min_u32 v7, L_att-L_p2, v7
  v_mfma_f32_16x16x32_bf16 v[32:35], a[0:3], a[64:67], v[32:35]
  s_add_u32 s28, s32, 16384
  s_getpc_b64 s[88:89]
L_ct_v:
  v_add_u32 v7, L_p2-L_ct_v, v7
  s_waitcnt lgkmcnt(0)
  v_mfma_f32_16x16x32_bf16 v[32:35], a[4:7], a[68:71], v[32:35]
  buffer_load_dwordx4 v5, s[12:15], s28 offen lds
  v_mfma_f32_16x16x32_bf16 v[36:39], a[12:15], a[68:71], v[36:39]
  ds_read_b64_tr_b16 a[72:73], v4 offset:160
  ds_read_b64_tr_b16 a[74:75], v4 offset:8608
  v_mfma_f32_16x16x32_bf16 v[36:39], a[8:11], a[64:67], v[36:39]
  ds_read_b64_tr_b16 a[76:77], v4 offset:672
  ds_read_b64_tr_b16 a[78:79], v4 offset:9120
  v_mfma_f32_16x16x32_bf16 v[96:99], a[16:19], a[64:67], v[96:99]
  v_mfma_f32_16x16x32_bf16 v[96:99], a[20:23], a[68:71], v[96:99]
  buffer_load_dwordx4 a[104:107], v1, s[60:63], s45 offen offset:0 sc1
  v_mfma_f32_16x16x32_bf16 v[100:103], a[28:31], a[68:71], v[100:103]
  v_mfma_f32_16x16x32_bf16 v[100:103], a[24:27], a[64:67], v[100:103]
  s_add_u32 m0, s34, 3072
  v_mfma_f32_16x16x32_bf16 v[160:163], a[32:35], a[64:67], v[160:163]
  s_add_u32 s28, s32, 24576
  v_mfma_f32_16x16x32_bf16 v[160:163], a[36:39], a[68:71], v[160:163]
  buffer_load_dwordx4 v5, s[12:15], s28 offen lds
  v_mfma_f32_16x16x32_bf16 v[164:167], a[44:47], a[68:71], v[164:167]
  v_mfma_f32_16x16x32_bf16 v[164:167], a[40:43], a[64:67], v[164:167]
  v_mfma_f32_16x16x32_bf16 v[224:227], a[48:51], a[64:67], v[224:227]
  v_mfma_f32_16x16x32_bf16 v[224:227], a[52:55], a[68:71], v[224:227]
  buffer_load_dwordx4 a[108:111], v1, s[60:63], s45 offen offset:1024 sc1
  v_mfma_f32_16x16x32_bf16 v[228:231], a[60:63], a[68:71], v[228:231]
  v_mfma_f32_16x16x32_bf16 v[228:231], a[56:59], a[64:67], v[228:231]
  s_waitcnt lgkmcnt(2)
  s_add_u32 m0, s34, 4096
  v_mfma_f32_16x16x32_bf16 v[40:43], a[0:3], a[72:75], v[40:43]
  s_waitcnt lgkmcnt(0)
  s_add_u32 s28, s32, 32768
  v_mfma_f32_16x16x32_bf16 v[40:43], a[4:7], a[76:79], v[40:43]
  buffer_load_dwordx4 v5, s[12:15], s28 offen lds
  v_mfma_f32_16x16x32_bf16 v[44:47], a[12:15], a[76:79], v[44:47]
  ds_read_b64_tr_b16 a[64:65], v4 offset:192
  ds_read_b64_tr_b16 a[66:67], v4 offset:8640
  v_mfma_f32_16x16x32_bf16 v[44:47], a[8:11], a[72:75], v[44:47]
  ds_read_b64_tr_b16 a[68:69], v4 offset:704
  ds_read_b64_tr_b16 a[70:71], v4 offset:9152
  v_mfma_f32_16x16x32_bf16 v[104:107], a[16:19], a[72:75], v[104:107]
  v_mfma_f32_16x16x32_bf16 v[104:107], a[20:23], a[76:79], v[104:107]
  buffer_load_dwordx4 a[112:115], v1, s[60:63], s46 offen offset:0 sc1
  v_mfma_f32_16x16x32_bf16 v[108:111], a[28:31], a[76:79], v[108:111]
  v_mfma_f32_16x16x32_bf16 v[108:111], a[24:27], a[72:75], v[108:111]
  s_add_u32 m0, s34, 5120
  v_mfma_f32_16x16x32_bf16 v[168:171], a[32:35], a[72:75], v[168:171]
  s_add_u32 s28, s32, 40960
  v_mfma_f32_16x16x32_bf16 v[168:171], a[36:39], a[76:79], v[168:171]
  buffer_load_dwordx4 v5, s[12:15], s28 offen lds
  v_mfma_f32_16x16x32_bf16 v[172:175], a[44:47], a[76:79], v[172:175]
  v_mfma_f32_16x16x32_bf16 v[172:175], a[40:43], a[72:75], v[172:175]
  v_mfma_f32_16x16x32_bf16 v[232:235], a[48:51], a[72:75], v[232:235]
  v_mfma_f32_16x16x32_bf16 v[232:235], a[52:55], a[76:79], v[232:235]
  buffer_load_dwordx4 a[116:119], v1, s[60:63], s46 offen offset:1024 sc1
  v_mfma_f32_16x16x32_bf16 v[236:239], a[60:63], a[76:79], v[236:239]
  v_mfma_f32_16x16x32_bf16 v[236:239], a[56:59], a[72:75], v[236:239]
  s_waitcnt lgkmcnt(2)
  s_add_u32 m0, s34, 6144
  v_mfma_f32_16x16x32_bf16 v[48:51], a[0:3], a[64:67], v[48:51]
  s_waitcnt lgkmcnt(0)
  s_add_u32 s28, s32, 49152
  v_mfma_f32_16x16x32_bf16 v[48:51], a[4:7], a[68:71], v[48:51]
  buffer_load_dwordx4 v5, s[12:15], s28 offen lds
  v_mfma_f32_16x16x32_bf16 v[52:55], a[12:15], a[68:71], v[52:55]
  ds_read_b64_tr_b16 a[72:73], v4 offset:224
  ds_read_b64_tr_b16 a[74:75], v4 offset:8672
  v_mfma_f32_16x16x32_bf16 v[52:55], a[8:11], a[64:67], v[52:55]
  ds_read_b64_tr_b16 a[76:77], v4 offset:736
  ds_read_b64_tr_b16 a[78:79], v4 offset:9184
  v_mfma_f32_16x16x32_bf16 v[112:115], a[16:19], a[64:67], v[112:115]
  v_mfma_f32_16x16x32_bf16 v[112:115], a[20:23], a[68:71], v[112:115]
  buffer_load_dwordx4 a[120:123], v1, s[60:63], s47 offen offset:0 sc1
  v_mfma_f32_16x16x32_bf16 v[116:119], a[28:31], a[68:71], v[116:119]
  v_mfma_f32_16x16x32_bf16 v[116:119], a[24:27], a[64:67], v[116:119]
  s_add_u32 m0, s34, 7168
  v_mfma_f32_16x16x32_bf16 v[176:179], a[32:35], a[64:67], v[176:179]
  s_add_u32 s28, s32, 57344
  v_mfma_f32_16x16x32_bf16 v[176:179], a[36:39], a[68:71], v[176:179]
  buffer_load_dwordx4 v5, s[12:15], s28 offen lds
  v_mfma_f32_16x16x32_bf16 v[180:183], a[44:47], a[68:71], v[180:183]
  v_add_u32 v4, s37, v4
  v_mfma_f32_16x16x32_bf16 v[180:183], a[40:43], a[64:67], v[180:183]
  v_mfma_f32_16x16x32_bf16 v[240:243], a[48:51], a[64:67], v[240:243]
  v_mfma_f32_16x16x32_bf16 v[240:243], a[52:55], a[68:71], v[240:243]
  buffer_load_dwordx4 a[124:127], v1, s[60:63], s47 offen offset:1024 sc1
  v_mfma_f32_16x16x32_bf16 v[244:247], a[60:63], a[68:71], v[244:247]
  s_waitcnt vmcnt(16)
  s_waitcnt lgkmcnt(0)
  s_sub_u32 s37, 0, s37
  v_mfma_f32_16x16x32_bf16 v[244:247], a[56:59], a[64:67], v[244:247]
  s_barrier
  v_mfma_f32_16x16x32_bf16 v[56:59], a[0:3], a[72:75], v[56:59]
  global_load_dword v10, v7, s[88:89]
  v_mfma_f32_16x16x32_bf16 v[56:59], a[4:7], a[76:79], v[56:59]
  ds_read_b64_tr_b16 a[64:65], v4 offset:0
  ds_read_b64_tr_b16 a[66:67], v4 offset:8448
  v_mfma_f32_16x16x32_bf16 v[60:63], a[12:15], a[76:79], v[60:63]
  ds_read_b64_tr_b16 a[68:69], v4 offset:512
  ds_read_b64_tr_b16 a[70:71], v4 offset:8960
  v_mfma_f32_16x16x32_bf16 v[60:63], a[8:11], a[72:75], v[60:63]
  ds_read_b128 a[0:3], v2 offset:0
  ds_read_b128 a[4:7], v3 offset:0
  v_mfma_f32_16x16x32_bf16 v[120:123], a[16:19], a[72:75], v[120:123]
  ds_read_b128 a[8:11], v2 offset:2048
  ds_read_b128 a[12:15], v3 offset:2048
  v_mfma_f32_16x16x32_bf16 v[120:123], a[20:23], a[76:79], v[120:123]
  ds_read_b128 a[16:19], v2 offset:4096
  v_mfma_f32_16x16x32_bf16 v[124:127], a[28:31], a[76:79], v[124:127]
  ds_read_b128 a[20:23], v3 offset:4096
  v_mfma_f32_16x16x32_bf16 v[124:127], a[24:27], a[72:75], v[124:127]
  ds_read_b128 a[24:27], v2 offset:6144
  v_mfma_f32_16x16x32_bf16 v[184:187], a[32:35], a[72:75], v[184:187]
  ds_read_b128 a[28:31], v3 offset:6144
  v_mfma_f32_16x16x32_bf16 v[184:187], a[36:39], a[76:79], v[184:187]
  ds_read_b128 a[32:35], v2 offset:8192
  v_mfma_f32_16x16x32_bf16 v[188:191], a[44:47], a[76:79], v[188:191]
  ds_read_b128 a[36:39], v3 offset:8192
  v_mfma_f32_16x16x32_bf16 v[188:191], a[40:43], a[72:75], v[188:191]
  ds_read_b128 a[40:43], v2 offset:10240
  v_mfma_f32_16x16x32_bf16 v[248:251], a[48:51], a[72:75], v[248:251]
  s_waitcnt lgkmcnt(14)
  ds_read_b128 a[44:47], v3 offset:10240
  v_mfma_f32_16x16x32_bf16 v[248:251], a[52:55], a[76:79], v[248:251]
  v_mfma_f32_16x16x32_bf16 v[252:255], a[60:63], a[76:79], v[252:255]
  v_mfma_f32_16x16x32_bf16 v[252:255], a[56:59], a[72:75], v[252:255]
  s_waitcnt lgkmcnt(11)
  v_mfma_f32_16x16x32_bf16 a[80:83], a[0:3], a[64:67], a[80:83]
  s_waitcnt lgkmcnt(10)
  ds_read_b128 a[48:51], v2 offset:12288
  ds_read_b128 a[52:55], v3 offset:12288
  v_mfma_f32_16x16x32_bf16 a[80:83], a[4:7], a[68:71], a[80:83]
  s_waitcnt lgkmcnt(10)
  ds_read_b128 a[56:59], v2 offset:14336
  ds_read_b128 a[60:63], v3 offset:14336
  v_mfma_f32_16x16x32_bf16 a[84:87], a[12:15], a[68:71], a[84:87]
  s_add_u32 m0, s35, 0
  v_mfma_f32_16x16x32_bf16 a[84:87], a[8:11], a[64:67], a[84:87]
  s_waitcnt lgkmcnt(11)
  s_add_u32 s28, s33, 0
  v_mfma_f32_16x16x32_bf16 v[64:67], a[16:19], a[64:67], v[64:67]
  s_waitcnt lgkmcnt(10)
  buffer_load_dwordx4 v6, s[16:19], s28 offen lds
  v_mfma_f32_16x16x32_bf16 v[64:67], a[20:23], a[68:71], v[64:67]
  s_waitcnt lgkmcnt(8)
  ds_read_b64_tr_b16 a[72:73], v4 offset:32
  ds_read_b64_tr_b16 a[74:75], v4 offset:8480
  v_mfma_f32_16x16x32_bf16 v[68:71], a[28:31], a[68:71], v[68:71]
  ds_read_b64_tr_b16 a[76:77], v4 offset:544
  ds_read_b64_tr_b16 a[78:79], v4 offset:8992
  v_mfma_f32_16x16x32_bf16 v[68:71], a[24:27], a[64:67], v[68:71]
  s_waitcnt lgkmcnt(11)
  s_add_u32 m0, s35, 1056
  v_bfe_u32 v7, v0, 3, 1
  v_bfe_u32 v8, v0, 4, 2
  v_mfma_f32_16x16x32_bf16 v[128:131], a[32:35], a[64:67], v[128:131]
  s_waitcnt lgkmcnt(10)
  s_add_u32 s28, s33, 8192
  v_lshlrev_b32 v8, 2, v8
  v_add_lshl_u32 v7, v7, v8, 2
  v_mfma_f32_16x16x32_bf16 v[128:131], a[36:39], a[68:71], v[128:131]
  s_waitcnt lgkmcnt(8)
  buffer_load_dwordx4 v6, s[16:19], s28 offen lds
  v_mfma_f32_16x16x32_bf16 v[132:135], a[44:47], a[68:71], v[132:135]
  v_mul_u32_u24 v7, 0xd80, v7
  v_and_b32 v8, 7, v0
  v_mfma_f32_16x16x32_bf16 v[132:135], a[40:43], a[64:67], v[132:135]
  s_waitcnt lgkmcnt(7)
  v_lshl_add_u32 v5, v8, 4, v7
  v_mfma_f32_16x16x32_bf16 v[192:195], a[48:51], a[64:67], v[192:195]
  s_waitcnt lgkmcnt(6)
  s_add_u32 m0, s35, 2112
  v_mfma_f32_16x16x32_bf16 v[192:195], a[52:55], a[68:71], v[192:195]
  s_waitcnt lgkmcnt(4)
  s_add_u32 s28, s33, 16384
  v_mfma_f32_16x16x32_bf16 v[196:199], a[60:63], a[68:71], v[196:199]
  buffer_load_dwordx4 v6, s[16:19], s28 offen lds
  v_mfma_f32_16x16x32_bf16 v[196:199], a[56:59], a[64:67], v[196:199]
  s_waitcnt lgkmcnt(2)
  v_mfma_f32_16x16x32_bf16 a[88:91], a[0:3], a[72:75], a[88:91]
  s_waitcnt lgkmcnt(0)
  v_mfma_f32_16x16x32_bf16 a[88:91], a[4:7], a[76:79], a[88:91]
  s_add_u32 m0, s35, 3168
  ds_read_b64_tr_b16 a[64:65], v4 offset:64
  ds_read_b64_tr_b16 a[66:67], v4 offset:8512
  v_mfma_f32_16x16x32_bf16 a[92:95], a[12:15], a[76:79], a[92:95]
  s_add_u32 s28, s33, 24576
  ds_read_b64_tr_b16 a[68:69], v4 offset:576
  ds_read_b64_tr_b16 a[70:71], v4 offset:9024
  v_mfma_f32_16x16x32_bf16 a[92:95], a[8:11], a[72:75], a[92:95]
  buffer_load_dwordx4 v6, s[16:19], s28 offen lds
  v_mfma_f32_16x16x32_bf16 v[72:75], a[16:19], a[72:75], v[72:75]
  v_xor_b32 v2, 0x8000, v2
  v_xor_b32 v3, 0x8000, v3
  v_mfma_f32_16x16x32_bf16 v[72:75], a[20:23], a[76:79], v[72:75]
  v_mfma_f32_16x16x32_bf16 v[76:79], a[28:31], a[76:79], v[76:79]
  s_add_u32 m0, s35, 16896
  v_mfma_f32_16x16x32_bf16 v[76:79], a[24:27], a[72:75], v[76:79]
  s_add_u32 s28, s33, 0
  v_mfma_f32_16x16x32_bf16 v[136:139], a[32:35], a[72:75], v[136:139]
  buffer_load_dwordx4 v6, s[20:23], s28 offen lds
  v_mfma_f32_16x16x32_bf16 v[136:139], a[36:39], a[76:79], v[136:139]
  v_mfma_f32_16x16x32_bf16 v[140:143], a[44:47], a[76:79], v[140:143]
  v_mfma_f32_16x16x32_bf16 v[140:143], a[40:43], a[72:75], v[140:143]
  s_add_u32 m0, s35, 17952
  v_mfma_f32_16x16x32_bf16 v[200:203], a[48:51], a[72:75], v[200:203]
  s_add_u32 s28, s33, 8192
  v_mfma_f32_16x16x32_bf16 v[200:203], a[52:55], a[76:79], v[200:203]
  buffer_load_dwordx4 v6, s[20:23], s28 offen lds
  v_mfma_f32_16x16x32_bf16 v[204:207], a[60:63], a[76:79], v[204:207]
  v_mfma_f32_16x16x32_bf16 v[204:207], a[56:59], a[72:75], v[204:207]
  s_waitcnt lgkmcnt(2)
  v_mfma_f32_16x16x32_bf16 v[16:19], a[0:3], a[64:67], v[16:19]
  s_waitcnt lgkmcnt(0)
  s_add_u32 m0, s35, 19008
  v_mfma_f32_16x16x32_bf16 v[16:19], a[4:7], a[68:71], v[16:19]
  s_add_u32 s28, s33, 16384
  ds_read_b64_tr_b16 a[72:73], v4 offset:96
  ds_read_b64_tr_b16 a[74:75], v4 offset:8544
  v_mfma_f32_16x16x32_bf16 v[20:23], a[12:15], a[68:71], v[20:23]
  buffer_load_dwordx4 v6, s[20:23], s28 offen lds
  v_mfma_f32_16x16x32_bf16 v[20:23], a[8:11], a[64:67], v[20:23]
  ds_read_b64_tr_b16 a[76:77], v4 offset:608
  ds_read_b64_tr_b16 a[78:79], v4 offset:9056
  v_mfma_f32_16x16x32_bf16 v[80:83], a[16:19], a[64:67], v[80:83]
  v_mfma_f32_16x16x32_bf16 v[80:83], a[20:23], a[68:71], v[80:83]
  s_add_u32 m0, s35, 20064
  v_mfma_f32_16x16x32_bf16 v[84:87], a[28:31], a[68:71], v[84:87]
  s_add_u32 s28, s33, 24576
  v_mfma_f32_16x16x32_bf16 v[84:87], a[24:27], a[64:67], v[84:87]
  buffer_load_dwordx4 v6, s[20:23], s28 offen lds
  v_mfma_f32_16x16x32_bf16 v[144:147], a[32:35], a[64:67], v[144:147]
  v_mfma_f32_16x16x32_bf16 v[144:147], a[36:39], a[68:71], v[144:147]
  v_mfma_f32_16x16x32_bf16 v[148:151], a[44:47], a[68:71], v[148:151]
  v_mfma_f32_16x16x32_bf16 v[148:151], a[40:43], a[64:67], v[148:151]
  s_add_u32 s33, s33, 524288
  s_add_u32 s35, s35, s36
  v_mfma_f32_16x16x32_bf16 v[208:211], a[48:51], a[64:67], v[208:211]
  s_add_u32 m0, s42, 133120
  s_add_u32 s28, s40, 0
  s_sub_u32 s36, 0, s36
  v_mfma_f32_16x16x32_bf16 v[208:211], a[52:55], a[68:71], v[208:211]
  v_mfma_f32_16x16x32_bf16 v[212:215], a[60:63], a[68:71], v[212:215]
  buffer_load_dwordx4 v6, s[52:55], s28 offen lds
  v_mfma_f32_16x16x32_bf16 v[212:215], a[56:59], a[64:67], v[212:215]
  s_waitcnt lgkmcnt(2)
  v_mfma_f32_16x16x32_bf16 v[24:27], a[0:3], a[72:75], v[24:27]
  s_waitcnt lgkmcnt(0)
  s_add_u32 m0, s42, 134176
  s_add_u32 s28, s40, 8192
  v_mfma_f32_16x16x32_bf16 v[24:27], a[4:7], a[76:79], v[24:27]
  ds_read_b64_tr_b16 a[64:65], v4 offset:128
  ds_read_b64_tr_b16 a[66:67], v4 offset:8576
  v_mfma_f32_16x16x32_bf16 v[28:31], a[12:15], a[76:79], v[28:31]
  buffer_load_dwordx4 v6, s[52:55], s28 offen lds
  v_mfma_f32_16x16x32_bf16 v[28:31], a[8:11], a[72:75], v[28:31]
  ds_read_b64_tr_b16 a[68:69], v4 offset:640
  ds_read_b64_tr_b16 a[70:71], v4 offset:9088
  v_mfma_f32_16x16x32_bf16 v[88:91], a[16:19], a[72:75], v[88:91]
  v_mfma_f32_16x16x32_bf16 v[88:91], a[20:23], a[76:79], v[88:91]
  s_add_u32 m0, s42, 135232
  s_add_u32 s28, s40, 16384
  v_mfma_f32_16x16x32_bf16 v[92:95], a[28:31], a[76:79], v[92:95]
  v_mfma_f32_16x16x32_bf16 v[92:95], a[24:27], a[72:75], v[92:95]
  buffer_load_dwordx4 v6, s[52:55], s28 offen lds
  v_mfma_f32_16x16x32_bf16 v[152:155], a[32:35], a[72:75], v[152:155]
  v_mfma_f32_16x16x32_bf16 v[152:155], a[36:39], a[76:79], v[152:155]
  v_mfma_f32_16x16x32_bf16 v[156:159], a[44:47], a[76:79], v[156:159]
  s_add_u32 m0, s42, 136288
  s_add_u32 s28, s40, 24576
  v_mfma_f32_16x16x32_bf16 v[156:159], a[40:43], a[72:75], v[156:159]
  v_mfma_f32_16x16x32_bf16 v[216:219], a[48:51], a[72:75], v[216:219]
  buffer_load_dwordx4 v6, s[52:55], s28 offen lds
  v_mfma_f32_16x16x32_bf16 v[216:219], a[52:55], a[76:79], v[216:219]
  v_mfma_f32_16x16x32_bf16 v[220:223], a[60:63], a[76:79], v[220:223]
  s_add_u32 m0, s43, 133120
  s_add_u32 s28, s41, 0
  v_mfma_f32_16x16x32_bf16 v[220:223], a[56:59], a[72:75], v[220:223]
  s_waitcnt lgkmcnt(2)
  v_mfma_f32_16x16x32_bf16 v[32:35], a[0:3], a[64:67], v[32:35]
  s_waitcnt lgkmcnt(0)
  buffer_load_dwordx4 v5, s[56:59], s28 offen lds
  v_mfma_f32_16x16x32_bf16 v[32:35], a[4:7], a[68:71], v[32:35]
  ds_read_b64_tr_b16 a[72:73], v4 offset:160
  ds_read_b64_tr_b16 a[74:75], v4 offset:8608
  v_mfma_f32_16x16x32_bf16 v[36:39], a[12:15], a[68:71], v[36:39]
  ds_read_b64_tr_b16 a[76:77], v4 offset:672
  ds_read_b64_tr_b16 a[78:79], v4 offset:9120
  v_mfma_f32_16x16x32_bf16 v[36:39], a[8:11], a[64:67], v[36:39]
  s_add_u32 m0, s43, 134176
  s_add_u32 s28, s41, 3456
  v_mfma_f32_16x16x32_bf16 v[96:99], a[16:19], a[64:67], v[96:99]
  v_mfma_f32_16x16x32_bf16 v[96:99], a[20:23], a[68:71], v[96:99]
  buffer_load_dwordx4 v5, s[56:59], s28 offen lds
  v_mfma_f32_16x16x32_bf16 v[100:103], a[28:31], a[68:71], v[100:103]
  v_mfma_f32_16x16x32_bf16 v[100:103], a[24:27], a[64:67], v[100:103]
  v_mfma_f32_16x16x32_bf16 v[160:163], a[32:35], a[64:67], v[160:163]
  v_mfma_f32_16x16x32_bf16 v[160:163], a[36:39], a[68:71], v[160:163]
  v_mfma_f32_16x16x32_bf16 v[164:167], a[44:47], a[68:71], v[164:167]
  v_mfma_f32_16x16x32_bf16 v[164:167], a[40:43], a[64:67], v[164:167]
  v_mfma_f32_16x16x32_bf16 v[224:227], a[48:51], a[64:67], v[224:227]
  buffer_load_dwordx4 a[128:131], v1, s[60:63], s44 offen offset:2048 sc1
  v_mfma_f32_16x16x32_bf16 v[224:227], a[52:55], a[68:71], v[224:227]
  v_mfma_f32_16x16x32_bf16 v[228:231], a[60:63], a[68:71], v[228:231]
  v_mfma_f32_16x16x32_bf16 v[228:231], a[56:59], a[64:67], v[228:231]
  s_waitcnt lgkmcnt(2)
  v_mfma_f32_16x16x32_bf16 v[40:43], a[0:3], a[72:75], v[40:43]
  s_waitcnt lgkmcnt(0)
  buffer_load_dwordx4 a[132:135], v1, s[60:63], s44 offen offset:3072 sc1
  v_mfma_f32_16x16x32_bf16 v[40:43], a[4:7], a[76:79], v[40:43]
  s_add_u32 s44, s44, 4096
  ds_read_b64_tr_b16 a[64:65], v4 offset:192
  ds_read_b64_tr_b16 a[66:67], v4 offset:8640
  v_mfma_f32_16x16x32_bf16 v[44:47], a[12:15], a[76:79], v[44:47]
  ds_read_b64_tr_b16 a[68:69], v4 offset:704
  ds_read_b64_tr_b16 a[70:71], v4 offset:9152
  v_mfma_f32_16x16x32_bf16 v[44:47], a[8:11], a[72:75], v[44:47]
  v_mfma_f32_16x16x32_bf16 v[104:107], a[16:19], a[72:75], v[104:107]
  buffer_load_dwordx4 a[136:139], v1, s[60:63], s45 offen offset:2048 sc1
  v_mfma_f32_16x16x32_bf16 v[104:107], a[20:23], a[76:79], v[104:107]
  v_mfma_f32_16x16x32_bf16 v[108:111], a[28:31], a[76:79], v[108:111]
  v_mfma_f32_16x16x32_bf16 v[108:111], a[24:27], a[72:75], v[108:111]
  v_mfma_f32_16x16x32_bf16 v[168:171], a[32:35], a[72:75], v[168:171]
  buffer_load_dwordx4 a[140:143], v1, s[60:63], s45 offen offset:3072 sc1
  v_mfma_f32_16x16x32_bf16 v[168:171], a[36:39], a[76:79], v[168:171]
  s_add_u32 s45, s45, 4096
  v_mfma_f32_16x16x32_bf16 v[172:175], a[44:47], a[76:79], v[172:175]
  v_mfma_f32_16x16x32_bf16 v[172:175], a[40:43], a[72:75], v[172:175]
  v_mfma_f32_16x16x32_bf16 v[232:235], a[48:51], a[72:75], v[232:235]
  buffer_load_dwordx4 a[144:147], v1, s[60:63], s46 offen offset:2048 sc1
  v_mfma_f32_16x16x32_bf16 v[232:235], a[52:55], a[76:79], v[232:235]
  v_mfma_f32_16x16x32_bf16 v[236:239], a[60:63], a[76:79], v[236:239]
  v_mfma_f32_16x16x32_bf16 v[236:239], a[56:59], a[72:75], v[236:239]
  s_waitcnt lgkmcnt(2)
  v_mfma_f32_16x16x32_bf16 v[48:51], a[0:3], a[64:67], v[48:51]
  s_waitcnt lgkmcnt(0)
  buffer_load_dwordx4 a[148:151], v1, s[60:63], s46 offen offset:3072 sc1
  v_mfma_f32_16x16x32_bf16 v[48:51], a[4:7], a[68:71], v[48:51]
  s_add_u32 s46, s46, 4096
  ds_read_b64_tr_b16 a[72:73], v4 offset:224
  ds_read_b64_tr_b16 a[74:75], v4 offset:8672
  v_mfma_f32_16x16x32_bf16 v[52:55], a[12:15], a[68:71], v[52:55]
  ds_read_b64_tr_b16 a[76:77], v4 offset:736
  ds_read_b64_tr_b16 a[78:79], v4 offset:9184
  v_mfma_f32_16x16x32_bf16 v[52:55], a[8:11], a[64:67], v[52:55]
  v_mfma_f32_16x16x32_bf16 v[112:115], a[16:19], a[64:67], v[112:115]
  buffer_load_dwordx4 a[152:155], v1, s[60:63], s47 offen offset:2048 sc1
  v_mfma_f32_16x16x32_bf16 v[112:115], a[20:23], a[68:71], v[112:115]
  v_mfma_f32_16x16x32_bf16 v[116:119], a[28:31], a[68:71], v[116:119]
  v_mfma_f32_16x16x32_bf16 v[116:119], a[24:27], a[64:67], v[116:119]
  v_mfma_f32_16x16x32_bf16 v[176:179], a[32:35], a[64:67], v[176:179]
  buffer_load_dwordx4 a[156:159], v1, s[60:63], s47 offen offset:3072 sc1
  v_mfma_f32_16x16x32_bf16 v[176:179], a[36:39], a[68:71], v[176:179]
  s_add_u32 s47, s47, 4096
  v_mfma_f32_16x16x32_bf16 v[180:183], a[44:47], a[68:71], v[180:183]
  v_add_u32 v4, s37, v4
  v_mfma_f32_16x16x32_bf16 v[180:183], a[40:43], a[64:67], v[180:183]
  v_mfma_f32_16x16x32_bf16 v[240:243], a[48:51], a[64:67], v[240:243]
  v_mfma_f32_16x16x32_bf16 v[240:243], a[52:55], a[68:71], v[240:243]
  v_mfma_f32_16x16x32_bf16 v[244:247], a[60:63], a[68:71], v[244:247]
  s_waitcnt vmcnt(14)
  s_waitcnt lgkmcnt(0)
  s_sub_u32 s37, 0, s37
  v_mfma_f32_16x16x32_bf16 v[244:247], a[56:59], a[64:67], v[244:247]
  s_barrier
  v_mfma_f32_16x16x32_bf16 v[56:59], a[0:3], a[72:75], v[56:59]
  v_mfma_f32_16x16x32_bf16 v[56:59], a[4:7], a[76:79], v[56:59]
  ds_read_b64_tr_b16 a[64:65], v4 offset:0
  ds_read_b64_tr_b16 a[66:67], v4 offset:8448
  v_mfma_f32_16x16x32_bf16 v[60:63], a[12:15], a[76:79], v[60:63]
  ds_read_b64_tr_b16 a[68:69], v4 offset:512
  ds_read_b64_tr_b16 a[70:71], v4 offset:8960
  v_mfma_f32_16x16x32_bf16 v[60:63], a[8:11], a[72:75], v[60:63]
  ds_read_b128 a[0:3], v2 offset:0
  ds_read_b128 a[4:7], v3 offset:0
  v_mfma_f32_16x16x32_bf16 v[120:123], a[16:19], a[72:75], v[120:123]
  ds_read_b128 a[8:11], v2 offset:2048
  ds_read_b128 a[12:15], v3 offset:2048
  v_mfma_f32_16x16x32_bf16 v[120:123], a[20:23], a[76:79], v[120:123]
  ds_read_b128 a[16:19], v2 offset:4096
  v_mfma_f32_16x16x32_bf16 v[124:127], a[28:31], a[76:79], v[124:127]
  ds_read_b128 a[20:23], v3 offset:4096
  v_mfma_f32_16x16x32_bf16 v[124:127], a[24:27], a[72:75], v[124:127]
  ds_read_b128 a[24:27], v2 offset:6144
  v_mfma_f32_16x16x32_bf16 v[184:187], a[32:35], a[72:75], v[184:187]
  ds_read_b128 a[28:31], v3 offset:6144
  v_mfma_f32_16x16x32_bf16 v[184:187], a[36:39], a[76:79], v[184:187]
  ds_read_b128 a[32:35], v2 offset:8192
  v_mfma_f32_16x16x32_bf16 v[188:191], a[44:47], a[76:79], v[188:191]
  ds_read_b128 a[36:39], v3 offset:8192
  v_mfma_f32_16x16x32_bf16 v[188:191], a[40:43], a[72:75], v[188:191]
  ds_read_b128 a[40:43], v2 offset:10240
  v_mfma_f32_16x16x32_bf16 v[248:251], a[48:51], a[72:75], v[248:251]
  s_waitcnt lgkmcnt(14)
  ds_read_b128 a[44:47], v3 offset:10240
  v_mfma_f32_16x16x32_bf16 v[248:251], a[52:55], a[76:79], v[248:251]
  v_mfma_f32_16x16x32_bf16 v[252:255], a[60:63], a[76:79], v[252:255]
  v_mfma_f32_16x16x32_bf16 v[252:255], a[56:59], a[72:75], v[252:255]
  s_waitcnt lgkmcnt(11)
  v_mfma_f32_16x16x32_bf16 a[80:83], a[0:3], a[64:67], a[80:83]
  s_waitcnt lgkmcnt(10)
  ds_read_b128 a[48:51], v2 offset:12288
  ds_read_b128 a[52:55], v3 offset:12288
  v_mfma_f32_16x16x32_bf16 a[80:83], a[4:7], a[68:71], a[80:83]
  s_waitcnt lgkmcnt(10)
  ds_read_b128 a[56:59], v2 offset:14336
  ds_read_b128 a[60:63], v3 offset:14336
  v_mfma_f32_16x16x32_bf16 a[84:87], a[12:15], a[68:71], a[84:87]
  s_add_u32 m0, s42, 73984
  s_add_u32 s28, s40, 524288
  v_mfma_f32_16x16x32_bf16 a[84:87], a[8:11], a[64:67], a[84:87]
  s_waitcnt lgkmcnt(11)
  v_mfma_f32_16x16x32_bf16 v[64:67], a[16:19], a[64:67], v[64:67]
  s_waitcnt lgkmcnt(10)
  buffer_load_dwordx4 v6, s[52:55], s28 offen lds
  v_mfma_f32_16x16x32_bf16 v[64:67], a[20:23], a[68:71], v[64:67]
  s_waitcnt lgkmcnt(8)
  ds_read_b64_tr_b16 a[72:73], v4 offset:32
  ds_read_b64_tr_b16 a[74:75], v4 offset:8480
  v_mfma_f32_16x16x32_bf16 v[68:71], a[28:31], a[68:71], v[68:71]
  ds_read_b64_tr_b16 a[76:77], v4 offset:544
  ds_read_b64_tr_b16 a[78:79], v4 offset:8992
  v_mfma_f32_16x16x32_bf16 v[68:71], a[24:27], a[64:67], v[68:71]
  s_waitcnt lgkmcnt(11)
  s_add_u32 m0, s42, 75040
  s_add_u32 s28, s40, 532480
  v_mfma_f32_16x16x32_bf16 v[128:131], a[32:35], a[64:67], v[128:131]
  s_waitcnt lgkmcnt(10)
  v_subrev_u32 v2, s91, v4
  v_add_u32 v3, 73984, v2
  v_mfma_f32_16x16x32_bf16 v[128:131], a[36:39], a[68:71], v[128:131]
  s_waitcnt lgkmcnt(8)
  buffer_load_dwordx4 v6, s[52:55], s28 offen lds
  v_mfma_f32_16x16x32_bf16 v[132:135], a[44:47], a[68:71], v[132:135]
  v_accvgpr_read_b32 v7, a80
  v_accvgpr_read_b32 v14, a81
  v_mfma_f32_16x16x32_bf16 v[132:135], a[40:43], a[64:67], v[132:135]
  s_waitcnt lgkmcnt(7)
  v_cvt_pk_bf16_f32 v8, v7, v14
  v_accvgpr_read_b32 v7, a82
  v_mfma_f32_16x16x32_bf16 v[192:195], a[48:51], a[64:67], v[192:195]
  s_waitcnt lgkmcnt(6)
  s_add_u32 m0, s42, 76096
  s_add_u32 s28, s40, 540672
  v_cvt_pk_bf16_f32 v64, v64, v65
  v_mfma_f32_16x16x32_bf16 v[192:195], a[52:55], a[68:71], v[192:195]
  s_waitcnt lgkmcnt(4)
  v_cvt_pk_bf16_f32 v65, v66, v67
  v_cvt_pk_bf16_f32 v66, v68, v69
  v_mfma_f32_16x16x32_bf16 v[196:199], a[60:63], a[68:71], v[196:199]
  buffer_load_dwordx4 v6, s[52:55], s28 offen lds
  v_mfma_f32_16x16x32_bf16 v[196:199], a[56:59], a[64:67], v[196:199]
  s_waitcnt lgkmcnt(2)
  v_cvt_pk_bf16_f32 v67, v70, v71
  v_accvgpr_read_b32 v14, a83
  v_mfma_f32_16x16x32_bf16 a[88:91], a[0:3], a[72:75], a[88:91]
  s_waitcnt lgkmcnt(0)
  v_cvt_pk_bf16_f32 v128, v128, v129
  v_cvt_pk_bf16_f32 v129, v130, v131
  v_mfma_f32_16x16x32_bf16 a[88:91], a[4:7], a[76:79], a[88:91]
  s_add_u32 m0, s42, 77152
  s_add_u32 s28, s40, 548864
  ds_read_b64_tr_b16 a[64:65], v4 offset:64
  v_mfma_f32_16x16x32_bf16 a[92:95], a[12:15], a[76:79], a[92:95]
  ds_read_b64_tr_b16 a[66:67], v4 offset:8512
  ds_read_b64_tr_b16 a[68:69], v4 offset:576
  v_mfma_f32_16x16x32_bf16 a[92:95], a[8:11], a[72:75], a[92:95]
  buffer_load_dwordx4 v6, s[52:55], s28 offen lds
  v_mfma_f32_16x16x32_bf16 v[72:75], a[16:19], a[72:75], v[72:75]
  ds_read_b64_tr_b16 a[70:71], v4 offset:9024
  v_cvt_pk_bf16_f32 v130, v132, v133
  v_mfma_f32_16x16x32_bf16 v[72:75], a[20:23], a[76:79], v[72:75]
  v_cvt_pk_bf16_f32 v131, v134, v135
  v_cvt_pk_bf16_f32 v192, v192, v193
  v_mfma_f32_16x16x32_bf16 v[76:79], a[28:31], a[76:79], v[76:79]
  s_add_u32 m0, s43, 73984
  s_add_u32 s28, s41, 221184
  v_cvt_pk_bf16_f32 v193, v194, v195
  v_mfma_f32_16x16x32_bf16 v[76:79], a[24:27], a[72:75], v[76:79]
  v_cvt_pk_bf16_f32 v194, v196, v197
  v_cvt_pk_bf16_f32 v195, v198, v199
  v_mfma_f32_16x16x32_bf16 v[136:139], a[32:35], a[72:75], v[136:139]
  buffer_load_dwordx4 v5, s[56:59], s28 offen lds
  v_mfma_f32_16x16x32_bf16 v[136:139], a[36:39], a[76:79], v[136:139]
  v_cvt_pk_bf16_f32 v9, v7, v14
  v_accvgpr_read_b32 v7, a84
  v_mfma_f32_16x16x32_bf16 v[140:143], a[44:47], a[76:79], v[140:143]
  v_accvgpr_read_b32 v14, a85
  v_cvt_pk_bf16_f32 v10, v7, v14
  v_mfma_f32_16x16x32_bf16 v[140:143], a[40:43], a[72:75], v[140:143]
  s_add_u32 m0, s43, 75040
  s_add_u32 s28, s41, 224640
  v_accvgpr_read_b32 v7, a86
  v_mfma_f32_16x16x32_bf16 v[200:203], a[48:51], a[72:75], v[200:203]
  v_cvt_pk_bf16_f32 v72, v72, v73
  v_cvt_pk_bf16_f32 v73, v74, v75
  v_mfma_f32_16x16x32_bf16 v[200:203], a[52:55], a[76:79], v[200:203]
  buffer_load_dwordx4 v5, s[56:59], s28 offen lds
  v_mfma_f32_16x16x32_bf16 v[204:207], a[60:63], a[76:79], v[204:207]
  v_cvt_pk_bf16_f32 v74, v76, v77
  v_cvt_pk_bf16_f32 v75, v78, v79
  v_mfma_f32_16x16x32_bf16 v[204:207], a[56:59], a[72:75], v[204:207]
  s_waitcnt lgkmcnt(2)
  v_accvgpr_read_b32 v14, a87
  v_cvt_pk_bf16_f32 v11, v7, v14
  v_mfma_f32_16x16x32_bf16 v[16:19], a[0:3], a[64:67], v[16:19]
  s_waitcnt lgkmcnt(0)
  buffer_store_dwordx4 v[8:11], v1, s[8:11], s93 offen offset:0 sc1
  v_mfma_f32_16x16x32_bf16 v[16:19], a[4:7], a[68:71], v[16:19]
  s_nop 0
  ds_read_b64_tr_b16 a[72:73], v4 offset:96
  ds_read_b64_tr_b16 a[74:75], v4 offset:8544
  v_mfma_f32_16x16x32_bf16 v[20:23], a[12:15], a[68:71], v[20:23]
  ds_read_b64_tr_b16 a[76:77], v4 offset:608
  ds_read_b64_tr_b16 a[78:79], v4 offset:9056
  v_mfma_f32_16x16x32_bf16 v[20:23], a[8:11], a[64:67], v[20:23]
  v_cvt_pk_bf16_f32 v136, v136, v137
  v_cvt_pk_bf16_f32 v137, v138, v139
  v_mfma_f32_16x16x32_bf16 v[80:83], a[16:19], a[64:67], v[80:83]
  buffer_load_dwordx4 a[160:163], v1, s[60:63], s44 offen offset:0 sc1
  v_mfma_f32_16x16x32_bf16 v[80:83], a[20:23], a[68:71], v[80:83]
  v_cvt_pk_bf16_f32 v138, v140, v141
  v_cvt_pk_bf16_f32 v139, v142, v143
  v_mfma_f32_16x16x32_bf16 v[84:87], a[28:31], a[68:71], v[84:87]
  v_cvt_pk_bf16_f32 v200, v200, v201
  v_cvt_pk_bf16_f32 v201, v202, v203
  v_mfma_f32_16x16x32_bf16 v[84:87], a[24:27], a[64:67], v[84:87]
  v_cvt_pk_bf16_f32 v202, v204, v205
  v_cvt_pk_bf16_f32 v203, v206, v207
  v_mfma_f32_16x16x32_bf16 v[144:147], a[32:35], a[64:67], v[144:147]
  s_add_u32 s1, s93, 8192
  buffer_store_dwordx4 v[64:67], v1, s[8:11], s1 offen sc1
  v_mfma_f32_16x16x32_bf16 v[144:147], a[36:39], a[68:71], v[144:147]
  v_cvt_pk_bf16_f32 v16, v16, v17
  v_cvt_pk_bf16_f32 v17, v18, v19
  v_mfma_f32_16x16x32_bf16 v[148:151], a[44:47], a[68:71], v[148:151]
  v_cvt_pk_bf16_f32 v18, v20, v21
  v_cvt_pk_bf16_f32 v19, v22, v23
  v_mfma_f32_16x16x32_bf16 v[148:151], a[40:43], a[64:67], v[148:151]
  v_accvgpr_read_b32 v7, a88
  v_accvgpr_read_b32 v14, a89
  v_mfma_f32_16x16x32_bf16 v[208:211], a[48:51], a[64:67], v[208:211]
  v_cvt_pk_bf16_f32 v80, v80, v81
  v_cvt_pk_bf16_f32 v81, v82, v83
  v_mfma_f32_16x16x32_bf16 v[208:211], a[52:55], a[68:71], v[208:211]
  v_cvt_pk_bf16_f32 v82, v84, v85
  v_cvt_pk_bf16_f32 v83, v86, v87
  v_mfma_f32_16x16x32_bf16 v[212:215], a[60:63], a[68:71], v[212:215]
  buffer_load_dwordx4 a[164:167], v1, s[60:63], s44 offen offset:1024 sc1
  v_mfma_f32_16x16x32_bf16 v[212:215], a[56:59], a[64:67], v[212:215]
  s_waitcnt lgkmcnt(2)
  v_cvt_pk_bf16_f32 v8, v7, v14
  v_accvgpr_read_b32 v7, a90
  v_mfma_f32_16x16x32_bf16 v[24:27], a[0:3], a[72:75], v[24:27]
  s_waitcnt lgkmcnt(0)
  v_cvt_pk_bf16_f32 v144, v144, v145
  v_cvt_pk_bf16_f32 v145, v146, v147
  v_mfma_f32_16x16x32_bf16 v[24:27], a[4:7], a[76:79], v[24:27]
  ds_read_b64_tr_b16 a[64:65], v4 offset:128
  ds_read_b64_tr_b16 a[66:67], v4 offset:8576
  v_mfma_f32_16x16x32_bf16 v[28:31], a[12:15], a[76:79], v[28:31]
  ds_read_b64_tr_b16 a[68:69], v4 offset:640
  ds_read_b64_tr_b16 a[70:71], v4 offset:9088
  v_mfma_f32_16x16x32_bf16 v[28:31], a[8:11], a[72:75], v[28:31]
  s_add_u32 s1, s93, 16384
  buffer_store_dwordx4 v[128:131], v1, s[8:11], s1 offen sc1
  v_mfma_f32_16x16x32_bf16 v[88:91], a[16:19], a[72:75], v[88:91]
  v_cvt_pk_bf16_f32 v146, v148, v149
  v_cvt_pk_bf16_f32 v147, v150, v151
  v_mfma_f32_16x16x32_bf16 v[88:91], a[20:23], a[76:79], v[88:91]
  v_cvt_pk_bf16_f32 v208, v208, v209
  v_cvt_pk_bf16_f32 v209, v210, v211
  v_mfma_f32_16x16x32_bf16 v[92:95], a[28:31], a[76:79], v[92:95]
  v_cvt_pk_bf16_f32 v210, v212, v213
  v_cvt_pk_bf16_f32 v211, v214, v215
  v_mfma_f32_16x16x32_bf16 v[92:95], a[24:27], a[72:75], v[92:95]
  v_accvgpr_read_b32 v14, a91
  v_cvt_pk_bf16_f32 v9, v7, v14
  v_mfma_f32_16x16x32_bf16 v[152:155], a[32:35], a[72:75], v[152:155]
  buffer_load_dwordx4 a[168:171], v1, s[60:63], s45 offen offset:0 sc1
  v_mfma_f32_16x16x32_bf16 v[152:155], a[36:39], a[76:79], v[152:155]
  v_cvt_pk_bf16_f32 v24, v24, v25
  v_cvt_pk_bf16_f32 v25, v26, v27
  v_mfma_f32_16x16x32_bf16 v[156:159], a[44:47], a[76:79], v[156:159]
  v_cvt_pk_bf16_f32 v26, v28, v29
  v_cvt_pk_bf16_f32 v27, v30, v31
  v_mfma_f32_16x16x32_bf16 v[156:159], a[40:43], a[72:75], v[156:159]
  v_accvgpr_read_b32 v7, a92
  v_accvgpr_read_b32 v14, a93
  v_mfma_f32_16x16x32_bf16 v[216:219], a[48:51], a[72:75], v[216:219]
  v_cvt_pk_bf16_f32 v88, v88, v89
  v_cvt_pk_bf16_f32 v89, v90, v91
  v_mfma_f32_16x16x32_bf16 v[216:219], a[52:55], a[76:79], v[216:219]
  v_cvt_pk_bf16_f32 v90, v92, v93
  v_cvt_pk_bf16_f32 v91, v94, v95
  v_mfma_f32_16x16x32_bf16 v[220:223], a[60:63], a[76:79], v[220:223]
  s_add_u32 s1, s93, 24576
  buffer_store_dwordx4 v[192:195], v1, s[8:11], s1 offen sc1
  v_mfma_f32_16x16x32_bf16 v[220:223], a[56:59], a[72:75], v[220:223]
  s_waitcnt lgkmcnt(2)
  v_cvt_pk_bf16_f32 v10, v7, v14
  v_accvgpr_read_b32 v7, a94
  v_mfma_f32_16x16x32_bf16 v[32:35], a[0:3], a[64:67], v[32:35]
  s_waitcnt lgkmcnt(0)
  v_cvt_pk_bf16_f32 v152, v152, v153
  v_cvt_pk_bf16_f32 v153, v154, v155
  v_mfma_f32_16x16x32_bf16 v[32:35], a[4:7], a[68:71], v[32:35]
  ds_read_b64_tr_b16 a[72:73], v4 offset:160
  ds_read_b64_tr_b16 a[74:75], v4 offset:8608
  v_mfma_f32_16x16x32_bf16 v[36:39], a[12:15], a[68:71], v[36:39]
  buffer_load_dwordx4 a[172:175], v1, s[60:63], s45 offen offset:1024 sc1
  v_mfma_f32_16x16x32_bf16 v[36:39], a[8:11], a[64:67], v[36:39]
  ds_read_b64_tr_b16 a[76:77], v4 offset:672
  ds_read_b64_tr_b16 a[78:79], v4 offset:9120
  v_mfma_f32_16x16x32_bf16 v[96:99], a[16:19], a[64:67], v[96:99]
  v_cvt_pk_bf16_f32 v154, v156, v157
  v_cvt_pk_bf16_f32 v155, v158, v159
  v_mfma_f32_16x16x32_bf16 v[96:99], a[20:23], a[68:71], v[96:99]
  v_cvt_pk_bf16_f32 v216, v216, v217
  v_cvt_pk_bf16_f32 v217, v218, v219
  v_mfma_f32_16x16x32_bf16 v[100:103], a[28:31], a[68:71], v[100:103]
  v_cvt_pk_bf16_f32 v218, v220, v221
  v_cvt_pk_bf16_f32 v219, v222, v223
  v_mfma_f32_16x16x32_bf16 v[100:103], a[24:27], a[64:67], v[100:103]
  v_accvgpr_read_b32 v14, a95
  v_cvt_pk_bf16_f32 v11, v7, v14
  v_mfma_f32_16x16x32_bf16 v[160:163], a[32:35], a[64:67], v[160:163]
  buffer_store_dwordx4 v[8:11], v1, s[8:11], s93 offen offset:1024 sc1
  v_mfma_f32_16x16x32_bf16 v[160:163], a[36:39], a[68:71], v[160:163]
  s_nop 0
  v_cvt_pk_bf16_f32 v32, v32, v33
  v_cvt_pk_bf16_f32 v33, v34, v35
  v_mfma_f32_16x16x32_bf16 v[164:167], a[44:47], a[68:71], v[164:167]
  v_cvt_pk_bf16_f32 v34, v36, v37
  v_cvt_pk_bf16_f32 v35, v38, v39
  v_mfma_f32_16x16x32_bf16 v[164:167], a[40:43], a[64:67], v[164:167]
  s_add_u32 s1, s93, 4096
  buffer_store_dwordx4 v[32:35], v1, s[8:11], s1 offen sc1
  v_mfma_f32_16x16x32_bf16 v[224:227], a[48:51], a[64:67], v[224:227]
  buffer_load_dwordx4 a[176:179], v1, s[60:63], s46 offen offset:0 sc1
  v_mfma_f32_16x16x32_bf16 v[224:227], a[52:55], a[68:71], v[224:227]
  v_cvt_pk_bf16_f32 v96, v96, v97
  v_cvt_pk_bf16_f32 v97, v98, v99
  v_mfma_f32_16x16x32_bf16 v[228:231], a[60:63], a[68:71], v[228:231]
  v_cvt_pk_bf16_f32 v98, v100, v101
  v_cvt_pk_bf16_f32 v99, v102, v103
  v_mfma_f32_16x16x32_bf16 v[228:231], a[56:59], a[64:67], v[228:231]
  s_waitcnt lgkmcnt(2)
  v_add_u32 v11, 133120, v2
  v_mfma_f32_16x16x32_bf16 v[40:43], a[0:3], a[72:75], v[40:43]
  s_waitcnt lgkmcnt(0)
  v_cvt_pk_bf16_f32 v160, v160, v161
  v_cvt_pk_bf16_f32 v161, v162, v163
  v_mfma_f32_16x16x32_bf16 v[40:43], a[4:7], a[76:79], v[40:43]
  ds_read_b64_tr_b16 a[64:65], v4 offset:192
  ds_read_b64_tr_b16 a[66:67], v4 offset:8640
  v_mfma_f32_16x16x32_bf16 v[44:47], a[12:15], a[76:79], v[44:47]
  ds_read_b64_tr_b16 a[68:69], v4 offset:704
  ds_read_b64_tr_b16 a[70:71], v4 offset:9152
  v_mfma_f32_16x16x32_bf16 v[44:47], a[8:11], a[72:75], v[44:47]
  v_cvt_pk_bf16_f32 v162, v164, v165
  v_cvt_pk_bf16_f32 v163, v166, v167
  v_mfma_f32_16x16x32_bf16 v[104:107], a[16:19], a[72:75], v[104:107]
  s_add_u32 s1, s93, 12288
  buffer_store_dwordx4 v[96:99], v1, s[8:11], s1 offen sc1
  v_mfma_f32_16x16x32_bf16 v[104:107], a[20:23], a[76:79], v[104:107]
  v_cvt_pk_bf16_f32 v224, v224, v225
  v_cvt_pk_bf16_f32 v225, v226, v227
  v_mfma_f32_16x16x32_bf16 v[108:111], a[28:31], a[76:79], v[108:111]
  buffer_load_dwordx4 a[180:183], v1, s[60:63], s46 offen offset:1024 sc1
  v_mfma_f32_16x16x32_bf16 v[108:111], a[24:27], a[72:75], v[108:111]
  v_cvt_pk_bf16_f32 v226, v228, v229
  v_cvt_pk_bf16_f32 v227, v230, v231
  v_mfma_f32_16x16x32_bf16 v[168:171], a[32:35], a[72:75], v[168:171]
  v_cvt_pk_bf16_f32 v40, v40, v41
  v_cvt_pk_bf16_f32 v41, v42, v43
  v_mfma_f32_16x16x32_bf16 v[168:171], a[36:39], a[76:79], v[168:171]
  v_cvt_pk_bf16_f32 v42, v44, v45
  v_cvt_pk_bf16_f32 v43, v46, v47
  v_mfma_f32_16x16x32_bf16 v[172:175], a[44:47], a[76:79], v[172:175]
  v_mfma_f32_16x16x32_bf16 v[172:175], a[40:43], a[72:75], v[172:175]
  v_mfma_f32_16x16x32_bf16 v[232:235], a[48:51], a[72:75], v[232:235]
  v_cvt_pk_bf16_f32 v104, v104, v105
  v_cvt_pk_bf16_f32 v105, v106, v107
  v_mfma_f32_16x16x32_bf16 v[232:235], a[52:55], a[76:79], v[232:235]
  v_cvt_pk_bf16_f32 v106, v108, v109
  v_cvt_pk_bf16_f32 v107, v110, v111
  v_mfma_f32_16x16x32_bf16 v[236:239], a[60:63], a[76:79], v[236:239]
  v_mfma_f32_16x16x32_bf16 v[236:239], a[56:59], a[72:75], v[236:239]
  s_waitcnt lgkmcnt(2)
  s_add_u32 s1, s93, 20480
  buffer_store_dwordx4 v[160:163], v1, s[8:11], s1 offen sc1
  v_mfma_f32_16x16x32_bf16 v[48:51], a[0:3], a[64:67], v[48:51]
  s_waitcnt lgkmcnt(0)
  buffer_load_dwordx4 a[184:187], v1, s[60:63], s47 offen offset:0 sc1
  v_mfma_f32_16x16x32_bf16 v[48:51], a[4:7], a[68:71], v[48:51]
  ds_read_b64_tr_b16 a[72:73], v4 offset:224
  ds_read_b64_tr_b16 a[74:75], v4 offset:8672
  v_mfma_f32_16x16x32_bf16 v[52:55], a[12:15], a[68:71], v[52:55]
  ds_read_b64_tr_b16 a[76:77], v4 offset:736
  ds_read_b64_tr_b16 a[78:79], v4 offset:9184
  v_mfma_f32_16x16x32_bf16 v[52:55], a[8:11], a[64:67], v[52:55]
  v_cvt_pk_bf16_f32 v168, v168, v169
  v_cvt_pk_bf16_f32 v169, v170, v171
  v_mfma_f32_16x16x32_bf16 v[112:115], a[16:19], a[64:67], v[112:115]
  v_cvt_pk_bf16_f32 v170, v172, v173
  v_cvt_pk_bf16_f32 v171, v174, v175
  v_mfma_f32_16x16x32_bf16 v[112:115], a[20:23], a[68:71], v[112:115]
  v_cvt_pk_bf16_f32 v232, v232, v233
  v_cvt_pk_bf16_f32 v233, v234, v235
  v_mfma_f32_16x16x32_bf16 v[116:119], a[28:31], a[68:71], v[116:119]
  v_cvt_pk_bf16_f32 v234, v236, v237
  v_cvt_pk_bf16_f32 v235, v238, v239
  v_mfma_f32_16x16x32_bf16 v[116:119], a[24:27], a[64:67], v[116:119]
  v_mfma_f32_16x16x32_bf16 v[176:179], a[32:35], a[64:67], v[176:179]
  v_cvt_pk_bf16_f32 v48, v48, v49
  v_cvt_pk_bf16_f32 v49, v50, v51
  v_mfma_f32_16x16x32_bf16 v[176:179], a[36:39], a[68:71], v[176:179]
  v_cvt_pk_bf16_f32 v50, v52, v53
  v_cvt_pk_bf16_f32 v51, v54, v55
  v_mfma_f32_16x16x32_bf16 v[180:183], a[44:47], a[68:71], v[180:183]
  buffer_load_dwordx4 a[188:191], v1, s[60:63], s47 offen offset:1024 sc1
  v_mfma_f32_16x16x32_bf16 v[180:183], a[40:43], a[64:67], v[180:183]
  s_add_u32 s1, s93, 28672
  buffer_store_dwordx4 v[224:227], v1, s[8:11], s1 offen sc1
  v_mfma_f32_16x16x32_bf16 v[240:243], a[48:51], a[64:67], v[240:243]
  s_waitcnt vmcnt(31)
  v_cvt_pk_bf16_f32 v112, v112, v113
  v_cvt_pk_bf16_f32 v113, v114, v115
  v_mfma_f32_16x16x32_bf16 v[240:243], a[52:55], a[68:71], v[240:243]
  s_barrier
  v_cvt_pk_bf16_f32 v114, v116, v117
  v_cvt_pk_bf16_f32 v115, v118, v119
  v_mfma_f32_16x16x32_bf16 v[244:247], a[60:63], a[68:71], v[244:247]
  v_mfma_f32_16x16x32_bf16 v[244:247], a[56:59], a[64:67], v[244:247]
  s_waitcnt lgkmcnt(2)
  v_mfma_f32_16x16x32_bf16 v[56:59], a[0:3], a[72:75], v[56:59]
  s_waitcnt lgkmcnt(0)
  v_cvt_pk_bf16_f32 v176, v176, v177
  v_cvt_pk_bf16_f32 v177, v178, v179
  v_mfma_f32_16x16x32_bf16 v[56:59], a[4:7], a[76:79], v[56:59]
  v_cvt_pk_bf16_f32 v178, v180, v181
  v_cvt_pk_bf16_f32 v179, v182, v183
  v_mfma_f32_16x16x32_bf16 v[60:63], a[12:15], a[76:79], v[60:63]
  ds_read_b64_tr_b16 a[0:1], v11 offset:16896
  ds_read_b64_tr_b16 a[2:3], v11 offset:17024
  v_mfma_f32_16x16x32_bf16 v[60:63], a[8:11], a[72:75], v[60:63]
  ds_read_b64_tr_b16 a[4:5], v11 offset:17408
  ds_read_b64_tr_b16 a[6:7], v11 offset:17536
  v_mfma_f32_16x16x32_bf16 v[120:123], a[16:19], a[72:75], v[120:123]
  ds_read_b64_tr_b16 a[8:9], v11 offset:16928
  ds_read_b64_tr_b16 a[10:11], v11 offset:17056
  v_mfma_f32_16x16x32_bf16 v[120:123], a[20:23], a[76:79], v[120:123]
  ds_read_b64_tr_b16 a[12:13], v11 offset:17440
  ds_read_b64_tr_b16 a[14:15], v11 offset:17568
  v_mfma_f32_16x16x32_bf16 v[124:127], a[28:31], a[76:79], v[124:127]
  v_cvt_pk_bf16_f32 v240, v240, v241
  v_cvt_pk_bf16_f32 v241, v242, v243
  v_mfma_f32_16x16x32_bf16 v[124:127], a[24:27], a[72:75], v[124:127]
  v_cvt_pk_bf16_f32 v242, v244, v245
  v_cvt_pk_bf16_f32 v243, v246, v247
  v_mfma_f32_16x16x32_bf16 v[184:187], a[32:35], a[72:75], v[184:187]
  v_cvt_pk_bf16_f32 v56, v56, v57
  v_cvt_pk_bf16_f32 v57, v58, v59
  v_mfma_f32_16x16x32_bf16 v[184:187], a[36:39], a[76:79], v[184:187]
  v_cvt_pk_bf16_f32 v58, v60, v61
  v_cvt_pk_bf16_f32 v59, v62, v63
  v_mfma_f32_16x16x32_bf16 v[188:191], a[44:47], a[76:79], v[188:191]
  v_mfma_f32_16x16x32_bf16 v[188:191], a[40:43], a[72:75], v[188:191]
  v_mfma_f32_16x16x32_bf16 v[248:251], a[48:51], a[72:75], v[248:251]
  v_cvt_pk_bf16_f32 v120, v120, v121
  v_cvt_pk_bf16_f32 v121, v122, v123
  v_mfma_f32_16x16x32_bf16 v[248:251], a[52:55], a[76:79], v[248:251]
  v_cvt_pk_bf16_f32 v122, v124, v125
  v_cvt_pk_bf16_f32 v123, v126, v127
  v_mfma_f32_16x16x32_bf16 v[252:255], a[60:63], a[76:79], v[252:255]
  v_mfma_f32_16x16x32_bf16 v[252:255], a[56:59], a[72:75], v[252:255]
  v_cvt_pk_bf16_f32 v184, v184, v185
  v_cvt_pk_bf16_f32 v185, v186, v187
  v_cvt_pk_bf16_f32 v186, v188, v189
  v_cvt_pk_bf16_f32 v187, v190, v191
  v_cvt_pk_bf16_f32 v248, v248, v249
  v_cvt_pk_bf16_f32 v249, v250, v251
  s_nop 1
  v_cvt_pk_bf16_f32 v250, v252, v253
  v_cvt_pk_bf16_f32 v251, v254, v255
L_p2:
  s_waitcnt lgkmcnt(6)
  v_mfma_f32_16x16x32_bf16 a[32:35], a[0:3], a[96:99], 0
  s_waitcnt lgkmcnt(4)
  s_add_u32 m0, s42, 0
  s_add_u32 s28, s40, 1048576
  ds_read_b64_tr_b16 a[16:17], v11 offset:16960
  v_mfma_f32_16x16x32_bf16 a[32:35], a[4:7], a[100:103], a[32:35]
  ds_read_b64_tr_b16 a[18:19], v11 offset:17088
  ds_read_b64_tr_b16 a[20:21], v11 offset:17472
  v_mfma_f32_16x16x32_bf16 a[48:51], a[4:7], a[108:111], 0
  buffer_load_dwordx4 v6, s[52:55], s28 offen lds
  v_mfma_f32_16x16x32_bf16 a[48:51], a[0:3], a[104:107], a[48:51]
  ds_read_b64_tr_b16 a[22:23], v11 offset:17600
  v_mfma_f32_16x16x32_bf16 a[64:67], a[0:3], a[112:115], 0
  v_mfma_f32_16x16x32_bf16 a[64:67], a[4:7], a[116:119], a[64:67]
  v_mfma_f32_16x16x32_bf16 a[80:83], a[4:7], a[124:127], 0
  s_add_u32 m0, s42, 1056
  s_add_u32 s28, s40, 1056768
  v_mfma_f32_16x16x32_bf16 a[80:83], a[0:3], a[120:123], a[80:83]
  s_waitcnt lgkmcnt(6)
  buffer_store_dwordx4 v[16:19], v1, s[8:11], s93 offen offset:2048 sc1
  v_mfma_f32_16x16x32_bf16 a[84:87], a[8:11], a[120:123], 0
  s_waitcnt lgkmcnt(4)
  buffer_load_dwordx4 v6, s[52:55], s28 offen lds
  v_mfma_f32_16x16x32_bf16 a[84:87], a[12:15], a[124:127], a[84:87]
  ds_read_b64_tr_b16 a[0:1], v11 offset:16992
  ds_read_b64_tr_b16 a[2:3], v11 offset:17120
  v_mfma_f32_16x16x32_bf16 a[68:71], a[12:15], a[116:119], 0
  ds_read_b64_tr_b16 a[4:5], v11 offset:17504
  ds_read_b64_tr_b16 a[6:7], v11 offset:17632
  v_mfma_f32_16x16x32_bf16 a[68:71], a[8:11], a[112:115], a[68:71]
  v_mfma_f32_16x16x32_bf16 a[52:55], a[8:11], a[104:107], 0
  s_add_u32 m0, s42, 2112
  s_add_u32 s28, s40, 1064960
  v_mfma_f32_16x16x32_bf16 a[52:55], a[12:15], a[108:111], a[52:55]
  v_mfma_f32_16x16x32_bf16 a[36:39], a[12:15], a[100:103], 0
  buffer_load_dwordx4 v6, s[52:55], s28 offen lds
  v_mfma_f32_16x16x32_bf16 a[36:39], a[8:11], a[96:99], a[36:39]
  s_waitcnt lgkmcnt(6)
  v_mfma_f32_16x16x32_bf16 a[40:43], a[16:19], a[96:99], 0
  s_waitcnt lgkmcnt(4)
  ds_read_b64_tr_b16 a[8:9], v11 offset:0
  ds_read_b64_tr_b16 a[10:11], v11 offset:8448
  v_mfma_f32_16x16x32_bf16 a[40:43], a[20:23], a[100:103], a[40:43]
  ds_read_b64_tr_b16 a[12:13], v11 offset:512
  ds_read_b64_tr_b16 a[14:15], v11 offset:8960
  v_mfma_f32_16x16x32_bf16 a[56:59], a[20:23], a[108:111], 0
  s_add_u32 m0, s42, 3168
  s_add_u32 s28, s40, 1073152
  v_mfma_f32_16x16x32_bf16 a[56:59], a[16:19], a[104:107], a[56:59]
  v_mfma_f32_16x16x32_bf16 a[72:75], a[16:19], a[112:115], 0
  buffer_load_dwordx4 v6, s[52:55], s28 offen lds
  v_mfma_f32_16x16x32_bf16 a[72:75], a[20:23], a[116:119], a[72:75]
  v_mfma_f32_16x16x32_bf16 a[88:91], a[20:23], a[124:127], 0
  v_mfma_f32_16x16x32_bf16 a[88:91], a[16:19], a[120:123], a[88:91]
  s_waitcnt lgkmcnt(6)
  v_mfma_f32_16x16x32_bf16 a[92:95], a[0:3], a[120:123], 0
  s_waitcnt lgkmcnt(4)
  ds_read_b64_tr_b16 a[16:17], v11 offset:32
  ds_read_b64_tr_b16 a[18:19], v11 offset:8480
  v_mfma_f32_16x16x32_bf16 a[92:95], a[4:7], a[124:127], a[92:95]
  s_add_u32 m0, s43, 0
  s_add_u32 s28, s41, 442368
  ds_read_b64_tr_b16 a[20:21], v11 offset:544
  v_mfma_f32_16x16x32_bf16 a[76:79], a[4:7], a[116:119], 0
  s_mul_i32 s29, s4, 1057792
  s_add_u32 s29, s29, 4194304
  s_add_u32 s12, s86, s29
  s_addc_u32 s13, s87, 0
  s_and_b32 s13, s13, 0xffff
  v_mfma_f32_16x16x32_bf16 a[76:79], a[0:3], a[112:115], a[76:79]
  s_sub_u32 s14, 16, s5
  s_lshl_b32 s14, s14, 16
  ds_read_b64_tr_b16 a[22:23], v11 offset:8992
  v_mfma_f32_16x16x32_bf16 a[60:63], a[0:3], a[104:107], 0
  s_mov_b32 s15, 0x20000
  buffer_load_dwordx4 v5, s[56:59], s28 offen lds
  v_mfma_f32_16x16x32_bf16 a[60:63], a[4:7], a[108:111], a[60:63]
  s_lshl_b32 s34, s3, 12
  s_lshl_b32 s35, s4, 7
  v_mfma_f32_16x16x32_bf16 a[44:47], a[4:7], a[100:103], 0
  s_cmp_eq_u32 s3, 0
  s_cselect_b32 s36, s35, 536870912
  s_add_u32 s37, s7, 1
  v_mfma_f32_16x16x32_bf16 a[44:47], a[0:3], a[96:99], a[44:47]
  s_waitcnt lgkmcnt(6)
  s_add_u32 m0, s43, 1056
  s_add_u32 s28, s41, 445824
  v_mfma_f32_16x16x32_bf16 a[28:31], a[8:11], a[96:99], 0
  s_waitcnt lgkmcnt(4)
  ds_read_b64_tr_b16 a[0:1], v11 offset:64
  ds_read_b64_tr_b16 a[2:3], v11 offset:8512
  v_mfma_f32_16x16x32_bf16 a[28:31], a[12:15], a[100:103], a[28:31]
  buffer_load_dwordx4 v5, s[56:59], s28 offen lds
  v_mfma_f32_16x16x32_bf16 a[24:27], a[12:15], a[108:111], 0
  ds_read_b64_tr_b16 a[4:5], v11 offset:576
  ds_read_b64_tr_b16 a[6:7], v11 offset:9024
  v_mfma_f32_16x16x32_bf16 a[24:27], a[8:11], a[104:107], a[24:27]
  s_cmp_eq_u32 s37, 7
  s_cselect_b32 s37, 0, s37
  v_mfma_f32_16x16x32_bf16 v[20:23], a[8:11], a[112:115], 0
  buffer_store_dwordx4 v[24:27], v1, s[8:11], s93 offen offset:3072 sc1
  v_mfma_f32_16x16x32_bf16 v[20:23], a[12:15], a[116:119], v[20:23]
  s_cmp_eq_u32 s6, 3
  s_cselect_b32 s37, s37, s7
  s_lshl_b32 s37, s37, 11
  v_mfma_f32_16x16x32_bf16 v[28:31], a[12:15], a[124:127], 0
  s_cmp_eq_u32 s7, 7
  s_cselect_b32 s37, 536870912, s37
  v_mfma_f32_16x16x32_bf16 v[28:31], a[8:11], a[120:123], v[28:31]
  s_waitcnt lgkmcnt(6)
  buffer_load_dwordx4 a[192:195], v1, s[60:63], s44 offen offset:2048 sc1
  v_mfma_f32_16x16x32_bf16 v[60:63], a[16:19], a[120:123], 0
  s_waitcnt lgkmcnt(4)
  ds_read_b64_tr_b16 a[8:9], v11 offset:96
  ds_read_b64_tr_b16 a[10:11], v11 offset:8544
  v_mfma_f32_16x16x32_bf16 v[60:63], a[20:23], a[124:127], v[60:63]
  ds_read_b64_tr_b16 a[12:13], v11 offset:608
  ds_read_b64_tr_b16 a[14:15], v11 offset:9056
  v_mfma_f32_16x16x32_bf16 v[52:55], a[20:23], a[116:119], 0
  v_mfma_f32_16x16x32_bf16 v[52:55], a[16:19], a[112:115], v[52:55]
  v_mfma_f32_16x16x32_bf16 v[44:47], a[16:19], a[104:107], 0
  v_mfma_f32_16x16x32_bf16 v[44:47], a[20:23], a[108:111], v[44:47]
  v_mfma_f32_16x16x32_bf16 v[36:39], a[20:23], a[100:103], 0
  buffer_load_dwordx4 a[196:199], v1, s[60:63], s44 offen offset:3072 sc1
  v_mfma_f32_16x16x32_bf16 v[36:39], a[16:19], a[96:99], v[36:39]
  s_waitcnt lgkmcnt(6)
  s_add_u32 s44, s44, 4096
  v_mfma_f32_16x16x32_bf16 v[148:151], a[0:3], a[96:99], 0
  s_waitcnt lgkmcnt(4)
  ds_read_b64_tr_b16 a[16:17], v11 offset:128
  ds_read_b64_tr_b16 a[18:19], v11 offset:8576
  v_mfma_f32_16x16x32_bf16 v[148:151], a[4:7], a[100:103], v[148:151]
  ds_read_b64_tr_b16 a[20:21], v11 offset:640
  ds_read_b64_tr_b16 a[22:23], v11 offset:9088
  v_mfma_f32_16x16x32_bf16 v[164:167], a[4:7], a[108:111], 0
  v_mfma_f32_16x16x32_bf16 v[164:167], a[0:3], a[104:107], v[164:167]
  v_mfma_f32_16x16x32_bf16 v[180:183], a[0:3], a[112:115], 0
  buffer_load_dwordx4 a[200:203], v1, s[60:63], s45 offen offset:2048 sc1
  v_mfma_f32_16x16x32_bf16 v[180:183], a[4:7], a[116:119], v[180:183]
  v_mfma_f32_16x16x32_bf16 v[196:199], a[4:7], a[124:127], 0
  v_mfma_f32_16x16x32_bf16 v[196:199], a[0:3], a[120:123], v[196:199]
  s_waitcnt lgkmcnt(6)
  v_mfma_f32_16x16x32_bf16 v[92:95], a[8:11], a[120:123], 0
  s_waitcnt lgkmcnt(4)
  ds_read_b64_tr_b16 a[0:1], v11 offset:160
  ds_read_b64_tr_b16 a[2:3], v11 offset:8608
  v_mfma_f32_16x16x32_bf16 v[92:95], a[12:15], a[124:127], v[92:95]
  ds_read_b64_tr_b16 a[4:5], v11 offset:672
  ds_read_b64_tr_b16 a[6:7], v11 offset:9120
  v_mfma_f32_16x16x32_bf16 v[84:87], a[12:15], a[116:119], 0
  buffer_load_dwordx4 a[204:207], v1, s[60:63], s45 offen offset:3072 sc1
  v_mfma_f32_16x16x32_bf16 v[84:87], a[8:11], a[112:115], v[84:87]
  s_add_u32 s45, s45, 4096
  v_mfma_f32_16x16x32_bf16 v[76:79], a[8:11], a[104:107], 0
  v_mfma_f32_16x16x32_bf16 v[76:79], a[12:15], a[108:111], v[76:79]
  v_mfma_f32_16x16x32_bf16 v[68:71], a[12:15], a[100:103], 0
  v_mfma_f32_16x16x32_bf16 v[68:71], a[8:11], a[96:99], v[68:71]
  s_waitcnt lgkmcnt(6)
  v_mfma_f32_16x16x32_bf16 v[100:103], a[16:19], a[96:99], 0
  s_waitcnt lgkmcnt(4)
  ds_read_b64_tr_b16 a[8:9], v11 offset:192
  ds_read_b64_tr_b16 a[10:11], v11 offset:8640
  v_mfma_f32_16x16x32_bf16 v[100:103], a[20:23], a[100:103], v[100:103]
  s_add_u32 s93, s93, 4096
  buffer_load_dwordx4 a[208:211], v1, s[60:63], s46 offen offset:2048 sc1
  v_mfma_f32_16x16x32_bf16 v[108:111], a[20:23], a[108:111], 0
  buffer_store_dwordx4 v[40:43], v1, s[8:11], s93 offen offset:1024 sc1
  v_mfma_f32_16x16x32_bf16 v[108:111], a[16:19], a[104:107], v[108:111]
  ds_read_b64_tr_b16 a[12:13], v11 offset:704
  ds_read_b64_tr_b16 a[14:15], v11 offset:9152
  v_mfma_f32_16x16x32_bf16 v[116:119], a[16:19], a[112:115], 0
  v_mfma_f32_16x16x32_bf16 v[116:119], a[20:23], a[116:119], v[116:119]
  v_mfma_f32_16x16x32_bf16 v[124:127], a[20:23], a[124:127], 0
  v_mfma_f32_16x16x32_bf16 v[124:127], a[16:19], a[120:123], v[124:127]
  s_waitcnt lgkmcnt(6)
  buffer_load_dwordx4 a[212:215], v1, s[60:63], s46 offen offset:3072 sc1
  v_mfma_f32_16x16x32_bf16 v[220:223], a[0:3], a[120:123], 0
  s_waitcnt lgkmcnt(4)
  s_add_u32 s46, s46, 4096
  ds_read_b64_tr_b16 a[16:17], v11 offset:224
  ds_read_b64_tr_b16 a[18:19], v11 offset:8672
  v_mfma_f32_16x16x32_bf16 v[220:223], a[4:7], a[124:127], v[220:223]
  ds_read_b64_tr_b16 a[20:21], v11 offset:736
  ds_read_b64_tr_b16 a[22:23], v11 offset:9184
  v_mfma_f32_16x16x32_bf16 v[212:215], a[4:7], a[116:119], 0
  v_mfma_f32_16x16x32_bf16 v[212:215], a[0:3], a[112:115], v[212:215]
  v_mfma_f32_16x16x32_bf16 v[140:143], a[0:3], a[104:107], 0
  v_mfma_f32_16x16x32_bf16 v[140:143], a[4:7], a[108:111], v[140:143]
  buffer_load_dwordx4 a[216:219], v1, s[60:63], s47 offen offset:2048 sc1
  v_mfma_f32_16x16x32_bf16 v[132:135], a[4:7], a[100:103], 0
  s_waitcnt vmcnt(33)
  v_mfma_f32_16x16x32_bf16 v[132:135], a[0:3], a[96:99], v[132:135]
  s_barrier
  s_waitcnt lgkmcnt(6)
  v_mfma_f32_16x16x32_bf16 v[156:159], a[8:11], a[96:99], 0
  s_waitcnt lgkmcnt(4)
  ds_read_b64_tr_b16 a[0:1], v3 offset:16896
  ds_read_b64_tr_b16 a[2:3], v3 offset:17024
  v_mfma_f32_16x16x32_bf16 v[156:159], a[12:15], a[100:103], v[156:159]
  ds_read_b64_tr_b16 a[4:5], v3 offset:17408
  ds_read_b64_tr_b16 a[6:7], v3 offset:17536
  v_mfma_f32_16x16x32_bf16 v[172:175], a[12:15], a[108:111], 0
  v_mfma_f32_16x16x32_bf16 v[172:175], a[8:11], a[104:107], v[172:175]
  v_mfma_f32_16x16x32_bf16 v[188:191], a[8:11], a[112:115], 0
  buffer_load_dwordx4 a[220:223], v1, s[60:63], s47 offen offset:3072 sc1
  v_mfma_f32_16x16x32_bf16 v[188:191], a[12:15], a[116:119], v[188:191]
  s_add_u32 s47, s47, 4096
  v_mfma_f32_16x16x32_bf16 v[204:207], a[12:15], a[124:127], 0
  v_mfma_f32_16x16x32_bf16 v[204:207], a[8:11], a[120:123], v[204:207]
  s_waitcnt lgkmcnt(6)
  v_mfma_f32_16x16x32_bf16 v[252:255], a[16:19], a[120:123], 0
  s_waitcnt lgkmcnt(4)
  s_add_u32 m0, s42, 25344
  s_add_u32 s28, s40, 1572864
  ds_read_b64_tr_b16 a[8:9], v3 offset:16928
  v_mfma_f32_16x16x32_bf16 v[252:255], a[20:23], a[124:127], v[252:255]
  ds_read_b64_tr_b16 a[10:11], v3 offset:17056
  ds_read_b64_tr_b16 a[12:13], v3 offset:17440
  v_mfma_f32_16x16x32_bf16 v[244:247], a[20:23], a[116:119], 0
  buffer_load_dwordx4 v6, s[52:55], s28 offen lds
  v_mfma_f32_16x16x32_bf16 v[244:247], a[16:19], a[112:115], v[244:247]
  ds_read_b64_tr_b16 a[14:15], v3 offset:17568
  v_mfma_f32_16x16x32_bf16 v[236:239], a[16:19], a[104:107], 0
  v_mfma_f32_16x16x32_bf16 v[236:239], a[20:23], a[108:111], v[236:239]
  v_mfma_f32_16x16x32_bf16 v[228:231], a[20:23], a[100:103], 0
  s_add_u32 m0, s42, 26400
  s_add_u32 s28, s40, 1581056
  v_mfma_f32_16x16x32_bf16 v[228:231], a[16:19], a[96:99], v[228:231]
  s_waitcnt lgkmcnt(6)
  v_mfma_f32_16x16x32_bf16 a[32:35], a[0:3], a[128:131], a[32:35]
  s_waitcnt lgkmcnt(4)
  buffer_load_dwordx4 v6, s[52:55], s28 offen lds
  v_mfma_f32_16x16x32_bf16 a[32:35], a[4:7], a[132:135], a[32:35]
  buffer_store_dwordx4 v[48:51], v1, s[8:11], s93 offen offset:2048 sc1
  v_mfma_f32_16x16x32_bf16 a[48:51], a[4:7], a[140:143], a[48:51]
  ds_read_b64_tr_b16 a[16:17], v3 offset:16960
  ds_read_b64_tr_b16 a[18:19], v3 offset:17088
  v_mfma_f32_16x16x32_bf16 a[48:51], a[0:3], a[136:139], a[48:51]
  ds_read_b64_tr_b16 a[20:21], v3 offset:17472
  ds_read_b64_tr_b16 a[22:23], v3 offset:17600
  v_mfma_f32_16x16x32_bf16 a[64:67], a[0:3], a[144:147], a[64:67]
  v_mfma_f32_16x16x32_bf16 a[64:67], a[4:7], a[148:151], a[64:67]
  s_add_u32 m0, s42, 27456
  s_add_u32 s28, s40, 1589248
  v_mfma_f32_16x16x32_bf16 a[80:83], a[4:7], a[156:159], a[80:83]
  v_mfma_f32_16x16x32_bf16 a[80:83], a[0:3], a[152:155], a[80:83]
  s_waitcnt lgkmcnt(6)
  buffer_load_dwordx4 v6, s[52:55], s28 offen lds
  v_mfma_f32_16x16x32_bf16 a[84:87], a[8:11], a[152:155], a[84:87]
  s_waitcnt lgkmcnt(4)
  ds_read_b64_tr_b16 a[0:1], v3 offset:16992
  ds_read_b64_tr_b16 a[2:3], v3 offset:17120
  v_mfma_f32_16x16x32_bf16 a[84:87], a[12:15], a[156:159], a[84:87]
  ds_read_b64_tr_b16 a[4:5], v3 offset:17504
  ds_read_b64_tr_b16 a[6:7], v3 offset:17632
  v_mfma_f32_16x16x32_bf16 a[68:71], a[12:15], a[148:151], a[68:71]
  v_mfma_f32_16x16x32_bf16 a[68:71], a[8:11], a[144:147], a[68:71]
  s_add_u32 m0, s42, 28512
  s_add_u32 s28, s40, 1597440
  v_mfma_f32_16x16x32_bf16 a[52:55], a[8:11], a[136:139], a[52:55]
  v_mfma_f32_16x16x32_bf16 a[52:55], a[12:15], a[140:143], a[52:55]
  buffer_load_dwordx4 v6, s[52:55], s28 offen lds
  v_mfma_f32_16x16x32_bf16 a[36:39], a[12:15], a[132:135], a[36:39]
  v_mfma_f32_16x16x32_bf16 a[36:39], a[8:11], a[128:131], a[36:39]
  s_waitcnt lgkmcnt(6)
  v_mfma_f32_16x16x32_bf16 a[40:43], a[16:19], a[128:131], a[40:43]
  s_waitcnt lgkmcnt(4)
  ds_read_b64_tr_b16 a[8:9], v3 offset:0
  ds_read_b64_tr_b16 a[10:11], v3 offset:8448
  v_mfma_f32_16x16x32_bf16 a[40:43], a[20:23], a[132:135], a[40:43]
  s_add_u32 m0, s43, 25344
  s_add_u32 s28, s41, 663552
  ds_read_b64_tr_b16 a[12:13], v3 offset:512
  v_mfma_f32_16x16x32_bf16 a[56:59], a[20:23], a[140:143], a[56:59]
  ds_read_b64_tr_b16 a[14:15], v3 offset:8960
  v_mfma_f32_16x16x32_bf16 a[56:59], a[16:19], a[136:139], a[56:59]
  buffer_load_dwordx4 v5, s[56:59], s28 offen lds
  v_mfma_f32_16x16x32_bf16 a[72:75], a[16:19], a[144:147], a[72:75]
  v_mfma_f32_16x16x32_bf16 a[72:75], a[20:23], a[148:151], a[72:75]
  v_mfma_f32_16x16x32_bf16 a[88:91], a[20:23], a[156:159], a[88:91]
  v_mfma_f32_16x16x32_bf16 a[88:91], a[16:19], a[152:155], a[88:91]
  s_waitcnt lgkmcnt(6)
  v_mfma_f32_16x16x32_bf16 a[92:95], a[0:3], a[152:155], a[92:95]
  s_waitcnt lgkmcnt(4)
  s_add_u32 m0, s43, 26400
  s_add_u32 s28, s41, 667008
  ds_read_b64_tr_b16 a[16:17], v3 offset:32
  v_mfma_f32_16x16x32_bf16 a[92:95], a[4:7], a[156:159], a[92:95]
  ds_read_b64_tr_b16 a[18:19], v3 offset:8480
  ds_read_b64_tr_b16 a[20:21], v3 offset:544
  v_mfma_f32_16x16x32_bf16 a[76:79], a[4:7], a[148:151], a[76:79]
  buffer_load_dwordx4 v5, s[56:59], s28 offen lds
  v_mfma_f32_16x16x32_bf16 a[76:79], a[0:3], a[144:147], a[76:79]
  ds_read_b64_tr_b16 a[22:23], v3 offset:8992
  v_mfma_f32_16x16x32_bf16 a[60:63], a[0:3], a[136:139], a[60:63]
  v_mfma_f32_16x16x32_bf16 a[60:63], a[4:7], a[140:143], a[60:63]
  v_mfma_f32_16x16x32_bf16 a[44:47], a[4:7], a[132:135], a[44:47]
  v_mfma_f32_16x16x32_bf16 a[44:47], a[0:3], a[128:131], a[44:47]
  s_waitcnt lgkmcnt(6)
  buffer_store_dwordx4 v[56:59], v1, s[8:11], s93 offen offset:3072 sc1
  v_mfma_f32_16x16x32_bf16 a[28:31], a[8:11], a[128:131], a[28:31]
  s_waitcnt lgkmcnt(4)
  buffer_load_dwordx4 a[96:99], v1, s[60:63], s44 offen offset:0 sc1
  v_mfma_f32_16x16x32_bf16 a[28:31], a[12:15], a[132:135], a[28:31]
  ds_read_b64_tr_b16 a[0:1], v3 offset:64
  ds_read_b64_tr_b16 a[2:3], v3 offset:8512
  v_mfma_f32_16x16x32_bf16 a[24:27], a[12:15], a[140:143], a[24:27]
  ds_read_b64_tr_b16 a[4:5], v3 offset:576
  ds_read_b64_tr_b16 a[6:7], v3 offset:9024
  v_mfma_f32_16x16x32_bf16 a[24:27], a[8:11], a[136:139], a[24:27]
  v_mfma_f32_16x16x32_bf16 v[20:23], a[8:11], a[144:147], v[20:23]
  v_mfma_f32_16x16x32_bf16 v[20:23], a[12:15], a[148:151], v[20:23]
  v_mfma_f32_16x16x32_bf16 v[28:31], a[12:15], a[156:159], v[28:31]
  buffer_load_dwordx4 a[100:103], v1, s[60:63], s44 offen offset:1024 sc1
  v_mfma_f32_16x16x32_bf16 v[28:31], a[8:11], a[152:155], v[28:31]
  s_waitcnt lgkmcnt(6)
  v_mfma_f32_16x16x32_bf16 v[60:63], a[16:19], a[152:155], v[60:63]
  s_waitcnt lgkmcnt(4)
  ds_read_b64_tr_b16 a[8:9], v3 offset:96
  ds_read_b64_tr_b16 a[10:11], v3 offset:8544
  v_mfma_f32_16x16x32_bf16 v[60:63], a[20:23], a[156:159], v[60:63]
  ds_read_b64_tr_b16 a[12:13], v3 offset:608
  ds_read_b64_tr_b16 a[14:15], v3 offset:9056
  v_mfma_f32_16x16x32_bf16 v[52:55], a[20:23], a[148:151], v[52:55]
  v_mfma_f32_16x16x32_bf16 v[52:55], a[16:19], a[144:147], v[52:55]
  v_mfma_f32_16x16x32_bf16 v[44:47], a[16:19], a[136:139], v[44:47]
  v_mfma_f32_16x16x32_bf16 v[44:47], a[20:23], a[140:143], v[44:47]
  buffer_load_dwordx4 a[104:107], v1, s[60:63], s45 offen offset:0 sc1
  v_mfma_f32_16x16x32_bf16 v[36:39], a[20:23], a[132:135], v[36:39]
  v_mfma_f32_16x16x32_bf16 v[36:39], a[16:19], a[128:131], v[36:39]
  s_waitcnt lgkmcnt(6)
  v_mfma_f32_16x16x32_bf16 v[148:151], a[0:3], a[128:131], v[148:151]
  s_waitcnt lgkmcnt(4)
  ds_read_b64_tr_b16 a[16:17], v3 offset:128
  ds_read_b64_tr_b16 a[18:19], v3 offset:8576
  v_mfma_f32_16x16x32_bf16 v[148:151], a[4:7], a[132:135], v[148:151]
  ds_read_b64_tr_b16 a[20:21], v3 offset:640
  ds_read_b64_tr_b16 a[22:23], v3 offset:9088
  v_mfma_f32_16x16x32_bf16 v[164:167], a[4:7], a[140:143], v[164:167]
  v_mfma_f32_16x16x32_bf16 v[164:167], a[0:3], a[136:139], v[164:167]
  buffer_load_dwordx4 a[108:111], v1, s[60:63], s45 offen offset:1024 sc1
  v_mfma_f32_16x16x32_bf16 v[180:183], a[0:3], a[144:147], v[180:183]
  v_mfma_f32_16x16x32_bf16 v[180:183], a[4:7], a[148:151], v[180:183]
  v_mfma_f32_16x16x32_bf16 v[196:199], a[4:7], a[156:159], v[196:199]
  v_mfma_f32_16x16x32_bf16 v[196:199], a[0:3], a[152:155], v[196:199]
  s_waitcnt lgkmcnt(6)
  v_mfma_f32_16x16x32_bf16 v[92:95], a[8:11], a[152:155], v[92:95]
  s_waitcnt lgkmcnt(4)
  ds_read_b64_tr_b16 a[0:1], v3 offset:160
  ds_read_b64_tr_b16 a[2:3], v3 offset:8608
  v_mfma_f32_16x16x32_bf16 v[92:95], a[12:15], a[156:159], v[92:95]
  buffer_load_dwordx4 a[112:115], v1, s[60:63], s46 offen offset:0 sc1
  v_mfma_f32_16x16x32_bf16 v[84:87], a[12:15], a[148:151], v[84:87]
  ds_read_b64_tr_b16 a[4:5], v3 offset:672
  ds_read_b64_tr_b16 a[6:7], v3 offset:9120
  v_mfma_f32_16x16x32_bf16 v[84:87], a[8:11], a[144:147], v[84:87]
  v_mfma_f32_16x16x32_bf16 v[76:79], a[8:11], a[136:139], v[76:79]
  v_mfma_f32_16x16x32_bf16 v[76:79], a[12:15], a[140:143], v[76:79]
  s_add_u32 s93, s93, 4096
  v_mfma_f32_16x16x32_bf16 v[68:71], a[12:15], a[132:135], v[68:71]
  buffer_store_dwordx4 v[72:75], v1, s[8:11], s93 offen offset:1024 sc1
  v_mfma_f32_16x16x32_bf16 v[68:71], a[8:11], a[128:131], v[68:71]
  s_waitcnt lgkmcnt(6)
  v_mfma_f32_16x16x32_bf16 v[100:103], a[16:19], a[128:131], v[100:103]
  s_waitcnt lgkmcnt(4)
  buffer_load_dwordx4 a[116:119], v1, s[60:63], s46 offen offset:1024 sc1
  v_mfma_f32_16x16x32_bf16 v[100:103], a[20:23], a[132:135], v[100:103]
  ds_read_b64_tr_b16 a[8:9], v3 offset:192
  ds_read_b64_tr_b16 a[10:11], v3 offset:8640
  v_mfma_f32_16x16x32_bf16 v[108:111], a[20:23], a[140:143], v[108:111]
  ds_read_b64_tr_b16 a[12:13], v3 offset:704
  ds_read_b64_tr_b16 a[14:15], v3 offset:9152
  v_mfma_f32_16x16x32_bf16 v[108:111], a[16:19], a[136:139], v[108:111]
  v_mfma_f32_16x16x32_bf16 v[116:119], a[16:19], a[144:147], v[116:119]
  v_mfma_f32_16x16x32_bf16 v[116:119], a[20:23], a[148:151], v[116:119]
  v_mfma_f32_16x16x32_bf16 v[124:127], a[20:23], a[156:159], v[124:127]
  buffer_load_dwordx4 a[120:123], v1, s[60:63], s47 offen offset:0 sc1
  v_mfma_f32_16x16x32_bf16 v[124:127], a[16:19], a[152:155], v[124:127]
  s_waitcnt lgkmcnt(6)
  v_mfma_f32_16x16x32_bf16 v[220:223], a[0:3], a[152:155], v[220:223]
  s_waitcnt lgkmcnt(4)
  ds_read_b64_tr_b16 a[16:17], v3 offset:224
  ds_read_b64_tr_b16 a[18:19], v3 offset:8672
  v_mfma_f32_16x16x32_bf16 v[220:223], a[4:7], a[156:159], v[220:223]
  ds_read_b64_tr_b16 a[20:21], v3 offset:736
  ds_read_b64_tr_b16 a[22:23], v3 offset:9184
  v_mfma_f32_16x16x32_bf16 v[212:215], a[4:7], a[148:151], v[212:215]
  v_mfma_f32_16x16x32_bf16 v[212:215], a[0:3], a[144:147], v[212:215]
  v_mfma_f32_16x16x32_bf16 v[140:143], a[0:3], a[136:139], v[140:143]
  buffer_load_dwordx4 a[124:127], v1, s[60:63], s47 offen offset:1024 sc1
  v_mfma_f32_16x16x32_bf16 v[140:143], a[4:7], a[140:143], v[140:143]
  v_mfma_f32_16x16x32_bf16 v[132:135], a[4:7], a[132:135], v[132:135]
  s_waitcnt vmcnt(27)
  v_mfma_f32_16x16x32_bf16 v[132:135], a[0:3], a[128:131], v[132:135]
  s_barrier
  s_waitcnt lgkmcnt(6)
  v_mfma_f32_16x16x32_bf16 v[156:159], a[8:11], a[128:131], v[156:159]
  s_waitcnt lgkmcnt(4)
  ds_read_b64_tr_b16 a[0:1], v2 offset:16896
  ds_read_b64_tr_b16 a[2:3], v2 offset:17024
  v_mfma_f32_16x16x32_bf16 v[156:159], a[12:15], a[132:135], v[156:159]
  s_add_u32 m0, s42, 105728
  s_add_u32 s28, s40, 2097152
  ds_read_b64_tr_b16 a[4:5], v2 offset:17408
  v_mfma_f32_16x16x32_bf16 v[172:175], a[12:15], a[140:143], v[172:175]
  ds_read_b64_tr_b16 a[6:7], v2 offset:17536
  v_mfma_f32_16x16x32_bf16 v[172:175], a[8:11], a[136:139], v[172:175]
  buffer_load_dwordx4 v6, s[52:55], s28 offen lds
  v_mfma_f32_16x16x32_bf16 v[188:191], a[8:11], a[144:147], v[188:191]
  v_mfma_f32_16x16x32_bf16 v[188:191], a[12:15], a[148:151], v[188:191]
  v_mfma_f32_16x16x32_bf16 v[204:207], a[12:15], a[156:159], v[204:207]
  v_mfma_f32_16x16x32_bf16 v[204:207], a[8:11], a[152:155], v[204:207]
  s_waitcnt lgkmcnt(6)
  s_add_u32 m0, s42, 106784
  s_add_u32 s28, s40, 2105344
  v_mfma_f32_16x16x32_bf16 v[252:255], a[16:19], a[152:155], v[252:255]
  s_waitcnt lgkmcnt(4)
  ds_read_b64_tr_b16 a[8:9], v2 offset:16928
  ds_read_b64_tr_b16 a[10:11], v2 offset:17056
  v_mfma_f32_16x16x32_bf16 v[252:255], a[20:23], a[156:159], v[252:255]
  buffer_load_dwordx4 v6, s[52:55], s28 offen lds
  v_mfma_f32_16x16x32_bf16 v[244:247], a[20:23], a[148:151], v[244:247]
  ds_read_b64_tr_b16 a[12:13], v2 offset:17440
  ds_read_b64_tr_b16 a[14:15], v2 offset:17568
  v_mfma_f32_16x16x32_bf16 v[244:247], a[16:19], a[144:147], v[244:247]
  v_mfma_f32_16x16x32_bf16 v[236:239], a[16:19], a[136:139], v[236:239]
  buffer_store_dwordx4 v[80:83], v1, s[8:11], s93 offen offset:2048 sc1
  v_mfma_f32_16x16x32_bf16 v[236:239], a[20:23], a[140:143], v[236:239]
  s_add_u32 m0, s42, 107840
  s_add_u32 s28, s40, 2113536
  v_mfma_f32_16x16x32_bf16 v[228:231], a[20:23], a[132:135], v[228:231]
  v_mfma_f32_16x16x32_bf16 v[228:231], a[16:19], a[128:131], v[228:231]
  s_waitcnt lgkmcnt(6)
  buffer_load_dwordx4 v6, s[52:55], s28 offen lds
  v_mfma_f32_16x16x32_bf16 a[32:35], a[0:3], a[160:163], a[32:35]
  s_waitcnt lgkmcnt(4)
  ds_read_b64_tr_b16 a[16:17], v2 offset:16960
  ds_read_b64_tr_b16 a[18:19], v2 offset:17088
  v_mfma_f32_16x16x32_bf16 a[32:35], a[4:7], a[164:167], a[32:35]
  ds_read_b64_tr_b16 a[20:21], v2 offset:17472
  ds_read_b64_tr_b16 a[22:23], v2 offset:17600
  v_mfma_f32_16x16x32_bf16 a[48:51], a[4:7], a[172:175], a[48:51]
  v_mfma_f32_16x16x32_bf16 a[48:51], a[0:3], a[168:171], a[48:51]
  v_mfma_f32_16x16x32_bf16 a[64:67], a[0:3], a[176:179], a[64:67]
  s_add_u32 m0, s42, 108896
  s_add_u32 s28, s40, 2121728
  v_mfma_f32_16x16x32_bf16 a[64:67], a[4:7], a[180:183], a[64:67]
  v_mfma_f32_16x16x32_bf16 a[80:83], a[4:7], a[188:191], a[80:83]
  buffer_load_dwordx4 v6, s[52:55], s28 offen lds
  v_mfma_f32_16x16x32_bf16 a[80:83], a[0:3], a[184:187], a[80:83]
  s_waitcnt lgkmcnt(6)
  v_mfma_f32_16x16x32_bf16 a[84:87], a[8:11], a[184:187], a[84:87]
  s_waitcnt lgkmcnt(4)
  ds_read_b64_tr_b16 a[0:1], v2 offset:16992
  ds_read_b64_tr_b16 a[2:3], v2 offset:17120
  v_mfma_f32_16x16x32_bf16 a[84:87], a[12:15], a[188:191], a[84:87]
  ds_read_b64_tr_b16 a[4:5], v2 offset:17504
  ds_read_b64_tr_b16 a[6:7], v2 offset:17632
  v_mfma_f32_16x16x32_bf16 a[68:71], a[12:15], a[180:183], a[68:71]
  s_add_u32 m0, s43, 105728
  s_add_u32 s28, s41, 884736
  v_mfma_f32_16x16x32_bf16 a[68:71], a[8:11], a[176:179], a[68:71]
  s_mov_b32 s94, 0x3e0293ee
  s_mov_b32 s95, 0x3e0293ee
  v_mfma_f32_16x16x32_bf16 a[52:55], a[8:11], a[168:171], a[52:55]
  buffer_load_dwordx4 v5, s[56:59], s28 offen lds
  v_mfma_f32_16x16x32_bf16 a[52:55], a[12:15], a[172:175], a[52:55]
  v_mfma_f32_16x16x32_bf16 a[36:39], a[12:15], a[164:167], a[36:39]
  v_mfma_f32_16x16x32_bf16 a[36:39], a[8:11], a[160:163], a[36:39]
  s_waitcnt lgkmcnt(6)
  v_mfma_f32_16x16x32_bf16 a[40:43], a[16:19], a[160:163], a[40:43]
  s_waitcnt lgkmcnt(4)
  s_add_u32 m0, s43, 106784
  s_add_u32 s28, s41, 888192
  ds_read_b64_tr_b16 a[8:9], v2 offset:0
  v_mfma_f32_16x16x32_bf16 a[40:43], a[20:23], a[164:167], a[40:43]
  ds_read_b64_tr_b16 a[10:11], v2 offset:8448
  ds_read_b64_tr_b16 a[12:13], v2 offset:512
  v_mfma_f32_16x16x32_bf16 a[56:59], a[20:23], a[172:175], a[56:59]
  buffer_load_dwordx4 v5, s[56:59], s28 offen lds
  v_mfma_f32_16x16x32_bf16 a[56:59], a[16:19], a[168:171], a[56:59]
  ds_read_b64_tr_b16 a[14:15], v2 offset:8960
  v_mfma_f32_16x16x32_bf16 a[72:75], a[16:19], a[176:179], a[72:75]
  v_mfma_f32_16x16x32_bf16 a[72:75], a[20:23], a[180:183], a[72:75]
  v_mfma_f32_16x16x32_bf16 a[88:91], a[20:23], a[188:191], a[88:91]
  v_mfma_f32_16x16x32_bf16 a[88:91], a[16:19], a[184:187], a[88:91]
  s_waitcnt lgkmcnt(6)
  v_mfma_f32_16x16x32_bf16 a[92:95], a[0:3], a[184:187], a[92:95]
  s_waitcnt lgkmcnt(4)
  ds_read_b64_tr_b16 a[16:17], v2 offset:32
  ds_read_b64_tr_b16 a[18:19], v2 offset:8480
  v_mfma_f32_16x16x32_bf16 a[92:95], a[4:7], a[188:191], a[92:95]
  buffer_load_dwordx4 a[128:131], v1, s[60:63], s44 offen offset:2048 sc1
  v_mfma_f32_16x16x32_bf16 a[76:79], a[4:7], a[180:183], a[76:79]
  ds_read_b64_tr_b16 a[20:21], v2 offset:544
  ds_read_b64_tr_b16 a[22:23], v2 offset:8992
  v_mfma_f32_16x16x32_bf16 a[76:79], a[0:3], a[176:179], a[76:79]
  buffer_store_dwordx4 v[88:91], v1, s[8:11], s93 offen offset:3072 sc1
  v_mfma_f32_16x16x32_bf16 a[60:63], a[0:3], a[168:171], a[60:63]
  v_mfma_f32_16x16x32_bf16 a[60:63], a[4:7], a[172:175], a[60:63]
  v_mfma_f32_16x16x32_bf16 a[44:47], a[4:7], a[164:167], a[44:47]
  v_mfma_f32_16x16x32_bf16 a[44:47], a[0:3], a[160:163], a[44:47]
  s_waitcnt lgkmcnt(6)
  buffer_load_dwordx4 a[132:135], v1, s[60:63], s44 offen offset:3072 sc1
  v_mfma_f32_16x16x32_bf16 a[28:31], a[8:11], a[160:163], a[28:31]
  s_waitcnt lgkmcnt(4)
  s_add_u32 s44, s44, 4096
  ds_read_b64_tr_b16 a[0:1], v2 offset:64
  ds_read_b64_tr_b16 a[2:3], v2 offset:8512
  v_mfma_f32_16x16x32_bf16 a[28:31], a[12:15], a[164:167], a[28:31]
  ds_read_b64_tr_b16 a[4:5], v2 offset:576
  ds_read_b64_tr_b16 a[6:7], v2 offset:9024
  v_mfma_f32_16x16x32_bf16 a[24:27], a[12:15], a[172:175], a[24:27]
  v_mfma_f32_16x16x32_bf16 a[24:27], a[8:11], a[168:171], a[24:27]
  v_mfma_f32_16x16x32_bf16 v[20:23], a[8:11], a[176:179], v[20:23]
  v_mfma_f32_16x16x32_bf16 v[20:23], a[12:15], a[180:183], v[20:23]
  buffer_load_dwordx4 a[136:139], v1, s[60:63], s45 offen offset:2048 sc1
  v_mfma_f32_16x16x32_bf16 v[28:31], a[12:15], a[188:191], v[28:31]
  v_mfma_f32_16x16x32_bf16 v[28:31], a[8:11], a[184:187], v[28:31]
  s_waitcnt lgkmcnt(6)
  v_mfma_f32_16x16x32_bf16 v[60:63], a[16:19], a[184:187], v[60:63]
  s_waitcnt lgkmcnt(4)
  ds_read_b64_tr_b16 a[8:9], v2 offset:96
  ds_read_b64_tr_b16 a[10:11], v2 offset:8544
  v_mfma_f32_16x16x32_bf16 v[60:63], a[20:23], a[188:191], v[60:63]
  ds_read_b64_tr_b16 a[12:13], v2 offset:608
  ds_read_b64_tr_b16 a[14:15], v2 offset:9056
  v_mfma_f32_16x16x32_bf16 v[52:55], a[20:23], a[180:183], v[52:55]
  v_mfma_f32_16x16x32_bf16 v[52:55], a[16:19], a[176:179], v[52:55]
  v_mfma_f32_16x16x32_bf16 v[44:47], a[16:19], a[168:171], v[44:47]
  buffer_load_dwordx4 a[140:143], v1, s[60:63], s45 offen offset:3072 sc1
  v_mfma_f32_16x16x32_bf16 v[44:47], a[20:23], a[172:175], v[44:47]
  s_add_u32 s45, s45, 4096
  v_mfma_f32_16x16x32_bf16 v[36:39], a[20:23], a[164:167], v[36:39]
  v_mfma_f32_16x16x32_bf16 v[36:39], a[16:19], a[160:163], v[36:39]
  s_waitcnt lgkmcnt(6)
  v_mfma_f32_16x16x32_bf16 v[148:151], a[0:3], a[160:163], v[148:151]
  s_waitcnt lgkmcnt(4)
  ds_read_b64_tr_b16 a[16:17], v2 offset:128
  ds_read_b64_tr_b16 a[18:19], v2 offset:8576
  v_mfma_f32_16x16x32_bf16 v[148:151], a[4:7], a[164:167], v[148:151]
  ds_read_b64_tr_b16 a[20:21], v2 offset:640
  ds_read_b64_tr_b16 a[22:23], v2 offset:9088
  v_mfma_f32_16x16x32_bf16 v[164:167], a[4:7], a[172:175], v[164:167]
  buffer_load_dwordx4 a[144:147], v1, s[60:63], s46 offen offset:2048 sc1
  v_mfma_f32_16x16x32_bf16 v[164:167], a[0:3], a[168:171], v[164:167]
  v_mfma_f32_16x16x32_bf16 v[180:183], a[0:3], a[176:179], v[180:183]
  v_mfma_f32_16x16x32_bf16 v[180:183], a[4:7], a[180:183], v[180:183]
  v_mfma_f32_16x16x32_bf16 v[196:199], a[4:7], a[188:191], v[196:199]
  v_mfma_f32_16x16x32_bf16 v[196:199], a[0:3], a[184:187], v[196:199]
  s_waitcnt lgkmcnt(6)
  v_mfma_f32_16x16x32_bf16 v[92:95], a[8:11], a[184:187], v[92:95]
  s_waitcnt lgkmcnt(4)
  s_add_u32 s93, s93, 4096
  buffer_load_dwordx4 a[148:151], v1, s[60:63], s46 offen offset:3072 sc1
  v_mfma_f32_16x16x32_bf16 v[92:95], a[12:15], a[188:191], v[92:95]
  s_add_u32 s46, s46, 4096
  buffer_store_dwordx4 v[104:107], v1, s[8:11], s93 offen offset:1024 sc1
  v_mfma_f32_16x16x32_bf16 v[84:87], a[12:15], a[180:183], v[84:87]
  ds_read_b64_tr_b16 a[0:1], v2 offset:160
  ds_read_b64_tr_b16 a[2:3], v2 offset:8608
  v_mfma_f32_16x16x32_bf16 v[84:87], a[8:11], a[176:179], v[84:87]
  ds_read_b64_tr_b16 a[4:5], v2 offset:672
  ds_read_b64_tr_b16 a[6:7], v2 offset:9120
  v_mfma_f32_16x16x32_bf16 v[76:79], a[8:11], a[168:171], v[76:79]
  v_mfma_f32_16x16x32_bf16 v[76:79], a[12:15], a[172:175], v[76:79]
  v_mfma_f32_16x16x32_bf16 v[68:71], a[12:15], a[164:167], v[68:71]
  v_mfma_f32_16x16x32_bf16 v[68:71], a[8:11], a[160:163], v[68:71]
  s_waitcnt lgkmcnt(6)
  buffer_load_dwordx4 a[152:155], v1, s[60:63], s47 offen offset:2048 sc1
  v_mfma_f32_16x16x32_bf16 v[100:103], a[16:19], a[160:163], v[100:103]
  s_waitcnt lgkmcnt(4)
  ds_read_b64_tr_b16 a[8:9], v2 offset:192
  ds_read_b64_tr_b16 a[10:11], v2 offset:8640
  v_mfma_f32_16x16x32_bf16 v[100:103], a[20:23], a[164:167], v[100:103]
  ds_read_b64_tr_b16 a[12:13], v2 offset:704
  ds_read_b64_tr_b16 a[14:15], v2 offset:9152
  v_mfma_f32_16x16x32_bf16 v[108:111], a[20:23], a[172:175], v[108:111]
  v_mfma_f32_16x16x32_bf16 v[108:111], a[16:19], a[168:171], v[108:111]
  v_mfma_f32_16x16x32_bf16 v[116:119], a[16:19], a[176:179], v[116:119]
  v_mfma_f32_16x16x32_bf16 v[116:119], a[20:23], a[180:183], v[116:119]
  buffer_load_dwordx4 a[156:159], v1, s[60:63], s47 offen offset:3072 sc1
  v_mfma_f32_16x16x32_bf16 v[124:127], a[20:23], a[188:191], v[124:127]
  s_add_u32 s47, s47, 4096
  v_mfma_f32_16x16x32_bf16 v[124:127], a[16:19], a[184:187], v[124:127]
  s_waitcnt lgkmcnt(6)
  v_mfma_f32_16x16x32_bf16 v[220:223], a[0:3], a[184:187], v[220:223]
  s_waitcnt lgkmcnt(4)
  ds_read_b64_tr_b16 a[16:17], v2 offset:224
  ds_read_b64_tr_b16 a[18:19], v2 offset:8672
  v_mfma_f32_16x16x32_bf16 v[220:223], a[4:7], a[188:191], v[220:223]
  s_add_u32 m0, s42, 133120
  s_add_u32 s28, s40, 2621440
  ds_read_b64_tr_b16 a[20:21], v2 offset:736
  v_mfma_f32_16x16x32_bf16 v[212:215], a[4:7], a[180:183], v[212:215]
  ds_read_b64_tr_b16 a[22:23], v2 offset:9184
  v_mfma_f32_16x16x32_bf16 v[212:215], a[0:3], a[176:179], v[212:215]
  buffer_load_dwordx4 v6, s[52:55], s28 offen lds
  v_mfma_f32_16x16x32_bf16 v[140:143], a[0:3], a[168:171], v[140:143]
  v_mfma_f32_16x16x32_bf16 v[140:143], a[4:7], a[172:175], v[140:143]
  v_mfma_f32_16x16x32_bf16 v[132:135], a[4:7], a[164:167], v[132:135]
  s_waitcnt vmcnt(28)
  v_mfma_f32_16x16x32_bf16 v[132:135], a[0:3], a[160:163], v[132:135]
  s_barrier
  s_waitcnt lgkmcnt(6)
  v_mfma_f32_16x16x32_bf16 v[156:159], a[8:11], a[160:163], v[156:159]
  s_waitcnt lgkmcnt(4)
  s_add_u32 m0, s42, 134176
  s_add_u32 s28, s40, 2629632
  ds_read_b64_tr_b16 a[0:1], v2 offset:42240
  v_mfma_f32_16x16x32_bf16 v[156:159], a[12:15], a[164:167], v[156:159]
  ds_read_b64_tr_b16 a[2:3], v2 offset:42368
  ds_read_b64_tr_b16 a[4:5], v2 offset:42752
  v_mfma_f32_16x16x32_bf16 v[172:175], a[12:15], a[172:175], v[172:175]
  buffer_load_dwordx4 v6, s[52:55], s28 offen lds
  v_mfma_f32_16x16x32_bf16 v[172:175], a[8:11], a[168:171], v[172:175]
  ds_read_b64_tr_b16 a[6:7], v2 offset:42880
  v_mfma_f32_16x16x32_bf16 v[188:191], a[8:11], a[176:179], v[188:191]
  v_mfma_f32_16x16x32_bf16 v[188:191], a[12:15], a[180:183], v[188:191]
  v_mfma_f32_16x16x32_bf16 v[204:207], a[12:15], a[188:191], v[204:207]
  s_add_u32 m0, s42, 135232
  s_add_u32 s28, s40, 2637824
  v_mfma_f32_16x16x32_bf16 v[204:207], a[8:11], a[184:187], v[204:207]
  s_waitcnt lgkmcnt(6)
  buffer_store_dwordx4 v[112:115], v1, s[8:11], s93 offen offset:2048 sc1
  v_mfma_f32_16x16x32_bf16 v[252:255], a[16:19], a[184:187], v[252:255]
  s_waitcnt lgkmcnt(4)
  buffer_load_dwordx4 v6, s[52:55], s28 offen lds
  v_mfma_f32_16x16x32_bf16 v[252:255], a[20:23], a[188:191], v[252:255]
  ds_read_b64_tr_b16 a[8:9], v2 offset:42272
  ds_read_b64_tr_b16 a[10:11], v2 offset:42400
  v_mfma_f32_16x16x32_bf16 v[244:247], a[20:23], a[180:183], v[244:247]
  ds_read_b64_tr_b16 a[12:13], v2 offset:42784
  ds_read_b64_tr_b16 a[14:15], v2 offset:42912
  v_mfma_f32_16x16x32_bf16 v[244:247], a[16:19], a[176:179], v[244:247]
  v_mfma_f32_16x16x32_bf16 v[236:239], a[16:19], a[168:171], v[236:239]
  s_add_u32 m0, s42, 136288
  s_add_u32 s28, s40, 2646016
  v_mfma_f32_16x16x32_bf16 v[236:239], a[20:23], a[172:175], v[236:239]
  v_mfma_f32_16x16x32_bf16 v[228:231], a[20:23], a[164:167], v[228:231]
  buffer_load_dwordx4 v6, s[52:55], s28 offen lds
  v_mfma_f32_16x16x32_bf16 v[228:231], a[16:19], a[160:163], v[228:231]
  s_waitcnt lgkmcnt(6)
  v_mfma_f32_16x16x32_bf16 a[32:35], a[0:3], a[192:195], a[32:35]
  s_waitcnt lgkmcnt(4)
  ds_read_b64_tr_b16 a[16:17], v2 offset:42304
  ds_read_b64_tr_b16 a[18:19], v2 offset:42432
  v_mfma_f32_16x16x32_bf16 a[32:35], a[4:7], a[196:199], a[32:35]
  ds_read_b64_tr_b16 a[20:21], v2 offset:42816
  ds_read_b64_tr_b16 a[22:23], v2 offset:42944
  v_mfma_f32_16x16x32_bf16 a[48:51], a[4:7], a[204:207], a[48:51]
  v_mfma_f32_16x16x32_bf16 a[48:51], a[0:3], a[200:203], a[48:51]
  s_add_u32 m0, s43, 133120
  s_add_u32 s28, s41, 1105920
  v_mfma_f32_16x16x32_bf16 a[64:67], a[0:3], a[208:211], a[64:67]
  v_mfma_f32_16x16x32_bf16 a[64:67], a[4:7], a[212:215], a[64:67]
  buffer_load_dwordx4 v5, s[56:59], s28 offen lds
  v_mfma_f32_16x16x32_bf16 a[80:83], a[4:7], a[220:223], a[80:83]
  v_mfma_f32_16x16x32_bf16 a[80:83], a[0:3], a[216:219], a[80:83]
  s_waitcnt lgkmcnt(6)
  v_mfma_f32_16x16x32_bf16 a[84:87], a[8:11], a[216:219], a[84:87]
  s_waitcnt lgkmcnt(4)
  ds_read_b64_tr_b16 a[0:1], v2 offset:42336
  ds_read_b64_tr_b16 a[2:3], v2 offset:42464
  v_mfma_f32_16x16x32_bf16 a[84:87], a[12:15], a[220:223], a[84:87]
  s_add_u32 m0, s43, 134176
  s_add_u32 s28, s41, 1109376
  ds_read_b64_tr_b16 a[4:5], v2 offset:42848
  v_mfma_f32_16x16x32_bf16 a[68:71], a[12:15], a[212:215], a[68:71]
  ds_read_b64_tr_b16 a[6:7], v2 offset:42976
  v_mfma_f32_16x16x32_bf16 a[68:71], a[8:11], a[208:211], a[68:71]
  buffer_load_dwordx4 v5, s[56:59], s28 offen lds
  v_mfma_f32_16x16x32_bf16 a[52:55], a[8:11], a[200:203], a[52:55]
  v_mfma_f32_16x16x32_bf16 a[52:55], a[12:15], a[204:207], a[52:55]
  v_mfma_f32_16x16x32_bf16 a[36:39], a[12:15], a[196:199], a[36:39]
  v_mfma_f32_16x16x32_bf16 a[36:39], a[8:11], a[192:195], a[36:39]
  s_waitcnt lgkmcnt(6)
  v_mfma_f32_16x16x32_bf16 a[40:43], a[16:19], a[192:195], a[40:43]
  s_waitcnt lgkmcnt(4)
  ds_read_b64_tr_b16 a[8:9], v2 offset:25344
  ds_read_b64_tr_b16 a[10:11], v2 offset:33792
  v_mfma_f32_16x16x32_bf16 a[40:43], a[20:23], a[196:199], a[40:43]
  buffer_load_dwordx4 a[160:163], v1, s[60:63], s44 offen offset:0 sc1
  v_mfma_f32_16x16x32_bf16 a[56:59], a[20:23], a[204:207], a[56:59]
  ds_read_b64_tr_b16 a[12:13], v2 offset:25856
  ds_read_b64_tr_b16 a[14:15], v2 offset:34304
  v_mfma_f32_16x16x32_bf16 a[56:59], a[16:19], a[200:203], a[56:59]
  v_mfma_f32_16x16x32_bf16 a[72:75], a[16:19], a[208:211], a[72:75]
  v_mfma_f32_16x16x32_bf16 a[72:75], a[20:23], a[212:215], a[72:75]
  v_mfma_f32_16x16x32_bf16 a[88:91], a[20:23], a[220:223], a[88:91]
  buffer_store_dwordx4 v[120:123], v1, s[8:11], s93 offen offset:3072 sc1
  v_mfma_f32_16x16x32_bf16 a[88:91], a[16:19], a[216:219], a[88:91]
  s_waitcnt lgkmcnt(6)
  v_mfma_f32_16x16x32_bf16 a[92:95], a[0:3], a[216:219], a[92:95]
  s_waitcnt lgkmcnt(4)
  buffer_load_dwordx4 a[164:167], v1, s[60:63], s44 offen offset:1024 sc1
  v_mfma_f32_16x16x32_bf16 a[92:95], a[4:7], a[220:223], a[92:95]
  ds_read_b64_tr_b16 a[16:17], v2 offset:25376
  ds_read_b64_tr_b16 a[18:19], v2 offset:33824
  v_mfma_f32_16x16x32_bf16 a[76:79], a[4:7], a[212:215], a[76:79]
  ds_read_b64_tr_b16 a[20:21], v2 offset:25888
  ds_read_b64_tr_b16 a[22:23], v2 offset:34336
  v_mfma_f32_16x16x32_bf16 a[76:79], a[0:3], a[208:211], a[76:79]
  v_mfma_f32_16x16x32_bf16 a[60:63], a[0:3], a[200:203], a[60:63]
  v_mfma_f32_16x16x32_bf16 a[60:63], a[4:7], a[204:207], a[60:63]
  v_mfma_f32_16x16x32_bf16 a[44:47], a[4:7], a[196:199], a[44:47]
  buffer_load_dwordx4 a[168:171], v1, s[60:63], s45 offen offset:0 sc1
  v_mfma_f32_16x16x32_bf16 a[44:47], a[0:3], a[192:195], a[44:47]
  s_waitcnt lgkmcnt(6)
  v_mfma_f32_16x16x32_bf16 a[28:31], a[8:11], a[192:195], a[28:31]
  s_waitcnt lgkmcnt(4)
  ds_read_b64_tr_b16 a[0:1], v2 offset:25408
  ds_read_b64_tr_b16 a[2:3], v2 offset:33856
  v_mfma_f32_16x16x32_bf16 a[28:31], a[12:15], a[196:199], a[28:31]
  ds_read_b64_tr_b16 a[4:5], v2 offset:25920
  ds_read_b64_tr_b16 a[6:7], v2 offset:34368
  v_mfma_f32_16x16x32_bf16 a[24:27], a[12:15], a[204:207], a[24:27]
  v_mfma_f32_16x16x32_bf16 a[24:27], a[8:11], a[200:203], a[24:27]
  v_mfma_f32_16x16x32_bf16 v[20:23], a[8:11], a[208:211], v[20:23]
  buffer_load_dwordx4 a[172:175], v1, s[60:63], s45 offen offset:1024 sc1
  v_mfma_f32_16x16x32_bf16 v[20:23], a[12:15], a[212:215], v[20:23]
  v_mfma_f32_16x16x32_bf16 v[28:31], a[12:15], a[220:223], v[28:31]
  v_mfma_f32_16x16x32_bf16 v[28:31], a[8:11], a[216:219], v[28:31]
  s_waitcnt lgkmcnt(6)
  v_mfma_f32_16x16x32_bf16 v[60:63], a[16:19], a[216:219], v[60:63]
  s_waitcnt lgkmcnt(4)
  ds_read_b64_tr_b16 a[8:9], v2 offset:25440
  ds_read_b64_tr_b16 a[10:11], v2 offset:33888
  v_mfma_f32_16x16x32_bf16 v[60:63], a[20:23], a[220:223], v[60:63]
  ds_read_b64_tr_b16 a[12:13], v2 offset:25952
  ds_read_b64_tr_b16 a[14:15], v2 offset:34400
  v_mfma_f32_16x16x32_bf16 v[52:55], a[20:23], a[212:215], v[52:55]
  v_mfma_f32_16x16x32_bf16 v[52:55], a[16:19], a[208:211], v[52:55]
  buffer_load_dwordx4 a[176:179], v1, s[60:63], s46 offen offset:0 sc1
  v_mfma_f32_16x16x32_bf16 v[44:47], a[16:19], a[200:203], v[44:47]
  v_mfma_f32_16x16x32_bf16 v[44:47], a[20:23], a[204:207], v[44:47]
  v_mfma_f32_16x16x32_bf16 v[36:39], a[20:23], a[196:199], v[36:39]
  v_mfma_f32_16x16x32_bf16 v[36:39], a[16:19], a[192:195], v[36:39]
  s_waitcnt lgkmcnt(6)
  v_mfma_f32_16x16x32_bf16 v[148:151], a[0:3], a[192:195], v[148:151]
  s_waitcnt lgkmcnt(4)
  ds_read_b64_tr_b16 a[16:17], v2 offset:25472
  ds_read_b64_tr_b16 a[18:19], v2 offset:33920
  v_mfma_f32_16x16x32_bf16 v[148:151], a[4:7], a[196:199], v[148:151]
  buffer_load_dwordx4 a[180:183], v1, s[60:63], s46 offen offset:1024 sc1
  v_mfma_f32_16x16x32_bf16 v[164:167], a[4:7], a[204:207], v[164:167]
  ds_read_b64_tr_b16 a[20:21], v2 offset:25984
  ds_read_b64_tr_b16 a[22:23], v2 offset:34432
  v_mfma_f32_16x16x32_bf16 v[164:167], a[0:3], a[200:203], v[164:167]
  s_add_u32 s93, s93, 4096
  v_mfma_f32_16x16x32_bf16 v[180:183], a[0:3], a[208:211], v[180:183]
  buffer_store_dwordx4 v[136:139], v1, s[8:11], s93 offen offset:1024 sc1
  v_mfma_f32_16x16x32_bf16 v[180:183], a[4:7], a[212:215], v[180:183]
  v_mfma_f32_16x16x32_bf16 v[196:199], a[4:7], a[220:223], v[196:199]
  v_mfma_f32_16x16x32_bf16 v[196:199], a[0:3], a[216:219], v[196:199]
  s_waitcnt lgkmcnt(6)
  buffer_load_dwordx4 a[184:187], v1, s[60:63], s47 offen offset:0 sc1
  v_mfma_f32_16x16x32_bf16 v[92:95], a[8:11], a[216:219], v[92:95]
  s_waitcnt lgkmcnt(4)
  ds_read_b64_tr_b16 a[0:1], v2 offset:25504
  ds_read_b64_tr_b16 a[2:3], v2 offset:33952
  v_mfma_f32_16x16x32_bf16 v[92:95], a[12:15], a[220:223], v[92:95]
  ds_read_b64_tr_b16 a[4:5], v2 offset:26016
  ds_read_b64_tr_b16 a[6:7], v2 offset:34464
  v_mfma_f32_16x16x32_bf16 v[84:87], a[12:15], a[212:215], v[84:87]
  v_mfma_f32_16x16x32_bf16 v[84:87], a[8:11], a[208:211], v[84:87]
  v_mfma_f32_16x16x32_bf16 v[76:79], a[8:11], a[200:203], v[76:79]
  v_mfma_f32_16x16x32_bf16 v[76:79], a[12:15], a[204:207], v[76:79]
  buffer_load_dwordx4 a[188:191], v1, s[60:63], s47 offen offset:1024 sc1
  v_mfma_f32_16x16x32_bf16 v[68:71], a[12:15], a[196:199], v[68:71]
  v_mfma_f32_16x16x32_bf16 v[68:71], a[8:11], a[192:195], v[68:71]
  s_waitcnt lgkmcnt(6)
  v_mfma_f32_16x16x32_bf16 v[100:103], a[16:19], a[192:195], v[100:103]
  s_waitcnt lgkmcnt(4)
  ds_read_b64_tr_b16 a[8:9], v2 offset:25536
  ds_read_b64_tr_b16 a[10:11], v2 offset:33984
  v_mfma_f32_16x16x32_bf16 v[100:103], a[20:23], a[196:199], v[100:103]
  ds_read_b64_tr_b16 a[12:13], v2 offset:26048
  ds_read_b64_tr_b16 a[14:15], v2 offset:34496
  v_mfma_f32_16x16x32_bf16 v[108:111], a[20:23], a[204:207], v[108:111]
  s_add_u32 m0, s42, 73984
  s_add_u32 s28, s40, 3145728
  v_mfma_f32_16x16x32_bf16 v[108:111], a[16:19], a[200:203], v[108:111]
  v_mfma_f32_16x16x32_bf16 v[116:119], a[16:19], a[208:211], v[116:119]
  buffer_load_dwordx4 v6, s[52:55], s28 offen lds
  v_mfma_f32_16x16x32_bf16 v[116:119], a[20:23], a[212:215], v[116:119]
  v_mfma_f32_16x16x32_bf16 v[124:127], a[20:23], a[220:223], v[124:127]
  v_mfma_f32_16x16x32_bf16 v[124:127], a[16:19], a[216:219], v[124:127]
  s_waitcnt lgkmcnt(6)
  v_mfma_f32_16x16x32_bf16 v[220:223], a[0:3], a[216:219], v[220:223]
  s_waitcnt lgkmcnt(4)
  s_add_u32 m0, s42, 75040
  s_add_u32 s28, s40, 3153920
  ds_read_b64_tr_b16 a[16:17], v2 offset:25568
  v_mfma_f32_16x16x32_bf16 v[220:223], a[4:7], a[220:223], v[220:223]
  ds_read_b64_tr_b16 a[18:19], v2 offset:34016
  ds_read_b64_tr_b16 a[20:21], v2 offset:26080
  v_mfma_f32_16x16x32_bf16 v[212:215], a[4:7], a[212:215], v[212:215]
  buffer_load_dwordx4 v6, s[52:55], s28 offen lds
  v_mfma_f32_16x16x32_bf16 v[212:215], a[0:3], a[208:211], v[212:215]
  ds_read_b64_tr_b16 a[22:23], v2 offset:34528
  v_mfma_f32_16x16x32_bf16 v[140:143], a[0:3], a[200:203], v[140:143]
  v_mfma_f32_16x16x32_bf16 v[140:143], a[4:7], a[204:207], v[140:143]
  v_mfma_f32_16x16x32_bf16 v[132:135], a[4:7], a[196:199], v[132:135]
  s_waitcnt vmcnt(29)
  s_add_u32 m0, s42, 76096
  s_add_u32 s28, s40, 3162112
  v_mfma_f32_16x16x32_bf16 v[132:135], a[0:3], a[192:195], v[132:135]
  s_barrier
  s_waitcnt lgkmcnt(6)
  v_mfma_f32_16x16x32_bf16 v[156:159], a[8:11], a[192:195], v[156:159]
  s_waitcnt lgkmcnt(4)
  buffer_load_dwordx4 v6, s[52:55], s28 offen lds
  v_mfma_f32_16x16x32_bf16 v[156:159], a[12:15], a[196:199], v[156:159]
  ds_read_b64_tr_b16 a[0:1], v3 offset:48640
  ds_read_b64_tr_b16 a[2:3], v3 offset:48768
  v_mfma_f32_16x16x32_bf16 v[172:175], a[12:15], a[204:207], v[172:175]
  ds_read_b64_tr_b16 a[4:5], v3 offset:49152
  ds_read_b64_tr_b16 a[6:7], v3 offset:49280
  v_mfma_f32_16x16x32_bf16 v[172:175], a[8:11], a[200:203], v[172:175]
  buffer_store_dwordx4 v[144:147], v1, s[8:11], s93 offen offset:2048 sc1
  v_mfma_f32_16x16x32_bf16 v[188:191], a[8:11], a[208:211], v[188:191]
  v_mfma_f32_16x16x32_bf16 v[188:191], a[12:15], a[212:215], v[188:191]
  s_add_u32 m0, s42, 77152
  s_add_u32 s28, s40, 3170304
  v_mfma_f32_16x16x32_bf16 v[204:207], a[12:15], a[220:223], v[204:207]
  v_mfma_f32_16x16x32_bf16 v[204:207], a[8:11], a[216:219], v[204:207]
  s_waitcnt lgkmcnt(6)
  buffer_load_dwordx4 v6, s[52:55], s28 offen lds
  v_mfma_f32_16x16x32_bf16 v[252:255], a[16:19], a[216:219], v[252:255]
  s_waitcnt lgkmcnt(4)
  ds_read_b64_tr_b16 a[8:9], v3 offset:48672
  ds_read_b64_tr_b16 a[10:11], v3 offset:48800
  v_mfma_f32_16x16x32_bf16 v[252:255], a[20:23], a[220:223], v[252:255]
  ds_read_b64_tr_b16 a[12:13], v3 offset:49184
  ds_read_b64_tr_b16 a[14:15], v3 offset:49312
  v_mfma_f32_16x16x32_bf16 v[244:247], a[20:23], a[212:215], v[244:247]
  v_mfma_f32_16x16x32_bf16 v[244:247], a[16:19], a[208:211], v[244:247]
  s_add_u32 m0, s43, 73984
  s_add_u32 s28, s41, 1327104
  v_mfma_f32_16x16x32_bf16 v[236:239], a[16:19], a[200:203], v[236:239]
  v_mfma_f32_16x16x32_bf16 v[236:239], a[20:23], a[204:207], v[236:239]
  buffer_load_dwordx4 v5, s[56:59], s28 offen lds
  v_mfma_f32_16x16x32_bf16 v[228:231], a[20:23], a[196:199], v[228:231]
  v_mfma_f32_16x16x32_bf16 v[228:231], a[16:19], a[192:195], v[228:231]
  s_waitcnt lgkmcnt(6)
  v_mfma_f32_16x16x32_bf16 a[32:35], a[0:3], a[96:99], a[32:35]
  s_waitcnt lgkmcnt(4)
  ds_read_b64_tr_b16 a[16:17], v3 offset:48704
  ds_read_b64_tr_b16 a[18:19], v3 offset:48832
  v_mfma_f32_16x16x32_bf16 a[32:35], a[4:7], a[100:103], a[32:35]
  s_add_u32 m0, s43, 75040
  s_add_u32 s28, s41, 1330560
  ds_read_b64_tr_b16 a[20:21], v3 offset:49216
  v_mfma_f32_16x16x32_bf16 a[48:51], a[4:7], a[108:111], a[48:51]
  ds_read_b64_tr_b16 a[22:23], v3 offset:49344
  v_mfma_f32_16x16x32_bf16 a[48:51], a[0:3], a[104:107], a[48:51]
  buffer_load_dwordx4 v5, s[56:59], s28 offen lds
  v_mfma_f32_16x16x32_bf16 a[64:67], a[0:3], a[112:115], a[64:67]
  v_mfma_f32_16x16x32_bf16 a[64:67], a[4:7], a[116:119], a[64:67]
  v_mfma_f32_16x16x32_bf16 a[80:83], a[4:7], a[124:127], a[80:83]
  v_mfma_f32_16x16x32_bf16 a[80:83], a[0:3], a[120:123], a[80:83]
  s_waitcnt lgkmcnt(6)
  v_mfma_f32_16x16x32_bf16 a[84:87], a[8:11], a[120:123], a[84:87]
  s_waitcnt lgkmcnt(4)
  ds_read_b64_tr_b16 a[0:1], v3 offset:48736
  ds_read_b64_tr_b16 a[2:3], v3 offset:48864
  v_mfma_f32_16x16x32_bf16 a[84:87], a[12:15], a[124:127], a[84:87]
  ds_read_b64_tr_b16 a[4:5], v3 offset:49248
  ds_read_b64_tr_b16 a[6:7], v3 offset:49376
  v_mfma_f32_16x16x32_bf16 a[68:71], a[12:15], a[116:119], a[68:71]
  buffer_load_dwordx4 a[192:195], v1, s[60:63], s44 offen offset:2048 sc1
  v_mfma_f32_16x16x32_bf16 a[68:71], a[8:11], a[112:115], a[68:71]
  v_mfma_f32_16x16x32_bf16 a[52:55], a[8:11], a[104:107], a[52:55]
  v_mfma_f32_16x16x32_bf16 a[52:55], a[12:15], a[108:111], a[52:55]
  v_mfma_f32_16x16x32_bf16 a[36:39], a[12:15], a[100:103], a[36:39]
  v_mfma_f32_16x16x32_bf16 a[36:39], a[8:11], a[96:99], a[36:39]
  s_waitcnt lgkmcnt(6)
  v_mfma_f32_16x16x32_bf16 a[40:43], a[16:19], a[96:99], a[40:43]
  s_waitcnt lgkmcnt(4)
  buffer_load_dwordx4 a[196:199], v1, s[60:63], s44 offen offset:3072 sc1
  v_mfma_f32_16x16x32_bf16 a[40:43], a[20:23], a[100:103], a[40:43]
  s_add_u32 s44, s44, 4096
  buffer_store_dwordx4 v[152:155], v1, s[8:11], s93 offen offset:3072 sc1
  v_mfma_f32_16x16x32_bf16 a[56:59], a[20:23], a[108:111], a[56:59]
  ds_read_b64_tr_b16 a[8:9], v3 offset:31744
  ds_read_b64_tr_b16 a[10:11], v3 offset:40192
  v_mfma_f32_16x16x32_bf16 a[56:59], a[16:19], a[104:107], a[56:59]
  ds_read_b64_tr_b16 a[12:13], v3 offset:32256
  ds_read_b64_tr_b16 a[14:15], v3 offset:40704
  v_mfma_f32_16x16x32_bf16 a[72:75], a[16:19], a[112:115], a[72:75]
  v_mfma_f32_16x16x32_bf16 a[72:75], a[20:23], a[116:119], a[72:75]
  v_mfma_f32_16x16x32_bf16 a[88:91], a[20:23], a[124:127], a[88:91]
  buffer_load_dwordx4 a[200:203], v1, s[60:63], s45 offen offset:2048 sc1
  v_mfma_f32_16x16x32_bf16 a[88:91], a[16:19], a[120:123], a[88:91]
  s_waitcnt lgkmcnt(6)
  v_mfma_f32_16x16x32_bf16 a[92:95], a[0:3], a[120:123], a[92:95]
  s_waitcnt lgkmcnt(4)
  ds_read_b64_tr_b16 a[16:17], v3 offset:31776
  ds_read_b64_tr_b16 a[18:19], v3 offset:40224
  v_mfma_f32_16x16x32_bf16 a[92:95], a[4:7], a[124:127], a[92:95]
  ds_read_b64_tr_b16 a[20:21], v3 offset:32288
  ds_read_b64_tr_b16 a[22:23], v3 offset:40736
  v_mfma_f32_16x16x32_bf16 a[76:79], a[4:7], a[116:119], a[76:79]
  v_mfma_f32_16x16x32_bf16 a[76:79], a[0:3], a[112:115], a[76:79]
  v_mfma_f32_16x16x32_bf16 a[60:63], a[0:3], a[104:107], a[60:63]
  v_mfma_f32_16x16x32_bf16 a[60:63], a[4:7], a[108:111], a[60:63]
  buffer_load_dwordx4 a[204:207], v1, s[60:63], s45 offen offset:3072 sc1
  v_mfma_f32_16x16x32_bf16 a[44:47], a[4:7], a[100:103], a[44:47]
  s_add_u32 s45, s45, 4096
  v_mfma_f32_16x16x32_bf16 a[44:47], a[0:3], a[96:99], a[44:47]
  s_waitcnt lgkmcnt(6)
  v_mfma_f32_16x16x32_bf16 a[28:31], a[8:11], a[96:99], a[28:31]
  s_waitcnt lgkmcnt(4)
  ds_read_b64_tr_b16 a[0:1], v3 offset:31808
  ds_read_b64_tr_b16 a[2:3], v3 offset:40256
  v_mfma_f32_16x16x32_bf16 a[28:31], a[12:15], a[100:103], a[28:31]
  ds_read_b64_tr_b16 a[4:5], v3 offset:32320
  ds_read_b64_tr_b16 a[6:7], v3 offset:40768
  v_mfma_f32_16x16x32_bf16 a[24:27], a[12:15], a[108:111], a[24:27]
  v_mfma_f32_16x16x32_bf16 a[24:27], a[8:11], a[104:107], a[24:27]
  buffer_load_dwordx4 a[208:211], v1, s[60:63], s46 offen offset:2048 sc1
  v_mfma_f32_16x16x32_bf16 v[20:23], a[8:11], a[112:115], v[20:23]
  v_mfma_f32_16x16x32_bf16 v[20:23], a[12:15], a[116:119], v[20:23]
  v_mfma_f32_16x16x32_bf16 v[28:31], a[12:15], a[124:127], v[28:31]
  v_mfma_f32_16x16x32_bf16 v[28:31], a[8:11], a[120:123], v[28:31]
  s_waitcnt lgkmcnt(6)
  v_mfma_f32_16x16x32_bf16 v[60:63], a[16:19], a[120:123], v[60:63]
  s_waitcnt lgkmcnt(4)
  ds_read_b64_tr_b16 a[8:9], v3 offset:31840
  ds_read_b64_tr_b16 a[10:11], v3 offset:40288
  v_mfma_f32_16x16x32_bf16 v[60:63], a[20:23], a[124:127], v[60:63]
  buffer_load_dwordx4 a[212:215], v1, s[60:63], s46 offen offset:3072 sc1
  v_mfma_f32_16x16x32_bf16 v[52:55], a[20:23], a[116:119], v[52:55]
  s_add_u32 s46, s46, 4096
  ds_read_b64_tr_b16 a[12:13], v3 offset:32352
  ds_read_b64_tr_b16 a[14:15], v3 offset:40800
  v_mfma_f32_16x16x32_bf16 v[52:55], a[16:19], a[112:115], v[52:55]
  v_mfma_f32_16x16x32_bf16 v[44:47], a[16:19], a[104:107], v[44:47]
  v_mfma_f32_16x16x32_bf16 v[44:47], a[20:23], a[108:111], v[44:47]
  v_mfma_f32_16x16x32_bf16 v[36:39], a[20:23], a[100:103], v[36:39]
  v_mfma_f32_16x16x32_bf16 v[36:39], a[16:19], a[96:99], v[36:39]
  s_waitcnt lgkmcnt(6)
  s_add_u32 s93, s93, 4096
  v_mfma_f32_16x16x32_bf16 v[148:151], a[0:3], a[96:99], v[148:151]
  s_waitcnt lgkmcnt(4)
  buffer_store_dwordx4 v[168:171], v1, s[8:11], s93 offen offset:1024 sc1
  v_mfma_f32_16x16x32_bf16 v[148:151], a[4:7], a[100:103], v[148:151]
  buffer_load_dwordx4 a[216:219], v1, s[60:63], s47 offen offset:2048 sc1
  v_mfma_f32_16x16x32_bf16 v[164:167], a[4:7], a[108:111], v[164:167]
  ds_read_b64_tr_b16 a[16:17], v3 offset:31872
  ds_read_b64_tr_b16 a[18:19], v3 offset:40320
  v_mfma_f32_16x16x32_bf16 v[164:167], a[0:3], a[104:107], v[164:167]
  ds_read_b64_tr_b16 a[20:21], v3 offset:32384
  ds_read_b64_tr_b16 a[22:23], v3 offset:40832
  v_mfma_f32_16x16x32_bf16 v[180:183], a[0:3], a[112:115], v[180:183]
  v_mfma_f32_16x16x32_bf16 v[180:183], a[4:7], a[116:119], v[180:183]
  v_mfma_f32_16x16x32_bf16 v[196:199], a[4:7], a[124:127], v[196:199]
  buffer_load_dwordx4 a[220:223], v1, s[60:63], s47 offen offset:3072 sc1
  v_mfma_f32_16x16x32_bf16 v[196:199], a[0:3], a[120:123], v[196:199]
  s_waitcnt lgkmcnt(6)
  s_add_u32 s47, s47, 4096
  v_mfma_f32_16x16x32_bf16 v[92:95], a[8:11], a[120:123], v[92:95]
  s_waitcnt lgkmcnt(4)
  ds_read_b64_tr_b16 a[0:1], v3 offset:31904
  ds_read_b64_tr_b16 a[2:3], v3 offset:40352
  v_mfma_f32_16x16x32_bf16 v[92:95], a[12:15], a[124:127], v[92:95]
  ds_read_b64_tr_b16 a[4:5], v3 offset:32416
  ds_read_b64_tr_b16 a[6:7], v3 offset:40864
  v_mfma_f32_16x16x32_bf16 v[84:87], a[12:15], a[116:119], v[84:87]
  s_add_u32 m0, s42, 0
  s_add_u32 s28, s40, 3670016
  v_mfma_f32_16x16x32_bf16 v[84:87], a[8:11], a[112:115], v[84:87]
  v_mfma_f32_16x16x32_bf16 v[76:79], a[8:11], a[104:107], v[76:79]
  buffer_load_dwordx4 v6, s[52:55], s28 offen lds
  v_mfma_f32_16x16x32_bf16 v[76:79], a[12:15], a[108:111], v[76:79]
  v_mfma_f32_16x16x32_bf16 v[68:71], a[12:15], a[100:103], v[68:71]
  v_mfma_f32_16x16x32_bf16 v[68:71], a[8:11], a[96:99], v[68:71]
  s_waitcnt lgkmcnt(6)
  v_mfma_f32_16x16x32_bf16 v[100:103], a[16:19], a[96:99], v[100:103]
  s_waitcnt lgkmcnt(4)
  ds_read_b64_tr_b16 a[8:9], v3 offset:31936
  ds_read_b64_tr_b16 a[10:11], v3 offset:40384
  v_mfma_f32_16x16x32_bf16 v[100:103], a[20:23], a[100:103], v[100:103]
  s_add_u32 m0, s42, 1056
  s_add_u32 s28, s40, 3678208
  ds_read_b64_tr_b16 a[12:13], v3 offset:32448
  v_mfma_f32_16x16x32_bf16 v[108:111], a[20:23], a[108:111], v[108:111]
  ds_read_b64_tr_b16 a[14:15], v3 offset:40896
  v_mfma_f32_16x16x32_bf16 v[108:111], a[16:19], a[104:107], v[108:111]
  buffer_load_dwordx4 v6, s[52:55], s28 offen lds
  v_mfma_f32_16x16x32_bf16 v[116:119], a[16:19], a[112:115], v[116:119]
  v_mfma_f32_16x16x32_bf16 v[116:119], a[20:23], a[116:119], v[116:119]
  v_mfma_f32_16x16x32_bf16 v[124:127], a[20:23], a[124:127], v[124:127]
  v_mfma_f32_16x16x32_bf16 v[124:127], a[16:19], a[120:123], v[124:127]
  s_waitcnt lgkmcnt(6)
  s_add_u32 m0, s42, 2112
  s_add_u32 s28, s40, 3686400
  v_mfma_f32_16x16x32_bf16 v[220:223], a[0:3], a[120:123], v[220:223]
  s_waitcnt lgkmcnt(4)
  ds_read_b64_tr_b16 a[16:17], v3 offset:31968
  ds_read_b64_tr_b16 a[18:19], v3 offset:40416
  v_mfma_f32_16x16x32_bf16 v[220:223], a[4:7], a[124:127], v[220:223]
  buffer_load_dwordx4 v6, s[52:55], s28 offen lds
  v_mfma_f32_16x16x32_bf16 v[212:215], a[4:7], a[116:119], v[212:215]
  ds_read_b64_tr_b16 a[20:21], v3 offset:32480
  ds_read_b64_tr_b16 a[22:23], v3 offset:40928
  v_mfma_f32_16x16x32_bf16 v[212:215], a[0:3], a[112:115], v[212:215]
  v_mfma_f32_16x16x32_bf16 v[140:143], a[0:3], a[104:107], v[140:143]
  v_mfma_f32_16x16x32_bf16 v[140:143], a[4:7], a[108:111], v[140:143]
  s_add_u32 m0, s42, 3168
  s_add_u32 s28, s40, 3694592
  v_mfma_f32_16x16x32_bf16 v[132:135], a[4:7], a[100:103], v[132:135]
  s_waitcnt vmcnt(30)
  buffer_store_dwordx4 v[176:179], v1, s[8:11], s93 offen offset:2048 sc1
  v_mfma_f32_16x16x32_bf16 v[132:135], a[0:3], a[96:99], v[132:135]
  s_barrier
  buffer_load_dwordx4 v6, s[52:55], s28 offen lds
  s_waitcnt lgkmcnt(6)
  v_mfma_f32_16x16x32_bf16 v[156:159], a[8:11], a[96:99], v[156:159]
  s_waitcnt lgkmcnt(4)
  ds_read_b64_tr_b16 a[0:1], v11 offset:16896
  ds_read_b64_tr_b16 a[2:3], v11 offset:17024
  v_mfma_f32_16x16x32_bf16 v[156:159], a[12:15], a[100:103], v[156:159]
  ds_read_b64_tr_b16 a[4:5], v11 offset:17408
  ds_read_b64_tr_b16 a[6:7], v11 offset:17536
  v_mfma_f32_16x16x32_bf16 v[172:175], a[12:15], a[108:111], v[172:175]
  v_mfma_f32_16x16x32_bf16 v[172:175], a[8:11], a[104:107], v[172:175]
  v_mfma_f32_16x16x32_bf16 v[188:191], a[8:11], a[112:115], v[188:191]
  s_add_u32 m0, s43, 0
  s_add_u32 s28, s41, 1548288
  v_mfma_f32_16x16x32_bf16 v[188:191], a[12:15], a[116:119], v[188:191]
  v_mfma_f32_16x16x32_bf16 v[204:207], a[12:15], a[124:127], v[204:207]
  buffer_load_dwordx4 v5, s[56:59], s28 offen lds
  v_mfma_f32_16x16x32_bf16 v[204:207], a[8:11], a[120:123], v[204:207]
  s_waitcnt lgkmcnt(6)
  v_mfma_f32_16x16x32_bf16 v[252:255], a[16:19], a[120:123], v[252:255]
  s_waitcnt lgkmcnt(4)
  ds_read_b64_tr_b16 a[8:9], v11 offset:16928
  ds_read_b64_tr_b16 a[10:11], v11 offset:17056
  v_mfma_f32_16x16x32_bf16 v[252:255], a[20:23], a[124:127], v[252:255]
  ds_read_b64_tr_b16 a[12:13], v11 offset:17440
  ds_read_b64_tr_b16 a[14:15], v11 offset:17568
  v_mfma_f32_16x16x32_bf16 v[244:247], a[20:23], a[116:119], v[244:247]
  s_add_u32 m0, s43, 1056
  s_add_u32 s28, s41, 1551744
  v_mfma_f32_16x16x32_bf16 v[244:247], a[16:19], a[112:115], v[244:247]
  v_mfma_f32_16x16x32_bf16 v[236:239], a[16:19], a[104:107], v[236:239]
  buffer_load_dwordx4 v5, s[56:59], s28 offen lds
  v_mfma_f32_16x16x32_bf16 v[236:239], a[20:23], a[108:111], v[236:239]
  v_mfma_f32_16x16x32_bf16 v[228:231], a[20:23], a[100:103], v[228:231]
  v_mfma_f32_16x16x32_bf16 v[228:231], a[16:19], a[96:99], v[228:231]
  s_waitcnt lgkmcnt(6)
  v_mfma_f32_16x16x32_bf16 a[32:35], a[0:3], a[128:131], a[32:35]
  s_waitcnt lgkmcnt(4)
  ds_read_b64_tr_b16 a[16:17], v11 offset:16960
  ds_read_b64_tr_b16 a[18:19], v11 offset:17088
  v_mfma_f32_16x16x32_bf16 a[32:35], a[4:7], a[132:135], a[32:35]
  ds_read_b64_tr_b16 a[20:21], v11 offset:17472
  ds_read_b64_tr_b16 a[22:23], v11 offset:17600
  v_mfma_f32_16x16x32_bf16 a[48:51], a[4:7], a[140:143], a[48:51]
  buffer_load_dwordx4 a[96:99], v1, s[60:63], s44 offen offset:0 sc1
  v_mfma_f32_16x16x32_bf16 a[48:51], a[0:3], a[136:139], a[48:51]
  v_mfma_f32_16x16x32_bf16 a[64:67], a[0:3], a[144:147], a[64:67]
  v_mfma_f32_16x16x32_bf16 a[64:67], a[4:7], a[148:151], a[64:67]
  v_mfma_f32_16x16x32_bf16 a[80:83], a[4:7], a[156:159], a[80:83]
  v_mfma_f32_16x16x32_bf16 a[80:83], a[0:3], a[152:155], a[80:83]
  s_waitcnt lgkmcnt(6)
  v_mfma_f32_16x16x32_bf16 a[84:87], a[8:11], a[152:155], a[84:87]
  s_waitcnt lgkmcnt(4)
  ds_read_b64_tr_b16 a[0:1], v11 offset:16992
  ds_read_b64_tr_b16 a[2:3], v11 offset:17120
  v_mfma_f32_16x16x32_bf16 a[84:87], a[12:15], a[156:159], a[84:87]
  buffer_load_dwordx4 a[100:103], v1, s[60:63], s44 offen offset:1024 sc1
  v_mfma_f32_16x16x32_bf16 a[68:71], a[12:15], a[148:151], a[68:71]
  ds_read_b64_tr_b16 a[4:5], v11 offset:17504
  ds_read_b64_tr_b16 a[6:7], v11 offset:17632
  v_mfma_f32_16x16x32_bf16 a[68:71], a[8:11], a[144:147], a[68:71]
  v_mfma_f32_16x16x32_bf16 a[52:55], a[8:11], a[136:139], a[52:55]
  buffer_store_dwordx4 v[184:187], v1, s[8:11], s93 offen offset:3072 sc1
  v_mfma_f32_16x16x32_bf16 a[52:55], a[12:15], a[140:143], a[52:55]
  v_mfma_f32_16x16x32_bf16 a[36:39], a[12:15], a[132:135], a[36:39]
  v_mfma_f32_16x16x32_bf16 a[36:39], a[8:11], a[128:131], a[36:39]
  s_waitcnt lgkmcnt(6)
  buffer_load_dwordx4 a[104:107], v1, s[60:63], s45 offen offset:0 sc1
  v_mfma_f32_16x16x32_bf16 a[40:43], a[16:19], a[128:131], a[40:43]
  s_waitcnt lgkmcnt(4)
  ds_read_b64_tr_b16 a[8:9], v11 offset:0
  ds_read_b64_tr_b16 a[10:11], v11 offset:8448
  v_mfma_f32_16x16x32_bf16 a[40:43], a[20:23], a[132:135], a[40:43]
  ds_read_b64_tr_b16 a[12:13], v11 offset:512
  ds_read_b64_tr_b16 a[14:15], v11 offset:8960
  v_mfma_f32_16x16x32_bf16 a[56:59], a[20:23], a[140:143], a[56:59]
  v_mfma_f32_16x16x32_bf16 a[56:59], a[16:19], a[136:139], a[56:59]
  v_mfma_f32_16x16x32_bf16 a[72:75], a[16:19], a[144:147], a[72:75]
  v_mfma_f32_16x16x32_bf16 a[72:75], a[20:23], a[148:151], a[72:75]
  buffer_load_dwordx4 a[108:111], v1, s[60:63], s45 offen offset:1024 sc1
  v_mfma_f32_16x16x32_bf16 a[88:91], a[20:23], a[156:159], a[88:91]
  v_mfma_f32_16x16x32_bf16 a[88:91], a[16:19], a[152:155], a[88:91]
  s_waitcnt lgkmcnt(6)
  v_mfma_f32_16x16x32_bf16 a[92:95], a[0:3], a[152:155], a[92:95]
  s_waitcnt lgkmcnt(4)
  ds_read_b64_tr_b16 a[16:17], v11 offset:32
  ds_read_b64_tr_b16 a[18:19], v11 offset:8480
  v_mfma_f32_16x16x32_bf16 a[92:95], a[4:7], a[156:159], a[92:95]
  ds_read_b64_tr_b16 a[20:21], v11 offset:544
  ds_read_b64_tr_b16 a[22:23], v11 offset:8992
  v_mfma_f32_16x16x32_bf16 a[76:79], a[4:7], a[148:151], a[76:79]
  v_mfma_f32_16x16x32_bf16 a[76:79], a[0:3], a[144:147], a[76:79]
  v_mfma_f32_16x16x32_bf16 a[60:63], a[0:3], a[136:139], a[60:63]
  buffer_load_dwordx4 a[112:115], v1, s[60:63], s46 offen offset:0 sc1
  v_mfma_f32_16x16x32_bf16 a[60:63], a[4:7], a[140:143], a[60:63]
  v_mfma_f32_16x16x32_bf16 a[44:47], a[4:7], a[132:135], a[44:47]
  v_mfma_f32_16x16x32_bf16 a[44:47], a[0:3], a[128:131], a[44:47]
  s_waitcnt lgkmcnt(6)
  v_mfma_f32_16x16x32_bf16 a[28:31], a[8:11], a[128:131], a[28:31]
  s_waitcnt lgkmcnt(4)
  ds_read_b64_tr_b16 a[0:1], v11 offset:64
  ds_read_b64_tr_b16 a[2:3], v11 offset:8512
  v_mfma_f32_16x16x32_bf16 a[28:31], a[12:15], a[132:135], a[28:31]
  ds_read_b64_tr_b16 a[4:5], v11 offset:576
  ds_read_b64_tr_b16 a[6:7], v11 offset:9024
  v_mfma_f32_16x16x32_bf16 a[24:27], a[12:15], a[140:143], a[24:27]
  buffer_load_dwordx4 a[116:119], v1, s[60:63], s46 offen offset:1024 sc1
  v_mfma_f32_16x16x32_bf16 a[24:27], a[8:11], a[136:139], a[24:27]
  v_mfma_f32_16x16x32_bf16 v[20:23], a[8:11], a[144:147], v[20:23]
  v_mfma_f32_16x16x32_bf16 v[20:23], a[12:15], a[148:151], v[20:23]
  v_mfma_f32_16x16x32_bf16 v[28:31], a[12:15], a[156:159], v[28:31]
  v_mfma_f32_16x16x32_bf16 v[28:31], a[8:11], a[152:155], v[28:31]
  s_waitcnt lgkmcnt(6)
  v_mfma_f32_16x16x32_bf16 v[60:63], a[16:19], a[152:155], v[60:63]
  s_waitcnt lgkmcnt(4)
  buffer_load_dwordx4 a[120:123], v1, s[60:63], s47 offen offset:0 sc1
  v_mfma_f32_16x16x32_bf16 v[60:63], a[20:23], a[156:159], v[60:63]
  ds_read_b64_tr_b16 a[8:9], v11 offset:96
  ds_read_b64_tr_b16 a[10:11], v11 offset:8544
  v_mfma_f32_16x16x32_bf16 v[52:55], a[20:23], a[148:151], v[52:55]
  s_add_u32 s93, s93, 4096
  ds_read_b64_tr_b16 a[12:13], v11 offset:608
  ds_read_b64_tr_b16 a[14:15], v11 offset:9056
  v_mfma_f32_16x16x32_bf16 v[52:55], a[16:19], a[144:147], v[52:55]
  buffer_store_dwordx4 v[200:203], v1, s[8:11], s93 offen offset:1024 sc1
  v_mfma_f32_16x16x32_bf16 v[44:47], a[16:19], a[136:139], v[44:47]
  v_mfma_f32_16x16x32_bf16 v[44:47], a[20:23], a[140:143], v[44:47]
  v_mfma_f32_16x16x32_bf16 v[36:39], a[20:23], a[132:135], v[36:39]
  v_mfma_f32_16x16x32_bf16 v[36:39], a[16:19], a[128:131], v[36:39]
  s_waitcnt lgkmcnt(6)
  buffer_load_dwordx4 a[124:127], v1, s[60:63], s47 offen offset:1024 sc1
  v_mfma_f32_16x16x32_bf16 v[148:151], a[0:3], a[128:131], v[148:151]
  s_waitcnt lgkmcnt(4)
  ds_read_b64_tr_b16 a[16:17], v11 offset:128
  ds_read_b64_tr_b16 a[18:19], v11 offset:8576
  v_mfma_f32_16x16x32_bf16 v[148:151], a[4:7], a[132:135], v[148:151]
  ds_read_b64_tr_b16 a[20:21], v11 offset:640
  ds_read_b64_tr_b16 a[22:23], v11 offset:9088
  v_mfma_f32_16x16x32_bf16 v[164:167], a[4:7], a[140:143], v[164:167]
  v_mfma_f32_16x16x32_bf16 v[164:167], a[0:3], a[136:139], v[164:167]
  s_add_u32 m0, s42, 25344
  s_add_u32 s28, s40, 4194304
  v_mfma_f32_16x16x32_bf16 v[180:183], a[0:3], a[144:147], v[180:183]
  v_mfma_f32_16x16x32_bf16 v[180:183], a[4:7], a[148:151], v[180:183]
  buffer_load_dwordx4 v6, s[52:55], s28 offen lds
  v_mfma_f32_16x16x32_bf16 v[196:199], a[4:7], a[156:159], v[196:199]
  v_mfma_f32_16x16x32_bf16 v[196:199], a[0:3], a[152:155], v[196:199]
  s_waitcnt lgkmcnt(6)
  v_mfma_f32_16x16x32_bf16 v[92:95], a[8:11], a[152:155], v[92:95]
  s_waitcnt lgkmcnt(4)
  ds_read_b64_tr_b16 a[0:1], v11 offset:160
  ds_read_b64_tr_b16 a[2:3], v11 offset:8608
  v_mfma_f32_16x16x32_bf16 v[92:95], a[12:15], a[156:159], v[92:95]
  s_add_u32 m0, s42, 26400
  s_add_u32 s28, s40, 4202496
  ds_read_b64_tr_b16 a[4:5], v11 offset:672
  v_mfma_f32_16x16x32_bf16 v[84:87], a[12:15], a[148:151], v[84:87]
  ds_read_b64_tr_b16 a[6:7], v11 offset:9120
  v_mfma_f32_16x16x32_bf16 v[84:87], a[8:11], a[144:147], v[84:87]
  buffer_load_dwordx4 v6, s[52:55], s28 offen lds
  v_mfma_f32_16x16x32_bf16 v[76:79], a[8:11], a[136:139], v[76:79]
  v_mfma_f32_16x16x32_bf16 v[76:79], a[12:15], a[140:143], v[76:79]
  v_mfma_f32_16x16x32_bf16 v[68:71], a[12:15], a[132:135], v[68:71]
  v_mfma_f32_16x16x32_bf16 v[68:71], a[8:11], a[128:131], v[68:71]
  s_waitcnt lgkmcnt(6)
  v_mfma_f32_16x16x32_bf16 v[100:103], a[16:19], a[128:131], v[100:103]
  s_waitcnt lgkmcnt(4)
  s_add_u32 m0, s42, 27456
  s_add_u32 s28, s40, 4210688
  ds_read_b64_tr_b16 a[8:9], v11 offset:192
  v_mfma_f32_16x16x32_bf16 v[100:103], a[20:23], a[132:135], v[100:103]
  ds_read_b64_tr_b16 a[10:11], v11 offset:8640
  ds_read_b64_tr_b16 a[12:13], v11 offset:704
  v_mfma_f32_16x16x32_bf16 v[108:111], a[20:23], a[140:143], v[108:111]
  buffer_load_dwordx4 v6, s[52:55], s28 offen lds
  v_mfma_f32_16x16x32_bf16 v[108:111], a[16:19], a[136:139], v[108:111]
  ds_read_b64_tr_b16 a[14:15], v11 offset:9152
  v_mfma_f32_16x16x32_bf16 v[116:119], a[16:19], a[144:147], v[116:119]
  v_mfma_f32_16x16x32_bf16 v[116:119], a[20:23], a[148:151], v[116:119]
  v_mfma_f32_16x16x32_bf16 v[124:127], a[20:23], a[156:159], v[124:127]
  s_add_u32 m0, s42, 28512
  s_add_u32 s28, s40, 4218880
  v_mfma_f32_16x16x32_bf16 v[124:127], a[16:19], a[152:155], v[124:127]
  s_waitcnt lgkmcnt(6)
  v_mfma_f32_16x16x32_bf16 v[220:223], a[0:3], a[152:155], v[220:223]
  s_waitcnt lgkmcnt(4)
  buffer_load_dwordx4 v6, s[52:55], s28 offen lds
  v_mfma_f32_16x16x32_bf16 v[220:223], a[4:7], a[156:159], v[220:223]
  buffer_store_dwordx4 v[208:211], v1, s[8:11], s93 offen offset:2048 sc1
  v_mfma_f32_16x16x32_bf16 v[212:215], a[4:7], a[148:151], v[212:215]
  ds_read_b64_tr_b16 a[16:17], v11 offset:224
  ds_read_b64_tr_b16 a[18:19], v11 offset:8672
  v_mfma_f32_16x16x32_bf16 v[212:215], a[0:3], a[144:147], v[212:215]
  ds_read_b64_tr_b16 a[20:21], v11 offset:736
  ds_read_b64_tr_b16 a[22:23], v11 offset:9184
  v_mfma_f32_16x16x32_bf16 v[140:143], a[0:3], a[136:139], v[140:143]
  s_add_u32 m0, s43, 25344
  s_add_u32 s28, s41, 1769472
  v_mfma_f32_16x16x32_bf16 v[140:143], a[4:7], a[140:143], v[140:143]
  v_mfma_f32_16x16x32_bf16 v[132:135], a[4:7], a[132:135], v[132:135]
  s_waitcnt vmcnt(32)
  buffer_load_dwordx4 v5, s[56:59], s28 offen lds
  v_mfma_f32_16x16x32_bf16 v[132:135], a[0:3], a[128:131], v[132:135]
  s_barrier
  s_waitcnt lgkmcnt(6)
  v_mfma_f32_16x16x32_bf16 v[156:159], a[8:11], a[128:131], v[156:159]
  s_waitcnt lgkmcnt(4)
  ds_read_b64_tr_b16 a[0:1], v3 offset:16896
  ds_read_b64_tr_b16 a[2:3], v3 offset:17024
  v_mfma_f32_16x16x32_bf16 v[156:159], a[12:15], a[132:135], v[156:159]
  ds_read_b64_tr_b16 a[4:5], v3 offset:17408
  ds_read_b64_tr_b16 a[6:7], v3 offset:17536
  v_mfma_f32_16x16x32_bf16 v[172:175], a[12:15], a[140:143], v[172:175]
  v_mfma_f32_16x16x32_bf16 v[172:175], a[8:11], a[136:139], v[172:175]
  s_add_u32 m0, s43, 26400
  s_add_u32 s28, s41, 1772928
  v_mfma_f32_16x16x32_bf16 v[188:191], a[8:11], a[144:147], v[188:191]
  v_mfma_f32_16x16x32_bf16 v[188:191], a[12:15], a[148:151], v[188:191]
  buffer_load_dwordx4 v5, s[56:59], s28 offen lds
  v_mfma_f32_16x16x32_bf16 v[204:207], a[12:15], a[156:159], v[204:207]
  v_mfma_f32_16x16x32_bf16 v[204:207], a[8:11], a[152:155], v[204:207]
  s_waitcnt lgkmcnt(6)
  v_mfma_f32_16x16x32_bf16 v[252:255], a[16:19], a[152:155], v[252:255]
  s_waitcnt lgkmcnt(4)
  ds_read_b64_tr_b16 a[8:9], v3 offset:16928
  ds_read_b64_tr_b16 a[10:11], v3 offset:17056
  v_mfma_f32_16x16x32_bf16 v[252:255], a[20:23], a[156:159], v[252:255]
  ds_read_b64_tr_b16 a[12:13], v3 offset:17440
  ds_read_b64_tr_b16 a[14:15], v3 offset:17568
  v_mfma_f32_16x16x32_bf16 v[244:247], a[20:23], a[148:151], v[244:247]
  v_mfma_f32_16x16x32_bf16 v[244:247], a[16:19], a[144:147], v[244:247]
  v_mfma_f32_16x16x32_bf16 v[236:239], a[16:19], a[136:139], v[236:239]
  v_mfma_f32_16x16x32_bf16 v[236:239], a[20:23], a[140:143], v[236:239]
  v_mfma_f32_16x16x32_bf16 v[228:231], a[20:23], a[132:135], v[228:231]
  v_mfma_f32_16x16x32_bf16 v[228:231], a[16:19], a[128:131], v[228:231]
  s_waitcnt lgkmcnt(6)
  v_mfma_f32_16x16x32_bf16 a[32:35], a[0:3], a[160:163], a[32:35]
  s_waitcnt lgkmcnt(4)
  buffer_load_dwordx4 a[128:131], v1, s[60:63], s44 offen offset:2048 sc1
  v_mfma_f32_16x16x32_bf16 a[32:35], a[4:7], a[164:167], a[32:35]
  buffer_load_dwordx4 a[132:135], v1, s[60:63], s44 offen offset:3072 sc1
  v_mfma_f32_16x16x32_bf16 a[48:51], a[4:7], a[172:175], a[48:51]
  ds_read_b64_tr_b16 a[16:17], v3 offset:16960
  ds_read_b64_tr_b16 a[18:19], v3 offset:17088
  v_mfma_f32_16x16x32_bf16 a[48:51], a[0:3], a[168:171], a[48:51]
  ds_read_b64_tr_b16 a[20:21], v3 offset:17472
  ds_read_b64_tr_b16 a[22:23], v3 offset:17600
  v_mfma_f32_16x16x32_bf16 a[64:67], a[0:3], a[176:179], a[64:67]
  v_mfma_f32_16x16x32_bf16 a[64:67], a[4:7], a[180:183], a[64:67]
  v_mfma_f32_16x16x32_bf16 a[80:83], a[4:7], a[188:191], a[80:83]
  v_mfma_f32_16x16x32_bf16 a[80:83], a[0:3], a[184:187], a[80:83]
  s_waitcnt lgkmcnt(6)
  v_mfma_f32_16x16x32_bf16 a[84:87], a[8:11], a[184:187], a[84:87]
  s_waitcnt lgkmcnt(4)
  buffer_store_dwordx4 v[216:219], v1, s[8:11], s93 offen offset:3072 sc1
  v_mfma_f32_16x16x32_bf16 a[84:87], a[12:15], a[188:191], a[84:87]
  buffer_load_dwordx4 a[136:139], v1, s[60:63], s45 offen offset:2048 sc1
  v_mfma_f32_16x16x32_bf16 a[68:71], a[12:15], a[180:183], a[68:71]
  ds_read_b64_tr_b16 a[0:1], v3 offset:16992
  ds_read_b64_tr_b16 a[2:3], v3 offset:17120
  v_mfma_f32_16x16x32_bf16 a[68:71], a[8:11], a[176:179], a[68:71]
  ds_read_b64_tr_b16 a[4:5], v3 offset:17504
  ds_read_b64_tr_b16 a[6:7], v3 offset:17632
  v_mfma_f32_16x16x32_bf16 a[52:55], a[8:11], a[168:171], a[52:55]
  v_mfma_f32_16x16x32_bf16 a[52:55], a[12:15], a[172:175], a[52:55]
  v_mfma_f32_16x16x32_bf16 a[36:39], a[12:15], a[164:167], a[36:39]
  buffer_load_dwordx4 a[140:143], v1, s[60:63], s45 offen offset:3072 sc1
  v_mfma_f32_16x16x32_bf16 a[36:39], a[8:11], a[160:163], a[36:39]
  s_waitcnt lgkmcnt(6)
  v_mfma_f32_16x16x32_bf16 a[40:43], a[16:19], a[160:163], a[40:43]
  s_waitcnt lgkmcnt(4)
  ds_read_b64_tr_b16 a[8:9], v3 offset:0
  ds_read_b64_tr_b16 a[10:11], v3 offset:8448
  v_mfma_f32_16x16x32_bf16 a[40:43], a[20:23], a[164:167], a[40:43]
  ds_read_b64_tr_b16 a[12:13], v3 offset:512
  ds_read_b64_tr_b16 a[14:15], v3 offset:8960
  v_mfma_f32_16x16x32_bf16 a[56:59], a[20:23], a[172:175], a[56:59]
  v_mfma_f32_16x16x32_bf16 a[56:59], a[16:19], a[168:171], a[56:59]
  v_mfma_f32_16x16x32_bf16 a[72:75], a[16:19], a[176:179], a[72:75]
  buffer_load_dwordx4 a[144:147], v1, s[60:63], s46 offen offset:2048 sc1
  v_mfma_f32_16x16x32_bf16 a[72:75], a[20:23], a[180:183], a[72:75]
  v_mfma_f32_16x16x32_bf16 a[88:91], a[20:23], a[188:191], a[88:91]
  v_mfma_f32_16x16x32_bf16 a[88:91], a[16:19], a[184:187], a[88:91]
  s_waitcnt lgkmcnt(6)
  v_mfma_f32_16x16x32_bf16 a[92:95], a[0:3], a[184:187], a[92:95]
  s_waitcnt lgkmcnt(4)
  ds_read_b64_tr_b16 a[16:17], v3 offset:32
  ds_read_b64_tr_b16 a[18:19], v3 offset:8480
  v_mfma_f32_16x16x32_bf16 a[92:95], a[4:7], a[188:191], a[92:95]
  ds_read_b64_tr_b16 a[20:21], v3 offset:544
  ds_read_b64_tr_b16 a[22:23], v3 offset:8992
  v_mfma_f32_16x16x32_bf16 a[76:79], a[4:7], a[180:183], a[76:79]
  v_mfma_f32_16x16x32_bf16 a[76:79], a[0:3], a[176:179], a[76:79]
  buffer_load_dwordx4 a[148:151], v1, s[60:63], s46 offen offset:3072 sc1
  v_mfma_f32_16x16x32_bf16 a[60:63], a[0:3], a[168:171], a[60:63]
  v_mfma_f32_16x16x32_bf16 a[60:63], a[4:7], a[172:175], a[60:63]
  v_mfma_f32_16x16x32_bf16 a[44:47], a[4:7], a[164:167], a[44:47]
  v_mfma_f32_16x16x32_bf16 a[44:47], a[0:3], a[160:163], a[44:47]
  s_waitcnt lgkmcnt(6)
  v_mfma_f32_16x16x32_bf16 a[28:31], a[8:11], a[160:163], a[28:31]
  s_waitcnt lgkmcnt(4)
  ds_read_b64_tr_b16 a[0:1], v3 offset:64
  ds_read_b64_tr_b16 a[2:3], v3 offset:8512
  v_mfma_f32_16x16x32_bf16 a[28:31], a[12:15], a[164:167], a[28:31]
  buffer_load_dwordx4 a[152:155], v1, s[60:63], s47 offen offset:2048 sc1
  v_mfma_f32_16x16x32_bf16 a[24:27], a[12:15], a[172:175], a[24:27]
  ds_read_b64_tr_b16 a[4:5], v3 offset:576
  ds_read_b64_tr_b16 a[6:7], v3 offset:9024
  v_mfma_f32_16x16x32_bf16 a[24:27], a[8:11], a[168:171], a[24:27]
  v_mfma_f32_16x16x32_bf16 v[20:23], a[8:11], a[176:179], v[20:23]
  v_mfma_f32_16x16x32_bf16 v[20:23], a[12:15], a[180:183], v[20:23]
  s_add_u32 s93, s93, 4096
  v_mfma_f32_16x16x32_bf16 v[28:31], a[12:15], a[188:191], v[28:31]
  buffer_store_dwordx4 v[232:235], v1, s[8:11], s93 offen offset:1024 sc1
  v_mfma_f32_16x16x32_bf16 v[28:31], a[8:11], a[184:187], v[28:31]
  s_waitcnt lgkmcnt(6)
  buffer_load_dwordx4 a[156:159], v1, s[60:63], s47 offen offset:3072 sc1
  v_mfma_f32_16x16x32_bf16 v[60:63], a[16:19], a[184:187], v[60:63]
  s_waitcnt lgkmcnt(4)
  ds_read_b64_tr_b16 a[8:9], v3 offset:96
  ds_read_b64_tr_b16 a[10:11], v3 offset:8544
  v_mfma_f32_16x16x32_bf16 v[60:63], a[20:23], a[188:191], v[60:63]
  ds_read_b64_tr_b16 a[12:13], v3 offset:608
  ds_read_b64_tr_b16 a[14:15], v3 offset:9056
  v_mfma_f32_16x16x32_bf16 v[52:55], a[20:23], a[180:183], v[52:55]
  v_mfma_f32_16x16x32_bf16 v[52:55], a[16:19], a[176:179], v[52:55]
  v_mfma_f32_16x16x32_bf16 v[44:47], a[16:19], a[168:171], v[44:47]
  s_add_u32 m0, s42, 105728
  s_add_u32 s28, s40, 4718592
  v_mfma_f32_16x16x32_bf16 v[44:47], a[20:23], a[172:175], v[44:47]
  v_mfma_f32_16x16x32_bf16 v[36:39], a[20:23], a[164:167], v[36:39]
  buffer_load_dwordx4 v6, s[52:55], s28 offen lds
  v_mfma_f32_16x16x32_bf16 v[36:39], a[16:19], a[160:163], v[36:39]
  s_waitcnt lgkmcnt(6)
  v_mfma_f32_16x16x32_bf16 v[148:151], a[0:3], a[160:163], v[148:151]
  s_waitcnt lgkmcnt(4)
  ds_read_b64_tr_b16 a[16:17], v3 offset:128
  ds_read_b64_tr_b16 a[18:19], v3 offset:8576
  v_mfma_f32_16x16x32_bf16 v[148:151], a[4:7], a[164:167], v[148:151]
  ds_read_b64_tr_b16 a[20:21], v3 offset:640
  ds_read_b64_tr_b16 a[22:23], v3 offset:9088
  v_mfma_f32_16x16x32_bf16 v[164:167], a[4:7], a[172:175], v[164:167]
  s_add_u32 m0, s42, 106784
  s_add_u32 s28, s40, 4726784
  v_mfma_f32_16x16x32_bf16 v[164:167], a[0:3], a[168:171], v[164:167]
  v_mfma_f32_16x16x32_bf16 v[180:183], a[0:3], a[176:179], v[180:183]
  buffer_load_dwordx4 v6, s[52:55], s28 offen lds
  v_mfma_f32_16x16x32_bf16 v[180:183], a[4:7], a[180:183], v[180:183]
  v_mfma_f32_16x16x32_bf16 v[196:199], a[4:7], a[188:191], v[196:199]
  v_mfma_f32_16x16x32_bf16 v[196:199], a[0:3], a[184:187], v[196:199]
  s_waitcnt lgkmcnt(6)
  v_mfma_f32_16x16x32_bf16 v[92:95], a[8:11], a[184:187], v[92:95]
  s_waitcnt lgkmcnt(4)
  s_add_u32 m0, s42, 107840
  s_add_u32 s28, s40, 4734976
  ds_read_b64_tr_b16 a[0:1], v3 offset:160
  v_mfma_f32_16x16x32_bf16 v[92:95], a[12:15], a[188:191], v[92:95]
  ds_read_b64_tr_b16 a[2:3], v3 offset:8608
  ds_read_b64_tr_b16 a[4:5], v3 offset:672
  v_mfma_f32_16x16x32_bf16 v[84:87], a[12:15], a[180:183], v[84:87]
  buffer_load_dwordx4 v6, s[52:55], s28 offen lds
  v_mfma_f32_16x16x32_bf16 v[84:87], a[8:11], a[176:179], v[84:87]
  ds_read_b64_tr_b16 a[6:7], v3 offset:9120
  v_mfma_f32_16x16x32_bf16 v[76:79], a[8:11], a[168:171], v[76:79]
  v_mfma_f32_16x16x32_bf16 v[76:79], a[12:15], a[172:175], v[76:79]
  v_mfma_f32_16x16x32_bf16 v[68:71], a[12:15], a[164:167], v[68:71]
  v_mfma_f32_16x16x32_bf16 v[68:71], a[8:11], a[160:163], v[68:71]
  s_waitcnt lgkmcnt(6)
  s_add_u32 m0, s42, 108896
  s_add_u32 s28, s40, 4743168
  v_mfma_f32_16x16x32_bf16 v[100:103], a[16:19], a[160:163], v[100:103]
  s_waitcnt lgkmcnt(4)
  ds_read_b64_tr_b16 a[8:9], v3 offset:192
  ds_read_b64_tr_b16 a[10:11], v3 offset:8640
  v_mfma_f32_16x16x32_bf16 v[100:103], a[20:23], a[164:167], v[100:103]
  buffer_load_dwordx4 v6, s[52:55], s28 offen lds
  v_mfma_f32_16x16x32_bf16 v[108:111], a[20:23], a[172:175], v[108:111]
  ds_read_b64_tr_b16 a[12:13], v3 offset:704
  ds_read_b64_tr_b16 a[14:15], v3 offset:9152
  v_mfma_f32_16x16x32_bf16 v[108:111], a[16:19], a[168:171], v[108:111]
  v_mfma_f32_16x16x32_bf16 v[116:119], a[16:19], a[176:179], v[116:119]
  v_mfma_f32_16x16x32_bf16 v[116:119], a[20:23], a[180:183], v[116:119]
  s_add_u32 m0, s43, 105728
  s_add_u32 s28, s41, 1990656
  v_mfma_f32_16x16x32_bf16 v[124:127], a[20:23], a[188:191], v[124:127]
  buffer_store_dwordx4 v[240:243], v1, s[8:11], s93 offen offset:2048 sc1
  v_mfma_f32_16x16x32_bf16 v[124:127], a[16:19], a[184:187], v[124:127]
  s_waitcnt lgkmcnt(6)
  buffer_load_dwordx4 v5, s[56:59], s28 offen lds
  v_mfma_f32_16x16x32_bf16 v[220:223], a[0:3], a[184:187], v[220:223]
  s_waitcnt lgkmcnt(4)
  ds_read_b64_tr_b16 a[16:17], v3 offset:224
  ds_read_b64_tr_b16 a[18:19], v3 offset:8672
  v_mfma_f32_16x16x32_bf16 v[220:223], a[4:7], a[188:191], v[220:223]
  ds_read_b64_tr_b16 a[20:21], v3 offset:736
  ds_read_b64_tr_b16 a[22:23], v3 offset:9184
  v_mfma_f32_16x16x32_bf16 v[212:215], a[4:7], a[180:183], v[212:215]
  v_mfma_f32_16x16x32_bf16 v[212:215], a[0:3], a[176:179], v[212:215]
  s_add_u32 m0, s43, 106784
  s_add_u32 s28, s41, 1994112
  v_mfma_f32_16x16x32_bf16 v[140:143], a[0:3], a[168:171], v[140:143]
  v_mfma_f32_16x16x32_bf16 v[140:143], a[4:7], a[172:175], v[140:143]
  buffer_load_dwordx4 v5, s[56:59], s28 offen lds
  v_mfma_f32_16x16x32_bf16 v[132:135], a[4:7], a[164:167], v[132:135]
  s_waitcnt vmcnt(34)
  v_mfma_f32_16x16x32_bf16 v[132:135], a[0:3], a[160:163], v[132:135]
  s_barrier
  s_waitcnt lgkmcnt(6)
  v_mfma_f32_16x16x32_bf16 v[156:159], a[8:11], a[160:163], v[156:159]
  s_waitcnt lgkmcnt(4)
  ds_read_b64_tr_b16 a[0:1], v2 offset:16896
  ds_read_b64_tr_b16 a[2:3], v2 offset:17024
  v_mfma_f32_16x16x32_bf16 v[156:159], a[12:15], a[164:167], v[156:159]
  ds_read_b64_tr_b16 a[4:5], v2 offset:17408
  ds_read_b64_tr_b16 a[6:7], v2 offset:17536
  v_mfma_f32_16x16x32_bf16 v[172:175], a[12:15], a[172:175], v[172:175]
  v_mfma_f32_16x16x32_bf16 v[172:175], a[8:11], a[168:171], v[172:175]
  v_mfma_f32_16x16x32_bf16 v[188:191], a[8:11], a[176:179], v[188:191]
  v_mfma_f32_16x16x32_bf16 v[188:191], a[12:15], a[180:183], v[188:191]
  v_mfma_f32_16x16x32_bf16 v[204:207], a[12:15], a[188:191], v[204:207]
  v_mfma_f32_16x16x32_bf16 v[204:207], a[8:11], a[184:187], v[204:207]
  s_waitcnt lgkmcnt(6)
  v_mfma_f32_16x16x32_bf16 v[252:255], a[16:19], a[184:187], v[252:255]
  s_waitcnt lgkmcnt(4)
  ds_read_b64_tr_b16 a[8:9], v2 offset:16928
  ds_read_b64_tr_b16 a[10:11], v2 offset:17056
  v_mfma_f32_16x16x32_bf16 v[252:255], a[20:23], a[188:191], v[252:255]
  ds_read_b64_tr_b16 a[12:13], v2 offset:17440
  ds_read_b64_tr_b16 a[14:15], v2 offset:17568
  v_mfma_f32_16x16x32_bf16 v[244:247], a[20:23], a[180:183], v[244:247]
  v_mfma_f32_16x16x32_bf16 v[244:247], a[16:19], a[176:179], v[244:247]
  v_mfma_f32_16x16x32_bf16 v[236:239], a[16:19], a[168:171], v[236:239]
  v_mfma_f32_16x16x32_bf16 v[236:239], a[20:23], a[172:175], v[236:239]
  v_mfma_f32_16x16x32_bf16 v[228:231], a[20:23], a[164:167], v[228:231]
  v_mfma_f32_16x16x32_bf16 v[228:231], a[16:19], a[160:163], v[228:231]
  s_waitcnt lgkmcnt(6)
  v_mfma_f32_16x16x32_bf16 a[32:35], a[0:3], a[192:195], a[32:35]
  s_waitcnt lgkmcnt(4)
  ds_read_b64_tr_b16 a[16:17], v2 offset:16960
  ds_read_b64_tr_b16 a[18:19], v2 offset:17088
  v_mfma_f32_16x16x32_bf16 a[32:35], a[4:7], a[196:199], a[32:35]
  ds_read_b64_tr_b16 a[20:21], v2 offset:17472
  ds_read_b64_tr_b16 a[22:23], v2 offset:17600
  v_mfma_f32_16x16x32_bf16 a[48:51], a[4:7], a[204:207], a[48:51]
  v_mfma_f32_16x16x32_bf16 a[48:51], a[0:3], a[200:203], a[48:51]
  buffer_store_dwordx4 v[248:251], v1, s[8:11], s93 offen offset:3072 sc1
  v_mfma_f32_16x16x32_bf16 a[64:67], a[0:3], a[208:211], a[64:67]
  v_mfma_f32_16x16x32_bf16 a[64:67], a[4:7], a[212:215], a[64:67]
  v_mfma_f32_16x16x32_bf16 a[80:83], a[4:7], a[220:223], a[80:83]
  v_mfma_f32_16x16x32_bf16 a[80:83], a[0:3], a[216:219], a[80:83]
  s_waitcnt lgkmcnt(6)
  v_mfma_f32_16x16x32_bf16 a[84:87], a[8:11], a[216:219], a[84:87]
  s_waitcnt lgkmcnt(4)
  s_sub_u32 s52, 15, s5
  ds_read_b64_tr_b16 a[0:1], v2 offset:16992
  ds_read_b64_tr_b16 a[2:3], v2 offset:17120
  v_mfma_f32_16x16x32_bf16 a[84:87], a[12:15], a[220:223], a[84:87]
  ds_read_b64_tr_b16 a[4:5], v2 offset:17504
  ds_read_b64_tr_b16 a[6:7], v2 offset:17632
  v_mfma_f32_16x16x32_bf16 a[68:71], a[12:15], a[212:215], a[68:71]
  s_bitcmp1_b32 s7, 0
  s_cselect_b32 s52, s52, s5
  s_lshr_b32 s53, s7, 1
  v_mfma_f32_16x16x32_bf16 a[68:71], a[8:11], a[208:211], a[68:71]
  s_lshl_b32 s61, s52, 2
  s_add_u32 s61, s61, s53
  s_mul_i32 s59, s61, 163840
  v_mfma_f32_16x16x32_bf16 a[52:55], a[8:11], a[200:203], a[52:55]
  s_mul_i32 s54, s3, 2560
  s_add_u32 s59, s59, s54
  s_add_u32 s59, s59, 63963136
  v_mfma_f32_16x16x32_bf16 a[52:55], a[12:15], a[204:207], a[52:55]
  s_mul_i32 s54, s6, 40960
  s_add_u32 s60, s59, s54
  s_add_u32 s54, s6, 1
  v_mfma_f32_16x16x32_bf16 a[36:39], a[12:15], a[196:199], a[36:39]
  s_waitcnt vmcnt(18)
  s_and_b32 s54, s54, 3
  s_mul_i32 s54, s54, 10240
  s_add_u32 s56, s60, s54
  v_mfma_f32_16x16x32_bf16 a[36:39], a[8:11], a[192:195], a[36:39]
  s_barrier
  s_add_u32 s54, s6, 2
  s_and_b32 s54, s54, 3
  s_waitcnt lgkmcnt(6)
  v_mfma_f32_16x16x32_bf16 a[40:43], a[16:19], a[192:195], a[40:43]
  s_waitcnt lgkmcnt(4)
  s_mul_i32 s54, s54, 10240
  ds_read_b64_tr_b16 a[8:9], v2 offset:42240
  ds_read_b64_tr_b16 a[10:11], v2 offset:42368
  v_mfma_f32_16x16x32_bf16 a[40:43], a[20:23], a[196:199], a[40:43]
  s_add_u32 s57, s60, s54
  ds_read_b64_tr_b16 a[12:13], v2 offset:42752
  ds_read_b64_tr_b16 a[14:15], v2 offset:42880
  v_mfma_f32_16x16x32_bf16 a[56:59], a[20:23], a[204:207], a[56:59]
  s_add_u32 s54, s6, 3
  s_and_b32 s54, s54, 3
  s_mul_i32 s54, s54, 10240
  v_mfma_f32_16x16x32_bf16 a[56:59], a[16:19], a[200:203], a[56:59]
  s_add_u32 s58, s60, s54
  s_mul_i32 s54, s6, 10240
  s_add_u32 s59, s59, s54
  v_mfma_f32_16x16x32_bf16 a[72:75], a[16:19], a[208:211], a[72:75]
  s_add_u32 s61, s61, 96
  s_lshl_b32 s61, s61, 7
  s_lshl_b32 s52, s52, 3
  v_mfma_f32_16x16x32_bf16 a[72:75], a[20:23], a[212:215], a[72:75]
  s_lshl_b32 s54, s3, 1
  s_add_u32 s52, s52, s54
  s_and_b32 s54, s6, 1
  v_mfma_f32_16x16x32_bf16 a[88:91], a[20:23], a[220:223], a[88:91]
  s_add_u32 s52, s52, s54
  s_mul_i32 s60, s52, 20480
  s_mul_i32 s53, s53, 320
  v_mfma_f32_16x16x32_bf16 a[88:91], a[16:19], a[216:219], a[88:91]
  s_waitcnt lgkmcnt(6)
  s_add_u32 s60, s60, s53
  s_lshr_b32 s54, s6, 1
  s_mul_i32 s54, s54, 160
  v_mfma_f32_16x16x32_bf16 a[92:95], a[0:3], a[216:219], a[92:95]
  s_waitcnt lgkmcnt(4)
  s_add_u32 s60, s60, s54
  ds_read_b64_tr_b16 a[16:17], v2 offset:42272
  ds_read_b64_tr_b16 a[18:19], v2 offset:42400
  v_mfma_f32_16x16x32_bf16 a[92:95], a[4:7], a[220:223], a[92:95]
  s_mov_b32 s84, s64
  ds_read_b64_tr_b16 a[20:21], v2 offset:42784
  ds_read_b64_tr_b16 a[22:23], v2 offset:42912
  v_mfma_f32_16x16x32_bf16 a[76:79], a[4:7], a[212:215], a[76:79]
  s_and_b32 s85, s65, 0xffff
  s_mov_b32 s86, 2621440
  s_mov_b32 s87, 0x20000
  v_mfma_f32_16x16x32_bf16 a[76:79], a[0:3], a[208:211], a[76:79]
  s_mov_b32 s40, s8
  s_mov_b32 s41, s9
  s_mov_b32 s43, 0x20000
  v_mfma_f32_16x16x32_bf16 a[60:63], a[0:3], a[200:203], a[60:63]
  s_sub_u32 s52, 15, s5
  s_bitcmp1_b32 s7, 0
  s_cselect_b32 s53, s52, s5
  v_mfma_f32_16x16x32_bf16 a[60:63], a[4:7], a[204:207], a[60:63]
  s_lshl_b32 s53, s53, 3
  s_lshl_b32 s54, s3, 1
  s_add_u32 s53, s53, s54
  v_mfma_f32_16x16x32_bf16 a[44:47], a[4:7], a[196:199], a[44:47]
  s_mul_i32 s53, s53, 188416
  s_mul_i32 s54, s6, 47104
  s_add_u32 s53, s53, s54
  v_mfma_f32_16x16x32_bf16 a[44:47], a[0:3], a[192:195], a[44:47]
  s_waitcnt lgkmcnt(6)
  s_add_u32 s46, s53, 38797312
  s_add_u32 s47, s46, 188416
  s_mul_i32 s44, s3, 5120
  v_mfma_f32_16x16x32_bf16 a[32:35], a[8:11], a[96:99], a[32:35]
  s_waitcnt lgkmcnt(4)
  s_mul_i32 s0, s3, 5120
  ds_read_b64_tr_b16 a[0:1], v2 offset:42304
  ds_read_b64_tr_b16 a[2:3], v2 offset:42432
  v_mfma_f32_16x16x32_bf16 a[32:35], a[12:15], a[100:103], a[32:35]
  s_add_u32 s1, s0, 163840
  ds_read_b64_tr_b16 a[4:5], v2 offset:42816
  ds_read_b64_tr_b16 a[6:7], v2 offset:42944
  v_mfma_f32_16x16x32_bf16 a[48:51], a[12:15], a[108:111], a[48:51]
  s_bitcmp1_b32 s52, 0
  s_cselect_b32 s53, 0, 81920
  s_add_u32 s96, s0, s53
  v_mfma_f32_16x16x32_bf16 a[48:51], a[8:11], a[104:107], a[48:51]
  s_mov_b32 s42, 268435456
  s_lshl_b32 s55, s53, 1
  s_sub_u32 s55, 81920, s55
  v_mfma_f32_16x16x32_bf16 a[64:67], a[8:11], a[112:115], a[64:67]
  s_lshl_b32 s45, s6, 2
  s_lshr_b32 s54, s7, 1
  s_add_u32 s45, s45, s54
  v_mfma_f32_16x16x32_bf16 a[64:67], a[12:15], a[116:119], a[64:67]
  s_mul_i32 s45, s45, 471040
  s_add_u32 s45, s45, 75497472
  s_lshl_b32 s53, s5, 3
  v_mfma_f32_16x16x32_bf16 a[80:83], a[12:15], a[124:127], a[80:83]
  s_add_u32 s53, s53, s7
  s_lshl_b32 s53, s53, 2
  s_add_u32 s53, s53, s3
  v_mfma_f32_16x16x32_bf16 a[80:83], a[8:11], a[120:123], a[80:83]
  s_waitcnt lgkmcnt(6)
  s_mul_i32 s54, s53, 205
  s_lshr_b32 s54, s54, 10
  s_mul_i32 s31, s54, 5
  v_mfma_f32_16x16x32_bf16 a[84:87], a[16:19], a[120:123], a[84:87]
  s_waitcnt lgkmcnt(4)
  s_sub_u32 s53, s53, s31
  ds_read_b64_tr_b16 a[8:9], v2 offset:42336
  ds_read_b64_tr_b16 a[10:11], v2 offset:42464
  v_mfma_f32_16x16x32_bf16 a[84:87], a[20:23], a[124:127], a[84:87]
  s_mul_i32 s31, s6, 14
  ds_read_b64_tr_b16 a[12:13], v2 offset:42848
  ds_read_b64_tr_b16 a[14:15], v2 offset:42976
  v_mfma_f32_16x16x32_bf16 a[68:71], a[20:23], a[116:119], a[68:71]
  s_min_u32 s31, s31, 40
  s_add_u32 s31, s31, s54
  s_lshl_b32 s38, s6, 5
  v_mfma_f32_16x16x32_bf16 a[68:71], a[16:19], a[112:115], a[68:71]
  s_add_u32 s38, s38, s54
  s_sub_u32 s38, s38, 14
  v_mfma_f32_16x16x32_bf16 a[52:55], a[16:19], a[104:107], a[52:55]
  s_cmp_lt_u32 s54, 14
  s_cselect_b32 s31, s31, s38
  v_mfma_f32_16x16x32_bf16 a[52:55], a[20:23], a[108:111], a[52:55]
  s_cmp_lt_u32 s54, 14
  s_cselect_b64 s[16:17], s[80:81], s[74:75]
  s_and_b32 s17, s17, 0xffff
  v_mfma_f32_16x16x32_bf16 a[36:39], a[20:23], a[100:103], a[36:39]
  s_waitcnt vmcnt(1)
  s_mov_b32 s18, 5242880
  s_cmp_lt_u32 s54, 14
  s_cselect_b32 s18, 2211840, s18
  v_mfma_f32_16x16x32_bf16 a[36:39], a[16:19], a[96:99], a[36:39]
  s_barrier
  s_cmp_lt_u32 s54, 46
  s_cselect_b32 s18, s18, 0
  s_waitcnt lgkmcnt(6)
  v_mfma_f32_16x16x32_bf16 a[40:43], a[0:3], a[96:99], a[40:43]
  s_waitcnt lgkmcnt(4)
  s_lshr_b32 s90, s2, 3
  ds_read_b64_tr_b16 a[16:17], v3 offset:48640
  ds_read_b64_tr_b16 a[18:19], v3 offset:48768
  v_mfma_f32_16x16x32_bf16 a[40:43], a[4:7], a[100:103], a[40:43]
  s_lshl_b32 s90, s90, 2
  ds_read_b64_tr_b16 a[20:21], v3 offset:49152
  ds_read_b64_tr_b16 a[22:23], v3 offset:49280
  v_mfma_f32_16x16x32_bf16 a[56:59], a[4:7], a[108:111], a[56:59]
  s_add_u32 s90, s90, s3
  s_and_b32 s90, s90, 127
  s_mul_i32 s90, s90, 256
  v_mfma_f32_16x16x32_bf16 a[56:59], a[0:3], a[104:107], a[56:59]
  s_mov_b32 s19, 0x20000
  v_and_b32 v7, 3, v0
  v_min_u32 v7, 1, v7
  v_mfma_f32_16x16x32_bf16 a[72:75], a[0:3], a[112:115], a[72:75]
  s_mul_i32 s31, s31, 40960
  v_lshlrev_b32 v7, 7, v7
  v_add_u32 v7, s90, v7
  v_mfma_f32_16x16x32_bf16 a[72:75], a[4:7], a[116:119], a[72:75]
  s_getpc_b64 s[88:89]
L_ct_a:
  v_min_u32 v7, L_att_e-L_att, v7
  v_add_u32 v7, L_att-L_ct_a, v7
  v_mfma_f32_16x16x32_bf16 a[88:91], a[4:7], a[124:127], a[88:91]
  s_lshl_b32 s38, s53, 8
  global_load_dword v10, v7, s[88:89]
  v_mfma_f32_16x16x32_bf16 a[88:91], a[0:3], a[120:123], a[88:91]
  s_waitcnt lgkmcnt(6)
  s_add_u32 s52, s31, s38
  s_lshl_b32 s53, s53, 3
  s_mul_i32 s31, s53, 205
  v_mfma_f32_16x16x32_bf16 a[92:95], a[8:11], a[120:123], a[92:95]
  s_waitcnt lgkmcnt(4)
  s_lshr_b32 s31, s31, 11
  ds_read_b64_tr_b16 a[0:1], v3 offset:48672
  ds_read_b64_tr_b16 a[2:3], v3 offset:48800
  v_mfma_f32_16x16x32_bf16 a[92:95], a[12:15], a[124:127], a[92:95]
  s_mul_i32 s38, s31, 10
  ds_read_b64_tr_b16 a[4:5], v3 offset:49184
  ds_read_b64_tr_b16 a[6:7], v3 offset:49312
  v_mfma_f32_16x16x32_bf16 a[76:79], a[12:15], a[116:119], a[76:79]
  s_sub_u32 s53, s53, s38
  s_lshl_b32 s38, s6, 2
  s_add_u32 s31, s31, s38
  v_mfma_f32_16x16x32_bf16 a[76:79], a[8:11], a[112:115], a[76:79]
  s_mul_i32 s31, s31, 46
  s_add_u32 s31, s31, s54
  s_mul_i32 s31, s31, 10
  v_mfma_f32_16x16x32_bf16 a[60:63], a[8:11], a[104:107], a[60:63]
  s_add_u32 s31, s31, s53
  s_lshl_b32 s31, s31, 10
  s_add_u32 s20, s31, 75497472
  v_mfma_f32_16x16x32_bf16 a[60:63], a[12:15], a[108:111], a[60:63]
  s_cmp_lt_u32 s54, 46
  s_cselect_b32 s20, s20, 536870912
  s_movk_i32 s54, 0x400
  v_mfma_f32_16x16x32_bf16 a[44:47], a[12:15], a[100:103], a[44:47]
  s_cmp_eq_u32 s53, 9
  s_cselect_b32 s31, 461824, s54
  s_add_u32 s21, s20, s31
  v_mfma_f32_16x16x32_bf16 a[44:47], a[8:11], a[96:99], a[44:47]
  s_waitcnt lgkmcnt(6)
  s_cmp_eq_u32 s53, 8
  s_cselect_b32 s31, 461824, s54
  s_add_u32 s22, s21, s31
  v_mfma_f32_16x16x32_bf16 a[32:35], a[16:19], a[128:131], a[32:35]
  s_waitcnt lgkmcnt(4)
  ds_read_b64_tr_b16 a[8:9], v3 offset:48704
  ds_read_b64_tr_b16 a[10:11], v3 offset:48832
  v_mfma_f32_16x16x32_bf16 a[32:35], a[20:23], a[132:135], a[32:35]
  ds_read_b64_tr_b16 a[12:13], v3 offset:49216
  ds_read_b64_tr_b16 a[14:15], v3 offset:49344
  v_mfma_f32_16x16x32_bf16 a[48:51], a[20:23], a[140:143], a[48:51]
  s_cmp_eq_u32 s53, 7
  s_cselect_b32 s31, 461824, s54
  s_add_u32 s23, s22, s31
  v_mfma_f32_16x16x32_bf16 a[48:51], a[16:19], a[136:139], a[48:51]
  s_cmp_eq_u32 s53, 6
  s_cselect_b32 s31, 461824, s54
  s_add_u32 s24, s23, s31
  v_mfma_f32_16x16x32_bf16 a[64:67], a[16:19], a[144:147], a[64:67]
  s_cmp_eq_u32 s53, 5
  s_cselect_b32 s31, 461824, s54
  s_add_u32 s25, s24, s31
  v_mfma_f32_16x16x32_bf16 a[64:67], a[20:23], a[148:151], a[64:67]
  s_cmp_eq_u32 s53, 4
  s_cselect_b32 s31, 461824, s54
  s_add_u32 s26, s25, s31
  v_mfma_f32_16x16x32_bf16 a[80:83], a[20:23], a[156:159], a[80:83]
  s_cmp_eq_u32 s53, 3
  s_cselect_b32 s31, 461824, s54
  s_add_u32 s27, s26, s31
  v_mfma_f32_16x16x32_bf16 a[80:83], a[16:19], a[152:155], a[80:83]
  s_waitcnt lgkmcnt(6)
  s_lshl_b32 s97, s6, 1
  s_cmp_ge_u32 s5, 5
  s_addc_u32 s97, s97, 160
  v_mfma_f32_16x16x32_bf16 a[84:87], a[0:3], a[152:155], a[84:87]
  s_waitcnt lgkmcnt(4)
  s_lshl_b32 s97, s97, 7
  ds_read_b64_tr_b16 a[16:17], v3 offset:48736
  ds_read_b64_tr_b16 a[18:19], v3 offset:48864
  v_mfma_f32_16x16x32_bf16 a[84:87], a[4:7], a[156:159], a[84:87]
  ds_read_b64_tr_b16 a[20:21], v3 offset:49248
  ds_read_b64_tr_b16 a[22:23], v3 offset:49376
  v_mfma_f32_16x16x32_bf16 a[68:71], a[4:7], a[148:151], a[68:71]
  s_cmp_eq_u32 s3, 0
  s_cselect_b32 s97, s97, 536870912
  v_mfma_f32_16x16x32_bf16 a[68:71], a[0:3], a[144:147], a[68:71]
  v_mfma_f32_16x16x32_bf16 a[52:55], a[0:3], a[136:139], a[52:55]
  v_mfma_f32_16x16x32_bf16 a[52:55], a[4:7], a[140:143], a[52:55]
  v_mfma_f32_16x16x32_bf16 a[36:39], a[4:7], a[132:135], a[36:39]
  v_mfma_f32_16x16x32_bf16 a[36:39], a[0:3], a[128:131], a[36:39]
  s_waitcnt lgkmcnt(6)
  v_mfma_f32_16x16x32_bf16 a[40:43], a[8:11], a[128:131], a[40:43]
  s_waitcnt lgkmcnt(4)
  ds_read_b64_tr_b16 a[0:1], v2 offset:0
  ds_read_b64_tr_b16 a[2:3], v2 offset:8448
  v_mfma_f32_16x16x32_bf16 a[40:43], a[12:15], a[132:135], a[40:43]
  ds_read_b64_tr_b16 a[4:5], v2 offset:512
  ds_read_b64_tr_b16 a[6:7], v2 offset:8960
  v_mfma_f32_16x16x32_bf16 a[56:59], a[12:15], a[140:143], a[56:59]
  v_mfma_f32_16x16x32_bf16 a[56:59], a[8:11], a[136:139], a[56:59]
  v_mfma_f32_16x16x32_bf16 a[72:75], a[8:11], a[144:147], a[72:75]
  v_mfma_f32_16x16x32_bf16 a[72:75], a[12:15], a[148:151], a[72:75]
  v_mfma_f32_16x16x32_bf16 a[88:91], a[12:15], a[156:159], a[88:91]
  v_mfma_f32_16x16x32_bf16 a[88:91], a[8:11], a[152:155], a[88:91]
  s_waitcnt lgkmcnt(6)
  v_mfma_f32_16x16x32_bf16 a[92:95], a[16:19], a[152:155], a[92:95]
  s_waitcnt lgkmcnt(4)
  ds_read_b64_tr_b16 a[8:9], v2 offset:32
  ds_read_b64_tr_b16 a[10:11], v2 offset:8480
  v_mfma_f32_16x16x32_bf16 a[92:95], a[20:23], a[156:159], a[92:95]
  ds_read_b64_tr_b16 a[12:13], v2 offset:544
  ds_read_b64_tr_b16 a[14:15], v2 offset:8992
  v_mfma_f32_16x16x32_bf16 a[76:79], a[20:23], a[148:151], a[76:79]
  v_mfma_f32_16x16x32_bf16 a[76:79], a[16:19], a[144:147], a[76:79]
  v_mfma_f32_16x16x32_bf16 a[60:63], a[16:19], a[136:139], a[60:63]
  v_mfma_f32_16x16x32_bf16 a[60:63], a[20:23], a[140:143], a[60:63]
  v_mfma_f32_16x16x32_bf16 a[44:47], a[20:23], a[132:135], a[44:47]
  v_mfma_f32_16x16x32_bf16 a[44:47], a[16:19], a[128:131], a[44:47]
  s_waitcnt lgkmcnt(6)
  v_mfma_f32_16x16x32_bf16 a[28:31], a[0:3], a[192:195], a[28:31]
  s_waitcnt lgkmcnt(4)
  ds_read_b64_tr_b16 a[16:17], v2 offset:64
  ds_read_b64_tr_b16 a[18:19], v2 offset:8512
  v_mfma_f32_16x16x32_bf16 a[28:31], a[4:7], a[196:199], a[28:31]
  ds_read_b64_tr_b16 a[20:21], v2 offset:576
  ds_read_b64_tr_b16 a[22:23], v2 offset:9024
  v_mfma_f32_16x16x32_bf16 a[24:27], a[4:7], a[204:207], a[24:27]
  v_mfma_f32_16x16x32_bf16 a[24:27], a[0:3], a[200:203], a[24:27]
  v_mfma_f32_16x16x32_bf16 v[20:23], a[0:3], a[208:211], v[20:23]
  v_mfma_f32_16x16x32_bf16 v[20:23], a[4:7], a[212:215], v[20:23]
  v_accvgpr_read_b32 v16, a32
  v_accvgpr_read_b32 v17, a33
  v_mfma_f32_16x16x32_bf16 v[28:31], a[4:7], a[220:223], v[28:31]
  v_accvgpr_read_b32 v18, a34
  v_accvgpr_read_b32 v19, a35
  v_mfma_f32_16x16x32_bf16 v[28:31], a[0:3], a[216:219], v[28:31]
  s_waitcnt lgkmcnt(6)
  v_accvgpr_read_b32 v24, a36
  v_accvgpr_read_b32 v25, a37
  v_mfma_f32_16x16x32_bf16 v[60:63], a[8:11], a[216:219], v[60:63]
  s_waitcnt lgkmcnt(4)
  ds_read_b64_tr_b16 a[0:1], v2 offset:96
  ds_read_b64_tr_b16 a[2:3], v2 offset:8544
  v_mfma_f32_16x16x32_bf16 v[60:63], a[12:15], a[220:223], v[60:63]
  ds_read_b64_tr_b16 a[4:5], v2 offset:608
  ds_read_b64_tr_b16 a[6:7], v2 offset:9056
  v_mfma_f32_16x16x32_bf16 v[52:55], a[12:15], a[212:215], v[52:55]
  v_accvgpr_read_b32 v26, a38
  v_accvgpr_read_b32 v27, a39
  v_mfma_f32_16x16x32_bf16 v[52:55], a[8:11], a[208:211], v[52:55]
  v_mul_f32 v32, 0xbfb8aa3b, v16
  v_mul_f32 v33, 0xbfb8aa3b, v17
  v_mfma_f32_16x16x32_bf16 v[44:47], a[8:11], a[200:203], v[44:47]
  s_waitcnt vmcnt(1)
  v_mul_f32 v34, 0xbfb8aa3b, v18
  v_mul_f32 v35, 0xbfb8aa3b, v19
  v_mfma_f32_16x16x32_bf16 v[44:47], a[12:15], a[204:207], v[44:47]
  s_barrier
  v_mul_f32 v40, 0xbfb8aa3b, v24
  v_mul_f32 v41, 0xbfb8aa3b, v25
  v_mfma_f32_16x16x32_bf16 v[36:39], a[12:15], a[196:199], v[36:39]
  buffer_atomic_add v13, v12, s[8:11], s36 offen sc1
  v_mfma_f32_16x16x32_bf16 v[36:39], a[8:11], a[192:195], v[36:39]
  s_waitcnt lgkmcnt(6)
  v_mul_f32 v42, 0xbfb8aa3b, v26
  v_mul_f32 v43, 0xbfb8aa3b, v27
  v_mfma_f32_16x16x32_bf16 v[148:151], a[16:19], a[192:195], v[148:151]
  s_waitcnt lgkmcnt(4)
  ds_read_b64_tr_b16 a[8:9], v2 offset:128
  ds_read_b64_tr_b16 a[10:11], v2 offset:8576
  v_mfma_f32_16x16x32_bf16 v[148:151], a[20:23], a[196:199], v[148:151]
  ds_read_b64_tr_b16 a[12:13], v2 offset:640
  ds_read_b64_tr_b16 a[14:15], v2 offset:9088
  v_mfma_f32_16x16x32_bf16 v[164:167], a[20:23], a[204:207], v[164:167]
  v_exp_f32 v32, v32
  v_mfma_f32_16x16x32_bf16 v[164:167], a[16:19], a[200:203], v[164:167]
  v_exp_f32 v33, v33
  v_mfma_f32_16x16x32_bf16 v[180:183], a[16:19], a[208:211], v[180:183]
  v_exp_f32 v34, v34
  v_mfma_f32_16x16x32_bf16 v[180:183], a[20:23], a[212:215], v[180:183]
  v_exp_f32 v35, v35
  v_mfma_f32_16x16x32_bf16 v[196:199], a[20:23], a[220:223], v[196:199]
  v_exp_f32 v40, v40
  v_mfma_f32_16x16x32_bf16 v[196:199], a[16:19], a[216:219], v[196:199]
  s_waitcnt lgkmcnt(6)
  v_exp_f32 v41, v41
  v_mfma_f32_16x16x32_bf16 v[92:95], a[0:3], a[216:219], v[92:95]
  s_waitcnt lgkmcnt(4)
  ds_read_b64_tr_b16 a[16:17], v2 offset:160
  ds_read_b64_tr_b16 a[18:19], v2 offset:8608
  v_mfma_f32_16x16x32_bf16 v[92:95], a[4:7], a[220:223], v[92:95]
  ds_read_b64_tr_b16 a[20:21], v2 offset:672
  ds_read_b64_tr_b16 a[22:23], v2 offset:9120
  v_mfma_f32_16x16x32_bf16 v[84:87], a[4:7], a[212:215], v[84:87]
  v_exp_f32 v42, v42
  v_mfma_f32_16x16x32_bf16 v[84:87], a[0:3], a[208:211], v[84:87]
  v_exp_f32 v43, v43
  v_mfma_f32_16x16x32_bf16 v[76:79], a[0:3], a[200:203], v[76:79]
  v_add_f32 v32, 1.0, v32
  v_add_f32 v33, 1.0, v33
  v_mfma_f32_16x16x32_bf16 v[76:79], a[4:7], a[204:207], v[76:79]
  v_add_f32 v34, 1.0, v34
  v_add_f32 v35, 1.0, v35
  v_mfma_f32_16x16x32_bf16 v[68:71], a[4:7], a[196:199], v[68:71]
  v_add_f32 v40, 1.0, v40
  v_add_f32 v41, 1.0, v41
  v_mfma_f32_16x16x32_bf16 v[68:71], a[0:3], a[192:195], v[68:71]
  s_waitcnt lgkmcnt(6)
  v_add_f32 v42, 1.0, v42
  v_add_f32 v43, 1.0, v43
  v_mfma_f32_16x16x32_bf16 v[100:103], a[8:11], a[192:195], v[100:103]
  s_waitcnt lgkmcnt(4)
  ds_read_b64_tr_b16 a[0:1], v2 offset:192
  ds_read_b64_tr_b16 a[2:3], v2 offset:8640
  v_mfma_f32_16x16x32_bf16 v[100:103], a[12:15], a[196:199], v[100:103]
  ds_read_b64_tr_b16 a[4:5], v2 offset:704
  ds_read_b64_tr_b16 a[6:7], v2 offset:9152
  v_mfma_f32_16x16x32_bf16 v[108:111], a[12:15], a[204:207], v[108:111]
  v_rcp_f32 v32, v32
  v_mfma_f32_16x16x32_bf16 v[108:111], a[8:11], a[200:203], v[108:111]
  v_rcp_f32 v33, v33
  v_mfma_f32_16x16x32_bf16 v[116:119], a[8:11], a[208:211], v[116:119]
  v_rcp_f32 v34, v34
  v_mfma_f32_16x16x32_bf16 v[116:119], a[12:15], a[212:215], v[116:119]
  v_rcp_f32 v35, v35
  v_mfma_f32_16x16x32_bf16 v[124:127], a[12:15], a[220:223], v[124:127]
  v_rcp_f32 v40, v40
  v_mfma_f32_16x16x32_bf16 v[124:127], a[8:11], a[216:219], v[124:127]
  s_waitcnt lgkmcnt(6)
  v_rcp_f32 v41, v41
  v_mfma_f32_16x16x32_bf16 v[220:223], a[16:19], a[216:219], v[220:223]
  s_waitcnt lgkmcnt(4)
  ds_read_b64_tr_b16 a[8:9], v2 offset:224
  ds_read_b64_tr_b16 a[10:11], v2 offset:8672
  v_mfma_f32_16x16x32_bf16 v[220:223], a[20:23], a[220:223], v[220:223]
  ds_read_b64_tr_b16 a[12:13], v2 offset:736
  ds_read_b64_tr_b16 a[14:15], v2 offset:9184
  v_mfma_f32_16x16x32_bf16 v[212:215], a[20:23], a[212:215], v[212:215]
  v_rcp_f32 v42, v42
  v_mfma_f32_16x16x32_bf16 v[212:215], a[16:19], a[208:211], v[212:215]
  v_rcp_f32 v43, v43
  v_mfma_f32_16x16x32_bf16 v[140:143], a[16:19], a[200:203], v[140:143]
  v_mul_f32 v16, v16, v32
  v_mul_f32 v17, v17, v33
  v_mfma_f32_16x16x32_bf16 v[140:143], a[20:23], a[204:207], v[140:143]
  v_mul_f32 v18, v18, v34
  v_mul_f32 v19, v19, v35
  v_mfma_f32_16x16x32_bf16 v[132:135], a[20:23], a[196:199], v[132:135]
  v_mul_f32 v24, v24, v40
  v_mul_f32 v25, v25, v41
  v_mfma_f32_16x16x32_bf16 v[132:135], a[16:19], a[192:195], v[132:135]
  s_waitcnt lgkmcnt(6)
  v_mul_f32 v26, v26, v42
  v_mul_f32 v27, v27, v43
  v_mfma_f32_16x16x32_bf16 v[156:159], a[0:3], a[192:195], v[156:159]
  s_waitcnt lgkmcnt(4)
  ds_read_b64_tr_b16 a[16:17], v2 offset:25344
  ds_read_b64_tr_b16 a[18:19], v2 offset:33792
  v_mfma_f32_16x16x32_bf16 v[156:159], a[4:7], a[196:199], v[156:159]
  ds_read_b64_tr_b16 a[20:21], v2 offset:25856
  ds_read_b64_tr_b16 a[22:23], v2 offset:34304
  v_mfma_f32_16x16x32_bf16 v[172:175], a[4:7], a[204:207], v[172:175]
  v_cvt_pk_bf16_f32 v48, v16, v17
  v_cvt_pk_bf16_f32 v49, v18, v19
  v_mfma_f32_16x16x32_bf16 v[172:175], a[0:3], a[200:203], v[172:175]
  v_cvt_pk_bf16_f32 v50, v24, v25
  v_cvt_pk_bf16_f32 v51, v26, v27
  v_mfma_f32_16x16x32_bf16 v[188:191], a[0:3], a[208:211], v[188:191]
  s_add_u32 s30, s48, s37
  buffer_store_dwordx4 v[48:51], v1, s[8:11], s30 offen offset:0 sc1
  v_mfma_f32_16x16x32_bf16 v[188:191], a[4:7], a[212:215], v[188:191]
  v_accvgpr_read_b32 v56, a40
  v_accvgpr_read_b32 v57, a41
  v_mfma_f32_16x16x32_bf16 v[204:207], a[4:7], a[220:223], v[204:207]
  v_accvgpr_read_b32 v58, a42
  v_accvgpr_read_b32 v59, a43
  v_mfma_f32_16x16x32_bf16 v[204:207], a[0:3], a[216:219], v[204:207]
  s_waitcnt lgkmcnt(6)
  v_accvgpr_read_b32 v64, a44
  v_accvgpr_read_b32 v65, a45
  v_mfma_f32_16x16x32_bf16 v[252:255], a[8:11], a[216:219], v[252:255]
  s_waitcnt lgkmcnt(4)
  ds_read_b64_tr_b16 a[0:1], v2 offset:25376
  ds_read_b64_tr_b16 a[2:3], v2 offset:33824
  v_mfma_f32_16x16x32_bf16 v[252:255], a[12:15], a[220:223], v[252:255]
  ds_read_b64_tr_b16 a[4:5], v2 offset:25888
  ds_read_b64_tr_b16 a[6:7], v2 offset:34336
  v_mfma_f32_16x16x32_bf16 v[244:247], a[12:15], a[212:215], v[244:247]
  v_accvgpr_read_b32 v66, a46
  v_accvgpr_read_b32 v67, a47
  v_mfma_f32_16x16x32_bf16 v[244:247], a[8:11], a[208:211], v[244:247]
  v_mul_f32 v72, 0xbfb8aa3b, v56
  v_mul_f32 v73, 0xbfb8aa3b, v57
  v_mfma_f32_16x16x32_bf16 v[236:239], a[8:11], a[200:203], v[236:239]
  v_mul_f32 v74, 0xbfb8aa3b, v58
  v_mul_f32 v75, 0xbfb8aa3b, v59
  v_mfma_f32_16x16x32_bf16 v[236:239], a[12:15], a[204:207], v[236:239]
  v_mul_f32 v80, 0xbfb8aa3b, v64
  v_mul_f32 v81, 0xbfb8aa3b, v65
  v_mfma_f32_16x16x32_bf16 v[228:231], a[12:15], a[196:199], v[228:231]
  v_mul_f32 v82, 0xbfb8aa3b, v66
  v_mul_f32 v83, 0xbfb8aa3b, v67
  v_mfma_f32_16x16x32_bf16 v[228:231], a[8:11], a[192:195], v[228:231]
  s_waitcnt lgkmcnt(6)
  v_exp_f32 v72, v72
  v_mfma_f32_16x16x32_bf16 a[28:31], a[16:19], a[96:99], a[28:31]
  s_waitcnt lgkmcnt(4)
  ds_read_b64_tr_b16 a[8:9], v2 offset:25408
  ds_read_b64_tr_b16 a[10:11], v2 offset:33856
  v_mfma_f32_16x16x32_bf16 a[28:31], a[20:23], a[100:103], a[28:31]
  ds_read_b64_tr_b16 a[12:13], v2 offset:25920
  ds_read_b64_tr_b16 a[14:15], v2 offset:34368
  v_mfma_f32_16x16x32_bf16 a[24:27], a[20:23], a[108:111], a[24:27]
  v_exp_f32 v73, v73
  v_mfma_f32_16x16x32_bf16 a[24:27], a[16:19], a[104:107], a[24:27]
  v_exp_f32 v74, v74
  v_mfma_f32_16x16x32_bf16 v[20:23], a[16:19], a[112:115], v[20:23]
  v_exp_f32 v75, v75
  v_mfma_f32_16x16x32_bf16 v[20:23], a[20:23], a[116:119], v[20:23]
  v_exp_f32 v80, v80
  v_mfma_f32_16x16x32_bf16 v[28:31], a[20:23], a[124:127], v[28:31]
  v_exp_f32 v81, v81
  v_mfma_f32_16x16x32_bf16 v[28:31], a[16:19], a[120:123], v[28:31]
  s_waitcnt lgkmcnt(6)
  v_exp_f32 v82, v82
  v_mfma_f32_16x16x32_bf16 v[60:63], a[0:3], a[120:123], v[60:63]
  s_waitcnt lgkmcnt(4)
  ds_read_b64_tr_b16 a[16:17], v2 offset:25440
  ds_read_b64_tr_b16 a[18:19], v2 offset:33888
  v_mfma_f32_16x16x32_bf16 v[60:63], a[4:7], a[124:127], v[60:63]
  ds_read_b64_tr_b16 a[20:21], v2 offset:25952
  ds_read_b64_tr_b16 a[22:23], v2 offset:34400
  v_mfma_f32_16x16x32_bf16 v[52:55], a[4:7], a[116:119], v[52:55]
  v_exp_f32 v83, v83
  v_mfma_f32_16x16x32_bf16 v[52:55], a[0:3], a[112:115], v[52:55]
  v_add_f32 v72, 1.0, v72
  v_add_f32 v73, 1.0, v73
  v_mfma_f32_16x16x32_bf16 v[44:47], a[0:3], a[104:107], v[44:47]
  v_add_f32 v74, 1.0, v74
  v_add_f32 v75, 1.0, v75
  v_mfma_f32_16x16x32_bf16 v[44:47], a[4:7], a[108:111], v[44:47]
  v_add_f32 v80, 1.0, v80
  v_add_f32 v81, 1.0, v81
  v_mfma_f32_16x16x32_bf16 v[36:39], a[4:7], a[100:103], v[36:39]
  v_add_f32 v82, 1.0, v82
  v_add_f32 v83, 1.0, v83
  v_mfma_f32_16x16x32_bf16 v[36:39], a[0:3], a[96:99], v[36:39]
  s_waitcnt lgkmcnt(6)
  v_rcp_f32 v72, v72
  v_mfma_f32_16x16x32_bf16 v[148:151], a[8:11], a[96:99], v[148:151]
  s_waitcnt lgkmcnt(4)
  ds_read_b64_tr_b16 a[0:1], v2 offset:25472
  ds_read_b64_tr_b16 a[2:3], v2 offset:33920
  v_mfma_f32_16x16x32_bf16 v[148:151], a[12:15], a[100:103], v[148:151]
  ds_read_b64_tr_b16 a[4:5], v2 offset:25984
  ds_read_b64_tr_b16 a[6:7], v2 offset:34432
  v_mfma_f32_16x16x32_bf16 v[164:167], a[12:15], a[108:111], v[164:167]
  v_rcp_f32 v73, v73
  v_mfma_f32_16x16x32_bf16 v[164:167], a[8:11], a[104:107], v[164:167]
  v_rcp_f32 v74, v74
  v_mfma_f32_16x16x32_bf16 v[180:183], a[8:11], a[112:115], v[180:183]
  v_rcp_f32 v75, v75
  v_mfma_f32_16x16x32_bf16 v[180:183], a[12:15], a[116:119], v[180:183]
  v_rcp_f32 v80, v80
  v_mfma_f32_16x16x32_bf16 v[196:199], a[12:15], a[124:127], v[196:199]
  v_rcp_f32 v81, v81
  v_mfma_f32_16x16x32_bf16 v[196:199], a[8:11], a[120:123], v[196:199]
  s_waitcnt lgkmcnt(6)
  v_rcp_f32 v82, v82
  v_mfma_f32_16x16x32_bf16 v[92:95], a[16:19], a[120:123], v[92:95]
  s_waitcnt lgkmcnt(4)
  ds_read_b64_tr_b16 a[8:9], v2 offset:25504
  ds_read_b64_tr_b16 a[10:11], v2 offset:33952
  v_mfma_f32_16x16x32_bf16 v[92:95], a[20:23], a[124:127], v[92:95]
  ds_read_b64_tr_b16 a[12:13], v2 offset:26016
  ds_read_b64_tr_b16 a[14:15], v2 offset:34464
  v_mfma_f32_16x16x32_bf16 v[84:87], a[20:23], a[116:119], v[84:87]
  v_rcp_f32 v83, v83
  v_mfma_f32_16x16x32_bf16 v[84:87], a[16:19], a[112:115], v[84:87]
  v_mul_f32 v56, v56, v72
  v_mul_f32 v57, v57, v73
  v_mfma_f32_16x16x32_bf16 v[76:79], a[16:19], a[104:107], v[76:79]
  v_mul_f32 v58, v58, v74
  v_mul_f32 v59, v59, v75
  v_mfma_f32_16x16x32_bf16 v[76:79], a[20:23], a[108:111], v[76:79]
  v_mul_f32 v64, v64, v80
  v_mul_f32 v65, v65, v81
  v_mfma_f32_16x16x32_bf16 v[68:71], a[20:23], a[100:103], v[68:71]
  v_mul_f32 v66, v66, v82
  v_mul_f32 v67, v67, v83
  v_mfma_f32_16x16x32_bf16 v[68:71], a[16:19], a[96:99], v[68:71]
  s_waitcnt lgkmcnt(6)
  v_cvt_pk_bf16_f32 v88, v56, v57
  v_cvt_pk_bf16_f32 v89, v58, v59
  v_mfma_f32_16x16x32_bf16 v[100:103], a[0:3], a[96:99], v[100:103]
  s_waitcnt lgkmcnt(4)
  ds_read_b64_tr_b16 a[16:17], v2 offset:25536
  ds_read_b64_tr_b16 a[18:19], v2 offset:33984
  v_mfma_f32_16x16x32_bf16 v[100:103], a[4:7], a[100:103], v[100:103]
  ds_read_b64_tr_b16 a[20:21], v2 offset:26048
  ds_read_b64_tr_b16 a[22:23], v2 offset:34496
  v_mfma_f32_16x16x32_bf16 v[108:111], a[4:7], a[108:111], v[108:111]
  v_cvt_pk_bf16_f32 v90, v64, v65
  v_cvt_pk_bf16_f32 v91, v66, v67
  v_mfma_f32_16x16x32_bf16 v[108:111], a[0:3], a[104:107], v[108:111]
  s_add_u32 s30, s48, s37
  buffer_store_dwordx4 v[88:91], v1, s[8:11], s30 offen offset:1024 sc1
  v_mfma_f32_16x16x32_bf16 v[116:119], a[0:3], a[112:115], v[116:119]
  v_accvgpr_read_b32 v16, a48
  v_accvgpr_read_b32 v17, a49
  v_mfma_f32_16x16x32_bf16 v[116:119], a[4:7], a[116:119], v[116:119]
  v_accvgpr_read_b32 v18, a50
  v_accvgpr_read_b32 v19, a51
  v_mfma_f32_16x16x32_bf16 v[124:127], a[4:7], a[124:127], v[124:127]
  v_accvgpr_read_b32 v24, a52
  v_accvgpr_read_b32 v25, a53
  v_mfma_f32_16x16x32_bf16 v[124:127], a[0:3], a[120:123], v[124:127]
  s_waitcnt lgkmcnt(6)
  v_accvgpr_read_b32 v26, a54
  v_accvgpr_read_b32 v27, a55
  v_mfma_f32_16x16x32_bf16 v[220:223], a[8:11], a[120:123], v[220:223]
  s_waitcnt lgkmcnt(4)
  ds_read_b64_tr_b16 a[0:1], v2 offset:25568
  ds_read_b64_tr_b16 a[2:3], v2 offset:34016
  v_mfma_f32_16x16x32_bf16 v[220:223], a[12:15], a[124:127], v[220:223]
  ds_read_b64_tr_b16 a[4:5], v2 offset:26080
  ds_read_b64_tr_b16 a[6:7], v2 offset:34528
  v_mfma_f32_16x16x32_bf16 v[212:215], a[12:15], a[116:119], v[212:215]
  v_mul_f32 v32, 0xbfb8aa3b, v16
  v_mul_f32 v33, 0xbfb8aa3b, v17
  v_mfma_f32_16x16x32_bf16 v[212:215], a[8:11], a[112:115], v[212:215]
  v_mul_f32 v34, 0xbfb8aa3b, v18
  v_mul_f32 v35, 0xbfb8aa3b, v19
  v_mfma_f32_16x16x32_bf16 v[140:143], a[8:11], a[104:107], v[140:143]
  v_mul_f32 v40, 0xbfb8aa3b, v24
  v_mul_f32 v41, 0xbfb8aa3b, v25
  v_mfma_f32_16x16x32_bf16 v[140:143], a[12:15], a[108:111], v[140:143]
  v_mul_f32 v42, 0xbfb8aa3b, v26
  v_mul_f32 v43, 0xbfb8aa3b, v27
  v_mfma_f32_16x16x32_bf16 v[132:135], a[12:15], a[100:103], v[132:135]
  v_exp_f32 v32, v32
  v_mfma_f32_16x16x32_bf16 v[132:135], a[8:11], a[96:99], v[132:135]
  s_waitcnt lgkmcnt(6)
  v_exp_f32 v33, v33
  v_mfma_f32_16x16x32_bf16 v[156:159], a[16:19], a[96:99], v[156:159]
  s_waitcnt lgkmcnt(4)
  buffer_load_dword v14, off, s[8:11], s35 sc1
  v_mfma_f32_16x16x32_bf16 v[156:159], a[20:23], a[100:103], v[156:159]
  ds_read_b64_tr_b16 a[8:9], v3 offset:31744
  ds_read_b64_tr_b16 a[10:11], v3 offset:40192
  v_mfma_f32_16x16x32_bf16 v[172:175], a[20:23], a[108:111], v[172:175]
  ds_read_b64_tr_b16 a[12:13], v3 offset:32256
  ds_read_b64_tr_b16 a[14:15], v3 offset:40704
  v_mfma_f32_16x16x32_bf16 v[172:175], a[16:19], a[104:107], v[172:175]
  v_exp_f32 v34, v34
  v_mfma_f32_16x16x32_bf16 v[188:191], a[16:19], a[112:115], v[188:191]
  v_exp_f32 v35, v35
  v_mfma_f32_16x16x32_bf16 v[188:191], a[20:23], a[116:119], v[188:191]
  v_exp_f32 v40, v40
  v_mfma_f32_16x16x32_bf16 v[204:207], a[20:23], a[124:127], v[204:207]
  v_exp_f32 v41, v41
  v_mfma_f32_16x16x32_bf16 v[204:207], a[16:19], a[120:123], v[204:207]
  s_waitcnt lgkmcnt(6)
  v_exp_f32 v42, v42
  v_mfma_f32_16x16x32_bf16 v[252:255], a[0:3], a[120:123], v[252:255]
  s_waitcnt lgkmcnt(4)
  ds_read_b64_tr_b16 a[16:17], v3 offset:31776
  ds_read_b64_tr_b16 a[18:19], v3 offset:40224
  v_mfma_f32_16x16x32_bf16 v[252:255], a[4:7], a[124:127], v[252:255]
  ds_read_b64_tr_b16 a[20:21], v3 offset:32288
  ds_read_b64_tr_b16 a[22:23], v3 offset:40736
  v_mfma_f32_16x16x32_bf16 v[244:247], a[4:7], a[116:119], v[244:247]
  v_exp_f32 v43, v43
  v_mfma_f32_16x16x32_bf16 v[244:247], a[0:3], a[112:115], v[244:247]
  v_add_f32 v32, 1.0, v32
  v_add_f32 v33, 1.0, v33
  v_mfma_f32_16x16x32_bf16 v[236:239], a[0:3], a[104:107], v[236:239]
  v_add_f32 v34, 1.0, v34
  v_add_f32 v35, 1.0, v35
  v_mfma_f32_16x16x32_bf16 v[236:239], a[4:7], a[108:111], v[236:239]
  v_add_f32 v40, 1.0, v40
  v_add_f32 v41, 1.0, v41
  v_mfma_f32_16x16x32_bf16 v[228:231], a[4:7], a[100:103], v[228:231]
  v_add_f32 v42, 1.0, v42
  v_add_f32 v43, 1.0, v43
  v_mfma_f32_16x16x32_bf16 v[228:231], a[0:3], a[96:99], v[228:231]
  s_waitcnt lgkmcnt(6)
  v_rcp_f32 v32, v32
  v_mfma_f32_16x16x32_bf16 a[28:31], a[8:11], a[128:131], a[28:31]
  s_waitcnt lgkmcnt(4)
  ds_read_b64_tr_b16 a[0:1], v3 offset:31808
  ds_read_b64_tr_b16 a[2:3], v3 offset:40256
  v_mfma_f32_16x16x32_bf16 a[28:31], a[12:15], a[132:135], a[28:31]
  ds_read_b64_tr_b16 a[4:5], v3 offset:32320
  ds_read_b64_tr_b16 a[6:7], v3 offset:40768
  v_mfma_f32_16x16x32_bf16 a[24:27], a[12:15], a[140:143], a[24:27]
  v_rcp_f32 v33, v33
  v_mfma_f32_16x16x32_bf16 a[24:27], a[8:11], a[136:139], a[24:27]
  s_barrier
  v_rcp_f32 v34, v34
  v_mfma_f32_16x16x32_bf16 v[20:23], a[8:11], a[144:147], v[20:23]
  v_rcp_f32 v35, v35
  v_mfma_f32_16x16x32_bf16 v[20:23], a[12:15], a[148:151], v[20:23]
  v_rcp_f32 v40, v40
  v_mfma_f32_16x16x32_bf16 v[28:31], a[12:15], a[156:159], v[28:31]
  v_rcp_f32 v41, v41
  v_mfma_f32_16x16x32_bf16 v[28:31], a[8:11], a[152:155], v[28:31]
  s_waitcnt lgkmcnt(6)
  v_rcp_f32 v42, v42
  v_mfma_f32_16x16x32_bf16 v[60:63], a[16:19], a[152:155], v[60:63]
  s_waitcnt lgkmcnt(4)
  ds_read_b64_tr_b16 a[8:9], v3 offset:31840
  ds_read_b64_tr_b16 a[10:11], v3 offset:40288
  v_mfma_f32_16x16x32_bf16 v[60:63], a[20:23], a[156:159], v[60:63]
  ds_read_b64_tr_b16 a[12:13], v3 offset:32352
  ds_read_b64_tr_b16 a[14:15], v3 offset:40800
  v_mfma_f32_16x16x32_bf16 v[52:55], a[20:23], a[148:151], v[52:55]
  v_rcp_f32 v43, v43
  v_mfma_f32_16x16x32_bf16 v[52:55], a[16:19], a[144:147], v[52:55]
  v_mul_f32 v16, v16, v32
  v_mul_f32 v17, v17, v33
  v_mfma_f32_16x16x32_bf16 v[44:47], a[16:19], a[136:139], v[44:47]
  v_mul_f32 v18, v18, v34
  v_mul_f32 v19, v19, v35
  v_mfma_f32_16x16x32_bf16 v[44:47], a[20:23], a[140:143], v[44:47]
  v_mul_f32 v24, v24, v40
  v_mul_f32 v25, v25, v41
  v_mfma_f32_16x16x32_bf16 v[36:39], a[20:23], a[132:135], v[36:39]
  v_mul_f32 v26, v26, v42
  v_mul_f32 v27, v27, v43
  v_mfma_f32_16x16x32_bf16 v[36:39], a[16:19], a[128:131], v[36:39]
  s_waitcnt lgkmcnt(6)
  v_cvt_pk_bf16_f32 v48, v16, v17
  v_cvt_pk_bf16_f32 v49, v18, v19
  v_mfma_f32_16x16x32_bf16 v[148:151], a[0:3], a[128:131], v[148:151]
  s_waitcnt lgkmcnt(4)
  ds_read_b64_tr_b16 a[16:17], v3 offset:31872
  ds_read_b64_tr_b16 a[18:19], v3 offset:40320
  v_mfma_f32_16x16x32_bf16 v[148:151], a[4:7], a[132:135], v[148:151]
  ds_read_b64_tr_b16 a[20:21], v3 offset:32384
  ds_read_b64_tr_b16 a[22:23], v3 offset:40832
  v_mfma_f32_16x16x32_bf16 v[164:167], a[4:7], a[140:143], v[164:167]
  v_cvt_pk_bf16_f32 v50, v24, v25
  v_cvt_pk_bf16_f32 v51, v26, v27
  v_mfma_f32_16x16x32_bf16 v[164:167], a[0:3], a[136:139], v[164:167]
  s_add_u32 s30, s49, s37
  buffer_store_dwordx4 v[48:51], v1, s[8:11], s30 offen offset:0 sc1
  v_mfma_f32_16x16x32_bf16 v[180:183], a[0:3], a[144:147], v[180:183]
  v_accvgpr_read_b32 v56, a56
  v_accvgpr_read_b32 v57, a57
  v_mfma_f32_16x16x32_bf16 v[180:183], a[4:7], a[148:151], v[180:183]
  v_accvgpr_read_b32 v58, a58
  v_accvgpr_read_b32 v59, a59
  v_mfma_f32_16x16x32_bf16 v[196:199], a[4:7], a[156:159], v[196:199]
  v_accvgpr_read_b32 v64, a60
  v_accvgpr_read_b32 v65, a61
  v_mfma_f32_16x16x32_bf16 v[196:199], a[0:3], a[152:155], v[196:199]
  s_waitcnt lgkmcnt(6)
  v_accvgpr_read_b32 v66, a62
  v_accvgpr_read_b32 v67, a63
  v_mfma_f32_16x16x32_bf16 v[92:95], a[8:11], a[152:155], v[92:95]
  s_waitcnt lgkmcnt(4)
  ds_read_b64_tr_b16 a[0:1], v3 offset:31904
  s_waitcnt vmcnt(1)
  v_cmp_gt_u32 vcc, 8, v14
  v_mfma_f32_16x16x32_bf16 v[92:95], a[12:15], a[156:159], v[92:95]
  ds_read_b64_tr_b16 a[2:3], v3 offset:40352
  ds_read_b64_tr_b16 a[4:5], v3 offset:32416
  v_mfma_f32_16x16x32_bf16 v[84:87], a[12:15], a[148:151], v[84:87]
  ds_read_b64_tr_b16 a[6:7], v3 offset:40864
  v_mul_f32 v72, 0xbfb8aa3b, v56
  v_mfma_f32_16x16x32_bf16 v[84:87], a[8:11], a[144:147], v[84:87]
  v_mul_f32 v73, 0xbfb8aa3b, v57
  v_mul_f32 v74, 0xbfb8aa3b, v58
  v_mfma_f32_16x16x32_bf16 v[76:79], a[8:11], a[136:139], v[76:79]
  s_cbranch_vccnz L_sl_s2
L_bk_s2:
  v_mul_f32 v75, 0xbfb8aa3b, v59
  v_mul_f32 v80, 0xbfb8aa3b, v64
  v_mfma_f32_16x16x32_bf16 v[76:79], a[12:15], a[140:143], v[76:79]
  s_add_u32 s28, s34, 0
  s_and_b32 m0, s28, 0x1ffff
  v_mul_f32 v81, 0xbfb8aa3b, v65
  v_mfma_f32_16x16x32_bf16 v[68:71], a[12:15], a[132:135], v[68:71]
  buffer_load_dwordx4 v1, s[12:15], s28 offen offset:0 sc1 lds
  v_mfma_f32_16x16x32_bf16 v[68:71], a[8:11], a[128:131], v[68:71]
  s_waitcnt lgkmcnt(6)
  v_mul_f32 v82, 0xbfb8aa3b, v66
  v_mul_f32 v83, 0xbfb8aa3b, v67
  v_mfma_f32_16x16x32_bf16 v[100:103], a[16:19], a[128:131], v[100:103]
  s_waitcnt lgkmcnt(4)
  ds_read_b64_tr_b16 a[8:9], v3 offset:31936
  ds_read_b64_tr_b16 a[10:11], v3 offset:40384
  v_mfma_f32_16x16x32_bf16 v[100:103], a[20:23], a[132:135], v[100:103]
  ds_read_b64_tr_b16 a[12:13], v3 offset:32448
  ds_read_b64_tr_b16 a[14:15], v3 offset:40896
  v_mfma_f32_16x16x32_bf16 v[108:111], a[20:23], a[140:143], v[108:111]
  buffer_load_dwordx4 v1, s[12:15], s28 offen offset:1024 sc1 lds
  v_mfma_f32_16x16x32_bf16 v[108:111], a[16:19], a[136:139], v[108:111]
  v_exp_f32 v72, v72
  v_mfma_f32_16x16x32_bf16 v[116:119], a[16:19], a[144:147], v[116:119]
  v_exp_f32 v73, v73
  v_mfma_f32_16x16x32_bf16 v[116:119], a[20:23], a[148:151], v[116:119]
  v_exp_f32 v74, v74
  v_mfma_f32_16x16x32_bf16 v[124:127], a[20:23], a[156:159], v[124:127]
  buffer_load_dwordx4 v1, s[12:15], s28 offen offset:2048 sc1 lds
  v_mfma_f32_16x16x32_bf16 v[124:127], a[16:19], a[152:155], v[124:127]
  s_waitcnt lgkmcnt(6)
  v_exp_f32 v75, v75
  v_mfma_f32_16x16x32_bf16 v[220:223], a[0:3], a[152:155], v[220:223]
  s_waitcnt lgkmcnt(4)
  ds_read_b64_tr_b16 a[16:17], v3 offset:31968
  ds_read_b64_tr_b16 a[18:19], v3 offset:40416
  v_mfma_f32_16x16x32_bf16 v[220:223], a[4:7], a[156:159], v[220:223]
  ds_read_b64_tr_b16 a[20:21], v3 offset:32480
  ds_read_b64_tr_b16 a[22:23], v3 offset:40928
  v_mfma_f32_16x16x32_bf16 v[212:215], a[4:7], a[148:151], v[212:215]
  buffer_load_dwordx4 v1, s[12:15], s28 offen offset:3072 sc1 lds
  v_mfma_f32_16x16x32_bf16 v[212:215], a[0:3], a[144:147], v[212:215]
  v_exp_f32 v80, v80
  v_mfma_f32_16x16x32_bf16 v[140:143], a[0:3], a[136:139], v[140:143]
  v_exp_f32 v81, v81
  v_mfma_f32_16x16x32_bf16 v[140:143], a[4:7], a[140:143], v[140:143]
  s_add_u32 s28, s34, 32768
  s_and_b32 m0, s28, 0x1ffff
  v_mfma_f32_16x16x32_bf16 v[132:135], a[4:7], a[132:135], v[132:135]
  buffer_load_dwordx4 v1, s[12:15], s28 offen offset:0 sc1 lds
  v_mfma_f32_16x16x32_bf16 v[132:135], a[0:3], a[128:131], v[132:135]
  s_waitcnt lgkmcnt(6)
  v_exp_f32 v82, v82
  v_mfma_f32_16x16x32_bf16 v[156:159], a[8:11], a[128:131], v[156:159]
  s_waitcnt lgkmcnt(4)
  v_exp_f32 v83, v83
  v_mfma_f32_16x16x32_bf16 v[156:159], a[12:15], a[132:135], v[156:159]
  v_add_f32 v72, 1.0, v72
  v_add_f32 v73, 1.0, v73
  v_mfma_f32_16x16x32_bf16 v[172:175], a[12:15], a[140:143], v[172:175]
  buffer_load_dwordx4 v1, s[12:15], s28 offen offset:1024 sc1 lds
  v_mfma_f32_16x16x32_bf16 v[172:175], a[8:11], a[136:139], v[172:175]
  v_add_f32 v74, 1.0, v74
  v_add_f32 v75, 1.0, v75
  v_mfma_f32_16x16x32_bf16 v[188:191], a[8:11], a[144:147], v[188:191]
  v_add_f32 v80, 1.0, v80
  v_add_f32 v81, 1.0, v81
  v_mfma_f32_16x16x32_bf16 v[188:191], a[12:15], a[148:151], v[188:191]
  v_add_f32 v82, 1.0, v82
  v_add_f32 v83, 1.0, v83
  v_mfma_f32_16x16x32_bf16 v[204:207], a[12:15], a[156:159], v[204:207]
  buffer_load_dwordx4 v1, s[12:15], s28 offen offset:2048 sc1 lds
  v_mfma_f32_16x16x32_bf16 v[204:207], a[8:11], a[152:155], v[204:207]
  s_waitcnt lgkmcnt(2)
  v_rcp_f32 v72, v72
  v_mfma_f32_16x16x32_bf16 v[252:255], a[16:19], a[152:155], v[252:255]
  s_waitcnt lgkmcnt(0)
  v_rcp_f32 v73, v73
  v_mfma_f32_16x16x32_bf16 v[252:255], a[20:23], a[156:159], v[252:255]
  v_rcp_f32 v74, v74
  v_mfma_f32_16x16x32_bf16 v[244:247], a[20:23], a[148:151], v[244:247]
  buffer_load_dwordx4 v1, s[12:15], s28 offen offset:3072 sc1 lds
  v_mfma_f32_16x16x32_bf16 v[244:247], a[16:19], a[144:147], v[244:247]
  v_rcp_f32 v75, v75
  v_mfma_f32_16x16x32_bf16 v[236:239], a[16:19], a[136:139], v[236:239]
  v_rcp_f32 v80, v80
  v_mfma_f32_16x16x32_bf16 v[236:239], a[20:23], a[140:143], v[236:239]
  s_add_u32 s28, s34, 16384
  s_and_b32 m0, s28, 0x1ffff
  v_mfma_f32_16x16x32_bf16 v[228:231], a[20:23], a[132:135], v[228:231]
  buffer_load_dwordx4 v1, s[12:15], s28 offen offset:0 sc1 lds
  v_mfma_f32_16x16x32_bf16 v[228:231], a[16:19], a[128:131], v[228:231]
  buffer_load_dwordx4 v1, s[12:15], s28 offen offset:1024 sc1 lds
  buffer_load_dwordx4 v1, s[12:15], s28 offen offset:2048 sc1 lds
  buffer_load_dwordx4 v1, s[12:15], s28 offen offset:3072 sc1 lds
  v_rcp_f32 v81, v81
  v_rcp_f32 v82, v82
  v_rcp_f32 v83, v83
  v_mul_f32 v56, v56, v72
  v_mul_f32 v57, v57, v73
  v_mul_f32 v58, v58, v74
  v_mul_f32 v59, v59, v75
  v_mul_f32 v64, v64, v80
  v_mul_f32 v65, v65, v81
  v_mul_f32 v66, v66, v82
  v_mul_f32 v67, v67, v83
  v_cvt_pk_bf16_f32 v88, v56, v57
  v_cvt_pk_bf16_f32 v89, v58, v59
  v_cvt_pk_bf16_f32 v90, v64, v65
  v_cvt_pk_bf16_f32 v91, v66, v67
  s_add_u32 s30, s49, s37
  buffer_store_dwordx4 v[88:91], v1, s[8:11], s30 offen offset:1024 sc1
  v_accvgpr_read_b32 v16, a64
  v_accvgpr_read_b32 v17, a65
  v_accvgpr_read_b32 v18, a66
  v_accvgpr_read_b32 v19, a67
  v_accvgpr_read_b32 v24, a68
  v_accvgpr_read_b32 v25, a69
  v_accvgpr_read_b32 v26, a70
  v_accvgpr_read_b32 v27, a71
  v_mul_f32 v32, 0xbfb8aa3b, v16
  v_mul_f32 v33, 0xbfb8aa3b, v17
  v_mul_f32 v34, 0xbfb8aa3b, v18
  v_mul_f32 v35, 0xbfb8aa3b, v19
  v_mul_f32 v40, 0xbfb8aa3b, v24
  v_mul_f32 v41, 0xbfb8aa3b, v25
  v_mul_f32 v42, 0xbfb8aa3b, v26
  v_mul_f32 v43, 0xbfb8aa3b, v27
  v_exp_f32 v32, v32
  v_exp_f32 v33, v33
  v_exp_f32 v34, v34
  v_exp_f32 v35, v35
  v_exp_f32 v40, v40
  v_exp_f32 v41, v41
  v_exp_f32 v42, v42
  v_exp_f32 v43, v43
  v_add_f32 v32, 1.0, v32
  v_add_f32 v33, 1.0, v33
  v_add_f32 v34, 1.0, v34
  v_add_f32 v35, 1.0, v35
  v_add_f32 v40, 1.0, v40
  v_add_f32 v41, 1.0, v41
  v_add_f32 v42, 1.0, v42
  v_add_f32 v43, 1.0, v43
  v_rcp_f32 v32, v32
  v_rcp_f32 v33, v33
  v_rcp_f32 v34, v34
  v_rcp_f32 v35, v35
  v_rcp_f32 v40, v40
  v_rcp_f32 v41, v41
  v_rcp_f32 v42, v42
  v_rcp_f32 v43, v43
  v_mul_f32 v16, v16, v32
  v_mul_f32 v17, v17, v33
  v_mul_f32 v18, v18, v34
  v_mul_f32 v19, v19, v35
  v_mul_f32 v24, v24, v40
  v_mul_f32 v25, v25, v41
  v_mul_f32 v26, v26, v42
  v_mul_f32 v27, v27, v43
  v_cvt_pk_bf16_f32 v48, v16, v17
  v_cvt_pk_bf16_f32 v49, v18, v19
  v_cvt_pk_bf16_f32 v50, v24, v25
  v_cvt_pk_bf16_f32 v51, v26, v27
  s_add_u32 s30, s50, s37
  buffer_store_dwordx4 v[48:51], v1, s[8:11], s30 offen offset:0 sc1
  v_mov_b32 v216, 0
  v_mov_b32 v217, 0
  v_mov_b32 v218, 0
  v_mov_b32 v219, 0
  s_add_u32 s28, s34, 49152
  s_and_b32 m0, s28, 0x1ffff
  v_accvgpr_read_b32 v56, a72
  v_accvgpr_read_b32 v57, a73
  v_accvgpr_read_b32 v58, a74
  v_accvgpr_read_b32 v59, a75
  v_mfma_f32_32x32x16_bf16 a[96:111], v[216:219], v[216:219], 0
  v_accvgpr_read_b32 v64, a76
  v_accvgpr_read_b32 v65, a77
  v_accvgpr_read_b32 v66, a78
  v_accvgpr_read_b32 v67, a79
  v_mul_f32 v72, 0xbfb8aa3b, v56
  v_mul_f32 v73, 0xbfb8aa3b, v57
  v_mul_f32 v74, 0xbfb8aa3b, v58
  v_mul_f32 v75, 0xbfb8aa3b, v59
  v_mfma_f32_32x32x16_bf16 a[112:127], v[216:219], v[216:219], 0
  v_mul_f32 v80, 0xbfb8aa3b, v64
  v_mul_f32 v81, 0xbfb8aa3b, v65
  v_mul_f32 v82, 0xbfb8aa3b, v66
  v_mul_f32 v83, 0xbfb8aa3b, v67
  v_exp_f32 v72, v72
  v_exp_f32 v73, v73
  buffer_load_dwordx4 v1, s[12:15], s28 offen offset:0 sc1 lds
  v_exp_f32 v74, v74
  v_exp_f32 v75, v75
  v_mfma_f32_32x32x16_bf16 a[160:175], v[216:219], v[216:219], 0
  v_exp_f32 v80, v80
  v_exp_f32 v81, v81
  v_exp_f32 v82, v82
  v_exp_f32 v83, v83
  v_add_f32 v72, 1.0, v72
  v_add_f32 v73, 1.0, v73
  v_add_f32 v74, 1.0, v74
  v_add_f32 v75, 1.0, v75
  v_mfma_f32_32x32x16_bf16 a[176:191], v[216:219], v[216:219], 0
  v_add_f32 v80, 1.0, v80
  v_add_f32 v81, 1.0, v81
  v_add_f32 v82, 1.0, v82
  v_add_f32 v83, 1.0, v83
  v_rcp_f32 v72, v72
  v_rcp_f32 v73, v73
  v_rcp_f32 v74, v74
  v_rcp_f32 v75, v75
  buffer_load_dwordx4 v1, s[12:15], s28 offen offset:1024 sc1 lds
  v_mfma_f32_32x32x16_bf16 a[192:207], v[216:219], v[216:219], 0
  v_rcp_f32 v80, v80
  v_rcp_f32 v81, v81
  v_rcp_f32 v82, v82
  v_rcp_f32 v83, v83
  v_mul_f32 v56, v56, v72
  v_mul_f32 v57, v57, v73
  v_mul_f32 v58, v58, v74
  v_mul_f32 v59, v59, v75
  v_mfma_f32_32x32x16_bf16 a[208:223], v[216:219], v[216:219], 0
  v_mul_f32 v64, v64, v80
  v_mul_f32 v65, v65, v81
  v_mul_f32 v66, v66, v82
  v_mul_f32 v67, v67, v83
  v_cvt_pk_bf16_f32 v88, v56, v57
  v_cvt_pk_bf16_f32 v89, v58, v59
  v_cvt_pk_bf16_f32 v90, v64, v65
  v_cvt_pk_bf16_f32 v91, v66, v67
  v_mfma_f32_32x32x16_bf16 a[224:239], v[216:219], v[216:219], 0
  s_add_u32 s30, s50, s37
  buffer_load_dwordx4 v1, s[12:15], s28 offen offset:2048 sc1 lds
  buffer_store_dwordx4 v[88:91], v1, s[8:11], s30 offen offset:1024 sc1
  v_accvgpr_read_b32 v16, a80
  v_accvgpr_read_b32 v17, a81
  v_accvgpr_read_b32 v18, a82
  v_accvgpr_read_b32 v19, a83
  v_accvgpr_read_b32 v24, a84
  v_accvgpr_read_b32 v25, a85
  v_mfma_f32_32x32x16_bf16 a[240:255], v[216:219], v[216:219], 0
  v_accvgpr_read_b32 v26, a86
  v_accvgpr_read_b32 v27, a87
  v_mul_f32 v32, 0xbfb8aa3b, v16
  v_mul_f32 v33, 0xbfb8aa3b, v17
  v_mul_f32 v34, 0xbfb8aa3b, v18
  v_mul_f32 v35, 0xbfb8aa3b, v19
  v_mul_f32 v40, 0xbfb8aa3b, v24
  v_mul_f32 v41, 0xbfb8aa3b, v25
  v_mul_f32 v42, 0xbfb8aa3b, v26
  v_mul_f32 v43, 0xbfb8aa3b, v27
  v_exp_f32 v32, v32
  v_exp_f32 v33, v33
  buffer_load_dwordx4 v1, s[12:15], s28 offen offset:3072 sc1 lds
  s_add_u32 s28, s34, 65536
  s_and_b32 m0, s28, 0x1ffff
  v_exp_f32 v34, v34
  v_exp_f32 v35, v35
  v_exp_f32 v40, v40
  v_exp_f32 v41, v41
  v_exp_f32 v42, v42
  v_exp_f32 v43, v43
  v_add_f32 v32, 1.0, v32
  v_add_f32 v33, 1.0, v33
  v_add_f32 v34, 1.0, v34
  v_add_f32 v35, 1.0, v35
  v_add_f32 v40, 1.0, v40
  v_add_f32 v41, 1.0, v41
  v_add_f32 v42, 1.0, v42
  v_add_f32 v43, 1.0, v43
  v_rcp_f32 v32, v32
  v_rcp_f32 v33, v33
  v_rcp_f32 v34, v34
  v_rcp_f32 v35, v35
  v_rcp_f32 v40, v40
  v_rcp_f32 v41, v41
  buffer_load_dwordx4 v1, s[12:15], s28 offen offset:0 sc1 lds
  v_rcp_f32 v42, v42
  v_rcp_f32 v43, v43
  v_mul_f32 v16, v16, v32
  v_mul_f32 v17, v17, v33
  v_mul_f32 v18, v18, v34
  v_mul_f32 v19, v19, v35
  v_mul_f32 v24, v24, v40
  v_mul_f32 v25, v25, v41
  v_mul_f32 v26, v26, v42
  v_mul_f32 v27, v27, v43
  v_cvt_pk_bf16_f32 v48, v16, v17
  v_cvt_pk_bf16_f32 v49, v18, v19
  v_cvt_pk_bf16_f32 v50, v24, v25
  v_cvt_pk_bf16_f32 v51, v26, v27
  s_add_u32 s30, s51, s37
  buffer_store_dwordx4 v[48:51], v1, s[8:11], s30 offen offset:0 sc1
  v_accvgpr_read_b32 v56, a88
  v_accvgpr_read_b32 v57, a89
  v_accvgpr_read_b32 v58, a90
  v_accvgpr_read_b32 v59, a91
  buffer_load_dwordx4 v1, s[12:15], s28 offen offset:1024 sc1 lds
  v_accvgpr_read_b32 v64, a92
  v_accvgpr_read_b32 v65, a93
  v_accvgpr_read_b32 v66, a94
  v_accvgpr_read_b32 v67, a95
  v_mul_f32 v72, 0xbfb8aa3b, v56
  v_mul_f32 v73, 0xbfb8aa3b, v57
  v_mul_f32 v74, 0xbfb8aa3b, v58
  v_mul_f32 v75, 0xbfb8aa3b, v59
  v_mul_f32 v80, 0xbfb8aa3b, v64
  v_mul_f32 v81, 0xbfb8aa3b, v65
  v_mul_f32 v82, 0xbfb8aa3b, v66
  v_mul_f32 v83, 0xbfb8aa3b, v67
  v_exp_f32 v72, v72
  v_exp_f32 v73, v73
  v_exp_f32 v74, v74
  v_exp_f32 v75, v75
  v_exp_f32 v80, v80
  v_exp_f32 v81, v81
  v_exp_f32 v82, v82
  v_exp_f32 v83, v83
  buffer_load_dwordx4 v1, s[12:15], s28 offen offset:2048 sc1 lds
  v_add_f32 v72, 1.0, v72
  v_add_f32 v73, 1.0, v73
  v_add_f32 v74, 1.0, v74
  v_add_f32 v75, 1.0, v75
  v_add_f32 v80, 1.0, v80
  v_add_f32 v81, 1.0, v81
  v_add_f32 v82, 1.0, v82
  v_add_f32 v83, 1.0, v83
  v_rcp_f32 v72, v72
  v_rcp_f32 v73, v73
  v_rcp_f32 v74, v74
  v_rcp_f32 v75, v75
  v_rcp_f32 v80, v80
  v_rcp_f32 v81, v81
  v_rcp_f32 v82, v82
  v_rcp_f32 v83, v83
  v_mul_f32 v56, v56, v72
  v_mul_f32 v57, v57, v73
  v_mul_f32 v58, v58, v74
  v_mul_f32 v59, v59, v75
  buffer_load_dwordx4 v1, s[12:15], s28 offen offset:3072 sc1 lds
  v_mul_f32 v64, v64, v80
  v_mul_f32 v65, v65, v81
  v_mul_f32 v66, v66, v82
  v_mul_f32 v67, v67, v83
  v_cvt_pk_bf16_f32 v88, v56, v57
  v_cvt_pk_bf16_f32 v89, v58, v59
  v_cvt_pk_bf16_f32 v90, v64, v65
  v_cvt_pk_bf16_f32 v91, v66, v67
  s_add_u32 s30, s51, s37
  buffer_store_dwordx4 v[88:91], v1, s[8:11], s30 offen offset:1024 sc1
  v_accvgpr_read_b32 v8, a28
  v_accvgpr_read_b32 v9, a29
  v_accvgpr_read_b32 v10, a30
  v_accvgpr_read_b32 v11, a31
  v_pk_mul_f32 v[8:9], v[8:9], s[94:95]
  v_pk_mul_f32 v[10:11], v[10:11], s[94:95]
  v_pk_mul_f32 v[36:37], v[36:37], s[94:95]
  v_pk_mul_f32 v[38:39], v[38:39], s[94:95]
  v_cvt_pk_bf16_f32 v144, v8, v9
  v_cvt_pk_bf16_f32 v145, v10, v11
  v_cvt_pk_bf16_f32 v146, v36, v37
  v_cvt_pk_bf16_f32 v147, v38, v39
  v_accvgpr_read_b32 v8, a24
  v_accvgpr_read_b32 v9, a25
  v_accvgpr_read_b32 v10, a26
  v_accvgpr_read_b32 v11, a27
  v_pk_mul_f32 v[8:9], v[8:9], s[94:95]
  v_pk_mul_f32 v[10:11], v[10:11], s[94:95]
  v_pk_mul_f32 v[44:45], v[44:45], s[94:95]
  v_pk_mul_f32 v[46:47], v[46:47], s[94:95]
  v_cvt_pk_bf16_f32 v160, v8, v9
  v_cvt_pk_bf16_f32 v161, v10, v11
  v_cvt_pk_bf16_f32 v162, v44, v45
  v_cvt_pk_bf16_f32 v163, v46, v47
  v_pk_mul_f32 v[20:21], v[20:21], s[94:95]
  v_pk_mul_f32 v[22:23], v[22:23], s[94:95]
  v_pk_mul_f32 v[52:53], v[52:53], s[94:95]
  v_pk_mul_f32 v[54:55], v[54:55], s[94:95]
  v_cvt_pk_bf16_f32 v176, v20, v21
  v_cvt_pk_bf16_f32 v177, v22, v23
  v_cvt_pk_bf16_f32 v178, v52, v53
  v_cvt_pk_bf16_f32 v179, v54, v55
  v_pk_mul_f32 v[28:29], v[28:29], s[94:95]
  v_pk_mul_f32 v[30:31], v[30:31], s[94:95]
  v_pk_mul_f32 v[60:61], v[60:61], s[94:95]
  v_pk_mul_f32 v[62:63], v[62:63], s[94:95]
  v_cvt_pk_bf16_f32 v192, v28, v29
  v_cvt_pk_bf16_f32 v193, v30, v31
  v_cvt_pk_bf16_f32 v194, v60, v61
  v_cvt_pk_bf16_f32 v195, v62, v63
  v_pk_mul_f32 v[148:149], v[148:149], s[94:95]
  v_pk_mul_f32 v[150:151], v[150:151], s[94:95]
  v_pk_mul_f32 v[68:69], v[68:69], s[94:95]
  v_pk_mul_f32 v[70:71], v[70:71], s[94:95]
  v_cvt_pk_bf16_f32 v148, v148, v149
  v_cvt_pk_bf16_f32 v149, v150, v151
  v_cvt_pk_bf16_f32 v150, v68, v69
  v_cvt_pk_bf16_f32 v151, v70, v71
  v_pk_mul_f32 v[164:165], v[164:165], s[94:95]
  v_pk_mul_f32 v[166:167], v[166:167], s[94:95]
  v_pk_mul_f32 v[76:77], v[76:77], s[94:95]
  v_pk_mul_f32 v[78:79], v[78:79], s[94:95]
  v_cvt_pk_bf16_f32 v164, v164, v165
  v_cvt_pk_bf16_f32 v165, v166, v167
  v_cvt_pk_bf16_f32 v166, v76, v77
  v_cvt_pk_bf16_f32 v167, v78, v79
  v_pk_mul_f32 v[180:181], v[180:181], s[94:95]
  v_pk_mul_f32 v[182:183], v[182:183], s[94:95]
  v_pk_mul_f32 v[84:85], v[84:85], s[94:95]
  v_pk_mul_f32 v[86:87], v[86:87], s[94:95]
  v_cvt_pk_bf16_f32 v180, v180, v181
  v_cvt_pk_bf16_f32 v181, v182, v183
  v_cvt_pk_bf16_f32 v182, v84, v85
  v_cvt_pk_bf16_f32 v183, v86, v87
  v_pk_mul_f32 v[196:197], v[196:197], s[94:95]
  v_pk_mul_f32 v[198:199], v[198:199], s[94:95]
  v_pk_mul_f32 v[92:93], v[92:93], s[94:95]
  v_pk_mul_f32 v[94:95], v[94:95], s[94:95]
  v_cvt_pk_bf16_f32 v196, v196, v197
  v_cvt_pk_bf16_f32 v197, v198, v199
  v_cvt_pk_bf16_f32 v198, v92, v93
  v_cvt_pk_bf16_f32 v199, v94, v95
  v_pk_mul_f32 v[100:101], v[100:101], s[94:95]
  v_pk_mul_f32 v[102:103], v[102:103], s[94:95]
  v_pk_mul_f32 v[132:133], v[132:133], s[94:95]
  v_pk_mul_f32 v[134:135], v[134:135], s[94:95]
  v_cvt_pk_bf16_f32 v152, v100, v101
  v_cvt_pk_bf16_f32 v153, v102, v103
  v_cvt_pk_bf16_f32 v154, v132, v133
  v_cvt_pk_bf16_f32 v155, v134, v135
  v_pk_mul_f32 v[108:109], v[108:109], s[94:95]
  v_pk_mul_f32 v[110:111], v[110:111], s[94:95]
  v_pk_mul_f32 v[140:141], v[140:141], s[94:95]
  v_pk_mul_f32 v[142:143], v[142:143], s[94:95]
  v_cvt_pk_bf16_f32 v168, v108, v109
  v_cvt_pk_bf16_f32 v169, v110, v111
  v_cvt_pk_bf16_f32 v170, v140, v141
  v_cvt_pk_bf16_f32 v171, v142, v143
  v_pk_mul_f32 v[116:117], v[116:117], s[94:95]
  v_pk_mul_f32 v[118:119], v[118:119], s[94:95]
  v_pk_mul_f32 v[212:213], v[212:213], s[94:95]
  v_pk_mul_f32 v[214:215], v[214:215], s[94:95]
  v_cvt_pk_bf16_f32 v184, v116, v117
  v_cvt_pk_bf16_f32 v185, v118, v119
  v_cvt_pk_bf16_f32 v186, v212, v213
  v_cvt_pk_bf16_f32 v187, v214, v215
  v_pk_mul_f32 v[124:125], v[124:125], s[94:95]
  v_pk_mul_f32 v[126:127], v[126:127], s[94:95]
  v_pk_mul_f32 v[220:221], v[220:221], s[94:95]
  v_pk_mul_f32 v[222:223], v[222:223], s[94:95]
  v_cvt_pk_bf16_f32 v200, v124, v125
  v_cvt_pk_bf16_f32 v201, v126, v127
  v_cvt_pk_bf16_f32 v202, v220, v221
  v_cvt_pk_bf16_f32 v203, v222, v223
  v_pk_mul_f32 v[156:157], v[156:157], s[94:95]
  v_pk_mul_f32 v[158:159], v[158:159], s[94:95]
  v_pk_mul_f32 v[228:229], v[228:229], s[94:95]
  v_pk_mul_f32 v[230:231], v[230:231], s[94:95]
  v_cvt_pk_bf16_f32 v156, v156, v157
  v_cvt_pk_bf16_f32 v157, v158, v159
  v_cvt_pk_bf16_f32 v158, v228, v229
  v_cvt_pk_bf16_f32 v159, v230, v231
  v_pk_mul_f32 v[172:173], v[172:173], s[94:95]
  v_pk_mul_f32 v[174:175], v[174:175], s[94:95]
  v_pk_mul_f32 v[236:237], v[236:237], s[94:95]
  v_pk_mul_f32 v[238:239], v[238:239], s[94:95]
  v_cvt_pk_bf16_f32 v172, v172, v173
  v_cvt_pk_bf16_f32 v173, v174, v175
  v_cvt_pk_bf16_f32 v174, v236, v237
  v_cvt_pk_bf16_f32 v175, v238, v239
  v_pk_mul_f32 v[188:189], v[188:189], s[94:95]
  v_pk_mul_f32 v[190:191], v[190:191], s[94:95]
  v_pk_mul_f32 v[244:245], v[244:245], s[94:95]
  v_pk_mul_f32 v[246:247], v[246:247], s[94:95]
  v_cvt_pk_bf16_f32 v188, v188, v189
  v_cvt_pk_bf16_f32 v189, v190, v191
  v_cvt_pk_bf16_f32 v190, v244, v245
  v_cvt_pk_bf16_f32 v191, v246, v247
  v_pk_mul_f32 v[204:205], v[204:205], s[94:95]
  v_pk_mul_f32 v[206:207], v[206:207], s[94:95]
  v_pk_mul_f32 v[252:253], v[252:253], s[94:95]
  v_pk_mul_f32 v[254:255], v[254:255], s[94:95]
  v_cvt_pk_bf16_f32 v204, v204, v205
  v_cvt_pk_bf16_f32 v205, v206, v207
  v_cvt_pk_bf16_f32 v206, v252, v253
  v_cvt_pk_bf16_f32 v207, v254, v255
  s_mov_b32 s38, 0
  v_bfe_u32 v7, v0, 4, 2
  v_and_b32 v8, 15, v0
  v_lshlrev_b32 v7, 2, v7
  v_add_u32 v9, 0, v7
  v_cmp_le_u32 s[88:89], v9, v8
  v_add_u32 v9, 1, v7
  v_cmp_le_u32 s[90:91], v9, v8
  v_add_u32 v9, 2, v7
  v_cmp_le_u32 s[92:93], v9, v8
  v_add_u32 v9, 3, v7
  v_cmp_le_u32 s[94:95], v9, v8
  v_mov_b32 v216, 0x3f803f80
  v_mov_b32 v217, 0x3f803f80
  v_mov_b32 v218, 0x3f803f80
  v_mov_b32 v219, 0x3f803f80
L_att:
  s_mov_b64 s[62:63], 0
  s_add_u32 s32, s34, 0x14000
  s_add_u32 s33, s34, 0x20000
  s_mov_b32 s36, 0x4000
  s_mov_b32 s37, 0xc000
  v_mov_b32 v2, v1
  v_add_u32 v3, 0x4000, v1
  v_mov_b32 v128, 0
  v_mov_b32 v129, 0
  v_mov_b32 v130, 0
  v_mov_b32 v131, 0
  v_mov_b32 v132, 0
  v_mov_b32 v133, 0
  v_mov_b32 v134, 0
  v_mov_b32 v135, 0
  v_mov_b32 v136, 0
  v_mov_b32 v137, 0
  v_mov_b32 v138, 0
  v_mov_b32 v139, 0
  v_mov_b32 v140, 0
  v_mov_b32 v141, 0
  v_mov_b32 v142, 0
  v_mov_b32 v143, 0
  s_waitcnt vmcnt(16)
  s_barrier
  ds_read_b128 a[0:3], v2 offset:0
  ds_read_b128 a[4:7], v2 offset:1024
  ds_read_b128 a[8:11], v2 offset:2048
  ds_read_b128 a[12:15], v2 offset:3072
  ds_read_b128 a[16:19], v2 offset:4096
  ds_read_b128 a[20:23], v2 offset:5120
  ds_read_b128 a[24:27], v2 offset:6144
  ds_read_b128 a[28:31], v2 offset:7168
  ds_read_b128 a[128:131], v2 offset:8192
  ds_read_b128 a[132:135], v2 offset:9216
  ds_read_b128 a[136:139], v2 offset:10240
  ds_read_b128 a[140:143], v2 offset:11264
  ds_read_b128 a[144:147], v2 offset:12288
  ds_read_b128 a[148:151], v2 offset:13312
  ds_read_b128 a[152:155], v2 offset:14336
  s_waitcnt lgkmcnt(14)
  ds_read_b128 a[156:159], v2 offset:15360
  s_add_u32 s28, s34, 98304
  s_and_b32 m0, s28, 0x1ffff
  s_nop 0
  buffer_load_dwordx4 v1, s[12:15], s28 offen offset:0 sc1 lds
  buffer_load_dwordx4 v1, s[12:15], s28 offen offset:1024 sc1 lds
  buffer_load_dwordx4 v1, s[12:15], s28 offen offset:2048 sc1 lds
  buffer_load_dwordx4 v1, s[12:15], s28 offen offset:3072 sc1 lds
  s_add_u32 s28, s34, 81920
  s_and_b32 m0, s28, 0x1ffff
  s_nop 0
  buffer_load_dwordx4 v1, s[12:15], s28 offen offset:0 sc1 lds
  buffer_load_dwordx4 v1, s[12:15], s28 offen offset:1024 sc1 lds
  buffer_load_dwordx4 v1, s[12:15], s28 offen offset:2048 sc1 lds
  buffer_load_dwordx4 v1, s[12:15], s28 offen offset:3072 sc1 lds
  s_cmp_lg_u32 s38, 0
  s_cbranch_scc1 L_att_go
  s_waitcnt lgkmcnt(15)
  v_mfma_f32_16x16x32_bf16 v[16:19], a[0:3], v[144:147], 0
  s_waitcnt lgkmcnt(14)
  v_lshrrev_b32 v6, 1, v1
  v_and_b32 v5, 15, v0
  v_mfma_f32_16x16x32_bf16 v[16:19], a[4:7], v[148:151], v[16:19]
  s_waitcnt lgkmcnt(13)
  v_mul_u32_u24 v5, 0x500, v5
  v_bfe_u32 v7, v0, 4, 2
  v_mfma_f32_16x16x32_bf16 v[16:19], a[8:11], v[152:155], v[16:19]
  s_waitcnt lgkmcnt(12)
  v_lshl_add_u32 v5, v7, 3, v5
  s_sub_u32 s54, s96, s0
  v_mfma_f32_16x16x32_bf16 v[16:19], a[12:15], v[156:159], v[16:19]
  v_add_u32 v244, s54, v1
  v_add_u32 v245, 40960, v244
  v_mfma_f32_16x16x32_bf16 v[20:23], a[0:3], v[160:163], 0
  v_and_b32 v8, 15, v0
  v_lshlrev_b32 v11, 1, v7
  v_mfma_f32_16x16x32_bf16 v[20:23], a[4:7], v[164:167], v[20:23]
  v_xor_b32 v8, v8, v11
  v_mul_u32_u24 v7, 0x500, v7
  v_mfma_f32_16x16x32_bf16 v[20:23], a[8:11], v[168:171], v[20:23]
  v_lshl_add_u32 v9, v8, 4, v7
  v_xor_b32 v8, 8, v8
  v_mfma_f32_16x16x32_bf16 v[20:23], a[12:15], v[172:175], v[20:23]
  v_lshl_add_u32 v10, v8, 4, v7
  v_bfe_u32 v7, v0, 2, 4
  v_mfma_f32_16x16x32_bf16 v[24:27], a[0:3], v[176:179], 0
  v_and_b32 v8, 7, v7
  v_lshlrev_b32 v7, 8, v7
  v_mfma_f32_16x16x32_bf16 v[24:27], a[4:7], v[180:183], v[24:27]
  v_lshl_add_u32 v7, v8, 5, v7
  v_and_b32 v8, 3, v0
  v_mfma_f32_16x16x32_bf16 v[24:27], a[8:11], v[184:187], v[24:27]
  v_lshl_add_u32 v7, v8, 3, v7
  s_lshl_b32 s31, s3, 13
  v_mfma_f32_16x16x32_bf16 v[24:27], a[12:15], v[188:191], v[24:27]
  s_add_u32 s31, s31, 131072
  v_add_u32 v11, s31, v7
  v_mfma_f32_16x16x32_bf16 v[28:31], a[0:3], v[192:195], 0
  v_mfma_f32_16x16x32_bf16 v[28:31], a[4:7], v[196:199], v[28:31]
  v_mfma_f32_16x16x32_bf16 v[28:31], a[8:11], v[200:203], v[28:31]
  v_mfma_f32_16x16x32_bf16 v[28:31], a[12:15], v[204:207], v[28:31]
  v_max3_f32 v16, v16, v17, v18
  v_max_f32 v16, v16, v19
  v_max3_f32 v20, v20, v21, v22
  v_max_f32 v20, v20, v23
  v_max3_f32 v24, v24, v25, v26
  v_max_f32 v24, v24, v27
  s_nop 1
  v_max3_f32 v28, v28, v29, v30
  v_max_f32 v28, v28, v31
  v_mov_b32 v220, v16
  v_mov_b32 v221, v20
  v_mov_b32 v222, v24
  v_mov_b32 v223, v28
  v_permlane16_swap_b32 v16, v220
  v_permlane16_swap_b32 v20, v221
  v_permlane16_swap_b32 v24, v222
  v_permlane16_swap_b32 v28, v223
  v_max_f32 v16, v16, v220
  v_max_f32 v20, v20, v221
  v_max_f32 v24, v24, v222
  v_max_f32 v28, v28, v223
  v_mov_b32 v220, v16
  v_mov_b32 v221, v20
  v_mov_b32 v222, v24
  v_mov_b32 v223, v28
  v_permlane32_swap_b32 v16, v220
  v_permlane32_swap_b32 v20, v221
  v_permlane32_swap_b32 v24, v222
  v_permlane32_swap_b32 v28, v223
  v_max_f32 v16, v16, v220
  v_max_f32 v20, v20, v221
  v_max_f32 v24, v24, v222
  v_max_f32 v28, v28, v223
  v_sub_f32 v112, 0, v16
  v_sub_f32 v113, 0, v16
  v_sub_f32 v114, 0, v16
  v_sub_f32 v115, 0, v16
  v_sub_f32 v116, 0, v20
  v_sub_f32 v117, 0, v20
  v_sub_f32 v118, 0, v20
  v_sub_f32 v119, 0, v20
  v_sub_f32 v120, 0, v24
  v_sub_f32 v121, 0, v24
  v_sub_f32 v122, 0, v24
  v_sub_f32 v123, 0, v24
  v_sub_f32 v124, 0, v28
  v_sub_f32 v125, 0, v28
  v_sub_f32 v126, 0, v28
  v_sub_f32 v127, 0, v28
L_att_go:
  s_lshl_b32 s28, s6, 3
  s_add_u32 s28, s28, s5
  s_add_u32 s28, s28, 32
  s_lshl_b32 s53, s28, 7
  s_cmp_eq_u32 s3, 0
  s_cselect_b32 s53, s53, 536870912
  s_cmp_eq_u32 s38, 0
  s_cselect_b32 s53, s53, 536870912
  s_cmp_eq_u32 s3, 0
  s_cselect_b32 s39, s61, 536870912
  s_lshl_b32 s54, s7, 12
  s_add_u32 s54, s54, 14336
  v_mov_b32 v220, 0xf149f2ca
  v_cndmask_b32 v208, v220, v120, s[88:89]
  v_cndmask_b32 v209, v220, v120, s[90:91]
  v_cndmask_b32 v210, v220, v120, s[92:93]
  v_cndmask_b32 v211, v220, v120, s[94:95]
  v_cndmask_b32 v212, v220, v124, s[88:89]
  v_cndmask_b32 v213, v220, v124, s[90:91]
  v_cndmask_b32 v214, v220, v124, s[92:93]
  v_cndmask_b32 v215, v220, v124, s[94:95]
  s_lshl_b32 s35, s5, 1
  s_cmp_eq_u32 s35, 0
  s_cbranch_scc1 L_att_d
.p2align 3
L_att_dual:
  s_waitcnt lgkmcnt(15)
  v_mfma_f32_16x16x32_bf16 v[16:19], a[0:3], v[144:147], v[112:115]
  s_waitcnt vmcnt(16) lgkmcnt(0)
  v_mfma_f32_16x16x32_bf16 v[16:19], a[4:7], v[148:151], v[16:19]
  s_barrier
  ds_read_b128 a[32:35], v2 offset:32768
  ds_read_b128 a[36:39], v2 offset:40960
  v_mfma_f32_16x16x32_bf16 v[16:19], a[8:11], v[152:155], v[16:19]
  s_add_u32 s28, s32, 0x8000
  s_and_b32 m0, s28, 0x1ffff
  ds_read_b128 a[44:47], v2 offset:41984
  v_mfma_f32_16x16x32_bf16 v[16:19], a[12:15], v[156:159], v[16:19]
  ds_read_b128 a[40:43], v2 offset:33792
  ds_read_b128 a[48:51], v2 offset:34816
  v_mfma_f32_16x16x32_bf16 v[20:23], a[28:31], v[156:159], v[112:115]
  buffer_load_dwordx4 v1, s[12:15], s28 offen offset:0 sc1 lds
  v_mfma_f32_16x16x32_bf16 v[20:23], a[24:27], v[152:155], v[20:23]
  ds_read_b128 a[52:55], v2 offset:43008
  ds_read_b128 a[60:63], v2 offset:44032
  v_mfma_f32_16x16x32_bf16 v[20:23], a[20:23], v[148:151], v[20:23]
  ds_read_b128 a[56:59], v2 offset:35840
  v_mfma_f32_16x16x32_bf16 v[20:23], a[16:19], v[144:147], v[20:23]
  ds_read_b128 a[64:67], v2 offset:36864
  v_mfma_f32_16x16x32_bf16 v[24:27], a[128:131], v[144:147], v[112:115]
  v_exp_f32 v16, v16
  v_mfma_f32_16x16x32_bf16 v[24:27], a[132:135], v[148:151], v[24:27]
  v_exp_f32 v17, v17
  v_mfma_f32_16x16x32_bf16 v[24:27], a[136:139], v[152:155], v[24:27]
  v_exp_f32 v18, v18
  v_mfma_f32_16x16x32_bf16 v[24:27], a[140:143], v[156:159], v[24:27]
  v_exp_f32 v19, v19
  v_mfma_f32_16x16x32_bf16 v[28:31], a[156:159], v[156:159], v[112:115]
  v_exp_f32 v20, v20
  v_mfma_f32_16x16x32_bf16 v[28:31], a[152:155], v[152:155], v[28:31]
  v_exp_f32 v21, v21
  v_mfma_f32_16x16x32_bf16 v[28:31], a[148:151], v[148:151], v[28:31]
  v_exp_f32 v22, v22
  v_mfma_f32_16x16x32_bf16 v[28:31], a[144:147], v[144:147], v[28:31]
  v_exp_f32 v23, v23
  v_mfma_f32_16x16x32_bf16 v[32:35], a[0:3], v[160:163], v[116:119]
  v_cvt_pk_bf16_f32 v80, v16, v17
  v_cvt_pk_bf16_f32 v81, v18, v19
  v_mfma_f32_16x16x32_bf16 v[32:35], a[4:7], v[164:167], v[32:35]
  v_cvt_pk_bf16_f32 v82, v20, v21
  v_cvt_pk_bf16_f32 v83, v22, v23
  v_mfma_f32_16x16x32_bf16 v[32:35], a[8:11], v[168:171], v[32:35]
  v_exp_f32 v24, v24
  v_mfma_f32_16x16x32_bf16 v[32:35], a[12:15], v[172:175], v[32:35]
  v_exp_f32 v25, v25
  v_mfma_f32_16x16x32_bf16 v[36:39], a[28:31], v[172:175], v[116:119]
  buffer_load_dwordx4 v1, s[12:15], s28 offen offset:1024 sc1 lds
  v_mfma_f32_16x16x32_bf16 v[36:39], a[24:27], v[168:171], v[36:39]
  v_exp_f32 v26, v26
  v_mfma_f32_16x16x32_bf16 v[36:39], a[20:23], v[164:167], v[36:39]
  v_exp_f32 v27, v27
  v_mfma_f32_16x16x32_bf16 v[36:39], a[16:19], v[160:163], v[36:39]
  v_exp_f32 v28, v28
  v_mfma_f32_16x16x32_bf16 v[40:43], a[128:131], v[160:163], v[116:119]
  v_exp_f32 v29, v29
  v_mfma_f32_16x16x32_bf16 v[40:43], a[132:135], v[164:167], v[40:43]
  v_exp_f32 v30, v30
  v_mfma_f32_16x16x32_bf16 v[40:43], a[136:139], v[168:171], v[40:43]
  v_exp_f32 v31, v31
  v_mfma_f32_16x16x32_bf16 v[40:43], a[140:143], v[172:175], v[40:43]
  v_cvt_pk_bf16_f32 v84, v24, v25
  v_cvt_pk_bf16_f32 v85, v26, v27
  v_mfma_f32_16x16x32_bf16 v[44:47], a[156:159], v[172:175], v[116:119]
  v_cvt_pk_bf16_f32 v86, v28, v29
  v_cvt_pk_bf16_f32 v87, v30, v31
  v_mfma_f32_16x16x32_bf16 v[44:47], a[152:155], v[168:171], v[44:47]
  ds_read_b128 a[68:71], v2 offset:45056
  ds_read_b128 a[76:79], v2 offset:46080
  v_mfma_f32_16x16x32_bf16 v[44:47], a[148:151], v[164:167], v[44:47]
  ds_read_b128 a[72:75], v2 offset:37888
  ds_read_b128 a[80:83], v2 offset:38912
  v_mfma_f32_16x16x32_bf16 v[44:47], a[144:147], v[160:163], v[44:47]
  v_exp_f32 v32, v32
  v_mfma_f32_16x16x32_bf16 v[48:51], a[0:3], v[176:179], v[120:123]
  ds_read_b128 a[84:87], v2 offset:47104
  ds_read_b128 a[92:95], v2 offset:48128
  v_mfma_f32_16x16x32_bf16 v[48:51], a[4:7], v[180:183], v[48:51]
  v_exp_f32 v33, v33
  v_mfma_f32_16x16x32_bf16 v[48:51], a[8:11], v[184:187], v[48:51]
  s_waitcnt lgkmcnt(14)
  ds_read_b128 a[88:91], v2 offset:39936
  v_cvt_pk_bf16_f32 v88, v32, v33
  v_mfma_f32_16x16x32_bf16 v[48:51], a[12:15], v[188:191], v[48:51]
  v_exp_f32 v34, v34
  v_mfma_f32_16x16x32_bf16 v[52:55], a[28:31], v[188:191], v[120:123]
  buffer_load_dwordx4 v1, s[12:15], s28 offen offset:2048 sc1 lds
  v_mfma_f32_16x16x32_bf16 v[52:55], a[24:27], v[184:187], v[52:55]
  v_exp_f32 v35, v35
  v_mfma_f32_16x16x32_bf16 v[52:55], a[20:23], v[180:183], v[52:55]
  v_exp_f32 v36, v36
  v_mfma_f32_16x16x32_bf16 v[52:55], a[16:19], v[176:179], v[52:55]
  v_exp_f32 v37, v37
  v_mfma_f32_16x16x32_bf16 v[56:59], a[128:131], v[176:179], v[120:123]
  v_exp_f32 v38, v38
  v_mfma_f32_16x16x32_bf16 v[56:59], a[132:135], v[180:183], v[56:59]
  v_exp_f32 v39, v39
  v_mfma_f32_16x16x32_bf16 v[56:59], a[136:139], v[184:187], v[56:59]
  v_cvt_pk_bf16_f32 v89, v34, v35
  v_cvt_pk_bf16_f32 v90, v36, v37
  v_mfma_f32_16x16x32_bf16 v[56:59], a[140:143], v[188:191], v[56:59]
  v_exp_f32 v40, v40
  v_mfma_f32_16x16x32_bf16 v[60:63], a[156:159], v[188:191], v[120:123]
  v_exp_f32 v41, v41
  v_mfma_f32_16x16x32_bf16 v[60:63], a[152:155], v[184:187], v[60:63]
  v_cvt_pk_bf16_f32 v91, v38, v39
  v_cvt_pk_bf16_f32 v92, v40, v41
  v_mfma_f32_16x16x32_bf16 v[60:63], a[148:151], v[180:183], v[60:63]
  v_exp_f32 v42, v42
  v_mfma_f32_16x16x32_bf16 v[60:63], a[144:147], v[176:179], v[60:63]
  v_exp_f32 v43, v43
  v_mfma_f32_16x16x32_bf16 v[64:67], a[0:3], v[192:195], v[124:127]
  v_exp_f32 v44, v44
  v_mfma_f32_16x16x32_bf16 v[64:67], a[4:7], v[196:199], v[64:67]
  v_exp_f32 v45, v45
  v_mfma_f32_16x16x32_bf16 v[64:67], a[8:11], v[200:203], v[64:67]
  v_exp_f32 v46, v46
  v_mfma_f32_16x16x32_bf16 v[64:67], a[12:15], v[204:207], v[64:67]
  v_exp_f32 v47, v47
  v_mfma_f32_16x16x32_bf16 v[68:71], a[28:31], v[204:207], v[124:127]
  buffer_load_dwordx4 v1, s[12:15], s28 offen offset:3072 sc1 lds
  v_mfma_f32_16x16x32_bf16 v[68:71], a[24:27], v[200:203], v[68:71]
  s_and_b32 m0, s33, 0x1ffff
  v_cvt_pk_bf16_f32 v93, v42, v43
  v_cvt_pk_bf16_f32 v94, v44, v45
  v_mfma_f32_16x16x32_bf16 v[68:71], a[20:23], v[196:199], v[68:71]
  s_waitcnt lgkmcnt(14)
  ds_read_b128 a[0:3], v3 offset:0
  v_cvt_pk_bf16_f32 v95, v46, v47
  v_mfma_f32_16x16x32_bf16 v[68:71], a[16:19], v[192:195], v[68:71]
  v_exp_f32 v48, v48
  v_mfma_f32_16x16x32_bf16 v[72:75], a[128:131], v[192:195], v[124:127]
  v_exp_f32 v49, v49
  v_mfma_f32_16x16x32_bf16 v[72:75], a[132:135], v[196:199], v[72:75]
  v_exp_f32 v50, v50
  v_mfma_f32_16x16x32_bf16 v[72:75], a[136:139], v[200:203], v[72:75]
  v_exp_f32 v51, v51
  v_mfma_f32_16x16x32_bf16 v[72:75], a[140:143], v[204:207], v[72:75]
  v_exp_f32 v52, v52
  v_mfma_f32_16x16x32_bf16 v[76:79], a[156:159], v[204:207], v[124:127]
  v_exp_f32 v53, v53
  v_mfma_f32_16x16x32_bf16 v[76:79], a[152:155], v[200:203], v[76:79]
  v_exp_f32 v54, v54
  v_mfma_f32_16x16x32_bf16 v[76:79], a[148:151], v[196:199], v[76:79]
  v_exp_f32 v55, v55
  v_mfma_f32_16x16x32_bf16 v[76:79], a[144:147], v[192:195], v[76:79]
  s_waitcnt lgkmcnt(15)
  v_cvt_pk_bf16_f32 v96, v48, v49
  v_cvt_pk_bf16_f32 v97, v50, v51
  v_mfma_f32_16x16x32_bf16 a[96:99], a[32:35], v[80:83], a[96:99]
  v_cvt_pk_bf16_f32 v98, v52, v53
  v_cvt_pk_bf16_f32 v99, v54, v55
  v_mfma_f32_16x16x32_bf16 a[96:99], a[36:39], v[84:87], a[96:99]
  s_waitcnt lgkmcnt(14)
  v_exp_f32 v56, v56
  v_mfma_f32_16x16x32_bf16 a[100:103], a[44:47], v[84:87], a[100:103]
  s_waitcnt lgkmcnt(13)
  v_exp_f32 v57, v57
  v_mfma_f32_16x16x32_bf16 a[100:103], a[40:43], v[80:83], a[100:103]
  s_waitcnt lgkmcnt(12)
  v_exp_f32 v58, v58
  v_mfma_f32_16x16x32_bf16 a[104:107], a[48:51], v[80:83], a[104:107]
  s_waitcnt lgkmcnt(11)
  buffer_load_dwordx4 v1, s[12:15], s33 offen offset:0 sc1 lds
  v_mfma_f32_16x16x32_bf16 a[104:107], a[52:55], v[84:87], a[104:107]
  s_waitcnt lgkmcnt(10)
  v_exp_f32 v59, v59
  v_mfma_f32_16x16x32_bf16 a[108:111], a[60:63], v[84:87], a[108:111]
  s_waitcnt lgkmcnt(9)
  v_exp_f32 v60, v60
  v_mfma_f32_16x16x32_bf16 a[108:111], a[56:59], v[80:83], a[108:111]
  s_waitcnt lgkmcnt(8)
  v_exp_f32 v61, v61
  v_mfma_f32_16x16x32_bf16 a[112:115], a[64:67], v[80:83], a[112:115]
  s_waitcnt lgkmcnt(7)
  v_exp_f32 v62, v62
  v_mfma_f32_16x16x32_bf16 a[112:115], a[68:71], v[84:87], a[112:115]
  s_waitcnt lgkmcnt(6)
  v_exp_f32 v63, v63
  v_mfma_f32_16x16x32_bf16 a[116:119], a[76:79], v[84:87], a[116:119]
  s_waitcnt lgkmcnt(5)
  v_cvt_pk_bf16_f32 v100, v56, v57
  v_cvt_pk_bf16_f32 v101, v58, v59
  v_mfma_f32_16x16x32_bf16 a[116:119], a[72:75], v[80:83], a[116:119]
  s_waitcnt lgkmcnt(4)
  v_cvt_pk_bf16_f32 v102, v60, v61
  v_cvt_pk_bf16_f32 v103, v62, v63
  v_mfma_f32_16x16x32_bf16 a[120:123], a[80:83], v[80:83], a[120:123]
  s_waitcnt lgkmcnt(3)
  v_exp_f32 v64, v64
  v_mfma_f32_16x16x32_bf16 a[120:123], a[84:87], v[84:87], a[120:123]
  s_waitcnt lgkmcnt(2)
  v_exp_f32 v65, v65
  v_mfma_f32_16x16x32_bf16 a[124:127], a[92:95], v[84:87], a[124:127]
  s_waitcnt lgkmcnt(1)
  v_exp_f32 v66, v66
  v_mfma_f32_16x16x32_bf16 a[124:127], a[88:91], v[80:83], a[124:127]
  v_exp_f32 v67, v67
  v_mfma_f32_16x16x32_bf16 v[128:131], v[216:219], v[80:83], v[128:131]
  v_exp_f32 v68, v68
  v_mfma_f32_16x16x32_bf16 v[128:131], v[216:219], v[84:87], v[128:131]
  v_exp_f32 v69, v69
  v_mfma_f32_16x16x32_bf16 a[160:163], a[32:35], v[88:91], a[160:163]
  v_exp_f32 v70, v70
  v_mfma_f32_16x16x32_bf16 a[160:163], a[36:39], v[92:95], a[160:163]
  v_exp_f32 v71, v71
  v_mfma_f32_16x16x32_bf16 a[164:167], a[44:47], v[92:95], a[164:167]
  buffer_load_dwordx4 v1, s[12:15], s33 offen offset:1024 sc1 lds
  v_mfma_f32_16x16x32_bf16 a[164:167], a[40:43], v[88:91], a[164:167]
  v_cvt_pk_bf16_f32 v104, v64, v65
  v_cvt_pk_bf16_f32 v105, v66, v67
  v_mfma_f32_16x16x32_bf16 a[168:171], a[48:51], v[88:91], a[168:171]
  v_cvt_pk_bf16_f32 v106, v68, v69
  v_cvt_pk_bf16_f32 v107, v70, v71
  v_mfma_f32_16x16x32_bf16 a[168:171], a[52:55], v[92:95], a[168:171]
  v_exp_f32 v72, v72
  v_mfma_f32_16x16x32_bf16 a[172:175], a[60:63], v[92:95], a[172:175]
  v_exp_f32 v73, v73
  v_mfma_f32_16x16x32_bf16 a[172:175], a[56:59], v[88:91], a[172:175]
  v_exp_f32 v74, v74
  v_mfma_f32_16x16x32_bf16 a[176:179], a[64:67], v[88:91], a[176:179]
  v_exp_f32 v75, v75
  v_mfma_f32_16x16x32_bf16 a[176:179], a[68:71], v[92:95], a[176:179]
  v_exp_f32 v76, v76
  v_mfma_f32_16x16x32_bf16 a[180:183], a[76:79], v[92:95], a[180:183]
  v_exp_f32 v77, v77
  v_mfma_f32_16x16x32_bf16 a[180:183], a[72:75], v[88:91], a[180:183]
  v_exp_f32 v78, v78
  v_mfma_f32_16x16x32_bf16 a[184:187], a[80:83], v[88:91], a[184:187]
  v_exp_f32 v79, v79
  v_mfma_f32_16x16x32_bf16 a[184:187], a[84:87], v[92:95], a[184:187]
  v_cvt_pk_bf16_f32 v108, v72, v73
  v_cvt_pk_bf16_f32 v109, v74, v75
  v_mfma_f32_16x16x32_bf16 a[188:191], a[92:95], v[92:95], a[188:191]
  v_cvt_pk_bf16_f32 v110, v76, v77
  v_cvt_pk_bf16_f32 v111, v78, v79
  v_mfma_f32_16x16x32_bf16 a[188:191], a[88:91], v[88:91], a[188:191]
  ds_read_b128 a[4:7], v3 offset:1024
  ds_read_b128 a[8:11], v3 offset:2048
  v_mfma_f32_16x16x32_bf16 v[132:135], v[216:219], v[88:91], v[132:135]
  ds_read_b128 a[12:15], v3 offset:3072
  ds_read_b128 a[16:19], v3 offset:4096
  v_mfma_f32_16x16x32_bf16 v[132:135], v[216:219], v[92:95], v[132:135]
  ds_read_b128 a[20:23], v3 offset:5120
  v_mfma_f32_16x16x32_bf16 a[192:195], a[32:35], v[96:99], a[192:195]
  buffer_load_dwordx4 v1, s[12:15], s33 offen offset:2048 sc1 lds
  v_mfma_f32_16x16x32_bf16 a[192:195], a[36:39], v[100:103], a[192:195]
  ds_read_b128 a[24:27], v3 offset:6144
  ds_read_b128 a[28:31], v3 offset:7168
  v_mfma_f32_16x16x32_bf16 a[196:199], a[44:47], v[100:103], a[196:199]
  ds_read_b128 a[128:131], v3 offset:8192
  v_mfma_f32_16x16x32_bf16 a[196:199], a[40:43], v[96:99], a[196:199]
  ds_read_b128 a[132:135], v3 offset:9216
  v_mfma_f32_16x16x32_bf16 a[200:203], a[48:51], v[96:99], a[200:203]
  ds_read_b128 a[136:139], v3 offset:10240
  v_mfma_f32_16x16x32_bf16 a[200:203], a[52:55], v[100:103], a[200:203]
  ds_read_b128 a[140:143], v3 offset:11264
  v_mfma_f32_16x16x32_bf16 a[204:207], a[60:63], v[100:103], a[204:207]
  ds_read_b128 a[144:147], v3 offset:12288
  v_mfma_f32_16x16x32_bf16 a[204:207], a[56:59], v[96:99], a[204:207]
  ds_read_b128 a[148:151], v3 offset:13312
  v_mfma_f32_16x16x32_bf16 a[208:211], a[64:67], v[96:99], a[208:211]
  ds_read_b128 a[152:155], v3 offset:14336
  v_mfma_f32_16x16x32_bf16 a[208:211], a[68:71], v[100:103], a[208:211]
  s_waitcnt lgkmcnt(14)
  ds_read_b128 a[156:159], v3 offset:15360
  v_mfma_f32_16x16x32_bf16 a[212:215], a[76:79], v[100:103], a[212:215]
  v_mfma_f32_16x16x32_bf16 a[212:215], a[72:75], v[96:99], a[212:215]
  v_mfma_f32_16x16x32_bf16 a[216:219], a[80:83], v[96:99], a[216:219]
  v_mfma_f32_16x16x32_bf16 a[216:219], a[84:87], v[100:103], a[216:219]
  v_mfma_f32_16x16x32_bf16 a[220:223], a[92:95], v[100:103], a[220:223]
  v_mfma_f32_16x16x32_bf16 a[220:223], a[88:91], v[96:99], a[220:223]
  v_mfma_f32_16x16x32_bf16 v[136:139], v[216:219], v[96:99], v[136:139]
  buffer_load_dwordx4 v1, s[12:15], s33 offen offset:3072 sc1 lds
  v_mfma_f32_16x16x32_bf16 v[136:139], v[216:219], v[100:103], v[136:139]
  s_mov_b32 s32, s33
  s_add_u32 s33, s33, s36
  s_xor_b32 s36, s36, 0x8000
  v_mfma_f32_16x16x32_bf16 a[224:227], a[32:35], v[104:107], a[224:227]
  v_mfma_f32_16x16x32_bf16 a[224:227], a[36:39], v[108:111], a[224:227]
  v_mfma_f32_16x16x32_bf16 a[228:231], a[44:47], v[108:111], a[228:231]
  v_mfma_f32_16x16x32_bf16 a[228:231], a[40:43], v[104:107], a[228:231]
  v_mfma_f32_16x16x32_bf16 a[232:235], a[48:51], v[104:107], a[232:235]
  v_mfma_f32_16x16x32_bf16 a[232:235], a[52:55], v[108:111], a[232:235]
  v_mfma_f32_16x16x32_bf16 a[236:239], a[60:63], v[108:111], a[236:239]
  v_mfma_f32_16x16x32_bf16 a[236:239], a[56:59], v[104:107], a[236:239]
  v_mfma_f32_16x16x32_bf16 a[240:243], a[64:67], v[104:107], a[240:243]
  v_mfma_f32_16x16x32_bf16 a[240:243], a[68:71], v[108:111], a[240:243]
  v_mfma_f32_16x16x32_bf16 a[244:247], a[76:79], v[108:111], a[244:247]
  s_sub_u32 s35, s35, 1
  v_mfma_f32_16x16x32_bf16 a[244:247], a[72:75], v[104:107], a[244:247]
  v_mfma_f32_16x16x32_bf16 a[248:251], a[80:83], v[104:107], a[248:251]
  v_mfma_f32_16x16x32_bf16 a[248:251], a[84:87], v[108:111], a[248:251]
  v_mfma_f32_16x16x32_bf16 a[252:255], a[92:95], v[108:111], a[252:255]
  v_mov_b32 v2, v3
  v_add_u32 v3, s37, v3
  v_mfma_f32_16x16x32_bf16 a[252:255], a[88:91], v[104:107], a[252:255]
  v_and_b32 v3, 0x1ffff, v3
  v_mfma_f32_16x16x32_bf16 v[140:143], v[216:219], v[104:107], v[140:143]
  s_xor_b32 s37, s37, 0x8000
  v_mfma_f32_16x16x32_bf16 v[140:143], v[216:219], v[108:111], v[140:143]
  s_cmp_lg_u32 s35, 0
  s_cbranch_scc1 L_att_dual
L_att_d:
  s_cmp_lg_u32 s3, 0
  s_cbranch_scc1 L_att_d1
  s_waitcnt lgkmcnt(15)
  v_mfma_f32_16x16x32_bf16 v[16:19], a[0:3], v[144:147], v[112:115]
  s_waitcnt vmcnt(16) lgkmcnt(0)
  v_mov_b32 v98, 0
  v_mov_b32 v99, 0
  v_mfma_f32_16x16x32_bf16 v[16:19], a[4:7], v[148:151], v[16:19]
  s_barrier
  ds_read_b128 a[32:35], v2 offset:32768
  ds_read_b128 a[36:39], v2 offset:40960
  v_mfma_f32_16x16x32_bf16 v[16:19], a[8:11], v[152:155], v[16:19]
  s_add_u32 m0, s31, 0
  s_add_u32 s29, s52, 0
  ds_read_b128 a[40:43], v2 offset:33792
  v_mfma_f32_16x16x32_bf16 v[16:19], a[12:15], v[156:159], v[16:19]
  ds_read_b128 a[44:47], v2 offset:41984
  ds_read_b128 a[48:51], v2 offset:34816
  v_mfma_f32_16x16x32_bf16 v[20:23], a[28:31], v[156:159], v[112:115]
  buffer_load_dwordx4 v9, s[16:19], s29 offen lds
  v_mfma_f32_16x16x32_bf16 v[20:23], a[24:27], v[152:155], v[20:23]
  s_add_u32 m0, s31, 1024
  s_add_u32 s29, s52, 5120
  ds_read_b128 a[52:55], v2 offset:43008
  v_mfma_f32_16x16x32_bf16 v[20:23], a[20:23], v[148:151], v[20:23]
  ds_read_b128 a[56:59], v2 offset:35840
  ds_read_b128 a[60:63], v2 offset:44032
  v_mfma_f32_16x16x32_bf16 v[20:23], a[16:19], v[144:147], v[20:23]
  ds_read_b128 a[64:67], v2 offset:36864
  v_mov_b32 v4, 0x5d800000
  v_mfma_f32_16x16x32_bf16 v[24:27], a[128:131], v[144:147], v[112:115]
  v_exp_f32 v16, v16
  v_mfma_f32_16x16x32_bf16 v[24:27], a[132:135], v[148:151], v[24:27]
  buffer_load_dwordx4 v10, s[16:19], s29 offen lds
  v_mfma_f32_16x16x32_bf16 v[24:27], a[136:139], v[152:155], v[24:27]
  s_add_u32 m0, s31, 2048
  s_add_u32 s29, s52, 10240
  ds_read_b128 a[68:71], v2 offset:45056
  v_mfma_f32_16x16x32_bf16 v[24:27], a[140:143], v[156:159], v[24:27]
  v_exp_f32 v17, v17
  v_mfma_f32_16x16x32_bf16 v[28:31], a[156:159], v[156:159], v[112:115]
  v_exp_f32 v18, v18
  v_mfma_f32_16x16x32_bf16 v[28:31], a[152:155], v[152:155], v[28:31]
  v_exp_f32 v19, v19
  v_mfma_f32_16x16x32_bf16 v[28:31], a[148:151], v[148:151], v[28:31]
  buffer_load_dwordx4 v9, s[16:19], s29 offen lds
  v_mfma_f32_16x16x32_bf16 v[28:31], a[144:147], v[144:147], v[28:31]
  s_add_u32 m0, s31, 3072
  s_add_u32 s29, s52, 15360
  v_cvt_pk_bf16_f32 v80, v16, v17
  v_mfma_f32_16x16x32_bf16 v[32:35], a[0:3], v[192:195], v[124:127]
  v_exp_f32 v20, v20
  v_mfma_f32_16x16x32_bf16 v[32:35], a[4:7], v[196:199], v[32:35]
  v_exp_f32 v21, v21
  v_mfma_f32_16x16x32_bf16 v[32:35], a[8:11], v[200:203], v[32:35]
  v_exp_f32 v22, v22
  v_mfma_f32_16x16x32_bf16 v[32:35], a[12:15], v[204:207], v[32:35]
  buffer_load_dwordx4 v10, s[16:19], s29 offen lds
  v_mfma_f32_16x16x32_bf16 v[36:39], a[28:31], v[204:207], v[124:127]
  s_add_u32 m0, s31, 4096
  s_add_u32 s29, s52, 20480
  v_cvt_pk_bf16_f32 v81, v18, v19
  v_mfma_f32_16x16x32_bf16 v[36:39], a[24:27], v[200:203], v[36:39]
  v_exp_f32 v23, v23
  v_mfma_f32_16x16x32_bf16 v[36:39], a[20:23], v[196:199], v[36:39]
  v_cvt_pk_bf16_f32 v82, v20, v21
  v_cvt_pk_bf16_f32 v83, v22, v23
  v_mfma_f32_16x16x32_bf16 v[36:39], a[16:19], v[192:195], v[36:39]
  v_exp_f32 v24, v24
  v_mfma_f32_16x16x32_bf16 v[40:43], a[128:131], v[192:195], v[124:127]
  buffer_load_dwordx4 v9, s[16:19], s29 offen lds
  v_mfma_f32_16x16x32_bf16 v[40:43], a[132:135], v[196:199], v[40:43]
  s_add_u32 m0, s31, 5120
  s_add_u32 s29, s52, 25600
  ds_read_b128 a[72:75], v2 offset:37888
  v_mfma_f32_16x16x32_bf16 v[40:43], a[136:139], v[200:203], v[40:43]
  v_exp_f32 v25, v25
  v_mfma_f32_16x16x32_bf16 v[40:43], a[140:143], v[204:207], v[40:43]
  v_exp_f32 v26, v26
  v_mfma_f32_16x16x32_bf16 v[44:47], a[156:159], v[204:207], v[124:127]
  v_exp_f32 v27, v27
  v_mfma_f32_16x16x32_bf16 v[44:47], a[152:155], v[200:203], v[44:47]
  buffer_load_dwordx4 v10, s[16:19], s29 offen lds
  v_mfma_f32_16x16x32_bf16 v[44:47], a[148:151], v[196:199], v[44:47]
  s_add_u32 m0, s31, 6144
  s_add_u32 s29, s52, 30720
  v_cvt_pk_bf16_f32 v84, v24, v25
  v_mfma_f32_16x16x32_bf16 v[44:47], a[144:147], v[192:195], v[44:47]
  v_exp_f32 v28, v28
  v_mfma_f32_16x16x32_bf16 v[48:51], a[0:3], v[176:179], v[208:211]
  v_exp_f32 v29, v29
  v_mfma_f32_16x16x32_bf16 v[48:51], a[4:7], v[180:183], v[48:51]
  v_exp_f32 v30, v30
  v_mfma_f32_16x16x32_bf16 v[48:51], a[8:11], v[184:187], v[48:51]
  buffer_load_dwordx4 v9, s[16:19], s29 offen lds
  v_mfma_f32_16x16x32_bf16 v[48:51], a[12:15], v[188:191], v[48:51]
  s_add_u32 m0, s31, 7168
  s_add_u32 s29, s52, 35840
  v_cvt_pk_bf16_f32 v85, v26, v27
  v_mfma_f32_16x16x32_bf16 v[64:67], a[0:3], v[160:163], v[116:119]
  v_exp_f32 v31, v31
  v_mfma_f32_16x16x32_bf16 v[64:67], a[4:7], v[164:167], v[64:67]
  v_cvt_pk_bf16_f32 v86, v28, v29
  v_cvt_pk_bf16_f32 v87, v30, v31
  v_mfma_f32_16x16x32_bf16 v[64:67], a[8:11], v[168:171], v[64:67]
  ds_read_b128 a[76:79], v2 offset:46080
  ds_read_b128 a[80:83], v2 offset:38912
  v_mfma_f32_16x16x32_bf16 v[64:67], a[12:15], v[172:175], v[64:67]
  buffer_load_dwordx4 v10, s[16:19], s29 offen lds
  v_mfma_f32_16x16x32_bf16 v[68:71], a[28:31], v[172:175], v[116:119]
  ds_read_b128 a[84:87], v2 offset:47104
  ds_read_b128 a[88:91], v2 offset:39936
  v_mfma_f32_16x16x32_bf16 v[68:71], a[24:27], v[168:171], v[68:71]
  s_waitcnt lgkmcnt(14)
  ds_read_b128 a[92:95], v2 offset:48128
  s_waitcnt lgkmcnt(14)
  ds_read_b128 a[0:3], v2 offset:16384
  v_mfma_f32_16x16x32_bf16 v[68:71], a[20:23], v[164:167], v[68:71]
  v_exp_f32 v32, v32
  v_mfma_f32_16x16x32_bf16 v[68:71], a[16:19], v[160:163], v[68:71]
  v_exp_f32 v33, v33
  v_mfma_f32_16x16x32_bf16 v[72:75], a[128:131], v[160:163], v[116:119]
  s_add_u32 s28, s32, 0x8000
  s_and_b32 m0, s28, 0x1ffff
  v_cvt_pk_bf16_f32 v88, v32, v33
  v_mfma_f32_16x16x32_bf16 v[72:75], a[132:135], v[164:167], v[72:75]
  v_exp_f32 v34, v34
  v_mfma_f32_16x16x32_bf16 v[72:75], a[136:139], v[168:171], v[72:75]
  buffer_load_dwordx4 v1, s[12:15], s28 offen offset:0 sc1 lds
  v_mfma_f32_16x16x32_bf16 v[72:75], a[140:143], v[172:175], v[72:75]
  v_exp_f32 v35, v35
  v_mfma_f32_16x16x32_bf16 v[76:79], a[156:159], v[172:175], v[116:119]
  v_exp_f32 v36, v36
  v_mfma_f32_16x16x32_bf16 v[76:79], a[152:155], v[168:171], v[76:79]
  v_exp_f32 v37, v37
  v_mfma_f32_16x16x32_bf16 v[76:79], a[148:151], v[164:167], v[76:79]
  v_exp_f32 v38, v38
  v_mfma_f32_16x16x32_bf16 v[76:79], a[144:147], v[160:163], v[76:79]
  v_exp_f32 v39, v39
  v_mfma_f32_16x16x32_bf16 v[128:131], v[216:219], v[80:83], v[128:131]
  v_cvt_pk_bf16_f32 v89, v34, v35
  v_cvt_pk_bf16_f32 v90, v36, v37
  v_mfma_f32_16x16x32_bf16 v[128:131], v[216:219], v[84:87], v[128:131]
  s_waitcnt lgkmcnt(15)
  buffer_load_dwordx4 v1, s[12:15], s28 offen offset:1024 sc1 lds
  v_mfma_f32_16x16x32_bf16 a[96:99], a[32:35], v[80:83], a[96:99]
  s_waitcnt lgkmcnt(14)
  ds_read_b128 a[4:7], v2 offset:17408
  v_cvt_pk_bf16_f32 v91, v38, v39
  v_mfma_f32_16x16x32_bf16 a[96:99], a[36:39], v[84:87], a[96:99]
  s_waitcnt lgkmcnt(15)
  v_exp_f32 v40, v40
  v_mfma_f32_16x16x32_bf16 a[100:103], a[40:43], v[80:83], a[100:103]
  s_waitcnt lgkmcnt(14)
  v_exp_f32 v41, v41
  v_mfma_f32_16x16x32_bf16 a[100:103], a[44:47], v[84:87], a[100:103]
  s_waitcnt lgkmcnt(13)
  v_exp_f32 v42, v42
  v_mfma_f32_16x16x32_bf16 a[104:107], a[48:51], v[80:83], a[104:107]
  s_waitcnt lgkmcnt(12)
  v_exp_f32 v43, v43
  v_mfma_f32_16x16x32_bf16 a[104:107], a[52:55], v[84:87], a[104:107]
  s_waitcnt lgkmcnt(11)
  v_exp_f32 v44, v44
  v_mfma_f32_16x16x32_bf16 a[108:111], a[56:59], v[80:83], a[108:111]
  s_waitcnt lgkmcnt(10)
  v_exp_f32 v45, v45
  v_mfma_f32_16x16x32_bf16 a[108:111], a[60:63], v[84:87], a[108:111]
  s_waitcnt lgkmcnt(9)
  buffer_load_dwordx4 v1, s[12:15], s28 offen offset:2048 sc1 lds
  v_mfma_f32_16x16x32_bf16 a[112:115], a[64:67], v[80:83], a[112:115]
  s_waitcnt lgkmcnt(8)
  v_exp_f32 v46, v46
  v_mfma_f32_16x16x32_bf16 a[112:115], a[68:71], v[84:87], a[112:115]
  s_waitcnt lgkmcnt(7)
  v_exp_f32 v47, v47
  v_mfma_f32_16x16x32_bf16 a[116:119], a[72:75], v[80:83], a[116:119]
  s_waitcnt lgkmcnt(6)
  v_cvt_pk_bf16_f32 v92, v40, v41
  v_cvt_pk_bf16_f32 v93, v42, v43
  v_mfma_f32_16x16x32_bf16 a[116:119], a[76:79], v[84:87], a[116:119]
  s_waitcnt lgkmcnt(5)
  v_cvt_pk_bf16_f32 v94, v44, v45
  v_cvt_pk_bf16_f32 v95, v46, v47
  v_mfma_f32_16x16x32_bf16 a[120:123], a[80:83], v[80:83], a[120:123]
  s_waitcnt lgkmcnt(4)
  v_exp_f32 v48, v48
  v_mfma_f32_16x16x32_bf16 a[120:123], a[84:87], v[84:87], a[120:123]
  s_waitcnt lgkmcnt(3)
  v_exp_f32 v49, v49
  v_mfma_f32_16x16x32_bf16 a[124:127], a[88:91], v[80:83], a[124:127]
  s_waitcnt lgkmcnt(2)
  v_exp_f32 v50, v50
  v_mfma_f32_16x16x32_bf16 a[124:127], a[92:95], v[84:87], a[124:127]
  buffer_load_dwordx4 v1, s[12:15], s28 offen offset:3072 sc1 lds
  v_mfma_f32_16x16x32_bf16 v[140:143], v[216:219], v[88:91], v[140:143]
  s_and_b32 m0, s33, 0x1ffff
  v_exp_f32 v51, v51
  v_mfma_f32_16x16x32_bf16 v[140:143], v[216:219], v[92:95], v[140:143]
  v_cvt_pk_bf16_f32 v96, v48, v49
  v_cvt_pk_bf16_f32 v97, v50, v51
  v_mfma_f32_16x16x32_bf16 a[224:227], a[32:35], v[88:91], a[224:227]
  v_exp_f32 v64, v64
  v_mfma_f32_16x16x32_bf16 a[224:227], a[36:39], v[92:95], a[224:227]
  v_exp_f32 v65, v65
  v_mfma_f32_16x16x32_bf16 a[228:231], a[40:43], v[88:91], a[228:231]
  v_exp_f32 v66, v66
  v_mfma_f32_16x16x32_bf16 a[228:231], a[44:47], v[92:95], a[228:231]
  v_exp_f32 v67, v67
  v_mfma_f32_16x16x32_bf16 a[232:235], a[48:51], v[88:91], a[232:235]
  v_exp_f32 v68, v68
  v_mfma_f32_16x16x32_bf16 a[232:235], a[52:55], v[92:95], a[232:235]
  buffer_load_dwordx4 v1, s[12:15], s33 offen offset:0 sc1 lds
  v_mfma_f32_16x16x32_bf16 a[236:239], a[56:59], v[88:91], a[236:239]
  v_exp_f32 v69, v69
  v_mfma_f32_16x16x32_bf16 a[236:239], a[60:63], v[92:95], a[236:239]
  v_exp_f32 v70, v70
  v_mfma_f32_16x16x32_bf16 a[240:243], a[64:67], v[88:91], a[240:243]
  v_exp_f32 v71, v71
  v_mfma_f32_16x16x32_bf16 a[240:243], a[68:71], v[92:95], a[240:243]
  v_cvt_pk_bf16_f32 v104, v64, v65
  v_cvt_pk_bf16_f32 v105, v66, v67
  v_mfma_f32_16x16x32_bf16 a[244:247], a[72:75], v[88:91], a[244:247]
  v_cvt_pk_bf16_f32 v106, v68, v69
  v_cvt_pk_bf16_f32 v107, v70, v71
  v_mfma_f32_16x16x32_bf16 a[244:247], a[76:79], v[92:95], a[244:247]
  v_exp_f32 v72, v72
  v_mfma_f32_16x16x32_bf16 a[248:251], a[80:83], v[88:91], a[248:251]
  buffer_load_dwordx4 v1, s[12:15], s33 offen offset:1024 sc1 lds
  v_mfma_f32_16x16x32_bf16 a[248:251], a[84:87], v[92:95], a[248:251]
  v_exp_f32 v73, v73
  v_mfma_f32_16x16x32_bf16 a[252:255], a[88:91], v[88:91], a[252:255]
  v_exp_f32 v74, v74
  v_mfma_f32_16x16x32_bf16 a[252:255], a[92:95], v[92:95], a[252:255]
  v_exp_f32 v75, v75
  v_mfma_f32_16x16x32_bf16 v[136:139], v[216:219], v[96:99], v[136:139]
  v_exp_f32 v76, v76
  v_mfma_f32_16x16x32_bf16 a[192:195], a[32:35], v[96:99], a[192:195]
  v_exp_f32 v77, v77
  v_mfma_f32_16x16x32_bf16 a[196:199], a[40:43], v[96:99], a[196:199]
  v_exp_f32 v78, v78
  v_mfma_f32_16x16x32_bf16 a[200:203], a[48:51], v[96:99], a[200:203]
  v_exp_f32 v79, v79
  v_mfma_f32_16x16x32_bf16 a[204:207], a[56:59], v[96:99], a[204:207]
  buffer_load_dwordx4 v1, s[12:15], s33 offen offset:2048 sc1 lds
  v_mfma_f32_16x16x32_bf16 a[208:211], a[64:67], v[96:99], a[208:211]
  v_cvt_pk_bf16_f32 v108, v72, v73
  v_cvt_pk_bf16_f32 v109, v74, v75
  v_mfma_f32_16x16x32_bf16 a[212:215], a[72:75], v[96:99], a[212:215]
  v_cvt_pk_bf16_f32 v110, v76, v77
  v_cvt_pk_bf16_f32 v111, v78, v79
  v_mfma_f32_16x16x32_bf16 a[216:219], a[80:83], v[96:99], a[216:219]
  ds_read_b128 a[8:11], v2 offset:18432
  ds_read_b128 a[12:15], v2 offset:19456
  v_mfma_f32_16x16x32_bf16 a[220:223], a[88:91], v[96:99], a[220:223]
  ds_read_b128 a[16:19], v2 offset:20480
  ds_read_b128 a[20:23], v2 offset:21504
  v_mfma_f32_16x16x32_bf16 v[132:135], v[216:219], v[104:107], v[132:135]
  ds_read_b128 a[24:27], v2 offset:22528
  v_xor_b32 v3, 0x10000, v2
  v_mfma_f32_16x16x32_bf16 v[132:135], v[216:219], v[108:111], v[132:135]
  ds_read_b128 a[28:31], v2 offset:23552
  v_cmp_nlt_f32 vcc, 0x21800000, v136
  v_mfma_f32_16x16x32_bf16 a[160:163], a[32:35], v[104:107], a[160:163]
  s_or_b64 s[62:63], s[62:63], vcc
  ds_read_b128 a[128:131], v2 offset:24576
  v_cmp_ngt_f32 vcc, v4, v136
  v_mfma_f32_16x16x32_bf16 a[160:163], a[36:39], v[108:111], a[160:163]
  s_or_b64 s[62:63], s[62:63], vcc
  buffer_load_dwordx4 v1, s[12:15], s33 offen offset:3072 sc1 lds
  v_mfma_f32_16x16x32_bf16 a[164:167], a[40:43], v[104:107], a[164:167]
  s_mov_b32 s32, s33
  ds_read_b128 a[132:135], v2 offset:25600
  ds_read_b128 a[136:139], v2 offset:26624
  v_mfma_f32_16x16x32_bf16 a[164:167], a[44:47], v[108:111], a[164:167]
  s_add_u32 s33, s33, s36
  s_xor_b32 s36, s36, 0x8000
  ds_read_b128 a[140:143], v2 offset:27648
  v_mfma_f32_16x16x32_bf16 a[168:171], a[48:51], v[104:107], a[168:171]
  v_rcp_f32 v136, v136
  v_mfma_f32_16x16x32_bf16 a[168:171], a[52:55], v[108:111], a[168:171]
  ds_read_b128 a[144:147], v2 offset:28672
  ds_read_b128 a[148:151], v2 offset:29696
  v_mfma_f32_16x16x32_bf16 a[172:175], a[56:59], v[104:107], a[172:175]
  ds_read_b128 a[152:155], v2 offset:30720
  v_accvgpr_read_b32 v220, a192
  v_mfma_f32_16x16x32_bf16 a[172:175], a[60:63], v[108:111], a[172:175]
  s_waitcnt lgkmcnt(14)
  ds_read_b128 a[156:159], v2 offset:31744
  v_accvgpr_read_b32 v221, a193
  v_mfma_f32_16x16x32_bf16 a[176:179], a[64:67], v[104:107], a[176:179]
  v_accvgpr_read_b32 v222, a194
  v_accvgpr_read_b32 v223, a195
  v_mfma_f32_16x16x32_bf16 a[176:179], a[68:71], v[108:111], a[176:179]
  v_accvgpr_read_b32 v224, a196
  v_accvgpr_read_b32 v225, a197
  v_mfma_f32_16x16x32_bf16 a[180:183], a[72:75], v[104:107], a[180:183]
  v_accvgpr_read_b32 v226, a198
  v_accvgpr_read_b32 v227, a199
  v_mfma_f32_16x16x32_bf16 a[180:183], a[76:79], v[108:111], a[180:183]
  v_mul_f32 v220, v220, v136
  v_mul_f32 v221, v221, v136
  v_mfma_f32_16x16x32_bf16 a[184:187], a[80:83], v[104:107], a[184:187]
  v_mul_f32 v222, v222, v136
  v_mul_f32 v223, v223, v136
  v_mfma_f32_16x16x32_bf16 a[184:187], a[84:87], v[108:111], a[184:187]
  s_waitcnt vmcnt(24)
  s_waitcnt vmcnt(16) lgkmcnt(0)
  v_mul_f32 v224, v224, v136
  v_mul_f32 v225, v225, v136
  v_mfma_f32_16x16x32_bf16 a[188:191], a[88:91], v[104:107], a[188:191]
  s_barrier
  ds_read_b128 a[32:35], v2 offset:49152
  ds_read_b128 a[36:39], v2 offset:57344
  v_mfma_f32_16x16x32_bf16 a[188:191], a[92:95], v[108:111], a[188:191]
  s_add_u32 s28, s32, 0x8000
  s_and_b32 m0, s28, 0x1ffff
  ds_read_b128 a[40:43], v2 offset:50176
  v_mfma_f32_16x16x32_bf16 v[16:19], a[0:3], v[192:195], v[124:127]
  buffer_atomic_add v13, v12, s[8:11], s53 offen sc1
  v_mfma_f32_16x16x32_bf16 v[16:19], a[4:7], v[196:199], v[16:19]
  ds_read_b128 a[44:47], v2 offset:58368
  v_xor_b32 v8, 0, v11
  v_mfma_f32_16x16x32_bf16 v[16:19], a[8:11], v[200:203], v[16:19]
  buffer_load_dwordx4 v1, s[12:15], s28 offen offset:0 sc1 lds
  v_mfma_f32_16x16x32_bf16 v[16:19], a[12:15], v[204:207], v[16:19]
  ds_read_b128 a[48:51], v2 offset:51200
  ds_read_b128 a[52:55], v2 offset:59392
  v_mfma_f32_16x16x32_bf16 v[20:23], a[28:31], v[204:207], v[124:127]
  s_waitcnt vmcnt(10)
  ds_read_b64_tr_b16 v[246:247], v8 offset:0
  ds_read_b64_tr_b16 v[248:249], v8 offset:4096
  v_mfma_f32_16x16x32_bf16 v[20:23], a[24:27], v[200:203], v[20:23]
  ds_read_b128 a[56:59], v2 offset:52224
  ds_read_b128 a[60:63], v2 offset:60416
  v_mfma_f32_16x16x32_bf16 v[20:23], a[20:23], v[196:199], v[20:23]
  ds_read_b128 a[64:67], v2 offset:53248
  v_mul_f32 v226, v226, v136
  v_mfma_f32_16x16x32_bf16 v[20:23], a[16:19], v[192:195], v[20:23]
  ds_read_b128 a[68:71], v2 offset:61440
  v_mul_f32 v227, v227, v136
  v_mfma_f32_16x16x32_bf16 v[24:27], a[128:131], v[192:195], v[124:127]
  v_exp_f32 v16, v16
  v_mfma_f32_16x16x32_bf16 v[24:27], a[132:135], v[196:199], v[24:27]
  v_exp_f32 v17, v17
  v_mfma_f32_16x16x32_bf16 v[24:27], a[136:139], v[200:203], v[24:27]
  v_exp_f32 v18, v18
  v_mfma_f32_16x16x32_bf16 v[24:27], a[140:143], v[204:207], v[24:27]
  v_xor_b32 v14, 32, v11
  v_cvt_pk_bf16_f32 v80, v16, v17
  v_mfma_f32_16x16x32_bf16 v[28:31], a[156:159], v[204:207], v[212:215]
  s_waitcnt lgkmcnt(4)
  buffer_store_dwordx4 v[246:249], v1, s[8:11], s20 offen sc1
  v_mfma_f32_16x16x32_bf16 v[28:31], a[152:155], v[200:203], v[28:31]
  buffer_load_dwordx4 v1, s[12:15], s28 offen offset:1024 sc1 lds
  v_mfma_f32_16x16x32_bf16 v[28:31], a[148:151], v[196:199], v[28:31]
  ds_read_b64_tr_b16 v[250:251], v14 offset:0
  ds_read_b64_tr_b16 v[252:253], v14 offset:4096
  v_mfma_f32_16x16x32_bf16 v[28:31], a[144:147], v[192:195], v[28:31]
  v_exp_f32 v19, v19
  v_mfma_f32_16x16x32_bf16 v[32:35], a[0:3], v[144:147], v[112:115]
  v_exp_f32 v20, v20
  v_mfma_f32_16x16x32_bf16 v[32:35], a[4:7], v[148:151], v[32:35]
  v_exp_f32 v21, v21
  v_mfma_f32_16x16x32_bf16 v[32:35], a[8:11], v[152:155], v[32:35]
  v_exp_f32 v22, v22
  v_mfma_f32_16x16x32_bf16 v[32:35], a[12:15], v[156:159], v[32:35]
  v_exp_f32 v23, v23
  v_mfma_f32_16x16x32_bf16 v[36:39], a[28:31], v[156:159], v[112:115]
  v_cvt_pk_bf16_f32 v81, v18, v19
  v_cvt_pk_bf16_f32 v82, v20, v21
  v_mfma_f32_16x16x32_bf16 v[36:39], a[24:27], v[152:155], v[36:39]
  v_xor_b32 v8, 64, v11
  v_cvt_pk_bf16_f32 v83, v22, v23
  v_mfma_f32_16x16x32_bf16 v[36:39], a[20:23], v[148:151], v[36:39]
  s_waitcnt lgkmcnt(0)
  buffer_store_dwordx4 v[250:253], v1, s[8:11], s21 offen sc1
  v_mfma_f32_16x16x32_bf16 v[36:39], a[16:19], v[144:147], v[36:39]
  v_exp_f32 v24, v24
  v_mfma_f32_16x16x32_bf16 v[40:43], a[128:131], v[144:147], v[112:115]
  ds_read_b64_tr_b16 v[246:247], v8 offset:0
  ds_read_b64_tr_b16 v[248:249], v8 offset:4096
  v_mfma_f32_16x16x32_bf16 v[40:43], a[132:135], v[148:151], v[40:43]
  buffer_load_dwordx4 v1, s[12:15], s28 offen offset:2048 sc1 lds
  v_mfma_f32_16x16x32_bf16 v[40:43], a[136:139], v[152:155], v[40:43]
  v_exp_f32 v25, v25
  v_mfma_f32_16x16x32_bf16 v[40:43], a[140:143], v[156:159], v[40:43]
  v_exp_f32 v26, v26
  v_mfma_f32_16x16x32_bf16 v[44:47], a[156:159], v[156:159], v[112:115]
  v_exp_f32 v27, v27
  v_mfma_f32_16x16x32_bf16 v[44:47], a[152:155], v[152:155], v[44:47]
  v_exp_f32 v28, v28
  v_mfma_f32_16x16x32_bf16 v[44:47], a[148:151], v[148:151], v[44:47]
  v_exp_f32 v29, v29
  v_mfma_f32_16x16x32_bf16 v[44:47], a[144:147], v[144:147], v[44:47]
  v_xor_b32 v14, 96, v11
  v_cvt_pk_bf16_f32 v84, v24, v25
  v_mfma_f32_16x16x32_bf16 v[48:51], a[0:3], v[160:163], v[116:119]
  s_waitcnt lgkmcnt(0)
  buffer_store_dwordx4 v[246:249], v1, s[8:11], s22 offen sc1
  v_mfma_f32_16x16x32_bf16 v[48:51], a[4:7], v[164:167], v[48:51]
  v_exp_f32 v30, v30
  v_mfma_f32_16x16x32_bf16 v[48:51], a[8:11], v[168:171], v[48:51]
  ds_read_b64_tr_b16 v[250:251], v14 offset:0
  ds_read_b64_tr_b16 v[252:253], v14 offset:4096
  v_mfma_f32_16x16x32_bf16 v[48:51], a[12:15], v[172:175], v[48:51]
  v_exp_f32 v31, v31
  v_mfma_f32_16x16x32_bf16 v[52:55], a[28:31], v[172:175], v[116:119]
  v_cvt_pk_bf16_f32 v85, v26, v27
  v_cvt_pk_bf16_f32 v86, v28, v29
  v_mfma_f32_16x16x32_bf16 v[52:55], a[24:27], v[168:171], v[52:55]
  buffer_load_dwordx4 v1, s[12:15], s28 offen offset:3072 sc1 lds
  v_mfma_f32_16x16x32_bf16 v[52:55], a[20:23], v[164:167], v[52:55]
  s_and_b32 m0, s33, 0x1ffff
  ds_read_b128 a[72:75], v2 offset:54272
  v_cvt_pk_bf16_f32 v87, v30, v31
  v_mfma_f32_16x16x32_bf16 v[52:55], a[16:19], v[160:163], v[52:55]
  ds_read_b128 a[76:79], v2 offset:62464
  ds_read_b128 a[80:83], v2 offset:55296
  v_mfma_f32_16x16x32_bf16 v[56:59], a[128:131], v[160:163], v[116:119]
  ds_read_b128 a[84:87], v2 offset:63488
  ds_read_b128 a[88:91], v2 offset:56320
  v_mfma_f32_16x16x32_bf16 v[56:59], a[132:135], v[164:167], v[56:59]
  ds_read_b128 a[92:95], v2 offset:64512
  v_xor_b32 v8, 128, v11
  v_mfma_f32_16x16x32_bf16 v[56:59], a[136:139], v[168:171], v[56:59]
  s_waitcnt lgkmcnt(6)
  buffer_store_dwordx4 v[250:253], v1, s[8:11], s23 offen sc1
  v_mfma_f32_16x16x32_bf16 v[56:59], a[140:143], v[172:175], v[56:59]
  v_exp_f32 v32, v32
  v_mfma_f32_16x16x32_bf16 v[60:63], a[156:159], v[172:175], v[116:119]
  ds_read_b64_tr_b16 v[246:247], v8 offset:0
  ds_read_b64_tr_b16 v[248:249], v8 offset:4096
  v_mfma_f32_16x16x32_bf16 v[60:63], a[152:155], v[168:171], v[60:63]
  v_exp_f32 v33, v33
  v_mfma_f32_16x16x32_bf16 v[60:63], a[148:151], v[164:167], v[60:63]
  v_exp_f32 v34, v34
  v_mfma_f32_16x16x32_bf16 v[60:63], a[144:147], v[160:163], v[60:63]
  v_exp_f32 v35, v35
  v_mfma_f32_16x16x32_bf16 v[140:143], v[216:219], v[80:83], v[140:143]
  v_exp_f32 v36, v36
  v_mfma_f32_16x16x32_bf16 v[140:143], v[216:219], v[84:87], v[140:143]
  buffer_load_dwordx4 v1, s[12:15], s33 offen offset:0 sc1 lds
  v_mfma_f32_16x16x32_bf16 a[224:227], a[32:35], v[80:83], a[224:227]
  v_exp_f32 v37, v37
  v_mfma_f32_16x16x32_bf16 a[224:227], a[36:39], v[84:87], a[224:227]
  v_xor_b32 v14, 160, v11
  v_cvt_pk_bf16_f32 v88, v32, v33
  v_mfma_f32_16x16x32_bf16 a[228:231], a[40:43], v[80:83], a[228:231]
  s_waitcnt lgkmcnt(0)
  buffer_store_dwordx4 v[246:249], v1, s[8:11], s24 offen sc1
  v_mfma_f32_16x16x32_bf16 a[228:231], a[44:47], v[84:87], a[228:231]
  v_exp_f32 v38, v38
  v_mfma_f32_16x16x32_bf16 a[232:235], a[48:51], v[80:83], a[232:235]
  ds_read_b64_tr_b16 v[250:251], v14 offset:0
  ds_read_b64_tr_b16 v[252:253], v14 offset:4096
  v_mfma_f32_16x16x32_bf16 a[232:235], a[52:55], v[84:87], a[232:235]
  v_exp_f32 v39, v39
  v_mfma_f32_16x16x32_bf16 a[236:239], a[56:59], v[80:83], a[236:239]
  v_cvt_pk_bf16_f32 v89, v34, v35
  v_cvt_pk_bf16_f32 v90, v36, v37
  v_mfma_f32_16x16x32_bf16 a[236:239], a[60:63], v[84:87], a[236:239]
  ds_read_b128 a[0:3], v3 offset:0
  v_cvt_pk_bf16_f32 v91, v38, v39
  v_mfma_f32_16x16x32_bf16 a[240:243], a[64:67], v[80:83], a[240:243]
  v_exp_f32 v40, v40
  v_mfma_f32_16x16x32_bf16 a[240:243], a[68:71], v[84:87], a[240:243]
  v_exp_f32 v41, v41
  v_mfma_f32_16x16x32_bf16 a[244:247], a[72:75], v[80:83], a[244:247]
  v_exp_f32 v42, v42
  v_mfma_f32_16x16x32_bf16 a[244:247], a[76:79], v[84:87], a[244:247]
  v_xor_b32 v8, 192, v11
  v_cvt_pk_bf16_f32 v92, v40, v41
  v_mfma_f32_16x16x32_bf16 a[248:251], a[80:83], v[80:83], a[248:251]
  buffer_load_dwordx4 v1, s[12:15], s33 offen offset:1024 sc1 lds
  v_mfma_f32_16x16x32_bf16 a[248:251], a[84:87], v[84:87], a[248:251]
  v_exp_f32 v43, v43
  v_mfma_f32_16x16x32_bf16 a[252:255], a[88:91], v[80:83], a[252:255]
  v_exp_f32 v44, v44
  v_exp_f32 v45, v45
  v_exp_f32 v46, v46
  v_exp_f32 v47, v47
  v_mfma_f32_16x16x32_bf16 a[252:255], a[92:95], v[84:87], a[252:255]
  s_waitcnt lgkmcnt(1)
  buffer_store_dwordx4 v[250:253], v1, s[8:11], s25 offen sc1
  v_cvt_pk_bf16_f32 v93, v42, v43
  v_cvt_pk_bf16_f32 v94, v44, v45
  v_cvt_pk_bf16_f32 v95, v46, v47
  v_mfma_f32_16x16x32_bf16 v[128:131], v[216:219], v[88:91], v[128:131]
  ds_read_b64_tr_b16 v[246:247], v8 offset:0
  ds_read_b64_tr_b16 v[248:249], v8 offset:4096
  v_mfma_f32_16x16x32_bf16 v[128:131], v[216:219], v[92:95], v[128:131]
  v_exp_f32 v48, v48
  v_mfma_f32_16x16x32_bf16 a[96:99], a[32:35], v[88:91], a[96:99]
  v_exp_f32 v49, v49
  v_mfma_f32_16x16x32_bf16 a[96:99], a[36:39], v[92:95], a[96:99]
  v_exp_f32 v50, v50
  v_mfma_f32_16x16x32_bf16 a[100:103], a[40:43], v[88:91], a[100:103]
  v_exp_f32 v51, v51
  v_mfma_f32_16x16x32_bf16 a[100:103], a[44:47], v[92:95], a[100:103]
  v_xor_b32 v14, 224, v11
  v_cvt_pk_bf16_f32 v96, v48, v49
  v_mfma_f32_16x16x32_bf16 a[104:107], a[48:51], v[88:91], a[104:107]
  s_waitcnt lgkmcnt(0)
  buffer_store_dwordx4 v[246:249], v1, s[8:11], s26 offen sc1
  v_mfma_f32_16x16x32_bf16 a[104:107], a[52:55], v[92:95], a[104:107]
  buffer_load_dwordx4 v1, s[12:15], s33 offen offset:2048 sc1 lds
  v_mfma_f32_16x16x32_bf16 a[108:111], a[56:59], v[88:91], a[108:111]
  ds_read_b64_tr_b16 v[250:251], v14 offset:0
  ds_read_b64_tr_b16 v[252:253], v14 offset:4096
  v_mfma_f32_16x16x32_bf16 a[108:111], a[60:63], v[92:95], a[108:111]
  v_exp_f32 v52, v52
  v_mfma_f32_16x16x32_bf16 a[112:115], a[64:67], v[88:91], a[112:115]
  v_exp_f32 v53, v53
  v_mfma_f32_16x16x32_bf16 a[112:115], a[68:71], v[92:95], a[112:115]
  v_exp_f32 v54, v54
  v_mfma_f32_16x16x32_bf16 a[116:119], a[72:75], v[88:91], a[116:119]
  v_exp_f32 v55, v55
  v_mfma_f32_16x16x32_bf16 a[116:119], a[76:79], v[92:95], a[116:119]
  v_cvt_pk_bf16_f32 v97, v50, v51
  v_cvt_pk_bf16_f32 v98, v52, v53
  v_mfma_f32_16x16x32_bf16 a[120:123], a[80:83], v[88:91], a[120:123]
  ds_read_b128 a[4:7], v3 offset:1024
  v_cvt_pk_bf16_f32 v99, v54, v55
  v_mfma_f32_16x16x32_bf16 a[120:123], a[84:87], v[92:95], a[120:123]
  v_exp_f32 v56, v56
  v_mfma_f32_16x16x32_bf16 a[124:127], a[88:91], v[88:91], a[124:127]
  v_exp_f32 v57, v57
  v_exp_f32 v58, v58
  v_exp_f32 v59, v59
  v_exp_f32 v60, v60
  v_exp_f32 v61, v61
  v_exp_f32 v62, v62
  v_exp_f32 v63, v63
  v_mfma_f32_16x16x32_bf16 a[124:127], a[92:95], v[92:95], a[124:127]
  v_cvt_pk_bf16_f32 v100, v56, v57
  v_cvt_pk_bf16_f32 v101, v58, v59
  v_cvt_pk_bf16_f32 v102, v60, v61
  v_cvt_pk_bf16_f32 v103, v62, v63
  v_mfma_f32_16x16x32_bf16 v[132:135], v[216:219], v[96:99], v[132:135]
  s_waitcnt lgkmcnt(1)
  buffer_store_dwordx4 v[250:253], v1, s[8:11], s27 offen sc1
  v_mfma_f32_16x16x32_bf16 v[132:135], v[216:219], v[100:103], v[132:135]
  buffer_load_dwordx4 v1, s[12:15], s33 offen offset:3072 sc1 lds
  v_mfma_f32_16x16x32_bf16 a[160:163], a[32:35], v[96:99], a[160:163]
  s_mov_b32 s32, s33
  ds_read_b128 a[8:11], v3 offset:2048
  ds_read_b128 a[12:15], v3 offset:3072
  v_mfma_f32_16x16x32_bf16 a[160:163], a[36:39], v[100:103], a[160:163]
  s_add_u32 s33, s33, s36
  ds_read_b128 a[16:19], v3 offset:4096
  ds_read_b128 a[20:23], v3 offset:5120
  v_mfma_f32_16x16x32_bf16 a[164:167], a[40:43], v[96:99], a[164:167]
  s_xor_b32 s36, s36, 0x8000
  ds_read_b128 a[24:27], v3 offset:6144
  v_cvt_pk_bf16_f32 v228, v220, v221
  v_mfma_f32_16x16x32_bf16 a[164:167], a[44:47], v[100:103], a[164:167]
  ds_read_b128 a[28:31], v3 offset:7168
  v_cvt_pk_bf16_f32 v229, v222, v223
  v_mfma_f32_16x16x32_bf16 a[168:171], a[48:51], v[96:99], a[168:171]
  ds_read_b128 a[128:131], v3 offset:8192
  v_cvt_pk_bf16_f32 v230, v224, v225
  v_mfma_f32_16x16x32_bf16 a[168:171], a[52:55], v[100:103], a[168:171]
  ds_read_b128 a[132:135], v3 offset:9216
  v_cvt_pk_bf16_f32 v231, v226, v227
  v_mfma_f32_16x16x32_bf16 a[172:175], a[56:59], v[96:99], a[172:175]
  s_add_u32 s30, s50, s54
  buffer_store_dwordx4 v[228:231], v1, s[8:11], s30 offen offset:0 sc1
  v_mfma_f32_16x16x32_bf16 a[172:175], a[60:63], v[100:103], a[172:175]
  ds_read_b128 a[136:139], v3 offset:10240
  ds_read_b128 a[140:143], v3 offset:11264
  v_mfma_f32_16x16x32_bf16 a[176:179], a[64:67], v[96:99], a[176:179]
  ds_read_b128 a[144:147], v3 offset:12288
  v_accvgpr_read_b32 v232, a200
  v_mfma_f32_16x16x32_bf16 a[176:179], a[68:71], v[100:103], a[176:179]
  ds_read_b128 a[148:151], v3 offset:13312
  v_accvgpr_read_b32 v233, a201
  v_mfma_f32_16x16x32_bf16 a[180:183], a[72:75], v[96:99], a[180:183]
  ds_read_b128 a[152:155], v3 offset:14336
  ds_read_b128 a[156:159], v3 offset:15360
  v_mfma_f32_16x16x32_bf16 a[180:183], a[76:79], v[100:103], a[180:183]
  v_accvgpr_read_b32 v234, a202
  v_accvgpr_read_b32 v235, a203
  v_mfma_f32_16x16x32_bf16 a[184:187], a[80:83], v[96:99], a[184:187]
  v_accvgpr_read_b32 v236, a204
  v_accvgpr_read_b32 v237, a205
  v_mfma_f32_16x16x32_bf16 a[184:187], a[84:87], v[100:103], a[184:187]
  v_mov_b32 v2, v3
  v_accvgpr_read_b32 v238, a206
  v_mfma_f32_16x16x32_bf16 a[188:191], a[88:91], v[96:99], a[188:191]
  v_accvgpr_read_b32 v239, a207
  v_mul_f32 v232, v232, v136
  v_mfma_f32_16x16x32_bf16 a[188:191], a[92:95], v[100:103], a[188:191]
  v_mul_f32 v233, v233, v136
  v_mul_f32 v234, v234, v136
  v_mul_f32 v235, v235, v136
  v_mul_f32 v236, v236, v136
  v_mul_f32 v237, v237, v136
  v_mul_f32 v238, v238, v136
  v_mul_f32 v239, v239, v136
  v_cvt_pk_bf16_f32 v240, v232, v233
  v_cvt_pk_bf16_f32 v241, v234, v235
  v_cvt_pk_bf16_f32 v242, v236, v237
  v_cvt_pk_bf16_f32 v243, v238, v239
  buffer_store_dwordx4 v[240:243], v1, s[8:11], s30 offen offset:1024 sc1
  v_accvgpr_read_b32 v220, a208
  v_accvgpr_read_b32 v221, a209
  v_accvgpr_read_b32 v222, a210
  v_accvgpr_read_b32 v223, a211
  v_accvgpr_read_b32 v224, a212
  v_accvgpr_read_b32 v225, a213
  v_accvgpr_read_b32 v226, a214
  v_accvgpr_read_b32 v227, a215
  v_mul_f32 v220, v220, v136
  v_mul_f32 v221, v221, v136
  v_mul_f32 v222, v222, v136
  v_mul_f32 v223, v223, v136
  v_mul_f32 v224, v224, v136
  v_mul_f32 v225, v225, v136
  v_mul_f32 v226, v226, v136
  v_mul_f32 v227, v227, v136
  v_cvt_pk_bf16_f32 v228, v220, v221
  v_cvt_pk_bf16_f32 v229, v222, v223
  v_cvt_pk_bf16_f32 v230, v224, v225
  v_cvt_pk_bf16_f32 v231, v226, v227
  buffer_store_dwordx4 v[228:231], v1, s[8:11], s30 offen offset:2048 sc1
  v_accvgpr_read_b32 v232, a216
  v_accvgpr_read_b32 v233, a217
  v_accvgpr_read_b32 v234, a218
  v_accvgpr_read_b32 v235, a219
  v_accvgpr_read_b32 v236, a220
  v_accvgpr_read_b32 v237, a221
  v_accvgpr_read_b32 v238, a222
  v_accvgpr_read_b32 v239, a223
  v_mul_f32 v232, v232, v136
  v_mul_f32 v233, v233, v136
  v_mul_f32 v234, v234, v136
  v_mul_f32 v235, v235, v136
  v_mul_f32 v236, v236, v136
  v_mul_f32 v237, v237, v136
  v_mul_f32 v238, v238, v136
  v_mul_f32 v239, v239, v136
  v_cvt_pk_bf16_f32 v240, v232, v233
  v_cvt_pk_bf16_f32 v241, v234, v235
  v_cvt_pk_bf16_f32 v242, v236, v237
  v_cvt_pk_bf16_f32 v243, v238, v239
  buffer_store_dwordx4 v[240:243], v1, s[8:11], s30 offen offset:3072 sc1
  v_cmp_nlt_f32 vcc, 0x21800000, v140
  s_nop 0
  s_or_b64 s[62:63], s[62:63], vcc
  v_cmp_ngt_f32 vcc, v4, v140
  s_nop 0
  s_or_b64 s[62:63], s[62:63], vcc
  v_rcp_f32 v140, v140
  v_accvgpr_read_b32 v220, a224
  v_accvgpr_read_b32 v221, a225
  v_accvgpr_read_b32 v222, a226
  v_accvgpr_read_b32 v223, a227
  v_accvgpr_read_b32 v224, a228
  v_accvgpr_read_b32 v225, a229
  v_accvgpr_read_b32 v226, a230
  v_accvgpr_read_b32 v227, a231
  v_mul_f32 v220, v220, v140
  v_mul_f32 v221, v221, v140
  v_mul_f32 v222, v222, v140
  v_mul_f32 v223, v223, v140
  v_mul_f32 v224, v224, v140
  v_mul_f32 v225, v225, v140
  v_mul_f32 v226, v226, v140
  v_mul_f32 v227, v227, v140
  v_cvt_pk_bf16_f32 v228, v220, v221
  v_cvt_pk_bf16_f32 v229, v222, v223
  v_cvt_pk_bf16_f32 v230, v224, v225
  v_cvt_pk_bf16_f32 v231, v226, v227
  s_add_u32 s30, s51, s54
  buffer_store_dwordx4 v[228:231], v1, s[8:11], s30 offen offset:0 sc1
  v_accvgpr_read_b32 v232, a232
  v_accvgpr_read_b32 v233, a233
  v_accvgpr_read_b32 v234, a234
  v_accvgpr_read_b32 v235, a235
  v_accvgpr_read_b32 v236, a236
  v_accvgpr_read_b32 v237, a237
  v_accvgpr_read_b32 v238, a238
  v_accvgpr_read_b32 v239, a239
  v_mul_f32 v232, v232, v140
  v_mul_f32 v233, v233, v140
  v_mul_f32 v234, v234, v140
  v_mul_f32 v235, v235, v140
  v_mul_f32 v236, v236, v140
  v_mul_f32 v237, v237, v140
  v_mul_f32 v238, v238, v140
  v_mul_f32 v239, v239, v140
  v_cvt_pk_bf16_f32 v240, v232, v233
  v_cvt_pk_bf16_f32 v241, v234, v235
  v_cvt_pk_bf16_f32 v242, v236, v237
  v_cvt_pk_bf16_f32 v243, v238, v239
  buffer_store_dwordx4 v[240:243], v1, s[8:11], s30 offen offset:1024 sc1
  v_accvgpr_read_b32 v220, a240
  v_accvgpr_read_b32 v221, a241
  v_accvgpr_read_b32 v222, a242
  v_accvgpr_read_b32 v223, a243
  v_accvgpr_read_b32 v224, a244
  v_accvgpr_read_b32 v225, a245
  v_accvgpr_read_b32 v226, a246
  v_accvgpr_read_b32 v227, a247
  v_mul_f32 v220, v220, v140
  v_mul_f32 v221, v221, v140
  v_mul_f32 v222, v222, v140
  v_mul_f32 v223, v223, v140
  v_mul_f32 v224, v224, v140
  v_mul_f32 v225, v225, v140
  v_mul_f32 v226, v226, v140
  v_mul_f32 v227, v227, v140
  v_cvt_pk_bf16_f32 v228, v220, v221
  v_cvt_pk_bf16_f32 v229, v222, v223
  v_cvt_pk_bf16_f32 v230, v224, v225
  v_cvt_pk_bf16_f32 v231, v226, v227
  buffer_store_dwordx4 v[228:231], v1, s[8:11], s30 offen offset:2048 sc1
  v_accvgpr_read_b32 v232, a248
  v_accvgpr_read_b32 v233, a249
  v_accvgpr_read_b32 v234, a250
  v_accvgpr_read_b32 v235, a251
  v_accvgpr_read_b32 v236, a252
  v_accvgpr_read_b32 v237, a253
  v_accvgpr_read_b32 v238, a254
  v_accvgpr_read_b32 v239, a255
  v_mul_f32 v232, v232, v140
  v_mul_f32 v233, v233, v140
  v_mul_f32 v234, v234, v140
  v_mul_f32 v235, v235, v140
  v_mul_f32 v236, v236, v140
  v_mul_f32 v237, v237, v140
  v_mul_f32 v238, v238, v140
  v_mul_f32 v239, v239, v140
  v_cvt_pk_bf16_f32 v240, v232, v233
  v_cvt_pk_bf16_f32 v241, v234, v235
  v_cvt_pk_bf16_f32 v242, v236, v237
  v_cvt_pk_bf16_f32 v243, v238, v239
  buffer_store_dwordx4 v[240:243], v1, s[8:11], s30 offen offset:3072 sc1
  s_branch L_att_dd
L_att_d1:
  s_cmp_lg_u32 s3, 1
  s_cbranch_scc1 L_att_d2
  s_waitcnt lgkmcnt(15)
  v_mfma_f32_16x16x32_bf16 v[16:19], a[0:3], v[144:147], v[112:115]
  s_waitcnt vmcnt(16) lgkmcnt(0)
  v_mfma_f32_16x16x32_bf16 v[16:19], a[4:7], v[148:151], v[16:19]
  s_barrier
  ds_read_b128 a[32:35], v2 offset:32768
  ds_read_b128 a[36:39], v2 offset:40960
  v_mfma_f32_16x16x32_bf16 v[16:19], a[8:11], v[152:155], v[16:19]
  s_add_u32 m0, s31, 0
  s_add_u32 s29, s52, 0
  ds_read_b128 a[40:43], v2 offset:33792
  v_mfma_f32_16x16x32_bf16 v[16:19], a[12:15], v[156:159], v[16:19]
  ds_read_b128 a[44:47], v2 offset:41984
  v_mov_b32 v4, 0x5d800000
  v_mfma_f32_16x16x32_bf16 v[20:23], a[28:31], v[156:159], v[112:115]
  buffer_load_dwordx4 v9, s[16:19], s29 offen lds
  v_mfma_f32_16x16x32_bf16 v[20:23], a[24:27], v[152:155], v[20:23]
  s_add_u32 m0, s31, 1024
  s_add_u32 s29, s52, 5120
  ds_read_b128 a[48:51], v2 offset:34816
  v_mfma_f32_16x16x32_bf16 v[20:23], a[20:23], v[148:151], v[20:23]
  ds_read_b128 a[52:55], v2 offset:43008
  ds_read_b128 a[56:59], v2 offset:35840
  v_mfma_f32_16x16x32_bf16 v[20:23], a[16:19], v[144:147], v[20:23]
  ds_read_b128 a[60:63], v2 offset:44032
  ds_read_b128 a[64:67], v2 offset:36864
  v_mfma_f32_16x16x32_bf16 v[24:27], a[128:131], v[144:147], v[112:115]
  v_exp_f32 v16, v16
  v_mfma_f32_16x16x32_bf16 v[24:27], a[132:135], v[148:151], v[24:27]
  buffer_load_dwordx4 v10, s[16:19], s29 offen lds
  v_mfma_f32_16x16x32_bf16 v[24:27], a[136:139], v[152:155], v[24:27]
  s_add_u32 m0, s31, 2048
  s_add_u32 s29, s52, 10240
  ds_read_b128 a[68:71], v2 offset:45056
  v_mfma_f32_16x16x32_bf16 v[24:27], a[140:143], v[156:159], v[24:27]
  v_exp_f32 v17, v17
  v_mfma_f32_16x16x32_bf16 v[28:31], a[156:159], v[156:159], v[112:115]
  ds_read_b128 a[72:75], v2 offset:37888
  v_cvt_pk_bf16_f32 v80, v16, v17
  v_mfma_f32_16x16x32_bf16 v[28:31], a[152:155], v[152:155], v[28:31]
  v_exp_f32 v18, v18
  v_mfma_f32_16x16x32_bf16 v[28:31], a[148:151], v[148:151], v[28:31]
  buffer_load_dwordx4 v9, s[16:19], s29 offen lds
  v_mfma_f32_16x16x32_bf16 v[28:31], a[144:147], v[144:147], v[28:31]
  s_add_u32 m0, s31, 3072
  s_add_u32 s29, s52, 15360
  ds_read_b128 a[76:79], v2 offset:46080
  v_mfma_f32_16x16x32_bf16 v[32:35], a[0:3], v[192:195], v[124:127]
  v_exp_f32 v19, v19
  v_mfma_f32_16x16x32_bf16 v[32:35], a[4:7], v[196:199], v[32:35]
  ds_read_b128 a[80:83], v2 offset:38912
  v_cvt_pk_bf16_f32 v81, v18, v19
  v_mfma_f32_16x16x32_bf16 v[32:35], a[8:11], v[200:203], v[32:35]
  v_exp_f32 v20, v20
  v_mfma_f32_16x16x32_bf16 v[32:35], a[12:15], v[204:207], v[32:35]
  buffer_load_dwordx4 v10, s[16:19], s29 offen lds
  v_mfma_f32_16x16x32_bf16 v[36:39], a[28:31], v[204:207], v[124:127]
  s_add_u32 m0, s31, 4096
  s_add_u32 s29, s52, 20480
  ds_read_b128 a[84:87], v2 offset:47104
  v_mfma_f32_16x16x32_bf16 v[36:39], a[24:27], v[200:203], v[36:39]
  v_exp_f32 v21, v21
  v_mfma_f32_16x16x32_bf16 v[36:39], a[20:23], v[196:199], v[36:39]
  ds_read_b128 a[88:91], v2 offset:39936
  v_cvt_pk_bf16_f32 v82, v20, v21
  v_mfma_f32_16x16x32_bf16 v[36:39], a[16:19], v[192:195], v[36:39]
  v_exp_f32 v22, v22
  v_mfma_f32_16x16x32_bf16 v[40:43], a[128:131], v[192:195], v[124:127]
  buffer_load_dwordx4 v9, s[16:19], s29 offen lds
  v_mfma_f32_16x16x32_bf16 v[40:43], a[132:135], v[196:199], v[40:43]
  s_add_u32 m0, s31, 5120
  s_add_u32 s29, s52, 25600
  s_waitcnt lgkmcnt(14)
  ds_read_b128 a[92:95], v2 offset:48128
  v_mfma_f32_16x16x32_bf16 v[40:43], a[136:139], v[200:203], v[40:43]
  v_exp_f32 v23, v23
  v_mfma_f32_16x16x32_bf16 v[40:43], a[140:143], v[204:207], v[40:43]
  v_cvt_pk_bf16_f32 v83, v22, v23
  v_xor_b32 v3, 0x10000, v2
  v_mfma_f32_16x16x32_bf16 v[44:47], a[156:159], v[204:207], v[124:127]
  v_exp_f32 v24, v24
  v_mfma_f32_16x16x32_bf16 v[44:47], a[152:155], v[200:203], v[44:47]
  buffer_load_dwordx4 v10, s[16:19], s29 offen lds
  v_mfma_f32_16x16x32_bf16 v[44:47], a[148:151], v[196:199], v[44:47]
  s_add_u32 m0, s31, 6144
  v_exp_f32 v25, v25
  v_mfma_f32_16x16x32_bf16 v[44:47], a[144:147], v[192:195], v[44:47]
  s_add_u32 s29, s52, 30720
  v_exp_f32 v26, v26
  v_mfma_f32_16x16x32_bf16 v[48:51], a[0:3], v[176:179], v[120:123]
  v_exp_f32 v27, v27
  v_mfma_f32_16x16x32_bf16 v[48:51], a[4:7], v[180:183], v[48:51]
  v_cvt_pk_bf16_f32 v84, v24, v25
  v_cvt_pk_bf16_f32 v85, v26, v27
  v_mfma_f32_16x16x32_bf16 v[48:51], a[8:11], v[184:187], v[48:51]
  buffer_load_dwordx4 v9, s[16:19], s29 offen lds
  v_mfma_f32_16x16x32_bf16 v[48:51], a[12:15], v[188:191], v[48:51]
  s_add_u32 m0, s31, 7168
  v_exp_f32 v28, v28
  v_mfma_f32_16x16x32_bf16 v[52:55], a[28:31], v[188:191], v[208:211]
  s_add_u32 s29, s52, 35840
  v_exp_f32 v29, v29
  v_mfma_f32_16x16x32_bf16 v[52:55], a[24:27], v[184:187], v[52:55]
  v_exp_f32 v30, v30
  v_mfma_f32_16x16x32_bf16 v[52:55], a[20:23], v[180:183], v[52:55]
  v_exp_f32 v31, v31
  v_mfma_f32_16x16x32_bf16 v[52:55], a[16:19], v[176:179], v[52:55]
  buffer_load_dwordx4 v10, s[16:19], s29 offen lds
  v_mfma_f32_16x16x32_bf16 v[64:67], a[0:3], v[160:163], v[116:119]
  v_cvt_pk_bf16_f32 v86, v28, v29
  v_cvt_pk_bf16_f32 v87, v30, v31
  v_mfma_f32_16x16x32_bf16 v[64:67], a[4:7], v[164:167], v[64:67]
  v_exp_f32 v32, v32
  v_mfma_f32_16x16x32_bf16 v[64:67], a[8:11], v[168:171], v[64:67]
  v_exp_f32 v33, v33
  v_mfma_f32_16x16x32_bf16 v[64:67], a[12:15], v[172:175], v[64:67]
  s_waitcnt lgkmcnt(14)
  ds_read_b128 a[0:3], v2 offset:16384
  v_cvt_pk_bf16_f32 v88, v32, v33
  v_mfma_f32_16x16x32_bf16 v[68:71], a[28:31], v[172:175], v[116:119]
  s_add_u32 s28, s32, 0x8000
  s_and_b32 m0, s28, 0x1ffff
  s_waitcnt lgkmcnt(14)
  ds_read_b128 a[4:7], v2 offset:17408
  v_mfma_f32_16x16x32_bf16 v[68:71], a[24:27], v[168:171], v[68:71]
  v_exp_f32 v34, v34
  v_mfma_f32_16x16x32_bf16 v[68:71], a[20:23], v[164:167], v[68:71]
  buffer_load_dwordx4 v1, s[12:15], s28 offen offset:0 sc1 lds
  v_mfma_f32_16x16x32_bf16 v[68:71], a[16:19], v[160:163], v[68:71]
  v_exp_f32 v35, v35
  v_mfma_f32_16x16x32_bf16 v[72:75], a[128:131], v[160:163], v[116:119]
  s_waitcnt lgkmcnt(14)
  ds_read_b128 a[8:11], v2 offset:18432
  v_cvt_pk_bf16_f32 v89, v34, v35
  v_mfma_f32_16x16x32_bf16 v[72:75], a[132:135], v[164:167], v[72:75]
  v_exp_f32 v36, v36
  v_mfma_f32_16x16x32_bf16 v[72:75], a[136:139], v[168:171], v[72:75]
  v_exp_f32 v37, v37
  v_mfma_f32_16x16x32_bf16 v[72:75], a[140:143], v[172:175], v[72:75]
  s_waitcnt lgkmcnt(14)
  ds_read_b128 a[12:15], v2 offset:19456
  v_cvt_pk_bf16_f32 v90, v36, v37
  v_mfma_f32_16x16x32_bf16 v[76:79], a[156:159], v[172:175], v[116:119]
  v_exp_f32 v38, v38
  v_mfma_f32_16x16x32_bf16 v[76:79], a[152:155], v[168:171], v[76:79]
  buffer_load_dwordx4 v1, s[12:15], s28 offen offset:1024 sc1 lds
  v_mfma_f32_16x16x32_bf16 v[76:79], a[148:151], v[164:167], v[76:79]
  v_exp_f32 v39, v39
  v_mfma_f32_16x16x32_bf16 v[76:79], a[144:147], v[160:163], v[76:79]
  s_waitcnt lgkmcnt(14)
  ds_read_b128 a[16:19], v2 offset:20480
  v_cvt_pk_bf16_f32 v91, v38, v39
  v_mfma_f32_16x16x32_bf16 v[128:131], v[216:219], v[80:83], v[128:131]
  v_exp_f32 v40, v40
  v_mfma_f32_16x16x32_bf16 v[128:131], v[216:219], v[84:87], v[128:131]
  s_waitcnt lgkmcnt(15)
  v_exp_f32 v41, v41
  v_mfma_f32_16x16x32_bf16 a[96:99], a[32:35], v[80:83], a[96:99]
  s_waitcnt lgkmcnt(14)
  ds_read_b128 a[20:23], v2 offset:21504
  v_cvt_pk_bf16_f32 v92, v40, v41
  v_mfma_f32_16x16x32_bf16 a[96:99], a[36:39], v[84:87], a[96:99]
  v_exp_f32 v42, v42
  v_mfma_f32_16x16x32_bf16 a[100:103], a[40:43], v[80:83], a[100:103]
  v_exp_f32 v43, v43
  v_mfma_f32_16x16x32_bf16 a[100:103], a[44:47], v[84:87], a[100:103]
  buffer_load_dwordx4 v1, s[12:15], s28 offen offset:2048 sc1 lds
  v_mfma_f32_16x16x32_bf16 a[104:107], a[48:51], v[80:83], a[104:107]
  s_waitcnt lgkmcnt(14)
  ds_read_b128 a[24:27], v2 offset:22528
  v_cvt_pk_bf16_f32 v93, v42, v43
  v_mfma_f32_16x16x32_bf16 a[104:107], a[52:55], v[84:87], a[104:107]
  s_waitcnt lgkmcnt(15)
  v_exp_f32 v44, v44
  v_mfma_f32_16x16x32_bf16 a[108:111], a[56:59], v[80:83], a[108:111]
  v_exp_f32 v45, v45
  v_mfma_f32_16x16x32_bf16 a[108:111], a[60:63], v[84:87], a[108:111]
  s_waitcnt lgkmcnt(14)
  ds_read_b128 a[28:31], v2 offset:23552
  v_cvt_pk_bf16_f32 v94, v44, v45
  v_mfma_f32_16x16x32_bf16 a[112:115], a[64:67], v[80:83], a[112:115]
  s_waitcnt lgkmcnt(14)
  v_exp_f32 v46, v46
  v_mfma_f32_16x16x32_bf16 a[112:115], a[68:71], v[84:87], a[112:115]
  s_waitcnt lgkmcnt(13)
  v_exp_f32 v47, v47
  v_mfma_f32_16x16x32_bf16 a[116:119], a[72:75], v[80:83], a[116:119]
  s_waitcnt lgkmcnt(12)
  ds_read_b128 a[128:131], v2 offset:24576
  v_cvt_pk_bf16_f32 v95, v46, v47
  v_mfma_f32_16x16x32_bf16 a[116:119], a[76:79], v[84:87], a[116:119]
  s_waitcnt lgkmcnt(12)
  buffer_load_dwordx4 v1, s[12:15], s28 offen offset:3072 sc1 lds
  v_mfma_f32_16x16x32_bf16 a[120:123], a[80:83], v[80:83], a[120:123]
  s_waitcnt lgkmcnt(11)
  s_and_b32 m0, s33, 0x1ffff
  v_exp_f32 v48, v48
  v_mfma_f32_16x16x32_bf16 a[120:123], a[84:87], v[84:87], a[120:123]
  s_waitcnt lgkmcnt(10)
  v_exp_f32 v49, v49
  v_mfma_f32_16x16x32_bf16 a[124:127], a[88:91], v[80:83], a[124:127]
  s_waitcnt lgkmcnt(9)
  ds_read_b128 a[132:135], v2 offset:25600
  v_cvt_pk_bf16_f32 v96, v48, v49
  v_mfma_f32_16x16x32_bf16 a[124:127], a[92:95], v[84:87], a[124:127]
  v_exp_f32 v50, v50
  v_mfma_f32_16x16x32_bf16 v[140:143], v[216:219], v[88:91], v[140:143]
  v_exp_f32 v51, v51
  v_mfma_f32_16x16x32_bf16 v[140:143], v[216:219], v[92:95], v[140:143]
  ds_read_b128 a[136:139], v2 offset:26624
  v_cvt_pk_bf16_f32 v97, v50, v51
  v_mfma_f32_16x16x32_bf16 a[224:227], a[32:35], v[88:91], a[224:227]
  v_exp_f32 v52, v52
  v_mfma_f32_16x16x32_bf16 a[224:227], a[36:39], v[92:95], a[224:227]
  buffer_load_dwordx4 v1, s[12:15], s33 offen offset:0 sc1 lds
  v_mfma_f32_16x16x32_bf16 a[228:231], a[40:43], v[88:91], a[228:231]
  v_exp_f32 v53, v53
  v_mfma_f32_16x16x32_bf16 a[228:231], a[44:47], v[92:95], a[228:231]
  ds_read_b128 a[140:143], v2 offset:27648
  v_cvt_pk_bf16_f32 v98, v52, v53
  v_mfma_f32_16x16x32_bf16 a[232:235], a[48:51], v[88:91], a[232:235]
  v_exp_f32 v54, v54
  v_mfma_f32_16x16x32_bf16 a[232:235], a[52:55], v[92:95], a[232:235]
  v_exp_f32 v55, v55
  v_mfma_f32_16x16x32_bf16 a[236:239], a[56:59], v[88:91], a[236:239]
  ds_read_b128 a[144:147], v2 offset:28672
  v_cvt_pk_bf16_f32 v99, v54, v55
  v_mfma_f32_16x16x32_bf16 a[236:239], a[60:63], v[92:95], a[236:239]
  v_exp_f32 v64, v64
  v_mfma_f32_16x16x32_bf16 a[240:243], a[64:67], v[88:91], a[240:243]
  buffer_load_dwordx4 v1, s[12:15], s33 offen offset:1024 sc1 lds
  v_mfma_f32_16x16x32_bf16 a[240:243], a[68:71], v[92:95], a[240:243]
  v_exp_f32 v65, v65
  v_mfma_f32_16x16x32_bf16 a[244:247], a[72:75], v[88:91], a[244:247]
  ds_read_b128 a[148:151], v2 offset:29696
  v_cvt_pk_bf16_f32 v104, v64, v65
  v_mfma_f32_16x16x32_bf16 a[244:247], a[76:79], v[92:95], a[244:247]
  v_exp_f32 v66, v66
  v_mfma_f32_16x16x32_bf16 a[248:251], a[80:83], v[88:91], a[248:251]
  v_exp_f32 v67, v67
  v_mfma_f32_16x16x32_bf16 a[248:251], a[84:87], v[92:95], a[248:251]
  ds_read_b128 a[152:155], v2 offset:30720
  v_cvt_pk_bf16_f32 v105, v66, v67
  v_mfma_f32_16x16x32_bf16 a[252:255], a[88:91], v[88:91], a[252:255]
  v_exp_f32 v68, v68
  v_mfma_f32_16x16x32_bf16 a[252:255], a[92:95], v[92:95], a[252:255]
  v_exp_f32 v69, v69
  v_mfma_f32_16x16x32_bf16 v[136:139], v[216:219], v[96:99], v[136:139]
  s_waitcnt lgkmcnt(14)
  ds_read_b128 a[156:159], v2 offset:31744
  v_cvt_pk_bf16_f32 v106, v68, v69
  v_mfma_f32_16x16x32_bf16 a[192:195], a[32:35], v[96:99], a[192:195]
  buffer_load_dwordx4 v1, s[12:15], s33 offen offset:2048 sc1 lds
  v_mfma_f32_16x16x32_bf16 a[196:199], a[40:43], v[96:99], a[196:199]
  v_exp_f32 v70, v70
  v_mfma_f32_16x16x32_bf16 a[200:203], a[48:51], v[96:99], a[200:203]
  v_exp_f32 v71, v71
  v_mfma_f32_16x16x32_bf16 a[204:207], a[56:59], v[96:99], a[204:207]
  v_exp_f32 v72, v72
  v_mfma_f32_16x16x32_bf16 a[208:211], a[64:67], v[96:99], a[208:211]
  v_cvt_pk_bf16_f32 v107, v70, v71
  v_cmp_nlt_f32 vcc, 0x21800000, v136
  v_mfma_f32_16x16x32_bf16 a[212:215], a[72:75], v[96:99], a[212:215]
  s_or_b64 s[62:63], s[62:63], vcc
  v_exp_f32 v73, v73
  v_mfma_f32_16x16x32_bf16 a[216:219], a[80:83], v[96:99], a[216:219]
  v_exp_f32 v74, v74
  v_exp_f32 v75, v75
  v_exp_f32 v76, v76
  v_exp_f32 v77, v77
  v_exp_f32 v78, v78
  v_exp_f32 v79, v79
  v_mfma_f32_16x16x32_bf16 a[220:223], a[88:91], v[96:99], a[220:223]
  v_cvt_pk_bf16_f32 v108, v72, v73
  v_cvt_pk_bf16_f32 v109, v74, v75
  v_cvt_pk_bf16_f32 v110, v76, v77
  v_cvt_pk_bf16_f32 v111, v78, v79
  v_mfma_f32_16x16x32_bf16 v[132:135], v[216:219], v[104:107], v[132:135]
  buffer_load_dwordx4 v1, s[12:15], s33 offen offset:3072 sc1 lds
  s_mov_b32 s32, s33
  v_mfma_f32_16x16x32_bf16 v[132:135], v[216:219], v[108:111], v[132:135]
  s_add_u32 s33, s33, s36
  s_xor_b32 s36, s36, 0x8000
  v_cmp_ngt_f32 vcc, v4, v136
  v_mfma_f32_16x16x32_bf16 a[160:163], a[32:35], v[104:107], a[160:163]
  s_or_b64 s[62:63], s[62:63], vcc
  v_rcp_f32 v136, v136
  v_mfma_f32_16x16x32_bf16 a[160:163], a[36:39], v[108:111], a[160:163]
  v_accvgpr_read_b32 v220, a192
  v_accvgpr_read_b32 v221, a193
  v_mfma_f32_16x16x32_bf16 a[164:167], a[40:43], v[104:107], a[164:167]
  v_accvgpr_read_b32 v222, a194
  v_accvgpr_read_b32 v223, a195
  v_mfma_f32_16x16x32_bf16 a[164:167], a[44:47], v[108:111], a[164:167]
  v_accvgpr_read_b32 v224, a196
  v_accvgpr_read_b32 v225, a197
  v_mfma_f32_16x16x32_bf16 a[168:171], a[48:51], v[104:107], a[168:171]
  v_accvgpr_read_b32 v226, a198
  v_accvgpr_read_b32 v227, a199
  v_mfma_f32_16x16x32_bf16 a[168:171], a[52:55], v[108:111], a[168:171]
  v_mul_f32 v220, v220, v136
  v_mul_f32 v221, v221, v136
  v_mfma_f32_16x16x32_bf16 a[172:175], a[56:59], v[104:107], a[172:175]
  v_mul_f32 v222, v222, v136
  v_mul_f32 v223, v223, v136
  v_mfma_f32_16x16x32_bf16 a[172:175], a[60:63], v[108:111], a[172:175]
  v_mul_f32 v224, v224, v136
  v_mul_f32 v225, v225, v136
  v_mfma_f32_16x16x32_bf16 a[176:179], a[64:67], v[104:107], a[176:179]
  v_mul_f32 v226, v226, v136
  v_mul_f32 v227, v227, v136
  v_mfma_f32_16x16x32_bf16 a[176:179], a[68:71], v[108:111], a[176:179]
  s_waitcnt vmcnt(24)
  s_waitcnt vmcnt(16) lgkmcnt(0)
  v_cvt_pk_bf16_f32 v228, v220, v221
  v_cvt_pk_bf16_f32 v229, v222, v223
  v_mfma_f32_16x16x32_bf16 a[180:183], a[72:75], v[104:107], a[180:183]
  s_barrier
  ds_read_b128 a[32:35], v2 offset:49152
  ds_read_b128 a[36:39], v2 offset:57344
  v_mfma_f32_16x16x32_bf16 a[180:183], a[76:79], v[108:111], a[180:183]
  s_add_u32 s28, s32, 0x8000
  s_and_b32 m0, s28, 0x1ffff
  ds_read_b128 a[40:43], v2 offset:50176
  v_mfma_f32_16x16x32_bf16 a[184:187], a[80:83], v[104:107], a[184:187]
  buffer_atomic_add v13, v12, s[8:11], s53 offen sc1
  v_mfma_f32_16x16x32_bf16 a[184:187], a[84:87], v[108:111], a[184:187]
  ds_read_b128 a[44:47], v2 offset:58368
  v_xor_b32 v8, 0, v11
  v_mfma_f32_16x16x32_bf16 a[188:191], a[88:91], v[104:107], a[188:191]
  buffer_load_dwordx4 v1, s[12:15], s28 offen offset:0 sc1 lds
  v_mfma_f32_16x16x32_bf16 a[188:191], a[92:95], v[108:111], a[188:191]
  ds_read_b128 a[48:51], v2 offset:51200
  ds_read_b128 a[52:55], v2 offset:59392
  v_mfma_f32_16x16x32_bf16 v[16:19], a[0:3], v[192:195], v[124:127]
  s_waitcnt vmcnt(10)
  ds_read_b64_tr_b16 v[246:247], v8 offset:0
  ds_read_b64_tr_b16 v[248:249], v8 offset:4096
  v_mfma_f32_16x16x32_bf16 v[16:19], a[4:7], v[196:199], v[16:19]
  v_mov_b32 v86, 0
  v_mov_b32 v87, 0
  v_mfma_f32_16x16x32_bf16 v[16:19], a[8:11], v[200:203], v[16:19]
  ds_read_b128 a[56:59], v2 offset:52224
  ds_read_b128 a[60:63], v2 offset:60416
  v_mfma_f32_16x16x32_bf16 v[16:19], a[12:15], v[204:207], v[16:19]
  ds_read_b128 a[64:67], v2 offset:53248
  ds_read_b128 a[68:71], v2 offset:61440
  v_mfma_f32_16x16x32_bf16 v[20:23], a[28:31], v[204:207], v[124:127]
  ds_read_b128 a[72:75], v2 offset:54272
  v_cvt_pk_bf16_f32 v230, v224, v225
  v_mfma_f32_16x16x32_bf16 v[20:23], a[24:27], v[200:203], v[20:23]
  ds_read_b128 a[76:79], v2 offset:62464
  v_cvt_pk_bf16_f32 v231, v226, v227
  v_mfma_f32_16x16x32_bf16 v[20:23], a[20:23], v[196:199], v[20:23]
  s_add_u32 s30, s50, s54
  buffer_store_dwordx4 v[228:231], v1, s[8:11], s30 offen offset:0 sc1
  v_mfma_f32_16x16x32_bf16 v[20:23], a[16:19], v[192:195], v[20:23]
  ds_read_b128 a[80:83], v2 offset:55296
  v_xor_b32 v14, 32, v11
  v_mfma_f32_16x16x32_bf16 v[24:27], a[128:131], v[192:195], v[212:215]
  s_waitcnt lgkmcnt(7)
  buffer_store_dwordx4 v[246:249], v1, s[8:11], s20 offen sc1
  v_mfma_f32_16x16x32_bf16 v[24:27], a[132:135], v[196:199], v[24:27]
  buffer_load_dwordx4 v1, s[12:15], s28 offen offset:1024 sc1 lds
  v_mfma_f32_16x16x32_bf16 v[24:27], a[136:139], v[200:203], v[24:27]
  ds_read_b64_tr_b16 v[250:251], v14 offset:0
  ds_read_b64_tr_b16 v[252:253], v14 offset:4096
  v_mfma_f32_16x16x32_bf16 v[24:27], a[140:143], v[204:207], v[24:27]
  v_exp_f32 v16, v16
  v_mfma_f32_16x16x32_bf16 v[32:35], a[0:3], v[144:147], v[112:115]
  v_exp_f32 v17, v17
  v_mfma_f32_16x16x32_bf16 v[32:35], a[4:7], v[148:151], v[32:35]
  ds_read_b128 a[84:87], v2 offset:63488
  v_cvt_pk_bf16_f32 v80, v16, v17
  v_mfma_f32_16x16x32_bf16 v[32:35], a[8:11], v[152:155], v[32:35]
  v_exp_f32 v18, v18
  v_mfma_f32_16x16x32_bf16 v[32:35], a[12:15], v[156:159], v[32:35]
  v_exp_f32 v19, v19
  v_mfma_f32_16x16x32_bf16 v[36:39], a[28:31], v[156:159], v[112:115]
  ds_read_b128 a[88:91], v2 offset:56320
  v_cvt_pk_bf16_f32 v81, v18, v19
  v_mfma_f32_16x16x32_bf16 v[36:39], a[24:27], v[152:155], v[36:39]
  ds_read_b128 a[92:95], v2 offset:64512
  v_xor_b32 v8, 64, v11
  v_mfma_f32_16x16x32_bf16 v[36:39], a[20:23], v[148:151], v[36:39]
  s_waitcnt lgkmcnt(3)
  buffer_store_dwordx4 v[250:253], v1, s[8:11], s21 offen sc1
  v_mfma_f32_16x16x32_bf16 v[36:39], a[16:19], v[144:147], v[36:39]
  v_exp_f32 v20, v20
  v_mfma_f32_16x16x32_bf16 v[40:43], a[128:131], v[144:147], v[112:115]
  ds_read_b64_tr_b16 v[246:247], v8 offset:0
  ds_read_b64_tr_b16 v[248:249], v8 offset:4096
  v_mfma_f32_16x16x32_bf16 v[40:43], a[132:135], v[148:151], v[40:43]
  buffer_load_dwordx4 v1, s[12:15], s28 offen offset:2048 sc1 lds
  v_mfma_f32_16x16x32_bf16 v[40:43], a[136:139], v[152:155], v[40:43]
  v_exp_f32 v21, v21
  v_mfma_f32_16x16x32_bf16 v[40:43], a[140:143], v[156:159], v[40:43]
  v_cvt_pk_bf16_f32 v82, v20, v21
  v_accvgpr_read_b32 v232, a200
  v_mfma_f32_16x16x32_bf16 v[44:47], a[156:159], v[156:159], v[112:115]
  v_exp_f32 v22, v22
  v_mfma_f32_16x16x32_bf16 v[44:47], a[152:155], v[152:155], v[44:47]
  v_exp_f32 v23, v23
  v_mfma_f32_16x16x32_bf16 v[44:47], a[148:151], v[148:151], v[44:47]
  v_cvt_pk_bf16_f32 v83, v22, v23
  v_accvgpr_read_b32 v233, a201
  v_mfma_f32_16x16x32_bf16 v[44:47], a[144:147], v[144:147], v[44:47]
  v_xor_b32 v14, 96, v11
  v_accvgpr_read_b32 v234, a202
  v_mfma_f32_16x16x32_bf16 v[48:51], a[0:3], v[160:163], v[116:119]
  s_waitcnt lgkmcnt(0)
  buffer_store_dwordx4 v[246:249], v1, s[8:11], s22 offen sc1
  v_mfma_f32_16x16x32_bf16 v[48:51], a[4:7], v[164:167], v[48:51]
  v_exp_f32 v24, v24
  v_mfma_f32_16x16x32_bf16 v[48:51], a[8:11], v[168:171], v[48:51]
  ds_read_b64_tr_b16 v[250:251], v14 offset:0
  ds_read_b64_tr_b16 v[252:253], v14 offset:4096
  v_mfma_f32_16x16x32_bf16 v[48:51], a[12:15], v[172:175], v[48:51]
  v_exp_f32 v25, v25
  v_mfma_f32_16x16x32_bf16 v[52:55], a[28:31], v[172:175], v[116:119]
  ds_read_b128 a[0:3], v3 offset:0
  v_cvt_pk_bf16_f32 v84, v24, v25
  v_mfma_f32_16x16x32_bf16 v[52:55], a[24:27], v[168:171], v[52:55]
  buffer_load_dwordx4 v1, s[12:15], s28 offen offset:3072 sc1 lds
  v_mfma_f32_16x16x32_bf16 v[52:55], a[20:23], v[164:167], v[52:55]
  s_and_b32 m0, s33, 0x1ffff
  v_exp_f32 v26, v26
  v_mfma_f32_16x16x32_bf16 v[52:55], a[16:19], v[160:163], v[52:55]
  v_exp_f32 v27, v27
  v_mfma_f32_16x16x32_bf16 v[56:59], a[128:131], v[160:163], v[116:119]
  ds_read_b128 a[4:7], v3 offset:1024
  v_cvt_pk_bf16_f32 v85, v26, v27
  v_mfma_f32_16x16x32_bf16 v[56:59], a[132:135], v[164:167], v[56:59]
  ds_read_b128 a[8:11], v3 offset:2048
  v_xor_b32 v8, 128, v11
  v_mfma_f32_16x16x32_bf16 v[56:59], a[136:139], v[168:171], v[56:59]
  s_waitcnt lgkmcnt(3)
  buffer_store_dwordx4 v[250:253], v1, s[8:11], s23 offen sc1
  v_mfma_f32_16x16x32_bf16 v[56:59], a[140:143], v[172:175], v[56:59]
  v_exp_f32 v32, v32
  v_mfma_f32_16x16x32_bf16 v[60:63], a[156:159], v[172:175], v[116:119]
  ds_read_b64_tr_b16 v[246:247], v8 offset:0
  ds_read_b64_tr_b16 v[248:249], v8 offset:4096
  v_mfma_f32_16x16x32_bf16 v[60:63], a[152:155], v[168:171], v[60:63]
  v_exp_f32 v33, v33
  v_mfma_f32_16x16x32_bf16 v[60:63], a[148:151], v[164:167], v[60:63]
  ds_read_b128 a[12:15], v3 offset:3072
  v_cvt_pk_bf16_f32 v88, v32, v33
  v_mfma_f32_16x16x32_bf16 v[60:63], a[144:147], v[160:163], v[60:63]
  v_exp_f32 v34, v34
  v_mfma_f32_16x16x32_bf16 v[140:143], v[216:219], v[80:83], v[140:143]
  v_exp_f32 v35, v35
  v_mfma_f32_16x16x32_bf16 v[140:143], v[216:219], v[84:87], v[140:143]
  buffer_load_dwordx4 v1, s[12:15], s33 offen offset:0 sc1 lds
  v_mfma_f32_16x16x32_bf16 a[224:227], a[32:35], v[80:83], a[224:227]
  ds_read_b128 a[16:19], v3 offset:4096
  v_cvt_pk_bf16_f32 v89, v34, v35
  v_mfma_f32_16x16x32_bf16 a[224:227], a[36:39], v[84:87], a[224:227]
  ds_read_b128 a[20:23], v3 offset:5120
  v_xor_b32 v14, 160, v11
  v_mfma_f32_16x16x32_bf16 a[228:231], a[40:43], v[80:83], a[228:231]
  s_waitcnt lgkmcnt(3)
  buffer_store_dwordx4 v[246:249], v1, s[8:11], s24 offen sc1
  v_mfma_f32_16x16x32_bf16 a[228:231], a[44:47], v[84:87], a[228:231]
  v_exp_f32 v36, v36
  v_mfma_f32_16x16x32_bf16 a[232:235], a[48:51], v[80:83], a[232:235]
  ds_read_b64_tr_b16 v[250:251], v14 offset:0
  ds_read_b64_tr_b16 v[252:253], v14 offset:4096
  v_mfma_f32_16x16x32_bf16 a[232:235], a[52:55], v[84:87], a[232:235]
  v_exp_f32 v37, v37
  v_mfma_f32_16x16x32_bf16 a[236:239], a[56:59], v[80:83], a[236:239]
  ds_read_b128 a[24:27], v3 offset:6144
  v_cvt_pk_bf16_f32 v90, v36, v37
  v_mfma_f32_16x16x32_bf16 a[236:239], a[60:63], v[84:87], a[236:239]
  v_exp_f32 v38, v38
  v_mfma_f32_16x16x32_bf16 a[240:243], a[64:67], v[80:83], a[240:243]
  v_exp_f32 v39, v39
  v_mfma_f32_16x16x32_bf16 a[240:243], a[68:71], v[84:87], a[240:243]
  ds_read_b128 a[28:31], v3 offset:7168
  v_cvt_pk_bf16_f32 v91, v38, v39
  v_mfma_f32_16x16x32_bf16 a[244:247], a[72:75], v[80:83], a[244:247]
  v_exp_f32 v40, v40
  v_mfma_f32_16x16x32_bf16 a[244:247], a[76:79], v[84:87], a[244:247]
  ds_read_b128 a[128:131], v3 offset:8192
  v_xor_b32 v8, 192, v11
  v_mfma_f32_16x16x32_bf16 a[248:251], a[80:83], v[80:83], a[248:251]
  buffer_load_dwordx4 v1, s[12:15], s33 offen offset:1024 sc1 lds
  v_mfma_f32_16x16x32_bf16 a[248:251], a[84:87], v[84:87], a[248:251]
  v_exp_f32 v41, v41
  v_mfma_f32_16x16x32_bf16 a[252:255], a[88:91], v[80:83], a[252:255]
  v_exp_f32 v42, v42
  v_exp_f32 v43, v43
  v_exp_f32 v44, v44
  v_exp_f32 v45, v45
  v_exp_f32 v46, v46
  v_exp_f32 v47, v47
  v_mfma_f32_16x16x32_bf16 a[252:255], a[92:95], v[84:87], a[252:255]
  s_waitcnt lgkmcnt(3)
  buffer_store_dwordx4 v[250:253], v1, s[8:11], s25 offen sc1
  v_cvt_pk_bf16_f32 v92, v40, v41
  v_cvt_pk_bf16_f32 v93, v42, v43
  v_cvt_pk_bf16_f32 v94, v44, v45
  v_cvt_pk_bf16_f32 v95, v46, v47
  v_mfma_f32_16x16x32_bf16 v[128:131], v[216:219], v[88:91], v[128:131]
  ds_read_b64_tr_b16 v[246:247], v8 offset:0
  ds_read_b64_tr_b16 v[248:249], v8 offset:4096
  v_mfma_f32_16x16x32_bf16 v[128:131], v[216:219], v[92:95], v[128:131]
  v_exp_f32 v48, v48
  v_mfma_f32_16x16x32_bf16 a[96:99], a[32:35], v[88:91], a[96:99]
  v_exp_f32 v49, v49
  v_mfma_f32_16x16x32_bf16 a[96:99], a[36:39], v[92:95], a[96:99]
  ds_read_b128 a[132:135], v3 offset:9216
  v_cvt_pk_bf16_f32 v96, v48, v49
  v_mfma_f32_16x16x32_bf16 a[100:103], a[40:43], v[88:91], a[100:103]
  v_exp_f32 v50, v50
  v_mfma_f32_16x16x32_bf16 a[100:103], a[44:47], v[92:95], a[100:103]
  ds_read_b128 a[136:139], v3 offset:10240
  v_xor_b32 v14, 224, v11
  v_mfma_f32_16x16x32_bf16 a[104:107], a[48:51], v[88:91], a[104:107]
  s_waitcnt lgkmcnt(2)
  buffer_store_dwordx4 v[246:249], v1, s[8:11], s26 offen sc1
  v_mfma_f32_16x16x32_bf16 a[104:107], a[52:55], v[92:95], a[104:107]
  buffer_load_dwordx4 v1, s[12:15], s33 offen offset:2048 sc1 lds
  v_mfma_f32_16x16x32_bf16 a[108:111], a[56:59], v[88:91], a[108:111]
  ds_read_b64_tr_b16 v[250:251], v14 offset:0
  ds_read_b64_tr_b16 v[252:253], v14 offset:4096
  v_mfma_f32_16x16x32_bf16 a[108:111], a[60:63], v[92:95], a[108:111]
  v_exp_f32 v51, v51
  v_mfma_f32_16x16x32_bf16 a[112:115], a[64:67], v[88:91], a[112:115]
  ds_read_b128 a[140:143], v3 offset:11264
  v_cvt_pk_bf16_f32 v97, v50, v51
  v_mfma_f32_16x16x32_bf16 a[112:115], a[68:71], v[92:95], a[112:115]
  v_exp_f32 v52, v52
  v_mfma_f32_16x16x32_bf16 a[116:119], a[72:75], v[88:91], a[116:119]
  v_exp_f32 v53, v53
  v_mfma_f32_16x16x32_bf16 a[116:119], a[76:79], v[92:95], a[116:119]
  v_cvt_pk_bf16_f32 v98, v52, v53
  v_accvgpr_read_b32 v235, a203
  v_mfma_f32_16x16x32_bf16 a[120:123], a[80:83], v[88:91], a[120:123]
  v_exp_f32 v54, v54
  v_mfma_f32_16x16x32_bf16 a[120:123], a[84:87], v[92:95], a[120:123]
  v_exp_f32 v55, v55
  v_mfma_f32_16x16x32_bf16 a[124:127], a[88:91], v[88:91], a[124:127]
  v_cvt_pk_bf16_f32 v99, v54, v55
  v_exp_f32 v56, v56
  v_exp_f32 v57, v57
  v_exp_f32 v58, v58
  v_exp_f32 v59, v59
  v_exp_f32 v60, v60
  v_exp_f32 v61, v61
  v_exp_f32 v62, v62
  v_exp_f32 v63, v63
  v_mfma_f32_16x16x32_bf16 a[124:127], a[92:95], v[92:95], a[124:127]
  v_cvt_pk_bf16_f32 v100, v56, v57
  v_cvt_pk_bf16_f32 v101, v58, v59
  v_cvt_pk_bf16_f32 v102, v60, v61
  v_cvt_pk_bf16_f32 v103, v62, v63
  v_mfma_f32_16x16x32_bf16 v[132:135], v[216:219], v[96:99], v[132:135]
  s_waitcnt lgkmcnt(1)
  buffer_store_dwordx4 v[250:253], v1, s[8:11], s27 offen sc1
  v_mfma_f32_16x16x32_bf16 v[132:135], v[216:219], v[100:103], v[132:135]
  buffer_load_dwordx4 v1, s[12:15], s33 offen offset:3072 sc1 lds
  v_mfma_f32_16x16x32_bf16 a[160:163], a[32:35], v[96:99], a[160:163]
  s_mov_b32 s32, s33
  v_accvgpr_read_b32 v236, a204
  v_accvgpr_read_b32 v237, a205
  v_mfma_f32_16x16x32_bf16 a[160:163], a[36:39], v[100:103], a[160:163]
  s_add_u32 s33, s33, s36
  v_accvgpr_read_b32 v238, a206
  v_accvgpr_read_b32 v239, a207
  v_mfma_f32_16x16x32_bf16 a[164:167], a[40:43], v[96:99], a[164:167]
  s_xor_b32 s36, s36, 0x8000
  v_mul_f32 v232, v232, v136
  v_mul_f32 v233, v233, v136
  v_mfma_f32_16x16x32_bf16 a[164:167], a[44:47], v[100:103], a[164:167]
  v_mul_f32 v234, v234, v136
  v_mul_f32 v235, v235, v136
  v_mfma_f32_16x16x32_bf16 a[168:171], a[48:51], v[96:99], a[168:171]
  v_mul_f32 v236, v236, v136
  v_mul_f32 v237, v237, v136
  v_mfma_f32_16x16x32_bf16 a[168:171], a[52:55], v[100:103], a[168:171]
  v_mul_f32 v238, v238, v136
  v_mul_f32 v239, v239, v136
  v_mfma_f32_16x16x32_bf16 a[172:175], a[56:59], v[96:99], a[172:175]
  v_cvt_pk_bf16_f32 v240, v232, v233
  v_cvt_pk_bf16_f32 v241, v234, v235
  v_mfma_f32_16x16x32_bf16 a[172:175], a[60:63], v[100:103], a[172:175]
  v_cvt_pk_bf16_f32 v242, v236, v237
  v_cvt_pk_bf16_f32 v243, v238, v239
  v_mfma_f32_16x16x32_bf16 a[176:179], a[64:67], v[96:99], a[176:179]
  ds_read_b128 a[144:147], v3 offset:12288
  ds_read_b128 a[148:151], v3 offset:13312
  v_mfma_f32_16x16x32_bf16 a[176:179], a[68:71], v[100:103], a[176:179]
  ds_read_b128 a[152:155], v3 offset:14336
  ds_read_b128 a[156:159], v3 offset:15360
  v_mfma_f32_16x16x32_bf16 a[180:183], a[72:75], v[96:99], a[180:183]
  buffer_store_dwordx4 v[240:243], v1, s[8:11], s30 offen offset:1024 sc1
  v_mfma_f32_16x16x32_bf16 a[180:183], a[76:79], v[100:103], a[180:183]
  v_accvgpr_read_b32 v220, a208
  v_accvgpr_read_b32 v221, a209
  v_mfma_f32_16x16x32_bf16 a[184:187], a[80:83], v[96:99], a[184:187]
  v_accvgpr_read_b32 v222, a210
  v_accvgpr_read_b32 v223, a211
  v_mfma_f32_16x16x32_bf16 a[184:187], a[84:87], v[100:103], a[184:187]
  v_mov_b32 v2, v3
  v_accvgpr_read_b32 v224, a212
  v_mfma_f32_16x16x32_bf16 a[188:191], a[88:91], v[96:99], a[188:191]
  v_accvgpr_read_b32 v225, a213
  v_accvgpr_read_b32 v226, a214
  v_mfma_f32_16x16x32_bf16 a[188:191], a[92:95], v[100:103], a[188:191]
  v_accvgpr_read_b32 v227, a215
  v_mul_f32 v220, v220, v136
  v_mul_f32 v221, v221, v136
  v_mul_f32 v222, v222, v136
  v_mul_f32 v223, v223, v136
  v_mul_f32 v224, v224, v136
  v_mul_f32 v225, v225, v136
  v_mul_f32 v226, v226, v136
  v_mul_f32 v227, v227, v136
  v_cvt_pk_bf16_f32 v228, v220, v221
  v_cvt_pk_bf16_f32 v229, v222, v223
  v_cvt_pk_bf16_f32 v230, v224, v225
  v_cvt_pk_bf16_f32 v231, v226, v227
  buffer_store_dwordx4 v[228:231], v1, s[8:11], s30 offen offset:2048 sc1
  v_accvgpr_read_b32 v232, a216
  v_accvgpr_read_b32 v233, a217
  v_accvgpr_read_b32 v234, a218
  v_accvgpr_read_b32 v235, a219
  v_accvgpr_read_b32 v236, a220
  v_accvgpr_read_b32 v237, a221
  v_accvgpr_read_b32 v238, a222
  v_accvgpr_read_b32 v239, a223
  v_mul_f32 v232, v232, v136
  v_mul_f32 v233, v233, v136
  v_mul_f32 v234, v234, v136
  v_mul_f32 v235, v235, v136
  v_mul_f32 v236, v236, v136
  v_mul_f32 v237, v237, v136
  v_mul_f32 v238, v238, v136
  v_mul_f32 v239, v239, v136
  v_cvt_pk_bf16_f32 v240, v232, v233
  v_cvt_pk_bf16_f32 v241, v234, v235
  v_cvt_pk_bf16_f32 v242, v236, v237
  v_cvt_pk_bf16_f32 v243, v238, v239
  buffer_store_dwordx4 v[240:243], v1, s[8:11], s30 offen offset:3072 sc1
  v_cmp_nlt_f32 vcc, 0x21800000, v140
  s_nop 0
  s_or_b64 s[62:63], s[62:63], vcc
  v_cmp_ngt_f32 vcc, v4, v140
  s_nop 0
  s_or_b64 s[62:63], s[62:63], vcc
  v_rcp_f32 v140, v140
  v_accvgpr_read_b32 v220, a224
  v_accvgpr_read_b32 v221, a225
  v_accvgpr_read_b32 v222, a226
  v_accvgpr_read_b32 v223, a227
  v_accvgpr_read_b32 v224, a228
  v_accvgpr_read_b32 v225, a229
  v_accvgpr_read_b32 v226, a230
  v_accvgpr_read_b32 v227, a231
  v_mul_f32 v220, v220, v140
  v_mul_f32 v221, v221, v140
  v_mul_f32 v222, v222, v140
  v_mul_f32 v223, v223, v140
  v_mul_f32 v224, v224, v140
  v_mul_f32 v225, v225, v140
  v_mul_f32 v226, v226, v140
  v_mul_f32 v227, v227, v140
  v_cvt_pk_bf16_f32 v228, v220, v221
  v_cvt_pk_bf16_f32 v229, v222, v223
  v_cvt_pk_bf16_f32 v230, v224, v225
  v_cvt_pk_bf16_f32 v231, v226, v227
  s_add_u32 s30, s51, s54
  buffer_store_dwordx4 v[228:231], v1, s[8:11], s30 offen offset:0 sc1
  v_accvgpr_read_b32 v232, a232
  v_accvgpr_read_b32 v233, a233
  v_accvgpr_read_b32 v234, a234
  v_accvgpr_read_b32 v235, a235
  v_accvgpr_read_b32 v236, a236
  v_accvgpr_read_b32 v237, a237
  v_accvgpr_read_b32 v238, a238
  v_accvgpr_read_b32 v239, a239
  v_mul_f32 v232, v232, v140
  v_mul_f32 v233, v233, v140
  v_mul_f32 v234, v234, v140
  v_mul_f32 v235, v235, v140
  v_mul_f32 v236, v236, v140
  v_mul_f32 v237, v237, v140
  v_mul_f32 v238, v238, v140
  v_mul_f32 v239, v239, v140
  v_cvt_pk_bf16_f32 v240, v232, v233
  v_cvt_pk_bf16_f32 v241, v234, v235
  v_cvt_pk_bf16_f32 v242, v236, v237
  v_cvt_pk_bf16_f32 v243, v238, v239
  buffer_store_dwordx4 v[240:243], v1, s[8:11], s30 offen offset:1024 sc1
  v_accvgpr_read_b32 v220, a240
  v_accvgpr_read_b32 v221, a241
  v_accvgpr_read_b32 v222, a242
  v_accvgpr_read_b32 v223, a243
  v_accvgpr_read_b32 v224, a244
  v_accvgpr_read_b32 v225, a245
  v_accvgpr_read_b32 v226, a246
  v_accvgpr_read_b32 v227, a247
  v_mul_f32 v220, v220, v140
  v_mul_f32 v221, v221, v140
  v_mul_f32 v222, v222, v140
  v_mul_f32 v223, v223, v140
  v_mul_f32 v224, v224, v140
  v_mul_f32 v225, v225, v140
  v_mul_f32 v226, v226, v140
  v_mul_f32 v227, v227, v140
  v_cvt_pk_bf16_f32 v228, v220, v221
  v_cvt_pk_bf16_f32 v229, v222, v223
  v_cvt_pk_bf16_f32 v230, v224, v225
  v_cvt_pk_bf16_f32 v231, v226, v227
  buffer_store_dwordx4 v[228:231], v1, s[8:11], s30 offen offset:2048 sc1
  v_accvgpr_read_b32 v232, a248
  v_accvgpr_read_b32 v233, a249
  v_accvgpr_read_b32 v234, a250
  v_accvgpr_read_b32 v235, a251
  v_accvgpr_read_b32 v236, a252
  v_accvgpr_read_b32 v237, a253
  v_accvgpr_read_b32 v238, a254
  v_accvgpr_read_b32 v239, a255
  v_mul_f32 v232, v232, v140
  v_mul_f32 v233, v233, v140
  v_mul_f32 v234, v234, v140
  v_mul_f32 v235, v235, v140
  v_mul_f32 v236, v236, v140
  v_mul_f32 v237, v237, v140
  v_mul_f32 v238, v238, v140
  v_mul_f32 v239, v239, v140
  v_cvt_pk_bf16_f32 v240, v232, v233
  v_cvt_pk_bf16_f32 v241, v234, v235
  v_cvt_pk_bf16_f32 v242, v236, v237
  v_cvt_pk_bf16_f32 v243, v238, v239
  buffer_store_dwordx4 v[240:243], v1, s[8:11], s30 offen offset:3072 sc1
  s_branch L_att_dd
L_att_d2:
  s_cmp_lg_u32 s3, 2
  s_cbranch_scc1 L_att_d3
  s_waitcnt lgkmcnt(15)
  v_mfma_f32_16x16x32_bf16 v[16:19], a[0:3], v[144:147], v[112:115]
  s_waitcnt vmcnt(16) lgkmcnt(0)
  v_mov_b32 v102, 0
  v_mov_b32 v103, 0
  v_mfma_f32_16x16x32_bf16 v[16:19], a[4:7], v[148:151], v[16:19]
  s_barrier
  ds_read_b128 a[32:35], v2 offset:32768
  ds_read_b128 a[36:39], v2 offset:40960
  v_mfma_f32_16x16x32_bf16 v[16:19], a[8:11], v[152:155], v[16:19]
  s_add_u32 m0, s31, 0
  s_add_u32 s29, s52, 0
  v_mov_b32 v4, 0x5d800000
  v_mfma_f32_16x16x32_bf16 v[16:19], a[12:15], v[156:159], v[16:19]
  ds_read_b128 a[40:43], v2 offset:33792
  ds_read_b128 a[44:47], v2 offset:41984
  v_mfma_f32_16x16x32_bf16 v[20:23], a[28:31], v[156:159], v[112:115]
  buffer_load_dwordx4 v9, s[16:19], s29 offen lds
  v_mfma_f32_16x16x32_bf16 v[20:23], a[24:27], v[152:155], v[20:23]
  s_add_u32 m0, s31, 1024
  s_add_u32 s29, s52, 5120
  ds_read_b128 a[48:51], v2 offset:34816
  v_mfma_f32_16x16x32_bf16 v[20:23], a[20:23], v[148:151], v[20:23]
  ds_read_b128 a[52:55], v2 offset:43008
  ds_read_b128 a[56:59], v2 offset:35840
  v_mfma_f32_16x16x32_bf16 v[20:23], a[16:19], v[144:147], v[20:23]
  ds_read_b128 a[60:63], v2 offset:44032
  ds_read_b128 a[64:67], v2 offset:36864
  v_mfma_f32_16x16x32_bf16 v[24:27], a[128:131], v[144:147], v[112:115]
  v_exp_f32 v16, v16
  v_mfma_f32_16x16x32_bf16 v[24:27], a[132:135], v[148:151], v[24:27]
  buffer_load_dwordx4 v10, s[16:19], s29 offen lds
  v_mfma_f32_16x16x32_bf16 v[24:27], a[136:139], v[152:155], v[24:27]
  s_add_u32 m0, s31, 2048
  s_add_u32 s29, s52, 10240
  ds_read_b128 a[68:71], v2 offset:45056
  v_mfma_f32_16x16x32_bf16 v[24:27], a[140:143], v[156:159], v[24:27]
  v_exp_f32 v17, v17
  v_mfma_f32_16x16x32_bf16 v[28:31], a[156:159], v[156:159], v[112:115]
  ds_read_b128 a[72:75], v2 offset:37888
  v_cvt_pk_bf16_f32 v80, v16, v17
  v_mfma_f32_16x16x32_bf16 v[28:31], a[152:155], v[152:155], v[28:31]
  v_exp_f32 v18, v18
  v_mfma_f32_16x16x32_bf16 v[28:31], a[148:151], v[148:151], v[28:31]
  buffer_load_dwordx4 v9, s[16:19], s29 offen lds
  v_mfma_f32_16x16x32_bf16 v[28:31], a[144:147], v[144:147], v[28:31]
  s_add_u32 m0, s31, 3072
  s_add_u32 s29, s52, 15360
  ds_read_b128 a[76:79], v2 offset:46080
  v_mfma_f32_16x16x32_bf16 v[32:35], a[0:3], v[192:195], v[124:127]
  v_exp_f32 v19, v19
  v_mfma_f32_16x16x32_bf16 v[32:35], a[4:7], v[196:199], v[32:35]
  ds_read_b128 a[80:83], v2 offset:38912
  v_cvt_pk_bf16_f32 v81, v18, v19
  v_mfma_f32_16x16x32_bf16 v[32:35], a[8:11], v[200:203], v[32:35]
  v_exp_f32 v20, v20
  v_mfma_f32_16x16x32_bf16 v[32:35], a[12:15], v[204:207], v[32:35]
  buffer_load_dwordx4 v10, s[16:19], s29 offen lds
  v_mfma_f32_16x16x32_bf16 v[36:39], a[28:31], v[204:207], v[124:127]
  s_add_u32 m0, s31, 4096
  s_add_u32 s29, s52, 20480
  ds_read_b128 a[84:87], v2 offset:47104
  v_mfma_f32_16x16x32_bf16 v[36:39], a[24:27], v[200:203], v[36:39]
  v_exp_f32 v21, v21
  v_mfma_f32_16x16x32_bf16 v[36:39], a[20:23], v[196:199], v[36:39]
  ds_read_b128 a[88:91], v2 offset:39936
  v_cvt_pk_bf16_f32 v82, v20, v21
  v_mfma_f32_16x16x32_bf16 v[36:39], a[16:19], v[192:195], v[36:39]
  v_exp_f32 v22, v22
  v_mfma_f32_16x16x32_bf16 v[40:43], a[128:131], v[192:195], v[124:127]
  buffer_load_dwordx4 v9, s[16:19], s29 offen lds
  v_mfma_f32_16x16x32_bf16 v[40:43], a[132:135], v[196:199], v[40:43]
  s_add_u32 m0, s31, 5120
  s_add_u32 s29, s52, 25600
  s_waitcnt lgkmcnt(14)
  ds_read_b128 a[92:95], v2 offset:48128
  v_mfma_f32_16x16x32_bf16 v[40:43], a[136:139], v[200:203], v[40:43]
  v_exp_f32 v23, v23
  v_mfma_f32_16x16x32_bf16 v[40:43], a[140:143], v[204:207], v[40:43]
  v_cvt_pk_bf16_f32 v83, v22, v23
  v_xor_b32 v3, 0x10000, v2
  v_mfma_f32_16x16x32_bf16 v[44:47], a[156:159], v[204:207], v[124:127]
  v_exp_f32 v24, v24
  v_mfma_f32_16x16x32_bf16 v[44:47], a[152:155], v[200:203], v[44:47]
  buffer_load_dwordx4 v10, s[16:19], s29 offen lds
  v_mfma_f32_16x16x32_bf16 v[44:47], a[148:151], v[196:199], v[44:47]
  s_add_u32 m0, s31, 6144
  v_exp_f32 v25, v25
  v_mfma_f32_16x16x32_bf16 v[44:47], a[144:147], v[192:195], v[44:47]
  s_add_u32 s29, s52, 30720
  v_exp_f32 v26, v26
  v_mfma_f32_16x16x32_bf16 v[48:51], a[0:3], v[176:179], v[120:123]
  v_exp_f32 v27, v27
  v_mfma_f32_16x16x32_bf16 v[48:51], a[4:7], v[180:183], v[48:51]
  v_cvt_pk_bf16_f32 v84, v24, v25
  v_cvt_pk_bf16_f32 v85, v26, v27
  v_mfma_f32_16x16x32_bf16 v[48:51], a[8:11], v[184:187], v[48:51]
  buffer_load_dwordx4 v9, s[16:19], s29 offen lds
  v_mfma_f32_16x16x32_bf16 v[48:51], a[12:15], v[188:191], v[48:51]
  s_add_u32 m0, s31, 7168
  v_exp_f32 v28, v28
  v_mfma_f32_16x16x32_bf16 v[52:55], a[28:31], v[188:191], v[120:123]
  s_add_u32 s29, s52, 35840
  v_exp_f32 v29, v29
  v_mfma_f32_16x16x32_bf16 v[52:55], a[24:27], v[184:187], v[52:55]
  v_exp_f32 v30, v30
  v_mfma_f32_16x16x32_bf16 v[52:55], a[20:23], v[180:183], v[52:55]
  v_exp_f32 v31, v31
  v_mfma_f32_16x16x32_bf16 v[52:55], a[16:19], v[176:179], v[52:55]
  buffer_load_dwordx4 v10, s[16:19], s29 offen lds
  v_mfma_f32_16x16x32_bf16 v[56:59], a[128:131], v[176:179], v[208:211]
  v_cvt_pk_bf16_f32 v86, v28, v29
  v_cvt_pk_bf16_f32 v87, v30, v31
  v_mfma_f32_16x16x32_bf16 v[56:59], a[132:135], v[180:183], v[56:59]
  v_exp_f32 v32, v32
  v_mfma_f32_16x16x32_bf16 v[56:59], a[136:139], v[184:187], v[56:59]
  v_exp_f32 v33, v33
  v_mfma_f32_16x16x32_bf16 v[56:59], a[140:143], v[188:191], v[56:59]
  v_exp_f32 v34, v34
  v_mfma_f32_16x16x32_bf16 v[64:67], a[0:3], v[160:163], v[116:119]
  s_add_u32 s28, s32, 0x8000
  s_and_b32 m0, s28, 0x1ffff
  v_cvt_pk_bf16_f32 v88, v32, v33
  v_mfma_f32_16x16x32_bf16 v[64:67], a[4:7], v[164:167], v[64:67]
  v_exp_f32 v35, v35
  v_mfma_f32_16x16x32_bf16 v[64:67], a[8:11], v[168:171], v[64:67]
  buffer_load_dwordx4 v1, s[12:15], s28 offen offset:0 sc1 lds
  v_mfma_f32_16x16x32_bf16 v[64:67], a[12:15], v[172:175], v[64:67]
  s_waitcnt lgkmcnt(14)
  ds_read_b128 a[0:3], v2 offset:16384
  v_cvt_pk_bf16_f32 v89, v34, v35
  v_mfma_f32_16x16x32_bf16 v[68:71], a[28:31], v[172:175], v[116:119]
  v_exp_f32 v36, v36
  v_mfma_f32_16x16x32_bf16 v[68:71], a[24:27], v[168:171], v[68:71]
  v_exp_f32 v37, v37
  v_mfma_f32_16x16x32_bf16 v[68:71], a[20:23], v[164:167], v[68:71]
  s_waitcnt lgkmcnt(14)
  ds_read_b128 a[4:7], v2 offset:17408
  v_cvt_pk_bf16_f32 v90, v36, v37
  v_mfma_f32_16x16x32_bf16 v[68:71], a[16:19], v[160:163], v[68:71]
  v_exp_f32 v38, v38
  v_mfma_f32_16x16x32_bf16 v[72:75], a[128:131], v[160:163], v[116:119]
  v_exp_f32 v39, v39
  v_mfma_f32_16x16x32_bf16 v[72:75], a[132:135], v[164:167], v[72:75]
  buffer_load_dwordx4 v1, s[12:15], s28 offen offset:1024 sc1 lds
  v_mfma_f32_16x16x32_bf16 v[72:75], a[136:139], v[168:171], v[72:75]
  s_waitcnt lgkmcnt(14)
  ds_read_b128 a[8:11], v2 offset:18432
  v_cvt_pk_bf16_f32 v91, v38, v39
  v_mfma_f32_16x16x32_bf16 v[72:75], a[140:143], v[172:175], v[72:75]
  v_exp_f32 v40, v40
  v_mfma_f32_16x16x32_bf16 v[76:79], a[156:159], v[172:175], v[116:119]
  v_exp_f32 v41, v41
  v_mfma_f32_16x16x32_bf16 v[76:79], a[152:155], v[168:171], v[76:79]
  s_waitcnt lgkmcnt(14)
  ds_read_b128 a[12:15], v2 offset:19456
  v_cvt_pk_bf16_f32 v92, v40, v41
  v_mfma_f32_16x16x32_bf16 v[76:79], a[148:151], v[164:167], v[76:79]
  v_exp_f32 v42, v42
  v_mfma_f32_16x16x32_bf16 v[76:79], a[144:147], v[160:163], v[76:79]
  v_exp_f32 v43, v43
  v_mfma_f32_16x16x32_bf16 v[128:131], v[216:219], v[80:83], v[128:131]
  s_waitcnt lgkmcnt(14)
  ds_read_b128 a[16:19], v2 offset:20480
  v_cvt_pk_bf16_f32 v93, v42, v43
  v_mfma_f32_16x16x32_bf16 v[128:131], v[216:219], v[84:87], v[128:131]
  s_waitcnt lgkmcnt(15)
  buffer_load_dwordx4 v1, s[12:15], s28 offen offset:2048 sc1 lds
  v_mfma_f32_16x16x32_bf16 a[96:99], a[32:35], v[80:83], a[96:99]
  v_exp_f32 v44, v44
  v_mfma_f32_16x16x32_bf16 a[96:99], a[36:39], v[84:87], a[96:99]
  v_exp_f32 v45, v45
  v_mfma_f32_16x16x32_bf16 a[100:103], a[40:43], v[80:83], a[100:103]
  s_waitcnt lgkmcnt(14)
  ds_read_b128 a[20:23], v2 offset:21504
  v_cvt_pk_bf16_f32 v94, v44, v45
  v_mfma_f32_16x16x32_bf16 a[100:103], a[44:47], v[84:87], a[100:103]
  v_exp_f32 v46, v46
  v_mfma_f32_16x16x32_bf16 a[104:107], a[48:51], v[80:83], a[104:107]
  v_exp_f32 v47, v47
  v_mfma_f32_16x16x32_bf16 a[104:107], a[52:55], v[84:87], a[104:107]
  s_waitcnt lgkmcnt(14)
  ds_read_b128 a[24:27], v2 offset:22528
  v_cvt_pk_bf16_f32 v95, v46, v47
  v_mfma_f32_16x16x32_bf16 a[108:111], a[56:59], v[80:83], a[108:111]
  s_waitcnt lgkmcnt(15)
  v_exp_f32 v48, v48
  v_mfma_f32_16x16x32_bf16 a[108:111], a[60:63], v[84:87], a[108:111]
  s_waitcnt lgkmcnt(14)
  buffer_load_dwordx4 v1, s[12:15], s28 offen offset:3072 sc1 lds
  v_mfma_f32_16x16x32_bf16 a[112:115], a[64:67], v[80:83], a[112:115]
  s_waitcnt lgkmcnt(13)
  s_and_b32 m0, s33, 0x1ffff
  v_exp_f32 v49, v49
  v_mfma_f32_16x16x32_bf16 a[112:115], a[68:71], v[84:87], a[112:115]
  s_waitcnt lgkmcnt(12)
  ds_read_b128 a[28:31], v2 offset:23552
  v_cvt_pk_bf16_f32 v96, v48, v49
  v_mfma_f32_16x16x32_bf16 a[116:119], a[72:75], v[80:83], a[116:119]
  s_waitcnt lgkmcnt(12)
  v_exp_f32 v50, v50
  v_mfma_f32_16x16x32_bf16 a[116:119], a[76:79], v[84:87], a[116:119]
  s_waitcnt lgkmcnt(11)
  v_exp_f32 v51, v51
  v_mfma_f32_16x16x32_bf16 a[120:123], a[80:83], v[80:83], a[120:123]
  s_waitcnt lgkmcnt(10)
  ds_read_b128 a[128:131], v2 offset:24576
  v_cvt_pk_bf16_f32 v97, v50, v51
  v_mfma_f32_16x16x32_bf16 a[120:123], a[84:87], v[84:87], a[120:123]
  s_waitcnt lgkmcnt(10)
  v_exp_f32 v52, v52
  v_mfma_f32_16x16x32_bf16 a[124:127], a[88:91], v[80:83], a[124:127]
  s_waitcnt lgkmcnt(9)
  v_exp_f32 v53, v53
  v_mfma_f32_16x16x32_bf16 a[124:127], a[92:95], v[84:87], a[124:127]
  buffer_load_dwordx4 v1, s[12:15], s33 offen offset:0 sc1 lds
  v_mfma_f32_16x16x32_bf16 v[140:143], v[216:219], v[88:91], v[140:143]
  ds_read_b128 a[132:135], v2 offset:25600
  v_cvt_pk_bf16_f32 v98, v52, v53
  v_mfma_f32_16x16x32_bf16 v[140:143], v[216:219], v[92:95], v[140:143]
  v_exp_f32 v54, v54
  v_mfma_f32_16x16x32_bf16 a[224:227], a[32:35], v[88:91], a[224:227]
  v_exp_f32 v55, v55
  v_mfma_f32_16x16x32_bf16 a[224:227], a[36:39], v[92:95], a[224:227]
  ds_read_b128 a[136:139], v2 offset:26624
  v_cvt_pk_bf16_f32 v99, v54, v55
  v_mfma_f32_16x16x32_bf16 a[228:231], a[40:43], v[88:91], a[228:231]
  v_exp_f32 v56, v56
  v_mfma_f32_16x16x32_bf16 a[228:231], a[44:47], v[92:95], a[228:231]
  v_exp_f32 v57, v57
  v_mfma_f32_16x16x32_bf16 a[232:235], a[48:51], v[88:91], a[232:235]
  buffer_load_dwordx4 v1, s[12:15], s33 offen offset:1024 sc1 lds
  v_mfma_f32_16x16x32_bf16 a[232:235], a[52:55], v[92:95], a[232:235]
  ds_read_b128 a[140:143], v2 offset:27648
  v_cvt_pk_bf16_f32 v100, v56, v57
  v_mfma_f32_16x16x32_bf16 a[236:239], a[56:59], v[88:91], a[236:239]
  v_exp_f32 v58, v58
  v_mfma_f32_16x16x32_bf16 a[236:239], a[60:63], v[92:95], a[236:239]
  v_exp_f32 v59, v59
  v_mfma_f32_16x16x32_bf16 a[240:243], a[64:67], v[88:91], a[240:243]
  ds_read_b128 a[144:147], v2 offset:28672
  v_cvt_pk_bf16_f32 v101, v58, v59
  v_mfma_f32_16x16x32_bf16 a[240:243], a[68:71], v[92:95], a[240:243]
  ds_read_b128 a[148:151], v2 offset:29696
  ds_read_b128 a[152:155], v2 offset:30720
  v_mfma_f32_16x16x32_bf16 a[244:247], a[72:75], v[88:91], a[244:247]
  v_exp_f32 v64, v64
  v_mfma_f32_16x16x32_bf16 a[244:247], a[76:79], v[92:95], a[244:247]
  v_exp_f32 v65, v65
  v_mfma_f32_16x16x32_bf16 a[248:251], a[80:83], v[88:91], a[248:251]
  buffer_load_dwordx4 v1, s[12:15], s33 offen offset:2048 sc1 lds
  v_mfma_f32_16x16x32_bf16 a[248:251], a[84:87], v[92:95], a[248:251]
  s_waitcnt lgkmcnt(14)
  ds_read_b128 a[156:159], v2 offset:31744
  v_cvt_pk_bf16_f32 v104, v64, v65
  v_mfma_f32_16x16x32_bf16 a[252:255], a[88:91], v[88:91], a[252:255]
  v_exp_f32 v66, v66
  v_mfma_f32_16x16x32_bf16 a[252:255], a[92:95], v[92:95], a[252:255]
  v_exp_f32 v67, v67
  v_mfma_f32_16x16x32_bf16 v[136:139], v[216:219], v[96:99], v[136:139]
  v_exp_f32 v68, v68
  v_mfma_f32_16x16x32_bf16 v[136:139], v[216:219], v[100:103], v[136:139]
  v_exp_f32 v69, v69
  v_mfma_f32_16x16x32_bf16 a[192:195], a[32:35], v[96:99], a[192:195]
  v_cvt_pk_bf16_f32 v105, v66, v67
  v_cvt_pk_bf16_f32 v106, v68, v69
  v_mfma_f32_16x16x32_bf16 a[192:195], a[36:39], v[100:103], a[192:195]
  v_exp_f32 v70, v70
  v_mfma_f32_16x16x32_bf16 a[196:199], a[40:43], v[96:99], a[196:199]
  buffer_load_dwordx4 v1, s[12:15], s33 offen offset:3072 sc1 lds
  v_mfma_f32_16x16x32_bf16 a[196:199], a[44:47], v[100:103], a[196:199]
  s_mov_b32 s32, s33
  v_exp_f32 v71, v71
  v_mfma_f32_16x16x32_bf16 a[200:203], a[48:51], v[96:99], a[200:203]
  s_add_u32 s33, s33, s36
  s_xor_b32 s36, s36, 0x8000
  v_cvt_pk_bf16_f32 v107, v70, v71
  v_mfma_f32_16x16x32_bf16 a[200:203], a[52:55], v[100:103], a[200:203]
  v_exp_f32 v72, v72
  v_mfma_f32_16x16x32_bf16 a[204:207], a[56:59], v[96:99], a[204:207]
  v_exp_f32 v73, v73
  v_mfma_f32_16x16x32_bf16 a[204:207], a[60:63], v[100:103], a[204:207]
  v_cvt_pk_bf16_f32 v108, v72, v73
  v_cmp_nlt_f32 vcc, 0x21800000, v136
  v_mfma_f32_16x16x32_bf16 a[208:211], a[64:67], v[96:99], a[208:211]
  s_or_b64 s[62:63], s[62:63], vcc
  v_exp_f32 v74, v74
  v_mfma_f32_16x16x32_bf16 a[208:211], a[68:71], v[100:103], a[208:211]
  v_exp_f32 v75, v75
  v_mfma_f32_16x16x32_bf16 a[212:215], a[72:75], v[96:99], a[212:215]
  v_cvt_pk_bf16_f32 v109, v74, v75
  v_cmp_ngt_f32 vcc, v4, v136
  v_mfma_f32_16x16x32_bf16 a[212:215], a[76:79], v[100:103], a[212:215]
  s_or_b64 s[62:63], s[62:63], vcc
  v_exp_f32 v76, v76
  v_mfma_f32_16x16x32_bf16 a[216:219], a[80:83], v[96:99], a[216:219]
  v_exp_f32 v77, v77
  v_mfma_f32_16x16x32_bf16 a[216:219], a[84:87], v[100:103], a[216:219]
  v_exp_f32 v78, v78
  v_mfma_f32_16x16x32_bf16 a[220:223], a[88:91], v[96:99], a[220:223]
  s_waitcnt vmcnt(24)
  s_waitcnt vmcnt(16) lgkmcnt(0)
  v_exp_f32 v79, v79
  v_mfma_f32_16x16x32_bf16 a[220:223], a[92:95], v[100:103], a[220:223]
  s_barrier
  v_cvt_pk_bf16_f32 v110, v76, v77
  v_cvt_pk_bf16_f32 v111, v78, v79
  v_mfma_f32_16x16x32_bf16 v[132:135], v[216:219], v[104:107], v[132:135]
  s_add_u32 s28, s32, 0x8000
  s_and_b32 m0, s28, 0x1ffff
  v_mfma_f32_16x16x32_bf16 v[132:135], v[216:219], v[108:111], v[132:135]
  buffer_atomic_add v13, v12, s[8:11], s53 offen sc1
  v_mfma_f32_16x16x32_bf16 a[160:163], a[32:35], v[104:107], a[160:163]
  buffer_load_dwordx4 v1, s[12:15], s28 offen offset:0 sc1 lds
  v_mfma_f32_16x16x32_bf16 a[160:163], a[36:39], v[108:111], a[160:163]
  ds_read_b128 a[32:35], v2 offset:49152
  v_xor_b32 v8, 0, v11
  v_mfma_f32_16x16x32_bf16 a[164:167], a[40:43], v[104:107], a[164:167]
  v_rcp_f32 v136, v136
  v_mfma_f32_16x16x32_bf16 a[164:167], a[44:47], v[108:111], a[164:167]
  s_waitcnt vmcnt(10)
  ds_read_b64_tr_b16 v[246:247], v8 offset:0
  ds_read_b64_tr_b16 v[248:249], v8 offset:4096
  v_mfma_f32_16x16x32_bf16 a[168:171], a[48:51], v[104:107], a[168:171]
  ds_read_b128 a[40:43], v2 offset:50176
  ds_read_b128 a[36:39], v2 offset:57344
  v_mfma_f32_16x16x32_bf16 a[168:171], a[52:55], v[108:111], a[168:171]
  ds_read_b128 a[48:51], v2 offset:51200
  ds_read_b128 a[44:47], v2 offset:58368
  v_mfma_f32_16x16x32_bf16 a[172:175], a[56:59], v[104:107], a[172:175]
  ds_read_b128 a[52:55], v2 offset:59392
  v_accvgpr_read_b32 v220, a192
  v_mfma_f32_16x16x32_bf16 a[172:175], a[60:63], v[108:111], a[172:175]
  ds_read_b128 a[56:59], v2 offset:52224
  v_accvgpr_read_b32 v221, a193
  v_mfma_f32_16x16x32_bf16 a[176:179], a[64:67], v[104:107], a[176:179]
  ds_read_b128 a[60:63], v2 offset:60416
  v_accvgpr_read_b32 v222, a194
  v_mfma_f32_16x16x32_bf16 a[176:179], a[68:71], v[108:111], a[176:179]
  ds_read_b128 a[64:67], v2 offset:53248
  v_accvgpr_read_b32 v223, a195
  v_mfma_f32_16x16x32_bf16 a[180:183], a[72:75], v[104:107], a[180:183]
  ds_read_b128 a[68:71], v2 offset:61440
  v_xor_b32 v14, 32, v11
  v_mfma_f32_16x16x32_bf16 a[180:183], a[76:79], v[108:111], a[180:183]
  s_waitcnt lgkmcnt(9)
  buffer_store_dwordx4 v[246:249], v1, s[8:11], s20 offen sc1
  v_mfma_f32_16x16x32_bf16 a[184:187], a[80:83], v[104:107], a[184:187]
  buffer_load_dwordx4 v1, s[12:15], s28 offen offset:1024 sc1 lds
  v_mfma_f32_16x16x32_bf16 a[184:187], a[84:87], v[108:111], a[184:187]
  ds_read_b64_tr_b16 v[250:251], v14 offset:0
  ds_read_b64_tr_b16 v[252:253], v14 offset:4096
  v_mfma_f32_16x16x32_bf16 a[188:191], a[88:91], v[104:107], a[188:191]
  ds_read_b128 a[72:75], v2 offset:54272
  ds_read_b128 a[80:83], v2 offset:55296
  v_mfma_f32_16x16x32_bf16 a[188:191], a[92:95], v[108:111], a[188:191]
  ds_read_b128 a[88:91], v2 offset:56320
  ds_read_b128 a[76:79], v2 offset:62464
  v_mfma_f32_16x16x32_bf16 v[16:19], a[0:3], v[192:195], v[124:127]
  s_waitcnt lgkmcnt(14)
  ds_read_b128 a[84:87], v2 offset:63488
  v_accvgpr_read_b32 v224, a196
  v_mfma_f32_16x16x32_bf16 v[16:19], a[4:7], v[196:199], v[16:19]
  s_waitcnt lgkmcnt(14)
  ds_read_b128 a[92:95], v2 offset:64512
  v_accvgpr_read_b32 v225, a197
  v_mfma_f32_16x16x32_bf16 v[16:19], a[8:11], v[200:203], v[16:19]
  v_accvgpr_read_b32 v226, a198
  v_accvgpr_read_b32 v227, a199
  v_mfma_f32_16x16x32_bf16 v[16:19], a[12:15], v[204:207], v[16:19]
  v_mul_f32 v220, v220, v136
  v_mul_f32 v221, v221, v136
  v_mfma_f32_16x16x32_bf16 v[20:23], a[28:31], v[204:207], v[212:215]
  v_xor_b32 v8, 64, v11
  v_mul_f32 v222, v222, v136
  v_mfma_f32_16x16x32_bf16 v[20:23], a[24:27], v[200:203], v[20:23]
  s_waitcnt lgkmcnt(6)
  buffer_store_dwordx4 v[250:253], v1, s[8:11], s21 offen sc1
  v_mfma_f32_16x16x32_bf16 v[20:23], a[20:23], v[196:199], v[20:23]
  v_mul_f32 v223, v223, v136
  v_mul_f32 v224, v224, v136
  v_mfma_f32_16x16x32_bf16 v[20:23], a[16:19], v[192:195], v[20:23]
  ds_read_b64_tr_b16 v[246:247], v8 offset:0
  ds_read_b64_tr_b16 v[248:249], v8 offset:4096
  v_mfma_f32_16x16x32_bf16 v[32:35], a[0:3], v[144:147], v[112:115]
  buffer_load_dwordx4 v1, s[12:15], s28 offen offset:2048 sc1 lds
  v_mfma_f32_16x16x32_bf16 v[32:35], a[4:7], v[148:151], v[32:35]
  v_exp_f32 v16, v16
  v_mfma_f32_16x16x32_bf16 v[32:35], a[8:11], v[152:155], v[32:35]
  v_exp_f32 v17, v17
  v_mfma_f32_16x16x32_bf16 v[32:35], a[12:15], v[156:159], v[32:35]
  v_cvt_pk_bf16_f32 v80, v16, v17
  v_mul_f32 v225, v225, v136
  v_mfma_f32_16x16x32_bf16 v[36:39], a[28:31], v[156:159], v[112:115]
  v_exp_f32 v18, v18
  v_mfma_f32_16x16x32_bf16 v[36:39], a[24:27], v[152:155], v[36:39]
  v_exp_f32 v19, v19
  v_mfma_f32_16x16x32_bf16 v[36:39], a[20:23], v[148:151], v[36:39]
  v_xor_b32 v14, 96, v11
  v_cvt_pk_bf16_f32 v81, v18, v19
  v_mfma_f32_16x16x32_bf16 v[36:39], a[16:19], v[144:147], v[36:39]
  s_waitcnt lgkmcnt(0)
  buffer_store_dwordx4 v[246:249], v1, s[8:11], s22 offen sc1
  v_mfma_f32_16x16x32_bf16 v[40:43], a[128:131], v[144:147], v[112:115]
  v_exp_f32 v20, v20
  v_mfma_f32_16x16x32_bf16 v[40:43], a[132:135], v[148:151], v[40:43]
  ds_read_b64_tr_b16 v[250:251], v14 offset:0
  ds_read_b64_tr_b16 v[252:253], v14 offset:4096
  v_mfma_f32_16x16x32_bf16 v[40:43], a[136:139], v[152:155], v[40:43]
  v_exp_f32 v21, v21
  v_mfma_f32_16x16x32_bf16 v[40:43], a[140:143], v[156:159], v[40:43]
  v_cvt_pk_bf16_f32 v82, v20, v21
  v_mul_f32 v226, v226, v136
  v_mfma_f32_16x16x32_bf16 v[44:47], a[156:159], v[156:159], v[112:115]
  buffer_load_dwordx4 v1, s[12:15], s28 offen offset:3072 sc1 lds
  v_mfma_f32_16x16x32_bf16 v[44:47], a[152:155], v[152:155], v[44:47]
  s_and_b32 m0, s33, 0x1ffff
  v_exp_f32 v22, v22
  v_mfma_f32_16x16x32_bf16 v[44:47], a[148:151], v[148:151], v[44:47]
  v_exp_f32 v23, v23
  v_mfma_f32_16x16x32_bf16 v[44:47], a[144:147], v[144:147], v[44:47]
  v_cvt_pk_bf16_f32 v83, v22, v23
  v_mul_f32 v227, v227, v136
  v_mfma_f32_16x16x32_bf16 v[48:51], a[0:3], v[160:163], v[116:119]
  v_xor_b32 v8, 128, v11
  v_cvt_pk_bf16_f32 v228, v220, v221
  v_mfma_f32_16x16x32_bf16 v[48:51], a[4:7], v[164:167], v[48:51]
  s_waitcnt lgkmcnt(0)
  buffer_store_dwordx4 v[250:253], v1, s[8:11], s23 offen sc1
  v_mfma_f32_16x16x32_bf16 v[48:51], a[8:11], v[168:171], v[48:51]
  v_exp_f32 v32, v32
  v_mfma_f32_16x16x32_bf16 v[48:51], a[12:15], v[172:175], v[48:51]
  ds_read_b64_tr_b16 v[246:247], v8 offset:0
  ds_read_b64_tr_b16 v[248:249], v8 offset:4096
  v_mfma_f32_16x16x32_bf16 v[52:55], a[28:31], v[172:175], v[116:119]
  v_exp_f32 v33, v33
  v_mfma_f32_16x16x32_bf16 v[52:55], a[24:27], v[168:171], v[52:55]
  ds_read_b128 a[0:3], v3 offset:0
  v_cvt_pk_bf16_f32 v88, v32, v33
  v_mfma_f32_16x16x32_bf16 v[52:55], a[20:23], v[164:167], v[52:55]
  v_exp_f32 v34, v34
  v_mfma_f32_16x16x32_bf16 v[52:55], a[16:19], v[160:163], v[52:55]
  v_exp_f32 v35, v35
  v_mfma_f32_16x16x32_bf16 v[56:59], a[128:131], v[160:163], v[116:119]
  buffer_load_dwordx4 v1, s[12:15], s33 offen offset:0 sc1 lds
  v_mfma_f32_16x16x32_bf16 v[56:59], a[132:135], v[164:167], v[56:59]
  ds_read_b128 a[4:7], v3 offset:1024
  v_cvt_pk_bf16_f32 v89, v34, v35
  v_mfma_f32_16x16x32_bf16 v[56:59], a[136:139], v[168:171], v[56:59]
  ds_read_b128 a[8:11], v3 offset:2048
  v_xor_b32 v14, 160, v11
  v_mfma_f32_16x16x32_bf16 v[56:59], a[140:143], v[172:175], v[56:59]
  s_waitcnt lgkmcnt(3)
  buffer_store_dwordx4 v[246:249], v1, s[8:11], s24 offen sc1
  v_mfma_f32_16x16x32_bf16 v[60:63], a[156:159], v[172:175], v[116:119]
  v_exp_f32 v36, v36
  v_mfma_f32_16x16x32_bf16 v[60:63], a[152:155], v[168:171], v[60:63]
  ds_read_b64_tr_b16 v[250:251], v14 offset:0
  ds_read_b64_tr_b16 v[252:253], v14 offset:4096
  v_mfma_f32_16x16x32_bf16 v[60:63], a[148:151], v[164:167], v[60:63]
  v_exp_f32 v37, v37
  v_mfma_f32_16x16x32_bf16 v[60:63], a[144:147], v[160:163], v[60:63]
  ds_read_b128 a[12:15], v3 offset:3072
  v_cvt_pk_bf16_f32 v90, v36, v37
  v_mfma_f32_16x16x32_bf16 v[140:143], v[216:219], v[80:83], v[140:143]
  v_exp_f32 v38, v38
  v_mfma_f32_16x16x32_bf16 a[224:227], a[32:35], v[80:83], a[224:227]
  v_exp_f32 v39, v39
  v_mfma_f32_16x16x32_bf16 a[228:231], a[40:43], v[80:83], a[228:231]
  ds_read_b128 a[16:19], v3 offset:4096
  v_cvt_pk_bf16_f32 v91, v38, v39
  v_mfma_f32_16x16x32_bf16 a[232:235], a[48:51], v[80:83], a[232:235]
  v_exp_f32 v40, v40
  v_mfma_f32_16x16x32_bf16 a[236:239], a[56:59], v[80:83], a[236:239]
  ds_read_b128 a[20:23], v3 offset:5120
  v_xor_b32 v8, 192, v11
  v_mfma_f32_16x16x32_bf16 a[240:243], a[64:67], v[80:83], a[240:243]
  buffer_load_dwordx4 v1, s[12:15], s33 offen offset:1024 sc1 lds
  v_mfma_f32_16x16x32_bf16 a[244:247], a[72:75], v[80:83], a[244:247]
  v_exp_f32 v41, v41
  v_mfma_f32_16x16x32_bf16 a[248:251], a[80:83], v[80:83], a[248:251]
  v_exp_f32 v42, v42
  v_exp_f32 v43, v43
  v_exp_f32 v44, v44
  v_exp_f32 v45, v45
  v_exp_f32 v46, v46
  v_exp_f32 v47, v47
  v_mfma_f32_16x16x32_bf16 a[252:255], a[88:91], v[80:83], a[252:255]
  s_waitcnt lgkmcnt(3)
  buffer_store_dwordx4 v[250:253], v1, s[8:11], s25 offen sc1
  v_cvt_pk_bf16_f32 v92, v40, v41
  v_cvt_pk_bf16_f32 v93, v42, v43
  v_cvt_pk_bf16_f32 v94, v44, v45
  v_cvt_pk_bf16_f32 v95, v46, v47
  v_mfma_f32_16x16x32_bf16 v[128:131], v[216:219], v[88:91], v[128:131]
  ds_read_b64_tr_b16 v[246:247], v8 offset:0
  ds_read_b64_tr_b16 v[248:249], v8 offset:4096
  v_mfma_f32_16x16x32_bf16 v[128:131], v[216:219], v[92:95], v[128:131]
  v_exp_f32 v48, v48
  v_mfma_f32_16x16x32_bf16 a[96:99], a[32:35], v[88:91], a[96:99]
  v_exp_f32 v49, v49
  v_mfma_f32_16x16x32_bf16 a[96:99], a[36:39], v[92:95], a[96:99]
  ds_read_b128 a[24:27], v3 offset:6144
  v_cvt_pk_bf16_f32 v96, v48, v49
  v_mfma_f32_16x16x32_bf16 a[100:103], a[40:43], v[88:91], a[100:103]
  v_exp_f32 v50, v50
  v_mfma_f32_16x16x32_bf16 a[100:103], a[44:47], v[92:95], a[100:103]
  ds_read_b128 a[28:31], v3 offset:7168
  v_xor_b32 v14, 224, v11
  v_mfma_f32_16x16x32_bf16 a[104:107], a[48:51], v[88:91], a[104:107]
  s_waitcnt lgkmcnt(2)
  buffer_store_dwordx4 v[246:249], v1, s[8:11], s26 offen sc1
  v_mfma_f32_16x16x32_bf16 a[104:107], a[52:55], v[92:95], a[104:107]
  buffer_load_dwordx4 v1, s[12:15], s33 offen offset:2048 sc1 lds
  v_mfma_f32_16x16x32_bf16 a[108:111], a[56:59], v[88:91], a[108:111]
  ds_read_b64_tr_b16 v[250:251], v14 offset:0
  ds_read_b64_tr_b16 v[252:253], v14 offset:4096
  v_mfma_f32_16x16x32_bf16 a[108:111], a[60:63], v[92:95], a[108:111]
  v_exp_f32 v51, v51
  v_mfma_f32_16x16x32_bf16 a[112:115], a[64:67], v[88:91], a[112:115]
  ds_read_b128 a[128:131], v3 offset:8192
  v_cvt_pk_bf16_f32 v97, v50, v51
  v_mfma_f32_16x16x32_bf16 a[112:115], a[68:71], v[92:95], a[112:115]
  v_exp_f32 v52, v52
  v_mfma_f32_16x16x32_bf16 a[116:119], a[72:75], v[88:91], a[116:119]
  v_exp_f32 v53, v53
  v_mfma_f32_16x16x32_bf16 a[116:119], a[76:79], v[92:95], a[116:119]
  ds_read_b128 a[132:135], v3 offset:9216
  v_cvt_pk_bf16_f32 v98, v52, v53
  v_mfma_f32_16x16x32_bf16 a[120:123], a[80:83], v[88:91], a[120:123]
  v_exp_f32 v54, v54
  v_mfma_f32_16x16x32_bf16 a[120:123], a[84:87], v[92:95], a[120:123]
  v_exp_f32 v55, v55
  v_mfma_f32_16x16x32_bf16 a[124:127], a[88:91], v[88:91], a[124:127]
  v_cvt_pk_bf16_f32 v99, v54, v55
  v_exp_f32 v56, v56
  v_exp_f32 v57, v57
  v_exp_f32 v58, v58
  v_exp_f32 v59, v59
  v_exp_f32 v60, v60
  v_exp_f32 v61, v61
  v_exp_f32 v62, v62
  v_exp_f32 v63, v63
  v_mfma_f32_16x16x32_bf16 a[124:127], a[92:95], v[92:95], a[124:127]
  v_cvt_pk_bf16_f32 v100, v56, v57
  v_cvt_pk_bf16_f32 v101, v58, v59
  v_cvt_pk_bf16_f32 v102, v60, v61
  v_cvt_pk_bf16_f32 v103, v62, v63
  v_mfma_f32_16x16x32_bf16 v[132:135], v[216:219], v[96:99], v[132:135]
  s_waitcnt lgkmcnt(2)
  buffer_store_dwordx4 v[250:253], v1, s[8:11], s27 offen sc1
  v_mfma_f32_16x16x32_bf16 v[132:135], v[216:219], v[100:103], v[132:135]
  buffer_load_dwordx4 v1, s[12:15], s33 offen offset:3072 sc1 lds
  v_mfma_f32_16x16x32_bf16 a[160:163], a[32:35], v[96:99], a[160:163]
  s_mov_b32 s32, s33
  ds_read_b128 a[136:139], v3 offset:10240
  ds_read_b128 a[140:143], v3 offset:11264
  v_mfma_f32_16x16x32_bf16 a[160:163], a[36:39], v[100:103], a[160:163]
  s_add_u32 s33, s33, s36
  v_cvt_pk_bf16_f32 v229, v222, v223
  v_cvt_pk_bf16_f32 v230, v224, v225
  v_mfma_f32_16x16x32_bf16 a[164:167], a[40:43], v[96:99], a[164:167]
  s_xor_b32 s36, s36, 0x8000
  ds_read_b128 a[144:147], v3 offset:12288
  v_cvt_pk_bf16_f32 v231, v226, v227
  v_mfma_f32_16x16x32_bf16 a[164:167], a[44:47], v[100:103], a[164:167]
  ds_read_b128 a[148:151], v3 offset:13312
  ds_read_b128 a[152:155], v3 offset:14336
  v_mfma_f32_16x16x32_bf16 a[168:171], a[48:51], v[96:99], a[168:171]
  s_add_u32 s30, s50, s54
  buffer_store_dwordx4 v[228:231], v1, s[8:11], s30 offen offset:0 sc1
  v_mfma_f32_16x16x32_bf16 a[168:171], a[52:55], v[100:103], a[168:171]
  v_accvgpr_read_b32 v232, a200
  v_accvgpr_read_b32 v233, a201
  v_mfma_f32_16x16x32_bf16 a[172:175], a[56:59], v[96:99], a[172:175]
  v_accvgpr_read_b32 v234, a202
  v_accvgpr_read_b32 v235, a203
  v_mfma_f32_16x16x32_bf16 a[172:175], a[60:63], v[100:103], a[172:175]
  v_accvgpr_read_b32 v236, a204
  v_accvgpr_read_b32 v237, a205
  v_mfma_f32_16x16x32_bf16 a[176:179], a[64:67], v[96:99], a[176:179]
  v_accvgpr_read_b32 v238, a206
  v_accvgpr_read_b32 v239, a207
  v_mfma_f32_16x16x32_bf16 a[176:179], a[68:71], v[100:103], a[176:179]
  v_mul_f32 v232, v232, v136
  v_mul_f32 v233, v233, v136
  v_mfma_f32_16x16x32_bf16 a[180:183], a[72:75], v[96:99], a[180:183]
  ds_read_b128 a[156:159], v3 offset:15360
  v_mul_f32 v234, v234, v136
  v_mfma_f32_16x16x32_bf16 a[180:183], a[76:79], v[100:103], a[180:183]
  v_mul_f32 v235, v235, v136
  v_mul_f32 v236, v236, v136
  v_mfma_f32_16x16x32_bf16 a[184:187], a[80:83], v[96:99], a[184:187]
  v_mul_f32 v237, v237, v136
  v_mul_f32 v238, v238, v136
  v_mfma_f32_16x16x32_bf16 a[184:187], a[84:87], v[100:103], a[184:187]
  v_mov_b32 v2, v3
  v_mul_f32 v239, v239, v136
  v_mfma_f32_16x16x32_bf16 a[188:191], a[88:91], v[96:99], a[188:191]
  v_cvt_pk_bf16_f32 v240, v232, v233
  v_cvt_pk_bf16_f32 v241, v234, v235
  v_mfma_f32_16x16x32_bf16 a[188:191], a[92:95], v[100:103], a[188:191]
  v_cvt_pk_bf16_f32 v242, v236, v237
  v_cvt_pk_bf16_f32 v243, v238, v239
  buffer_store_dwordx4 v[240:243], v1, s[8:11], s30 offen offset:1024 sc1
  v_accvgpr_read_b32 v220, a208
  v_accvgpr_read_b32 v221, a209
  v_accvgpr_read_b32 v222, a210
  v_accvgpr_read_b32 v223, a211
  v_accvgpr_read_b32 v224, a212
  v_accvgpr_read_b32 v225, a213
  v_accvgpr_read_b32 v226, a214
  v_accvgpr_read_b32 v227, a215
  v_mul_f32 v220, v220, v136
  v_mul_f32 v221, v221, v136
  v_mul_f32 v222, v222, v136
  v_mul_f32 v223, v223, v136
  v_mul_f32 v224, v224, v136
  v_mul_f32 v225, v225, v136
  v_mul_f32 v226, v226, v136
  v_mul_f32 v227, v227, v136
  v_cvt_pk_bf16_f32 v228, v220, v221
  v_cvt_pk_bf16_f32 v229, v222, v223
  v_cvt_pk_bf16_f32 v230, v224, v225
  v_cvt_pk_bf16_f32 v231, v226, v227
  buffer_store_dwordx4 v[228:231], v1, s[8:11], s30 offen offset:2048 sc1
  v_accvgpr_read_b32 v232, a216
  v_accvgpr_read_b32 v233, a217
  v_accvgpr_read_b32 v234, a218
  v_accvgpr_read_b32 v235, a219
  v_accvgpr_read_b32 v236, a220
  v_accvgpr_read_b32 v237, a221
  v_accvgpr_read_b32 v238, a222
  v_accvgpr_read_b32 v239, a223
  v_mul_f32 v232, v232, v136
  v_mul_f32 v233, v233, v136
  v_mul_f32 v234, v234, v136
  v_mul_f32 v235, v235, v136
  v_mul_f32 v236, v236, v136
  v_mul_f32 v237, v237, v136
  v_mul_f32 v238, v238, v136
  v_mul_f32 v239, v239, v136
  v_cvt_pk_bf16_f32 v240, v232, v233
  v_cvt_pk_bf16_f32 v241, v234, v235
  v_cvt_pk_bf16_f32 v242, v236, v237
  v_cvt_pk_bf16_f32 v243, v238, v239
  buffer_store_dwordx4 v[240:243], v1, s[8:11], s30 offen offset:3072 sc1
  v_cmp_nlt_f32 vcc, 0x21800000, v140
  s_nop 0
  s_or_b64 s[62:63], s[62:63], vcc
  v_cmp_ngt_f32 vcc, v4, v140
  s_nop 0
  s_or_b64 s[62:63], s[62:63], vcc
  v_rcp_f32 v140, v140
  v_accvgpr_read_b32 v220, a224
  v_accvgpr_read_b32 v221, a225
  v_accvgpr_read_b32 v222, a226
  v_accvgpr_read_b32 v223, a227
  v_accvgpr_read_b32 v224, a228
  v_accvgpr_read_b32 v225, a229
  v_accvgpr_read_b32 v226, a230
  v_accvgpr_read_b32 v227, a231
  v_mul_f32 v220, v220, v140
  v_mul_f32 v221, v221, v140
  v_mul_f32 v222, v222, v140
  v_mul_f32 v223, v223, v140
  v_mul_f32 v224, v224, v140
  v_mul_f32 v225, v225, v140
  v_mul_f32 v226, v226, v140
  v_mul_f32 v227, v227, v140
  v_cvt_pk_bf16_f32 v228, v220, v221
  v_cvt_pk_bf16_f32 v229, v222, v223
  v_cvt_pk_bf16_f32 v230, v224, v225
  v_cvt_pk_bf16_f32 v231, v226, v227
  s_add_u32 s30, s51, s54
  buffer_store_dwordx4 v[228:231], v1, s[8:11], s30 offen offset:0 sc1
  v_accvgpr_read_b32 v232, a232
  v_accvgpr_read_b32 v233, a233
  v_accvgpr_read_b32 v234, a234
  v_accvgpr_read_b32 v235, a235
  v_accvgpr_read_b32 v236, a236
  v_accvgpr_read_b32 v237, a237
  v_accvgpr_read_b32 v238, a238
  v_accvgpr_read_b32 v239, a239
  v_mul_f32 v232, v232, v140
  v_mul_f32 v233, v233, v140
  v_mul_f32 v234, v234, v140
  v_mul_f32 v235, v235, v140
  v_mul_f32 v236, v236, v140
  v_mul_f32 v237, v237, v140
  v_mul_f32 v238, v238, v140
  v_mul_f32 v239, v239, v140
  v_cvt_pk_bf16_f32 v240, v232, v233
  v_cvt_pk_bf16_f32 v241, v234, v235
  v_cvt_pk_bf16_f32 v242, v236, v237
  v_cvt_pk_bf16_f32 v243, v238, v239
  buffer_store_dwordx4 v[240:243], v1, s[8:11], s30 offen offset:1024 sc1
  v_accvgpr_read_b32 v220, a240
  v_accvgpr_read_b32 v221, a241
  v_accvgpr_read_b32 v222, a242
  v_accvgpr_read_b32 v223, a243
  v_accvgpr_read_b32 v224, a244
  v_accvgpr_read_b32 v225, a245
  v_accvgpr_read_b32 v226, a246
  v_accvgpr_read_b32 v227, a247
  v_mul_f32 v220, v220, v140
  v_mul_f32 v221, v221, v140
  v_mul_f32 v222, v222, v140
  v_mul_f32 v223, v223, v140
  v_mul_f32 v224, v224, v140
  v_mul_f32 v225, v225, v140
  v_mul_f32 v226, v226, v140
  v_mul_f32 v227, v227, v140
  v_cvt_pk_bf16_f32 v228, v220, v221
  v_cvt_pk_bf16_f32 v229, v222, v223
  v_cvt_pk_bf16_f32 v230, v224, v225
  v_cvt_pk_bf16_f32 v231, v226, v227
  buffer_store_dwordx4 v[228:231], v1, s[8:11], s30 offen offset:2048 sc1
  v_accvgpr_read_b32 v232, a248
  v_accvgpr_read_b32 v233, a249
  v_accvgpr_read_b32 v234, a250
  v_accvgpr_read_b32 v235, a251
  v_accvgpr_read_b32 v236, a252
  v_accvgpr_read_b32 v237, a253
  v_accvgpr_read_b32 v238, a254
  v_accvgpr_read_b32 v239, a255
  v_mul_f32 v232, v232, v140
  v_mul_f32 v233, v233, v140
  v_mul_f32 v234, v234, v140
  v_mul_f32 v235, v235, v140
  v_mul_f32 v236, v236, v140
  v_mul_f32 v237, v237, v140
  v_mul_f32 v238, v238, v140
  v_mul_f32 v239, v239, v140
  v_cvt_pk_bf16_f32 v240, v232, v233
  v_cvt_pk_bf16_f32 v241, v234, v235
  v_cvt_pk_bf16_f32 v242, v236, v237
  v_cvt_pk_bf16_f32 v243, v238, v239
  buffer_store_dwordx4 v[240:243], v1, s[8:11], s30 offen offset:3072 sc1
  s_branch L_att_dd
L_att_d3:
  s_waitcnt lgkmcnt(15)
  v_mfma_f32_16x16x32_bf16 v[16:19], a[0:3], v[144:147], v[112:115]
  s_waitcnt vmcnt(16) lgkmcnt(0)
  v_mfma_f32_16x16x32_bf16 v[16:19], a[4:7], v[148:151], v[16:19]
  s_barrier
  ds_read_b128 a[32:35], v2 offset:32768
  ds_read_b128 a[36:39], v2 offset:40960
  v_mfma_f32_16x16x32_bf16 v[16:19], a[8:11], v[152:155], v[16:19]
  s_add_u32 m0, s31, 0
  s_add_u32 s29, s52, 0
  v_mov_b32 v4, 0x5d800000
  v_mfma_f32_16x16x32_bf16 v[16:19], a[12:15], v[156:159], v[16:19]
  ds_read_b128 a[40:43], v2 offset:33792
  ds_read_b128 a[44:47], v2 offset:41984
  v_mfma_f32_16x16x32_bf16 v[20:23], a[28:31], v[156:159], v[112:115]
  buffer_load_dwordx4 v9, s[16:19], s29 offen lds
  v_mfma_f32_16x16x32_bf16 v[20:23], a[24:27], v[152:155], v[20:23]
  s_add_u32 m0, s31, 1024
  s_add_u32 s29, s52, 5120
  ds_read_b128 a[48:51], v2 offset:34816
  v_mfma_f32_16x16x32_bf16 v[20:23], a[20:23], v[148:151], v[20:23]
  ds_read_b128 a[52:55], v2 offset:43008
  ds_read_b128 a[56:59], v2 offset:35840
  v_mfma_f32_16x16x32_bf16 v[20:23], a[16:19], v[144:147], v[20:23]
  ds_read_b128 a[60:63], v2 offset:44032
  ds_read_b128 a[64:67], v2 offset:36864
  v_mfma_f32_16x16x32_bf16 v[24:27], a[128:131], v[144:147], v[112:115]
  v_exp_f32 v16, v16
  v_mfma_f32_16x16x32_bf16 v[24:27], a[132:135], v[148:151], v[24:27]
  buffer_load_dwordx4 v10, s[16:19], s29 offen lds
  v_mfma_f32_16x16x32_bf16 v[24:27], a[136:139], v[152:155], v[24:27]
  s_add_u32 m0, s31, 2048
  s_add_u32 s29, s52, 10240
  ds_read_b128 a[68:71], v2 offset:45056
  v_mfma_f32_16x16x32_bf16 v[24:27], a[140:143], v[156:159], v[24:27]
  v_exp_f32 v17, v17
  v_mfma_f32_16x16x32_bf16 v[28:31], a[156:159], v[156:159], v[112:115]
  ds_read_b128 a[72:75], v2 offset:37888
  v_cvt_pk_bf16_f32 v80, v16, v17
  v_mfma_f32_16x16x32_bf16 v[28:31], a[152:155], v[152:155], v[28:31]
  v_exp_f32 v18, v18
  v_mfma_f32_16x16x32_bf16 v[28:31], a[148:151], v[148:151], v[28:31]
  buffer_load_dwordx4 v9, s[16:19], s29 offen lds
  v_mfma_f32_16x16x32_bf16 v[28:31], a[144:147], v[144:147], v[28:31]
  s_add_u32 m0, s31, 3072
  s_add_u32 s29, s52, 15360
  ds_read_b128 a[76:79], v2 offset:46080
  v_mfma_f32_16x16x32_bf16 v[32:35], a[0:3], v[192:195], v[124:127]
  v_exp_f32 v19, v19
  v_mfma_f32_16x16x32_bf16 v[32:35], a[4:7], v[196:199], v[32:35]
  ds_read_b128 a[80:83], v2 offset:38912
  v_cvt_pk_bf16_f32 v81, v18, v19
  v_mfma_f32_16x16x32_bf16 v[32:35], a[8:11], v[200:203], v[32:35]
  v_exp_f32 v20, v20
  v_mfma_f32_16x16x32_bf16 v[32:35], a[12:15], v[204:207], v[32:35]
  buffer_load_dwordx4 v10, s[16:19], s29 offen lds
  v_mfma_f32_16x16x32_bf16 v[36:39], a[28:31], v[204:207], v[124:127]
  s_add_u32 m0, s31, 4096
  s_add_u32 s29, s52, 20480
  ds_read_b128 a[84:87], v2 offset:47104
  v_mfma_f32_16x16x32_bf16 v[36:39], a[24:27], v[200:203], v[36:39]
  v_exp_f32 v21, v21
  v_mfma_f32_16x16x32_bf16 v[36:39], a[20:23], v[196:199], v[36:39]
  ds_read_b128 a[88:91], v2 offset:39936
  v_cvt_pk_bf16_f32 v82, v20, v21
  v_mfma_f32_16x16x32_bf16 v[36:39], a[16:19], v[192:195], v[36:39]
  v_exp_f32 v22, v22
  v_mfma_f32_16x16x32_bf16 v[40:43], a[128:131], v[192:195], v[124:127]
  buffer_load_dwordx4 v9, s[16:19], s29 offen lds
  v_mfma_f32_16x16x32_bf16 v[40:43], a[132:135], v[196:199], v[40:43]
  s_add_u32 m0, s31, 5120
  s_add_u32 s29, s52, 25600
  s_waitcnt lgkmcnt(14)
  ds_read_b128 a[92:95], v2 offset:48128
  v_mfma_f32_16x16x32_bf16 v[40:43], a[136:139], v[200:203], v[40:43]
  v_exp_f32 v23, v23
  v_mfma_f32_16x16x32_bf16 v[40:43], a[140:143], v[204:207], v[40:43]
  v_cvt_pk_bf16_f32 v83, v22, v23
  v_xor_b32 v3, 0x10000, v2
  v_mfma_f32_16x16x32_bf16 v[44:47], a[156:159], v[204:207], v[124:127]
  v_exp_f32 v24, v24
  v_mfma_f32_16x16x32_bf16 v[44:47], a[152:155], v[200:203], v[44:47]
  buffer_load_dwordx4 v10, s[16:19], s29 offen lds
  v_mfma_f32_16x16x32_bf16 v[44:47], a[148:151], v[196:199], v[44:47]
  s_add_u32 m0, s31, 6144
  v_exp_f32 v25, v25
  v_mfma_f32_16x16x32_bf16 v[44:47], a[144:147], v[192:195], v[44:47]
  s_add_u32 s29, s52, 30720
  v_exp_f32 v26, v26
  v_mfma_f32_16x16x32_bf16 v[48:51], a[0:3], v[176:179], v[120:123]
  v_exp_f32 v27, v27
  v_mfma_f32_16x16x32_bf16 v[48:51], a[4:7], v[180:183], v[48:51]
  v_cvt_pk_bf16_f32 v84, v24, v25
  v_cvt_pk_bf16_f32 v85, v26, v27
  v_mfma_f32_16x16x32_bf16 v[48:51], a[8:11], v[184:187], v[48:51]
  buffer_load_dwordx4 v9, s[16:19], s29 offen lds
  v_mfma_f32_16x16x32_bf16 v[48:51], a[12:15], v[188:191], v[48:51]
  s_add_u32 m0, s31, 7168
  v_exp_f32 v28, v28
  v_mfma_f32_16x16x32_bf16 v[52:55], a[28:31], v[188:191], v[120:123]
  s_add_u32 s29, s52, 35840
  v_exp_f32 v29, v29
  v_mfma_f32_16x16x32_bf16 v[52:55], a[24:27], v[184:187], v[52:55]
  v_exp_f32 v30, v30
  v_mfma_f32_16x16x32_bf16 v[52:55], a[20:23], v[180:183], v[52:55]
  v_exp_f32 v31, v31
  v_mfma_f32_16x16x32_bf16 v[52:55], a[16:19], v[176:179], v[52:55]
  buffer_load_dwordx4 v10, s[16:19], s29 offen lds
  v_mfma_f32_16x16x32_bf16 v[56:59], a[128:131], v[176:179], v[120:123]
  v_cvt_pk_bf16_f32 v86, v28, v29
  v_cvt_pk_bf16_f32 v87, v30, v31
  v_mfma_f32_16x16x32_bf16 v[56:59], a[132:135], v[180:183], v[56:59]
  v_exp_f32 v32, v32
  v_mfma_f32_16x16x32_bf16 v[56:59], a[136:139], v[184:187], v[56:59]
  v_exp_f32 v33, v33
  v_mfma_f32_16x16x32_bf16 v[56:59], a[140:143], v[188:191], v[56:59]
  v_exp_f32 v34, v34
  v_mfma_f32_16x16x32_bf16 v[60:63], a[156:159], v[188:191], v[208:211]
  s_add_u32 s28, s32, 0x8000
  s_and_b32 m0, s28, 0x1ffff
  v_cvt_pk_bf16_f32 v88, v32, v33
  v_mfma_f32_16x16x32_bf16 v[60:63], a[152:155], v[184:187], v[60:63]
  v_exp_f32 v35, v35
  v_mfma_f32_16x16x32_bf16 v[60:63], a[148:151], v[180:183], v[60:63]
  buffer_load_dwordx4 v1, s[12:15], s28 offen offset:0 sc1 lds
  v_mfma_f32_16x16x32_bf16 v[60:63], a[144:147], v[176:179], v[60:63]
  v_exp_f32 v36, v36
  v_mfma_f32_16x16x32_bf16 v[64:67], a[0:3], v[160:163], v[116:119]
  v_exp_f32 v37, v37
  v_mfma_f32_16x16x32_bf16 v[64:67], a[4:7], v[164:167], v[64:67]
  v_cvt_pk_bf16_f32 v89, v34, v35
  v_cvt_pk_bf16_f32 v90, v36, v37
  v_mfma_f32_16x16x32_bf16 v[64:67], a[8:11], v[168:171], v[64:67]
  v_exp_f32 v38, v38
  v_mfma_f32_16x16x32_bf16 v[64:67], a[12:15], v[172:175], v[64:67]
  v_exp_f32 v39, v39
  v_mfma_f32_16x16x32_bf16 v[68:71], a[28:31], v[172:175], v[116:119]
  s_waitcnt lgkmcnt(14)
  ds_read_b128 a[0:3], v2 offset:16384
  v_cvt_pk_bf16_f32 v91, v38, v39
  v_mfma_f32_16x16x32_bf16 v[68:71], a[24:27], v[168:171], v[68:71]
  buffer_load_dwordx4 v1, s[12:15], s28 offen offset:1024 sc1 lds
  v_mfma_f32_16x16x32_bf16 v[68:71], a[20:23], v[164:167], v[68:71]
  v_exp_f32 v40, v40
  v_mfma_f32_16x16x32_bf16 v[68:71], a[16:19], v[160:163], v[68:71]
  v_exp_f32 v41, v41
  v_mfma_f32_16x16x32_bf16 v[72:75], a[128:131], v[160:163], v[116:119]
  s_waitcnt lgkmcnt(14)
  ds_read_b128 a[4:7], v2 offset:17408
  v_cvt_pk_bf16_f32 v92, v40, v41
  v_mfma_f32_16x16x32_bf16 v[72:75], a[132:135], v[164:167], v[72:75]
  v_exp_f32 v42, v42
  v_mfma_f32_16x16x32_bf16 v[72:75], a[136:139], v[168:171], v[72:75]
  v_exp_f32 v43, v43
  v_mfma_f32_16x16x32_bf16 v[72:75], a[140:143], v[172:175], v[72:75]
  s_waitcnt lgkmcnt(14)
  ds_read_b128 a[8:11], v2 offset:18432
  v_cvt_pk_bf16_f32 v93, v42, v43
  v_mfma_f32_16x16x32_bf16 v[76:79], a[156:159], v[172:175], v[116:119]
  v_exp_f32 v44, v44
  v_mfma_f32_16x16x32_bf16 v[76:79], a[152:155], v[168:171], v[76:79]
  buffer_load_dwordx4 v1, s[12:15], s28 offen offset:2048 sc1 lds
  v_mfma_f32_16x16x32_bf16 v[76:79], a[148:151], v[164:167], v[76:79]
  v_exp_f32 v45, v45
  v_mfma_f32_16x16x32_bf16 v[76:79], a[144:147], v[160:163], v[76:79]
  s_waitcnt lgkmcnt(14)
  ds_read_b128 a[12:15], v2 offset:19456
  v_cvt_pk_bf16_f32 v94, v44, v45
  v_mfma_f32_16x16x32_bf16 v[128:131], v[216:219], v[80:83], v[128:131]
  v_exp_f32 v46, v46
  v_mfma_f32_16x16x32_bf16 v[128:131], v[216:219], v[84:87], v[128:131]
  s_waitcnt lgkmcnt(15)
  v_exp_f32 v47, v47
  v_mfma_f32_16x16x32_bf16 a[96:99], a[32:35], v[80:83], a[96:99]
  s_waitcnt lgkmcnt(14)
  ds_read_b128 a[16:19], v2 offset:20480
  v_cvt_pk_bf16_f32 v95, v46, v47
  v_mfma_f32_16x16x32_bf16 a[96:99], a[36:39], v[84:87], a[96:99]
  v_exp_f32 v48, v48
  v_mfma_f32_16x16x32_bf16 a[100:103], a[40:43], v[80:83], a[100:103]
  v_exp_f32 v49, v49
  v_mfma_f32_16x16x32_bf16 a[100:103], a[44:47], v[84:87], a[100:103]
  buffer_load_dwordx4 v1, s[12:15], s28 offen offset:3072 sc1 lds
  v_mfma_f32_16x16x32_bf16 a[104:107], a[48:51], v[80:83], a[104:107]
  s_waitcnt lgkmcnt(15)
  s_and_b32 m0, s33, 0x1ffff
  s_waitcnt lgkmcnt(14)
  ds_read_b128 a[20:23], v2 offset:21504
  v_cvt_pk_bf16_f32 v96, v48, v49
  v_mfma_f32_16x16x32_bf16 a[104:107], a[52:55], v[84:87], a[104:107]
  s_waitcnt lgkmcnt(15)
  v_exp_f32 v50, v50
  v_mfma_f32_16x16x32_bf16 a[108:111], a[56:59], v[80:83], a[108:111]
  s_waitcnt lgkmcnt(14)
  v_exp_f32 v51, v51
  v_mfma_f32_16x16x32_bf16 a[108:111], a[60:63], v[84:87], a[108:111]
  s_waitcnt lgkmcnt(13)
  ds_read_b128 a[24:27], v2 offset:22528
  v_cvt_pk_bf16_f32 v97, v50, v51
  v_mfma_f32_16x16x32_bf16 a[112:115], a[64:67], v[80:83], a[112:115]
  s_waitcnt lgkmcnt(13)
  v_exp_f32 v52, v52
  v_mfma_f32_16x16x32_bf16 a[112:115], a[68:71], v[84:87], a[112:115]
  s_waitcnt lgkmcnt(12)
  v_exp_f32 v53, v53
  v_mfma_f32_16x16x32_bf16 a[116:119], a[72:75], v[80:83], a[116:119]
  s_waitcnt lgkmcnt(11)
  ds_read_b128 a[28:31], v2 offset:23552
  v_cvt_pk_bf16_f32 v98, v52, v53
  v_mfma_f32_16x16x32_bf16 a[116:119], a[76:79], v[84:87], a[116:119]
  s_waitcnt lgkmcnt(11)
  buffer_load_dwordx4 v1, s[12:15], s33 offen offset:0 sc1 lds
  v_mfma_f32_16x16x32_bf16 a[120:123], a[80:83], v[80:83], a[120:123]
  s_waitcnt lgkmcnt(10)
  v_exp_f32 v54, v54
  v_mfma_f32_16x16x32_bf16 a[120:123], a[84:87], v[84:87], a[120:123]
  s_waitcnt lgkmcnt(9)
  v_exp_f32 v55, v55
  v_mfma_f32_16x16x32_bf16 a[124:127], a[88:91], v[80:83], a[124:127]
  s_waitcnt lgkmcnt(8)
  ds_read_b128 a[128:131], v2 offset:24576
  v_cvt_pk_bf16_f32 v99, v54, v55
  v_mfma_f32_16x16x32_bf16 a[124:127], a[92:95], v[84:87], a[124:127]
  v_exp_f32 v56, v56
  v_mfma_f32_16x16x32_bf16 v[140:143], v[216:219], v[88:91], v[140:143]
  v_exp_f32 v57, v57
  v_mfma_f32_16x16x32_bf16 v[140:143], v[216:219], v[92:95], v[140:143]
  ds_read_b128 a[132:135], v2 offset:25600
  v_cvt_pk_bf16_f32 v100, v56, v57
  v_mfma_f32_16x16x32_bf16 a[224:227], a[32:35], v[88:91], a[224:227]
  buffer_load_dwordx4 v1, s[12:15], s33 offen offset:1024 sc1 lds
  v_mfma_f32_16x16x32_bf16 a[224:227], a[36:39], v[92:95], a[224:227]
  v_exp_f32 v58, v58
  v_mfma_f32_16x16x32_bf16 a[228:231], a[40:43], v[88:91], a[228:231]
  v_exp_f32 v59, v59
  v_mfma_f32_16x16x32_bf16 a[228:231], a[44:47], v[92:95], a[228:231]
  ds_read_b128 a[136:139], v2 offset:26624
  v_cvt_pk_bf16_f32 v101, v58, v59
  v_mfma_f32_16x16x32_bf16 a[232:235], a[48:51], v[88:91], a[232:235]
  v_exp_f32 v60, v60
  v_mfma_f32_16x16x32_bf16 a[232:235], a[52:55], v[92:95], a[232:235]
  v_exp_f32 v61, v61
  v_mfma_f32_16x16x32_bf16 a[236:239], a[56:59], v[88:91], a[236:239]
  ds_read_b128 a[140:143], v2 offset:27648
  v_cvt_pk_bf16_f32 v102, v60, v61
  v_mfma_f32_16x16x32_bf16 a[236:239], a[60:63], v[92:95], a[236:239]
  v_exp_f32 v62, v62
  v_mfma_f32_16x16x32_bf16 a[240:243], a[64:67], v[88:91], a[240:243]
  buffer_load_dwordx4 v1, s[12:15], s33 offen offset:2048 sc1 lds
  v_mfma_f32_16x16x32_bf16 a[240:243], a[68:71], v[92:95], a[240:243]
  v_exp_f32 v63, v63
  v_mfma_f32_16x16x32_bf16 a[244:247], a[72:75], v[88:91], a[244:247]
  ds_read_b128 a[144:147], v2 offset:28672
  v_cvt_pk_bf16_f32 v103, v62, v63
  v_mfma_f32_16x16x32_bf16 a[244:247], a[76:79], v[92:95], a[244:247]
  ds_read_b128 a[148:151], v2 offset:29696
  ds_read_b128 a[152:155], v2 offset:30720
  v_mfma_f32_16x16x32_bf16 a[248:251], a[80:83], v[88:91], a[248:251]
  v_exp_f32 v64, v64
  v_mfma_f32_16x16x32_bf16 a[248:251], a[84:87], v[92:95], a[248:251]
  v_exp_f32 v65, v65
  v_mfma_f32_16x16x32_bf16 a[252:255], a[88:91], v[88:91], a[252:255]
  s_waitcnt lgkmcnt(14)
  ds_read_b128 a[156:159], v2 offset:31744
  v_cvt_pk_bf16_f32 v104, v64, v65
  v_mfma_f32_16x16x32_bf16 a[252:255], a[92:95], v[92:95], a[252:255]
  v_exp_f32 v66, v66
  v_mfma_f32_16x16x32_bf16 v[136:139], v[216:219], v[96:99], v[136:139]
  buffer_load_dwordx4 v1, s[12:15], s33 offen offset:3072 sc1 lds
  v_mfma_f32_16x16x32_bf16 v[136:139], v[216:219], v[100:103], v[136:139]
  s_mov_b32 s32, s33
  v_exp_f32 v67, v67
  v_mfma_f32_16x16x32_bf16 a[192:195], a[32:35], v[96:99], a[192:195]
  s_add_u32 s33, s33, s36
  s_xor_b32 s36, s36, 0x8000
  v_cvt_pk_bf16_f32 v105, v66, v67
  v_mfma_f32_16x16x32_bf16 a[192:195], a[36:39], v[100:103], a[192:195]
  v_exp_f32 v68, v68
  v_mfma_f32_16x16x32_bf16 a[196:199], a[40:43], v[96:99], a[196:199]
  v_exp_f32 v69, v69
  v_mfma_f32_16x16x32_bf16 a[196:199], a[44:47], v[100:103], a[196:199]
  v_exp_f32 v70, v70
  v_mfma_f32_16x16x32_bf16 a[200:203], a[48:51], v[96:99], a[200:203]
  v_cvt_pk_bf16_f32 v106, v68, v69
  v_cmp_nlt_f32 vcc, 0x21800000, v136
  v_mfma_f32_16x16x32_bf16 a[200:203], a[52:55], v[100:103], a[200:203]
  s_or_b64 s[62:63], s[62:63], vcc
  v_exp_f32 v71, v71
  v_mfma_f32_16x16x32_bf16 a[204:207], a[56:59], v[96:99], a[204:207]
  v_cvt_pk_bf16_f32 v107, v70, v71
  v_cmp_ngt_f32 vcc, v4, v136
  v_mfma_f32_16x16x32_bf16 a[204:207], a[60:63], v[100:103], a[204:207]
  s_or_b64 s[62:63], s[62:63], vcc
  v_exp_f32 v72, v72
  v_mfma_f32_16x16x32_bf16 a[208:211], a[64:67], v[96:99], a[208:211]
  v_exp_f32 v73, v73
  v_mfma_f32_16x16x32_bf16 a[208:211], a[68:71], v[100:103], a[208:211]
  v_exp_f32 v74, v74
  v_mfma_f32_16x16x32_bf16 a[212:215], a[72:75], v[96:99], a[212:215]
  s_waitcnt vmcnt(24)
  s_waitcnt vmcnt(16) lgkmcnt(0)
  v_exp_f32 v75, v75
  v_mfma_f32_16x16x32_bf16 a[212:215], a[76:79], v[100:103], a[212:215]
  s_barrier
  v_cvt_pk_bf16_f32 v108, v72, v73
  v_cvt_pk_bf16_f32 v109, v74, v75
  v_mfma_f32_16x16x32_bf16 a[216:219], a[80:83], v[96:99], a[216:219]
  s_add_u32 s28, s32, 0x8000
  s_and_b32 m0, s28, 0x1ffff
  v_mfma_f32_16x16x32_bf16 a[216:219], a[84:87], v[100:103], a[216:219]
  v_exp_f32 v76, v76
  v_mfma_f32_16x16x32_bf16 a[220:223], a[88:91], v[96:99], a[220:223]
  v_exp_f32 v77, v77
  v_exp_f32 v78, v78
  v_exp_f32 v79, v79
  v_mfma_f32_16x16x32_bf16 a[220:223], a[92:95], v[100:103], a[220:223]
  v_cvt_pk_bf16_f32 v110, v76, v77
  v_cvt_pk_bf16_f32 v111, v78, v79
  v_mfma_f32_16x16x32_bf16 v[132:135], v[216:219], v[104:107], v[132:135]
  buffer_load_dwordx4 v1, s[12:15], s28 offen offset:0 sc1 lds
  v_xor_b32 v8, 0, v11
  v_mfma_f32_16x16x32_bf16 v[132:135], v[216:219], v[108:111], v[132:135]
  s_waitcnt vmcnt(9)
  ds_read_b64_tr_b16 v[246:247], v8 offset:0
  ds_read_b64_tr_b16 v[248:249], v8 offset:4096
  v_mfma_f32_16x16x32_bf16 a[160:163], a[32:35], v[104:107], a[160:163]
  buffer_atomic_add v13, v12, s[8:11], s53 offen sc1
  v_mfma_f32_16x16x32_bf16 a[160:163], a[36:39], v[108:111], a[160:163]
  v_rcp_f32 v136, v136
  v_mfma_f32_16x16x32_bf16 a[164:167], a[40:43], v[104:107], a[164:167]
  ds_read_b128 a[32:35], v2 offset:49152
  ds_read_b128 a[36:39], v2 offset:57344
  v_mfma_f32_16x16x32_bf16 a[164:167], a[44:47], v[108:111], a[164:167]
  ds_read_b128 a[40:43], v2 offset:50176
  v_accvgpr_read_b32 v220, a192
  v_mfma_f32_16x16x32_bf16 a[168:171], a[48:51], v[104:107], a[168:171]
  ds_read_b128 a[44:47], v2 offset:58368
  v_accvgpr_read_b32 v221, a193
  v_mfma_f32_16x16x32_bf16 a[168:171], a[52:55], v[108:111], a[168:171]
  ds_read_b128 a[48:51], v2 offset:51200
  v_accvgpr_read_b32 v222, a194
  v_mfma_f32_16x16x32_bf16 a[172:175], a[56:59], v[104:107], a[172:175]
  ds_read_b128 a[52:55], v2 offset:59392
  v_xor_b32 v14, 32, v11
  v_mfma_f32_16x16x32_bf16 a[172:175], a[60:63], v[108:111], a[172:175]
  s_waitcnt lgkmcnt(6)
  buffer_store_dwordx4 v[246:249], v1, s[8:11], s20 offen sc1
  v_mfma_f32_16x16x32_bf16 a[176:179], a[64:67], v[104:107], a[176:179]
  buffer_load_dwordx4 v1, s[12:15], s28 offen offset:1024 sc1 lds
  v_mfma_f32_16x16x32_bf16 a[176:179], a[68:71], v[108:111], a[176:179]
  ds_read_b64_tr_b16 v[250:251], v14 offset:0
  ds_read_b64_tr_b16 v[252:253], v14 offset:4096
  v_mfma_f32_16x16x32_bf16 a[180:183], a[72:75], v[104:107], a[180:183]
  ds_read_b128 a[56:59], v2 offset:52224
  ds_read_b128 a[64:67], v2 offset:53248
  v_mfma_f32_16x16x32_bf16 a[180:183], a[76:79], v[108:111], a[180:183]
  ds_read_b128 a[72:75], v2 offset:54272
  ds_read_b128 a[60:63], v2 offset:60416
  v_mfma_f32_16x16x32_bf16 a[184:187], a[80:83], v[104:107], a[184:187]
  ds_read_b128 a[68:71], v2 offset:61440
  v_accvgpr_read_b32 v223, a195
  v_mfma_f32_16x16x32_bf16 a[184:187], a[84:87], v[108:111], a[184:187]
  ds_read_b128 a[80:83], v2 offset:55296
  v_accvgpr_read_b32 v224, a196
  v_mfma_f32_16x16x32_bf16 a[188:191], a[88:91], v[104:107], a[188:191]
  ds_read_b128 a[76:79], v2 offset:62464
  v_accvgpr_read_b32 v225, a197
  v_mfma_f32_16x16x32_bf16 a[188:191], a[92:95], v[108:111], a[188:191]
  s_waitcnt lgkmcnt(14)
  ds_read_b128 a[88:91], v2 offset:56320
  v_accvgpr_read_b32 v226, a198
  v_mfma_f32_16x16x32_bf16 v[16:19], a[0:3], v[192:195], v[212:215]
  v_xor_b32 v8, 64, v11
  v_mov_b32 v82, 0
  v_mfma_f32_16x16x32_bf16 v[16:19], a[4:7], v[196:199], v[16:19]
  s_waitcnt lgkmcnt(8)
  buffer_store_dwordx4 v[250:253], v1, s[8:11], s21 offen sc1
  v_mfma_f32_16x16x32_bf16 v[16:19], a[8:11], v[200:203], v[16:19]
  ds_read_b128 a[84:87], v2 offset:63488
  v_mov_b32 v83, 0
  v_mfma_f32_16x16x32_bf16 v[16:19], a[12:15], v[204:207], v[16:19]
  ds_read_b64_tr_b16 v[246:247], v8 offset:0
  ds_read_b64_tr_b16 v[248:249], v8 offset:4096
  v_mfma_f32_16x16x32_bf16 v[32:35], a[0:3], v[144:147], v[112:115]
  buffer_load_dwordx4 v1, s[12:15], s28 offen offset:2048 sc1 lds
  v_mfma_f32_16x16x32_bf16 v[32:35], a[4:7], v[148:151], v[32:35]
  ds_read_b128 a[92:95], v2 offset:64512
  v_accvgpr_read_b32 v227, a199
  v_mfma_f32_16x16x32_bf16 v[32:35], a[8:11], v[152:155], v[32:35]
  v_mul_f32 v220, v220, v136
  v_mul_f32 v221, v221, v136
  v_mfma_f32_16x16x32_bf16 v[32:35], a[12:15], v[156:159], v[32:35]
  v_mul_f32 v222, v222, v136
  v_mul_f32 v223, v223, v136
  v_mfma_f32_16x16x32_bf16 v[36:39], a[28:31], v[156:159], v[112:115]
  v_exp_f32 v16, v16
  v_mfma_f32_16x16x32_bf16 v[36:39], a[24:27], v[152:155], v[36:39]
  v_exp_f32 v17, v17
  v_mfma_f32_16x16x32_bf16 v[36:39], a[20:23], v[148:151], v[36:39]
  v_xor_b32 v14, 96, v11
  v_cvt_pk_bf16_f32 v80, v16, v17
  v_mfma_f32_16x16x32_bf16 v[36:39], a[16:19], v[144:147], v[36:39]
  s_waitcnt lgkmcnt(1)
  buffer_store_dwordx4 v[246:249], v1, s[8:11], s22 offen sc1
  v_mfma_f32_16x16x32_bf16 v[40:43], a[128:131], v[144:147], v[112:115]
  v_exp_f32 v18, v18
  v_mfma_f32_16x16x32_bf16 v[40:43], a[132:135], v[148:151], v[40:43]
  ds_read_b64_tr_b16 v[250:251], v14 offset:0
  ds_read_b64_tr_b16 v[252:253], v14 offset:4096
  v_mfma_f32_16x16x32_bf16 v[40:43], a[136:139], v[152:155], v[40:43]
  v_exp_f32 v19, v19
  v_mfma_f32_16x16x32_bf16 v[40:43], a[140:143], v[156:159], v[40:43]
  v_cvt_pk_bf16_f32 v81, v18, v19
  v_mul_f32 v224, v224, v136
  v_mfma_f32_16x16x32_bf16 v[44:47], a[156:159], v[156:159], v[112:115]
  buffer_load_dwordx4 v1, s[12:15], s28 offen offset:3072 sc1 lds
  v_mfma_f32_16x16x32_bf16 v[44:47], a[152:155], v[152:155], v[44:47]
  s_and_b32 m0, s33, 0x1ffff
  v_exp_f32 v32, v32
  v_mfma_f32_16x16x32_bf16 v[44:47], a[148:151], v[148:151], v[44:47]
  v_exp_f32 v33, v33
  v_mfma_f32_16x16x32_bf16 v[44:47], a[144:147], v[144:147], v[44:47]
  v_cvt_pk_bf16_f32 v88, v32, v33
  v_mul_f32 v225, v225, v136
  v_mfma_f32_16x16x32_bf16 v[48:51], a[0:3], v[160:163], v[116:119]
  v_xor_b32 v8, 128, v11
  v_mul_f32 v226, v226, v136
  v_mfma_f32_16x16x32_bf16 v[48:51], a[4:7], v[164:167], v[48:51]
  s_waitcnt lgkmcnt(0)
  buffer_store_dwordx4 v[250:253], v1, s[8:11], s23 offen sc1
  v_mfma_f32_16x16x32_bf16 v[48:51], a[8:11], v[168:171], v[48:51]
  v_exp_f32 v34, v34
  v_mfma_f32_16x16x32_bf16 v[48:51], a[12:15], v[172:175], v[48:51]
  ds_read_b64_tr_b16 v[246:247], v8 offset:0
  ds_read_b64_tr_b16 v[248:249], v8 offset:4096
  v_mfma_f32_16x16x32_bf16 v[52:55], a[28:31], v[172:175], v[116:119]
  v_exp_f32 v35, v35
  v_mfma_f32_16x16x32_bf16 v[52:55], a[24:27], v[168:171], v[52:55]
  ds_read_b128 a[0:3], v3 offset:0
  v_cvt_pk_bf16_f32 v89, v34, v35
  v_mfma_f32_16x16x32_bf16 v[52:55], a[20:23], v[164:167], v[52:55]
  v_exp_f32 v36, v36
  v_mfma_f32_16x16x32_bf16 v[52:55], a[16:19], v[160:163], v[52:55]
  v_exp_f32 v37, v37
  v_mfma_f32_16x16x32_bf16 v[56:59], a[128:131], v[160:163], v[116:119]
  buffer_load_dwordx4 v1, s[12:15], s33 offen offset:0 sc1 lds
  v_mfma_f32_16x16x32_bf16 v[56:59], a[132:135], v[164:167], v[56:59]
  ds_read_b128 a[4:7], v3 offset:1024
  v_cvt_pk_bf16_f32 v90, v36, v37
  v_mfma_f32_16x16x32_bf16 v[56:59], a[136:139], v[168:171], v[56:59]
  ds_read_b128 a[8:11], v3 offset:2048
  v_xor_b32 v14, 160, v11
  v_mfma_f32_16x16x32_bf16 v[56:59], a[140:143], v[172:175], v[56:59]
  s_waitcnt lgkmcnt(3)
  buffer_store_dwordx4 v[246:249], v1, s[8:11], s24 offen sc1
  v_mfma_f32_16x16x32_bf16 v[60:63], a[156:159], v[172:175], v[116:119]
  v_exp_f32 v38, v38
  v_mfma_f32_16x16x32_bf16 v[60:63], a[152:155], v[168:171], v[60:63]
  ds_read_b64_tr_b16 v[250:251], v14 offset:0
  ds_read_b64_tr_b16 v[252:253], v14 offset:4096
  v_mfma_f32_16x16x32_bf16 v[60:63], a[148:151], v[164:167], v[60:63]
  v_exp_f32 v39, v39
  v_mfma_f32_16x16x32_bf16 v[60:63], a[144:147], v[160:163], v[60:63]
  ds_read_b128 a[12:15], v3 offset:3072
  v_cvt_pk_bf16_f32 v91, v38, v39
  v_mfma_f32_16x16x32_bf16 v[140:143], v[216:219], v[80:83], v[140:143]
  v_exp_f32 v40, v40
  v_mfma_f32_16x16x32_bf16 a[224:227], a[32:35], v[80:83], a[224:227]
  v_exp_f32 v41, v41
  v_mfma_f32_16x16x32_bf16 a[228:231], a[40:43], v[80:83], a[228:231]
  ds_read_b128 a[16:19], v3 offset:4096
  v_cvt_pk_bf16_f32 v92, v40, v41
  v_mfma_f32_16x16x32_bf16 a[232:235], a[48:51], v[80:83], a[232:235]
  v_exp_f32 v42, v42
  v_mfma_f32_16x16x32_bf16 a[236:239], a[56:59], v[80:83], a[236:239]
  ds_read_b128 a[20:23], v3 offset:5120
  v_xor_b32 v8, 192, v11
  v_mfma_f32_16x16x32_bf16 a[240:243], a[64:67], v[80:83], a[240:243]
  buffer_load_dwordx4 v1, s[12:15], s33 offen offset:1024 sc1 lds
  v_mfma_f32_16x16x32_bf16 a[244:247], a[72:75], v[80:83], a[244:247]
  v_exp_f32 v43, v43
  v_mfma_f32_16x16x32_bf16 a[248:251], a[80:83], v[80:83], a[248:251]
  v_exp_f32 v44, v44
  v_exp_f32 v45, v45
  v_exp_f32 v46, v46
  v_exp_f32 v47, v47
  v_mfma_f32_16x16x32_bf16 a[252:255], a[88:91], v[80:83], a[252:255]
  s_waitcnt lgkmcnt(3)
  buffer_store_dwordx4 v[250:253], v1, s[8:11], s25 offen sc1
  v_cvt_pk_bf16_f32 v93, v42, v43
  v_cvt_pk_bf16_f32 v94, v44, v45
  v_cvt_pk_bf16_f32 v95, v46, v47
  v_mfma_f32_16x16x32_bf16 v[128:131], v[216:219], v[88:91], v[128:131]
  ds_read_b64_tr_b16 v[246:247], v8 offset:0
  ds_read_b64_tr_b16 v[248:249], v8 offset:4096
  v_mfma_f32_16x16x32_bf16 v[128:131], v[216:219], v[92:95], v[128:131]
  v_exp_f32 v48, v48
  v_mfma_f32_16x16x32_bf16 a[96:99], a[32:35], v[88:91], a[96:99]
  v_exp_f32 v49, v49
  v_mfma_f32_16x16x32_bf16 a[96:99], a[36:39], v[92:95], a[96:99]
  ds_read_b128 a[24:27], v3 offset:6144
  v_cvt_pk_bf16_f32 v96, v48, v49
  v_mfma_f32_16x16x32_bf16 a[100:103], a[40:43], v[88:91], a[100:103]
  v_exp_f32 v50, v50
  v_mfma_f32_16x16x32_bf16 a[100:103], a[44:47], v[92:95], a[100:103]
  ds_read_b128 a[28:31], v3 offset:7168
  v_xor_b32 v14, 224, v11
  v_mfma_f32_16x16x32_bf16 a[104:107], a[48:51], v[88:91], a[104:107]
  s_waitcnt lgkmcnt(2)
  buffer_store_dwordx4 v[246:249], v1, s[8:11], s26 offen sc1
  v_mfma_f32_16x16x32_bf16 a[104:107], a[52:55], v[92:95], a[104:107]
  buffer_load_dwordx4 v1, s[12:15], s33 offen offset:2048 sc1 lds
  v_mfma_f32_16x16x32_bf16 a[108:111], a[56:59], v[88:91], a[108:111]
  ds_read_b64_tr_b16 v[250:251], v14 offset:0
  ds_read_b64_tr_b16 v[252:253], v14 offset:4096
  v_mfma_f32_16x16x32_bf16 a[108:111], a[60:63], v[92:95], a[108:111]
  v_exp_f32 v51, v51
  v_mfma_f32_16x16x32_bf16 a[112:115], a[64:67], v[88:91], a[112:115]
  ds_read_b128 a[128:131], v3 offset:8192
  v_cvt_pk_bf16_f32 v97, v50, v51
  v_mfma_f32_16x16x32_bf16 a[112:115], a[68:71], v[92:95], a[112:115]
  v_exp_f32 v52, v52
  v_mfma_f32_16x16x32_bf16 a[116:119], a[72:75], v[88:91], a[116:119]
  v_exp_f32 v53, v53
  v_mfma_f32_16x16x32_bf16 a[116:119], a[76:79], v[92:95], a[116:119]
  ds_read_b128 a[132:135], v3 offset:9216
  v_cvt_pk_bf16_f32 v98, v52, v53
  v_mfma_f32_16x16x32_bf16 a[120:123], a[80:83], v[88:91], a[120:123]
  v_exp_f32 v54, v54
  v_mfma_f32_16x16x32_bf16 a[120:123], a[84:87], v[92:95], a[120:123]
  v_exp_f32 v55, v55
  v_mfma_f32_16x16x32_bf16 a[124:127], a[88:91], v[88:91], a[124:127]
  v_cvt_pk_bf16_f32 v99, v54, v55
  v_exp_f32 v56, v56
  v_exp_f32 v57, v57
  v_exp_f32 v58, v58
  v_exp_f32 v59, v59
  v_exp_f32 v60, v60
  v_exp_f32 v61, v61
  v_exp_f32 v62, v62
  v_exp_f32 v63, v63
  v_mfma_f32_16x16x32_bf16 a[124:127], a[92:95], v[92:95], a[124:127]
  v_cvt_pk_bf16_f32 v100, v56, v57
  v_cvt_pk_bf16_f32 v101, v58, v59
  v_cvt_pk_bf16_f32 v102, v60, v61
  v_cvt_pk_bf16_f32 v103, v62, v63
  v_mfma_f32_16x16x32_bf16 v[132:135], v[216:219], v[96:99], v[132:135]
  s_waitcnt lgkmcnt(2)
  buffer_store_dwordx4 v[250:253], v1, s[8:11], s27 offen sc1
  v_mfma_f32_16x16x32_bf16 v[132:135], v[216:219], v[100:103], v[132:135]
  buffer_load_dwordx4 v1, s[12:15], s33 offen offset:3072 sc1 lds
  v_mfma_f32_16x16x32_bf16 a[160:163], a[32:35], v[96:99], a[160:163]
  s_mov_b32 s32, s33
  ds_read_b128 a[136:139], v3 offset:10240
  ds_read_b128 a[140:143], v3 offset:11264
  v_mfma_f32_16x16x32_bf16 a[160:163], a[36:39], v[100:103], a[160:163]
  s_add_u32 s33, s33, s36
  v_mul_f32 v227, v227, v136
  v_cvt_pk_bf16_f32 v228, v220, v221
  v_mfma_f32_16x16x32_bf16 a[164:167], a[40:43], v[96:99], a[164:167]
  s_xor_b32 s36, s36, 0x8000
  v_cvt_pk_bf16_f32 v229, v222, v223
  v_cvt_pk_bf16_f32 v230, v224, v225
  v_mfma_f32_16x16x32_bf16 a[164:167], a[44:47], v[100:103], a[164:167]
  ds_read_b128 a[144:147], v3 offset:12288
  v_cvt_pk_bf16_f32 v231, v226, v227
  v_mfma_f32_16x16x32_bf16 a[168:171], a[48:51], v[96:99], a[168:171]
  ds_read_b128 a[148:151], v3 offset:13312
  ds_read_b128 a[152:155], v3 offset:14336
  v_mfma_f32_16x16x32_bf16 a[168:171], a[52:55], v[100:103], a[168:171]
  s_add_u32 s30, s50, s54
  buffer_store_dwordx4 v[228:231], v1, s[8:11], s30 offen offset:0 sc1
  v_mfma_f32_16x16x32_bf16 a[172:175], a[56:59], v[96:99], a[172:175]
  v_accvgpr_read_b32 v232, a200
  v_accvgpr_read_b32 v233, a201
  v_mfma_f32_16x16x32_bf16 a[172:175], a[60:63], v[100:103], a[172:175]
  v_accvgpr_read_b32 v234, a202
  v_accvgpr_read_b32 v235, a203
  v_mfma_f32_16x16x32_bf16 a[176:179], a[64:67], v[96:99], a[176:179]
  v_accvgpr_read_b32 v236, a204
  v_accvgpr_read_b32 v237, a205
  v_mfma_f32_16x16x32_bf16 a[176:179], a[68:71], v[100:103], a[176:179]
  v_accvgpr_read_b32 v238, a206
  v_accvgpr_read_b32 v239, a207
  v_mfma_f32_16x16x32_bf16 a[180:183], a[72:75], v[96:99], a[180:183]
  ds_read_b128 a[156:159], v3 offset:15360
  v_mul_f32 v232, v232, v136
  v_mfma_f32_16x16x32_bf16 a[180:183], a[76:79], v[100:103], a[180:183]
  v_mul_f32 v233, v233, v136
  v_mul_f32 v234, v234, v136
  v_mfma_f32_16x16x32_bf16 a[184:187], a[80:83], v[96:99], a[184:187]
  v_mul_f32 v235, v235, v136
  v_mul_f32 v236, v236, v136
  v_mfma_f32_16x16x32_bf16 a[184:187], a[84:87], v[100:103], a[184:187]
  v_mov_b32 v2, v3
  v_mul_f32 v237, v237, v136
  v_mfma_f32_16x16x32_bf16 a[188:191], a[88:91], v[96:99], a[188:191]
  v_mul_f32 v238, v238, v136
  v_mul_f32 v239, v239, v136
  v_mfma_f32_16x16x32_bf16 a[188:191], a[92:95], v[100:103], a[188:191]
  v_cvt_pk_bf16_f32 v240, v232, v233
  v_cvt_pk_bf16_f32 v241, v234, v235
  v_cvt_pk_bf16_f32 v242, v236, v237
  v_cvt_pk_bf16_f32 v243, v238, v239
  buffer_store_dwordx4 v[240:243], v1, s[8:11], s30 offen offset:1024 sc1
  v_accvgpr_read_b32 v220, a208
  v_accvgpr_read_b32 v221, a209
  v_accvgpr_read_b32 v222, a210
  v_accvgpr_read_b32 v223, a211
  v_accvgpr_read_b32 v224, a212
  v_accvgpr_read_b32 v225, a213
  v_accvgpr_read_b32 v226, a214
  v_accvgpr_read_b32 v227, a215
  v_mul_f32 v220, v220, v136
  v_mul_f32 v221, v221, v136
  v_mul_f32 v222, v222, v136
  v_mul_f32 v223, v223, v136
  v_mul_f32 v224, v224, v136
  v_mul_f32 v225, v225, v136
  v_mul_f32 v226, v226, v136
  v_mul_f32 v227, v227, v136
  v_cvt_pk_bf16_f32 v228, v220, v221
  v_cvt_pk_bf16_f32 v229, v222, v223
  v_cvt_pk_bf16_f32 v230, v224, v225
  v_cvt_pk_bf16_f32 v231, v226, v227
  buffer_store_dwordx4 v[228:231], v1, s[8:11], s30 offen offset:2048 sc1
  v_accvgpr_read_b32 v232, a216
  v_accvgpr_read_b32 v233, a217
  v_accvgpr_read_b32 v234, a218
  v_accvgpr_read_b32 v235, a219
  v_accvgpr_read_b32 v236, a220
  v_accvgpr_read_b32 v237, a221
  v_accvgpr_read_b32 v238, a222
  v_accvgpr_read_b32 v239, a223
  v_mul_f32 v232, v232, v136
  v_mul_f32 v233, v233, v136
  v_mul_f32 v234, v234, v136
  v_mul_f32 v235, v235, v136
  v_mul_f32 v236, v236, v136
  v_mul_f32 v237, v237, v136
  v_mul_f32 v238, v238, v136
  v_mul_f32 v239, v239, v136
  v_cvt_pk_bf16_f32 v240, v232, v233
  v_cvt_pk_bf16_f32 v241, v234, v235
  v_cvt_pk_bf16_f32 v242, v236, v237
  v_cvt_pk_bf16_f32 v243, v238, v239
  buffer_store_dwordx4 v[240:243], v1, s[8:11], s30 offen offset:3072 sc1
  v_cmp_nlt_f32 vcc, 0x21800000, v140
  s_nop 0
  s_or_b64 s[62:63], s[62:63], vcc
  v_cmp_ngt_f32 vcc, v4, v140
  s_nop 0
  s_or_b64 s[62:63], s[62:63], vcc
  v_rcp_f32 v140, v140
  v_accvgpr_read_b32 v220, a224
  v_accvgpr_read_b32 v221, a225
  v_accvgpr_read_b32 v222, a226
  v_accvgpr_read_b32 v223, a227
  v_accvgpr_read_b32 v224, a228
  v_accvgpr_read_b32 v225, a229
  v_accvgpr_read_b32 v226, a230
  v_accvgpr_read_b32 v227, a231
  v_mul_f32 v220, v220, v140
  v_mul_f32 v221, v221, v140
  v_mul_f32 v222, v222, v140
  v_mul_f32 v223, v223, v140
  v_mul_f32 v224, v224, v140
  v_mul_f32 v225, v225, v140
  v_mul_f32 v226, v226, v140
  v_mul_f32 v227, v227, v140
  v_cvt_pk_bf16_f32 v228, v220, v221
  v_cvt_pk_bf16_f32 v229, v222, v223
  v_cvt_pk_bf16_f32 v230, v224, v225
  v_cvt_pk_bf16_f32 v231, v226, v227
  s_add_u32 s30, s51, s54
  buffer_store_dwordx4 v[228:231], v1, s[8:11], s30 offen offset:0 sc1
  v_accvgpr_read_b32 v232, a232
  v_accvgpr_read_b32 v233, a233
  v_accvgpr_read_b32 v234, a234
  v_accvgpr_read_b32 v235, a235
  v_accvgpr_read_b32 v236, a236
  v_accvgpr_read_b32 v237, a237
  v_accvgpr_read_b32 v238, a238
  v_accvgpr_read_b32 v239, a239
  v_mul_f32 v232, v232, v140
  v_mul_f32 v233, v233, v140
  v_mul_f32 v234, v234, v140
  v_mul_f32 v235, v235, v140
  v_mul_f32 v236, v236, v140
  v_mul_f32 v237, v237, v140
  v_mul_f32 v238, v238, v140
  v_mul_f32 v239, v239, v140
  v_cvt_pk_bf16_f32 v240, v232, v233
  v_cvt_pk_bf16_f32 v241, v234, v235
  v_cvt_pk_bf16_f32 v242, v236, v237
  v_cvt_pk_bf16_f32 v243, v238, v239
  buffer_store_dwordx4 v[240:243], v1, s[8:11], s30 offen offset:1024 sc1
  v_accvgpr_read_b32 v220, a240
  v_accvgpr_read_b32 v221, a241
  v_accvgpr_read_b32 v222, a242
  v_accvgpr_read_b32 v223, a243
  v_accvgpr_read_b32 v224, a244
  v_accvgpr_read_b32 v225, a245
  v_accvgpr_read_b32 v226, a246
  v_accvgpr_read_b32 v227, a247
  v_mul_f32 v220, v220, v140
  v_mul_f32 v221, v221, v140
  v_mul_f32 v222, v222, v140
  v_mul_f32 v223, v223, v140
  v_mul_f32 v224, v224, v140
  v_mul_f32 v225, v225, v140
  v_mul_f32 v226, v226, v140
  v_mul_f32 v227, v227, v140
  v_cvt_pk_bf16_f32 v228, v220, v221
  v_cvt_pk_bf16_f32 v229, v222, v223
  v_cvt_pk_bf16_f32 v230, v224, v225
  v_cvt_pk_bf16_f32 v231, v226, v227
  buffer_store_dwordx4 v[228:231], v1, s[8:11], s30 offen offset:2048 sc1
  v_accvgpr_read_b32 v232, a248
  v_accvgpr_read_b32 v233, a249
  v_accvgpr_read_b32 v234, a250
  v_accvgpr_read_b32 v235, a251
  v_accvgpr_read_b32 v236, a252
  v_accvgpr_read_b32 v237, a253
  v_accvgpr_read_b32 v238, a254
  v_accvgpr_read_b32 v239, a255
  v_mul_f32 v232, v232, v140
  v_mul_f32 v233, v233, v140
  v_mul_f32 v234, v234, v140
  v_mul_f32 v235, v235, v140
  v_mul_f32 v236, v236, v140
  v_mul_f32 v237, v237, v140
  v_mul_f32 v238, v238, v140
  v_mul_f32 v239, v239, v140
  v_cvt_pk_bf16_f32 v240, v232, v233
  v_cvt_pk_bf16_f32 v241, v234, v235
  v_cvt_pk_bf16_f32 v242, v236, v237
  v_cvt_pk_bf16_f32 v243, v238, v239
  buffer_store_dwordx4 v[240:243], v1, s[8:11], s30 offen offset:3072 sc1
L_att_dd:
  s_add_u32 s16, s8, s45
  s_addc_u32 s17, s9, 0
  s_mov_b32 s18, 471040
  s_waitcnt lgkmcnt(0)
  v_lshrrev_b32 v14, 4, v1
  v_add_u32 v7, 0, v14
  v_mul_u32_u24 v8, 0xcd, v7
  v_lshrrev_b32 v8, 11, v8
  v_mul_u32_u24 v8, 1120, v8
  v_lshl_add_u32 v7, v7, 4, v8
  s_add_u32 m0, s31, 0
  s_nop 0
  buffer_load_dwordx4 v7, s[84:87], s60 offen lds
  v_add_u32 v7, 64, v14
  v_mul_u32_u24 v8, 0xcd, v7
  v_lshrrev_b32 v8, 11, v8
  v_mul_u32_u24 v8, 1120, v8
  v_lshl_add_u32 v7, v7, 4, v8
  s_add_u32 m0, s31, 1024
  s_nop 0
  buffer_load_dwordx4 v7, s[84:87], s60 offen lds
  v_add_u32 v7, 128, v14
  v_mul_u32_u24 v8, 0xcd, v7
  v_lshrrev_b32 v8, 11, v8
  v_mul_u32_u24 v8, 1120, v8
  v_lshl_add_u32 v7, v7, 4, v8
  v_cmp_gt_u32 vcc, 32, v14
  v_mov_b32 v8, 2.0
  s_nop 0
  v_cndmask_b32 v7, v8, v7, vcc
  s_add_u32 m0, s31, 2048
  s_nop 0
  buffer_load_dwordx4 v7, s[84:87], s60 offen lds
  s_lshr_b32 s28, s2, 3
  s_lshl_b32 s28, s28, 2
  s_add_u32 s28, s28, s3
  s_and_b32 s28, s28, 63
  s_mul_i32 s28, s28, 384
  v_and_b32 v7, 3, v0
  v_min_u32 v7, 2, v7
  v_lshlrev_b32 v7, 7, v7
  v_add_u32 v7, s28, v7
  s_getpc_b64 s[28:29]
L_ct_b:
  v_min_u32 v7, L_end-L_att_e, v7
  v_add_u32 v7, L_att_e-L_ct_b, v7
  global_load_dword v10, v7, s[28:29]
  v_mov_b32 v220, 0xf149f2ca
  v_cndmask_b32 v208, v220, v112, s[88:89]
  v_cndmask_b32 v209, v220, v112, s[90:91]
  v_cndmask_b32 v210, v220, v112, s[92:93]
  v_cndmask_b32 v211, v220, v112, s[94:95]
  v_cndmask_b32 v212, v220, v116, s[88:89]
  v_cndmask_b32 v213, v220, v116, s[90:91]
  v_cndmask_b32 v214, v220, v116, s[92:93]
  v_cndmask_b32 v215, v220, v116, s[94:95]
  s_lshl_b32 s35, s5, 1
  s_sub_u32 s35, 14, s35
  s_sub_u32 s53, s35, 1
  s_cmp_lt_u32 s5, 5
  s_cselect_b32 s53, s53, -1
  s_cmp_eq_u32 s35, 0
  s_cbranch_scc1 L_att_z
  s_branch L_att_single
L_s5:
  buffer_atomic_add v13, v12, s[8:11], s97 offen sc1
  s_branch L_s5b
.p2align 3
L_att_single:
  s_waitcnt lgkmcnt(15)
  v_mfma_f32_16x16x32_bf16 v[16:19], a[0:3], v[144:147], v[112:115]
  s_waitcnt vmcnt(16) lgkmcnt(0)
  v_xor_b32 v3, 0x10000, v2
  v_mfma_f32_16x16x32_bf16 v[16:19], a[4:7], v[148:151], v[16:19]
  s_barrier
  ds_read_b128 a[32:35], v2 offset:16384
  ds_read_b128 a[36:39], v2 offset:17408
  v_mfma_f32_16x16x32_bf16 v[16:19], a[8:11], v[152:155], v[16:19]
  s_add_u32 s28, s32, 0x8000
  s_and_b32 m0, s28, 0x1ffff
  ds_read_b128 a[40:43], v2 offset:18432
  v_mfma_f32_16x16x32_bf16 v[16:19], a[12:15], v[156:159], v[16:19]
  s_cmp_eq_u32 s35, s53
  s_cbranch_scc1 L_s5
L_s5b:
  ds_read_b128 a[44:47], v2 offset:19456
  v_mfma_f32_16x16x32_bf16 v[20:23], a[28:31], v[156:159], v[112:115]
  buffer_load_dwordx4 v1, s[12:15], s28 offen offset:0 sc1 lds
  v_mfma_f32_16x16x32_bf16 v[20:23], a[24:27], v[152:155], v[20:23]
  ds_read_b128 a[60:63], v2 offset:23552
  ds_read_b128 a[56:59], v2 offset:22528
  v_mfma_f32_16x16x32_bf16 v[20:23], a[20:23], v[148:151], v[20:23]
  ds_read_b128 a[52:55], v2 offset:21504
  ds_read_b128 a[48:51], v2 offset:20480
  v_mfma_f32_16x16x32_bf16 v[20:23], a[16:19], v[144:147], v[20:23]
  ds_read_b128 a[64:67], v2 offset:24576
  v_mfma_f32_16x16x32_bf16 v[24:27], a[128:131], v[144:147], v[112:115]
  v_exp_f32 v16, v16
  v_mfma_f32_16x16x32_bf16 v[24:27], a[132:135], v[148:151], v[24:27]
  ds_read_b128 a[68:71], v2 offset:25600
  ds_read_b128 a[72:75], v2 offset:26624
  v_mfma_f32_16x16x32_bf16 v[24:27], a[136:139], v[152:155], v[24:27]
  v_exp_f32 v17, v17
  v_mfma_f32_16x16x32_bf16 v[24:27], a[140:143], v[156:159], v[24:27]
  buffer_load_dwordx4 v1, s[12:15], s28 offen offset:1024 sc1 lds
  v_mfma_f32_16x16x32_bf16 v[28:31], a[156:159], v[156:159], v[112:115]
  ds_read_b128 a[76:79], v2 offset:27648
  ds_read_b128 a[92:95], v2 offset:31744
  v_mfma_f32_16x16x32_bf16 v[28:31], a[152:155], v[152:155], v[28:31]
  ds_read_b128 a[88:91], v2 offset:30720
  ds_read_b128 a[84:87], v2 offset:29696
  v_mfma_f32_16x16x32_bf16 v[28:31], a[148:151], v[148:151], v[28:31]
  s_waitcnt lgkmcnt(14)
  ds_read_b128 a[80:83], v2 offset:28672
  v_cvt_pk_bf16_f32 v80, v16, v17
  v_mfma_f32_16x16x32_bf16 v[28:31], a[144:147], v[144:147], v[28:31]
  v_exp_f32 v18, v18
  v_mfma_f32_16x16x32_bf16 v[32:35], a[0:3], v[160:163], v[116:119]
  v_exp_f32 v19, v19
  v_mfma_f32_16x16x32_bf16 v[32:35], a[4:7], v[164:167], v[32:35]
  s_waitcnt lgkmcnt(14)
  ds_read_b128 a[0:3], v2 offset:32768
  v_cvt_pk_bf16_f32 v81, v18, v19
  v_mfma_f32_16x16x32_bf16 v[32:35], a[8:11], v[168:171], v[32:35]
  buffer_load_dwordx4 v1, s[12:15], s28 offen offset:2048 sc1 lds
  v_mfma_f32_16x16x32_bf16 v[32:35], a[12:15], v[172:175], v[32:35]
  s_waitcnt lgkmcnt(14)
  ds_read_b128 a[4:7], v2 offset:40960
  s_waitcnt lgkmcnt(14)
  ds_read_b128 a[8:11], v2 offset:33792
  v_mfma_f32_16x16x32_bf16 v[36:39], a[28:31], v[172:175], v[116:119]
  v_exp_f32 v20, v20
  v_mfma_f32_16x16x32_bf16 v[36:39], a[24:27], v[168:171], v[36:39]
  s_waitcnt lgkmcnt(14)
  ds_read_b128 a[12:15], v2 offset:41984
  s_waitcnt lgkmcnt(14)
  ds_read_b128 a[28:31], v2 offset:44032
  v_mfma_f32_16x16x32_bf16 v[36:39], a[20:23], v[164:167], v[36:39]
  v_exp_f32 v21, v21
  v_mfma_f32_16x16x32_bf16 v[36:39], a[16:19], v[160:163], v[36:39]
  v_exp_f32 v22, v22
  v_mfma_f32_16x16x32_bf16 v[40:43], a[128:131], v[160:163], v[116:119]
  v_exp_f32 v23, v23
  v_mfma_f32_16x16x32_bf16 v[40:43], a[132:135], v[164:167], v[40:43]
  buffer_load_dwordx4 v1, s[12:15], s28 offen offset:3072 sc1 lds
  v_mfma_f32_16x16x32_bf16 v[40:43], a[136:139], v[168:171], v[40:43]
  s_and_b32 m0, s33, 0x1ffff
  s_waitcnt lgkmcnt(14)
  ds_read_b128 a[16:19], v2 offset:34816
  v_cvt_pk_bf16_f32 v82, v20, v21
  v_mfma_f32_16x16x32_bf16 v[40:43], a[140:143], v[172:175], v[40:43]
  s_waitcnt lgkmcnt(14)
  ds_read_b128 a[20:23], v2 offset:43008
  v_cvt_pk_bf16_f32 v83, v22, v23
  v_mfma_f32_16x16x32_bf16 v[44:47], a[156:159], v[172:175], v[116:119]
  v_exp_f32 v24, v24
  v_mfma_f32_16x16x32_bf16 v[44:47], a[152:155], v[168:171], v[44:47]
  v_exp_f32 v25, v25
  v_mfma_f32_16x16x32_bf16 v[44:47], a[148:151], v[164:167], v[44:47]
  v_exp_f32 v26, v26
  v_mfma_f32_16x16x32_bf16 v[44:47], a[144:147], v[160:163], v[44:47]
  s_waitcnt lgkmcnt(15)
  v_exp_f32 v27, v27
  v_mfma_f32_16x16x32_bf16 v[48:51], a[32:35], v[144:147], v[112:115]
  buffer_load_dwordx4 v1, s[12:15], s33 offen offset:0 sc1 lds
  v_mfma_f32_16x16x32_bf16 v[48:51], a[36:39], v[148:151], v[48:51]
  v_exp_f32 v28, v28
  v_mfma_f32_16x16x32_bf16 v[48:51], a[40:43], v[152:155], v[48:51]
  v_exp_f32 v29, v29
  v_mfma_f32_16x16x32_bf16 v[48:51], a[44:47], v[156:159], v[48:51]
  v_exp_f32 v30, v30
  v_mfma_f32_16x16x32_bf16 v[52:55], a[60:63], v[156:159], v[112:115]
  v_exp_f32 v31, v31
  v_mfma_f32_16x16x32_bf16 v[52:55], a[56:59], v[152:155], v[52:55]
  v_cvt_pk_bf16_f32 v84, v24, v25
  v_cvt_pk_bf16_f32 v85, v26, v27
  v_mfma_f32_16x16x32_bf16 v[52:55], a[52:55], v[148:151], v[52:55]
  v_cvt_pk_bf16_f32 v86, v28, v29
  v_cvt_pk_bf16_f32 v87, v30, v31
  v_mfma_f32_16x16x32_bf16 v[52:55], a[48:51], v[144:147], v[52:55]
  s_waitcnt lgkmcnt(14)
  buffer_load_dwordx4 v1, s[12:15], s33 offen offset:1024 sc1 lds
  v_mfma_f32_16x16x32_bf16 v[56:59], a[64:67], v[144:147], v[112:115]
  s_waitcnt lgkmcnt(13)
  ds_read_b128 a[24:27], v2 offset:35840
  ds_read_b128 a[128:131], v2 offset:36864
  v_mfma_f32_16x16x32_bf16 v[56:59], a[68:71], v[148:151], v[56:59]
  s_waitcnt lgkmcnt(14)
  ds_read_b128 a[132:135], v2 offset:45056
  s_waitcnt lgkmcnt(14)
  ds_read_b128 a[140:143], v2 offset:46080
  v_mfma_f32_16x16x32_bf16 v[56:59], a[72:75], v[152:155], v[56:59]
  s_waitcnt lgkmcnt(15)
  v_exp_f32 v32, v32
  v_mfma_f32_16x16x32_bf16 v[56:59], a[76:79], v[156:159], v[56:59]
  s_waitcnt lgkmcnt(14)
  ds_read_b128 a[136:139], v2 offset:37888
  s_waitcnt lgkmcnt(14)
  ds_read_b128 a[144:147], v2 offset:38912
  v_mfma_f32_16x16x32_bf16 v[60:63], a[92:95], v[156:159], v[112:115]
  s_waitcnt lgkmcnt(15)
  v_exp_f32 v33, v33
  v_mfma_f32_16x16x32_bf16 v[60:63], a[88:91], v[152:155], v[60:63]
  s_waitcnt lgkmcnt(14)
  ds_read_b128 a[148:151], v2 offset:47104
  s_waitcnt lgkmcnt(14)
  ds_read_b128 a[156:159], v2 offset:48128
  v_mfma_f32_16x16x32_bf16 v[60:63], a[84:87], v[148:151], v[60:63]
  s_waitcnt lgkmcnt(15)
  buffer_load_dwordx4 v1, s[12:15], s33 offen offset:2048 sc1 lds
  v_mfma_f32_16x16x32_bf16 v[60:63], a[80:83], v[144:147], v[60:63]
  s_waitcnt lgkmcnt(14)
  ds_read_b128 a[152:155], v2 offset:39936
  v_cvt_pk_bf16_f32 v88, v32, v33
  v_mfma_f32_16x16x32_bf16 v[64:67], a[32:35], v[160:163], v[116:119]
  v_exp_f32 v34, v34
  v_mfma_f32_16x16x32_bf16 v[64:67], a[36:39], v[164:167], v[64:67]
  v_exp_f32 v35, v35
  v_mfma_f32_16x16x32_bf16 v[64:67], a[40:43], v[168:171], v[64:67]
  v_exp_f32 v36, v36
  v_mfma_f32_16x16x32_bf16 v[64:67], a[44:47], v[172:175], v[64:67]
  v_exp_f32 v37, v37
  v_mfma_f32_16x16x32_bf16 v[68:71], a[60:63], v[172:175], v[116:119]
  v_exp_f32 v38, v38
  v_mfma_f32_16x16x32_bf16 v[68:71], a[56:59], v[168:171], v[68:71]
  buffer_load_dwordx4 v1, s[12:15], s33 offen offset:3072 sc1 lds
  v_mfma_f32_16x16x32_bf16 v[68:71], a[52:55], v[164:167], v[68:71]
  s_mov_b32 s32, s33
  s_add_u32 s33, s33, s36
  s_xor_b32 s36, s36, 0x8000
  v_mfma_f32_16x16x32_bf16 v[68:71], a[48:51], v[160:163], v[68:71]
  v_exp_f32 v39, v39
  v_mfma_f32_16x16x32_bf16 v[72:75], a[64:67], v[160:163], v[116:119]
  v_cvt_pk_bf16_f32 v89, v34, v35
  v_cvt_pk_bf16_f32 v90, v36, v37
  v_mfma_f32_16x16x32_bf16 v[72:75], a[68:71], v[164:167], v[72:75]
  v_exp_f32 v40, v40
  v_mfma_f32_16x16x32_bf16 v[72:75], a[72:75], v[168:171], v[72:75]
  v_exp_f32 v41, v41
  v_mfma_f32_16x16x32_bf16 v[72:75], a[76:79], v[172:175], v[72:75]
  v_cvt_pk_bf16_f32 v91, v38, v39
  v_cvt_pk_bf16_f32 v92, v40, v41
  v_mfma_f32_16x16x32_bf16 v[76:79], a[92:95], v[172:175], v[116:119]
  v_exp_f32 v42, v42
  v_mfma_f32_16x16x32_bf16 v[76:79], a[88:91], v[168:171], v[76:79]
  v_exp_f32 v43, v43
  v_mfma_f32_16x16x32_bf16 v[76:79], a[84:87], v[164:167], v[76:79]
  v_exp_f32 v44, v44
  v_mfma_f32_16x16x32_bf16 v[76:79], a[80:83], v[160:163], v[76:79]
  s_waitcnt vmcnt(16) lgkmcnt(0)
  v_exp_f32 v45, v45
  v_mfma_f32_16x16x32_bf16 a[96:99], a[0:3], v[80:83], a[96:99]
  s_barrier
  v_exp_f32 v46, v46
  v_mfma_f32_16x16x32_bf16 a[96:99], a[4:7], v[84:87], a[96:99]
  s_add_u32 s28, s32, 0x8000
  s_and_b32 m0, s28, 0x1ffff
  v_cvt_pk_bf16_f32 v93, v42, v43
  v_mfma_f32_16x16x32_bf16 a[100:103], a[12:15], v[84:87], a[100:103]
  v_exp_f32 v47, v47
  v_mfma_f32_16x16x32_bf16 a[100:103], a[8:11], v[80:83], a[100:103]
  buffer_load_dwordx4 v1, s[12:15], s28 offen offset:0 sc1 lds
  v_mfma_f32_16x16x32_bf16 a[104:107], a[16:19], v[80:83], a[104:107]
  v_cvt_pk_bf16_f32 v94, v44, v45
  v_cvt_pk_bf16_f32 v95, v46, v47
  v_mfma_f32_16x16x32_bf16 a[104:107], a[20:23], v[84:87], a[104:107]
  ds_read_b128 a[32:35], v2 offset:49152
  ds_read_b128 a[36:39], v2 offset:57344
  v_mfma_f32_16x16x32_bf16 a[108:111], a[28:31], v[84:87], a[108:111]
  ds_read_b128 a[44:47], v2 offset:58368
  ds_read_b128 a[40:43], v2 offset:50176
  v_mfma_f32_16x16x32_bf16 a[108:111], a[24:27], v[80:83], a[108:111]
  v_exp_f32 v48, v48
  v_mfma_f32_16x16x32_bf16 a[112:115], a[128:131], v[80:83], a[112:115]
  v_exp_f32 v49, v49
  v_mfma_f32_16x16x32_bf16 a[112:115], a[132:135], v[84:87], a[112:115]
  v_exp_f32 v50, v50
  v_mfma_f32_16x16x32_bf16 a[116:119], a[140:143], v[84:87], a[116:119]
  v_exp_f32 v51, v51
  v_mfma_f32_16x16x32_bf16 a[116:119], a[136:139], v[80:83], a[116:119]
  buffer_load_dwordx4 v1, s[12:15], s28 offen offset:1024 sc1 lds
  v_mfma_f32_16x16x32_bf16 a[120:123], a[144:147], v[80:83], a[120:123]
  v_exp_f32 v52, v52
  v_mfma_f32_16x16x32_bf16 a[120:123], a[148:151], v[84:87], a[120:123]
  v_exp_f32 v53, v53
  v_mfma_f32_16x16x32_bf16 a[124:127], a[156:159], v[84:87], a[124:127]
  v_exp_f32 v54, v54
  v_mfma_f32_16x16x32_bf16 a[124:127], a[152:155], v[80:83], a[124:127]
  v_exp_f32 v55, v55
  v_mfma_f32_16x16x32_bf16 v[128:131], v[216:219], v[80:83], v[128:131]
  ds_read_b128 a[48:51], v2 offset:51200
  v_cvt_pk_bf16_f32 v96, v48, v49
  v_mfma_f32_16x16x32_bf16 v[128:131], v[216:219], v[84:87], v[128:131]
  v_cvt_pk_bf16_f32 v97, v50, v51
  v_cvt_pk_bf16_f32 v98, v52, v53
  v_mfma_f32_16x16x32_bf16 a[160:163], a[0:3], v[88:91], a[160:163]
  ds_read_b128 a[52:55], v2 offset:59392
  v_cvt_pk_bf16_f32 v99, v54, v55
  v_mfma_f32_16x16x32_bf16 a[160:163], a[4:7], v[92:95], a[160:163]
  buffer_load_dwordx4 v1, s[12:15], s28 offen offset:2048 sc1 lds
  v_mfma_f32_16x16x32_bf16 a[164:167], a[12:15], v[92:95], a[164:167]
  v_exp_f32 v56, v56
  v_mfma_f32_16x16x32_bf16 a[164:167], a[8:11], v[88:91], a[164:167]
  v_exp_f32 v57, v57
  v_mfma_f32_16x16x32_bf16 a[168:171], a[16:19], v[88:91], a[168:171]
  v_exp_f32 v58, v58
  v_mfma_f32_16x16x32_bf16 a[168:171], a[20:23], v[92:95], a[168:171]
  v_exp_f32 v59, v59
  v_mfma_f32_16x16x32_bf16 a[172:175], a[28:31], v[92:95], a[172:175]
  v_exp_f32 v60, v60
  v_mfma_f32_16x16x32_bf16 a[172:175], a[24:27], v[88:91], a[172:175]
  v_exp_f32 v61, v61
  v_mfma_f32_16x16x32_bf16 a[176:179], a[128:131], v[88:91], a[176:179]
  v_exp_f32 v62, v62
  v_mfma_f32_16x16x32_bf16 a[176:179], a[132:135], v[92:95], a[176:179]
  buffer_load_dwordx4 v1, s[12:15], s28 offen offset:3072 sc1 lds
  v_mfma_f32_16x16x32_bf16 a[180:183], a[140:143], v[92:95], a[180:183]
  s_and_b32 m0, s33, 0x1ffff
  v_exp_f32 v63, v63
  v_mfma_f32_16x16x32_bf16 a[180:183], a[136:139], v[88:91], a[180:183]
  v_cvt_pk_bf16_f32 v100, v56, v57
  v_cvt_pk_bf16_f32 v101, v58, v59
  v_mfma_f32_16x16x32_bf16 a[184:187], a[144:147], v[88:91], a[184:187]
  v_cvt_pk_bf16_f32 v102, v60, v61
  v_cvt_pk_bf16_f32 v103, v62, v63
  v_mfma_f32_16x16x32_bf16 a[184:187], a[148:151], v[92:95], a[184:187]
  ds_read_b128 a[60:63], v2 offset:60416
  ds_read_b128 a[56:59], v2 offset:52224
  v_mfma_f32_16x16x32_bf16 a[188:191], a[156:159], v[92:95], a[188:191]
  ds_read_b128 a[64:67], v2 offset:53248
  ds_read_b128 a[68:71], v2 offset:61440
  v_mfma_f32_16x16x32_bf16 a[188:191], a[152:155], v[88:91], a[188:191]
  v_exp_f32 v64, v64
  v_mfma_f32_16x16x32_bf16 v[132:135], v[216:219], v[88:91], v[132:135]
  ds_read_b128 a[76:79], v2 offset:62464
  ds_read_b128 a[72:75], v2 offset:54272
  v_mfma_f32_16x16x32_bf16 v[132:135], v[216:219], v[92:95], v[132:135]
  s_waitcnt lgkmcnt(11)
  buffer_load_dwordx4 v1, s[12:15], s33 offen offset:0 sc1 lds
  v_mfma_f32_16x16x32_bf16 a[96:99], a[32:35], v[96:99], a[96:99]
  s_waitcnt lgkmcnt(10)
  ds_read_b128 a[80:83], v2 offset:55296
  ds_read_b128 a[84:87], v2 offset:63488
  v_mfma_f32_16x16x32_bf16 a[96:99], a[36:39], v[100:103], a[96:99]
  s_waitcnt lgkmcnt(11)
  v_exp_f32 v65, v65
  v_mfma_f32_16x16x32_bf16 a[100:103], a[44:47], v[100:103], a[100:103]
  s_waitcnt lgkmcnt(10)
  ds_read_b128 a[92:95], v2 offset:64512
  ds_read_b128 a[88:91], v2 offset:56320
  v_mfma_f32_16x16x32_bf16 a[100:103], a[40:43], v[96:99], a[100:103]
  s_waitcnt lgkmcnt(11)
  v_exp_f32 v66, v66
  v_mfma_f32_16x16x32_bf16 a[104:107], a[48:51], v[96:99], a[104:107]
  s_waitcnt lgkmcnt(10)
  v_exp_f32 v67, v67
  v_mfma_f32_16x16x32_bf16 a[104:107], a[52:55], v[100:103], a[104:107]
  s_waitcnt lgkmcnt(9)
  v_exp_f32 v68, v68
  v_mfma_f32_16x16x32_bf16 a[108:111], a[60:63], v[100:103], a[108:111]
  s_waitcnt lgkmcnt(8)
  v_exp_f32 v69, v69
  v_mfma_f32_16x16x32_bf16 a[108:111], a[56:59], v[96:99], a[108:111]
  s_waitcnt lgkmcnt(7)
  buffer_load_dwordx4 v1, s[12:15], s33 offen offset:1024 sc1 lds
  v_mfma_f32_16x16x32_bf16 a[112:115], a[64:67], v[96:99], a[112:115]
  s_waitcnt lgkmcnt(6)
  v_exp_f32 v70, v70
  v_mfma_f32_16x16x32_bf16 a[112:115], a[68:71], v[100:103], a[112:115]
  s_waitcnt lgkmcnt(5)
  v_exp_f32 v71, v71
  v_mfma_f32_16x16x32_bf16 a[116:119], a[76:79], v[100:103], a[116:119]
  s_waitcnt lgkmcnt(4)
  v_cvt_pk_bf16_f32 v104, v64, v65
  v_cvt_pk_bf16_f32 v105, v66, v67
  v_mfma_f32_16x16x32_bf16 a[116:119], a[72:75], v[96:99], a[116:119]
  s_waitcnt lgkmcnt(3)
  v_cvt_pk_bf16_f32 v106, v68, v69
  v_cvt_pk_bf16_f32 v107, v70, v71
  v_mfma_f32_16x16x32_bf16 a[120:123], a[80:83], v[96:99], a[120:123]
  s_waitcnt lgkmcnt(2)
  v_exp_f32 v72, v72
  v_mfma_f32_16x16x32_bf16 a[120:123], a[84:87], v[100:103], a[120:123]
  s_waitcnt lgkmcnt(1)
  v_exp_f32 v73, v73
  v_mfma_f32_16x16x32_bf16 a[124:127], a[92:95], v[100:103], a[124:127]
  s_waitcnt lgkmcnt(0)
  v_exp_f32 v74, v74
  v_mfma_f32_16x16x32_bf16 a[124:127], a[88:91], v[96:99], a[124:127]
  v_exp_f32 v75, v75
  v_mfma_f32_16x16x32_bf16 v[128:131], v[216:219], v[96:99], v[128:131]
  v_exp_f32 v76, v76
  v_exp_f32 v77, v77
  v_exp_f32 v78, v78
  v_exp_f32 v79, v79
  v_mfma_f32_16x16x32_bf16 v[128:131], v[216:219], v[100:103], v[128:131]
  buffer_load_dwordx4 v1, s[12:15], s33 offen offset:2048 sc1 lds
  v_cvt_pk_bf16_f32 v108, v72, v73
  v_cvt_pk_bf16_f32 v109, v74, v75
  v_cvt_pk_bf16_f32 v110, v76, v77
  v_cvt_pk_bf16_f32 v111, v78, v79
  v_mfma_f32_16x16x32_bf16 a[160:163], a[32:35], v[104:107], a[160:163]
  ds_read_b128 a[0:3], v3 offset:0
  ds_read_b128 a[4:7], v3 offset:1024
  v_mfma_f32_16x16x32_bf16 a[160:163], a[36:39], v[108:111], a[160:163]
  ds_read_b128 a[8:11], v3 offset:2048
  ds_read_b128 a[12:15], v3 offset:3072
  v_mfma_f32_16x16x32_bf16 a[164:167], a[44:47], v[108:111], a[164:167]
  ds_read_b128 a[16:19], v3 offset:4096
  v_mfma_f32_16x16x32_bf16 a[164:167], a[40:43], v[104:107], a[164:167]
  ds_read_b128 a[20:23], v3 offset:5120
  v_mfma_f32_16x16x32_bf16 a[168:171], a[48:51], v[104:107], a[168:171]
  ds_read_b128 a[24:27], v3 offset:6144
  v_mfma_f32_16x16x32_bf16 a[168:171], a[52:55], v[108:111], a[168:171]
  buffer_load_dwordx4 v1, s[12:15], s33 offen offset:3072 sc1 lds
  v_mfma_f32_16x16x32_bf16 a[172:175], a[60:63], v[108:111], a[172:175]
  s_mov_b32 s32, s33
  ds_read_b128 a[28:31], v3 offset:7168
  ds_read_b128 a[128:131], v3 offset:8192
  v_mfma_f32_16x16x32_bf16 a[172:175], a[56:59], v[104:107], a[172:175]
  s_add_u32 s33, s33, s36
  s_xor_b32 s36, s36, 0x8000
  ds_read_b128 a[132:135], v3 offset:9216
  v_mfma_f32_16x16x32_bf16 a[176:179], a[64:67], v[104:107], a[176:179]
  ds_read_b128 a[136:139], v3 offset:10240
  v_mfma_f32_16x16x32_bf16 a[176:179], a[68:71], v[108:111], a[176:179]
  ds_read_b128 a[140:143], v3 offset:11264
  v_mfma_f32_16x16x32_bf16 a[180:183], a[76:79], v[108:111], a[180:183]
  s_sub_u32 s35, s35, 1
  ds_read_b128 a[144:147], v3 offset:12288
  v_mfma_f32_16x16x32_bf16 a[180:183], a[72:75], v[104:107], a[180:183]
  ds_read_b128 a[148:151], v3 offset:13312
  v_mfma_f32_16x16x32_bf16 a[184:187], a[80:83], v[104:107], a[184:187]
  ds_read_b128 a[152:155], v3 offset:14336
  s_waitcnt lgkmcnt(14)
  ds_read_b128 a[156:159], v3 offset:15360
  v_mfma_f32_16x16x32_bf16 a[184:187], a[84:87], v[108:111], a[184:187]
  v_mfma_f32_16x16x32_bf16 a[188:191], a[92:95], v[108:111], a[188:191]
  v_mfma_f32_16x16x32_bf16 a[188:191], a[88:91], v[104:107], a[188:191]
  v_mov_b32 v2, v3
  v_mfma_f32_16x16x32_bf16 v[132:135], v[216:219], v[104:107], v[132:135]
  v_mfma_f32_16x16x32_bf16 v[132:135], v[216:219], v[108:111], v[132:135]
  s_cmp_lg_u32 s35, 0
  s_cbranch_scc1 L_att_single
L_att_e:
  s_lshl_b32 s28, s6, 3
  s_add_u32 s28, s28, s5
  s_add_u32 s28, s28, 32
  s_lshl_b32 s35, s28, 7
  s_lshl_b32 s53, s6, 8
  s_add_u32 s53, s53, 20480
  s_cmp_ge_u32 s5, 5
  s_cselect_b32 s97, s97, 536870912
  s_waitcnt vmcnt(17)
  v_and_b32 v8, 15, v0
  v_mul_u32_u24 v8, 160, v8
  v_bfe_u32 v14, v0, 4, 2
  v_lshl_add_u32 v8, v14, 3, v8
  v_add_u32 v8, s31, v8
  s_waitcnt lgkmcnt(14)
  ds_read_b64 v[104:105], v8 offset:0
  s_waitcnt lgkmcnt(14)
  ds_read_b64 v[106:107], v8 offset:32
  s_waitcnt lgkmcnt(14)
  ds_read_b64 v[108:109], v8 offset:64
  s_waitcnt lgkmcnt(14)
  ds_read_b64 v[110:111], v8 offset:96
  s_waitcnt lgkmcnt(14)
  ds_read_b64 v[254:255], v8 offset:128
  s_cmp_lg_u32 s3, 0
  s_cbranch_scc1 L_att_e1
  s_waitcnt vmcnt(16) lgkmcnt(0)
  s_barrier
  buffer_load_dword v11, off, s[8:11], s35 sc1
  buffer_load_dword v14, off, s[8:11], s53 sc1
  v_mfma_f32_16x16x32_bf16 v[16:19], a[0:3], v[160:163], v[116:119]
  ds_read_b128 a[32:35], v2 offset:16384
  ds_read_b128 a[36:39], v2 offset:17408
  v_mfma_f32_16x16x32_bf16 v[16:19], a[4:7], v[164:167], v[16:19]
  ds_read_b128 a[40:43], v2 offset:18432
  ds_read_b128 a[44:47], v2 offset:19456
  v_mfma_f32_16x16x32_bf16 v[16:19], a[8:11], v[168:171], v[16:19]
  ds_read_b128 a[60:63], v2 offset:23552
  v_mov_b32 v90, 0
  v_mfma_f32_16x16x32_bf16 v[16:19], a[12:15], v[172:175], v[16:19]
  buffer_atomic_add v13, v12, s[8:11], s97 offen sc1
  v_mfma_f32_16x16x32_bf16 v[20:23], a[28:31], v[172:175], v[116:119]
  ds_read_b128 a[56:59], v2 offset:22528
  ds_read_b128 a[52:55], v2 offset:21504
  v_mfma_f32_16x16x32_bf16 v[20:23], a[24:27], v[168:171], v[20:23]
  ds_read_b128 a[48:51], v2 offset:20480
  v_mov_b32 v91, 0
  v_mfma_f32_16x16x32_bf16 v[20:23], a[20:23], v[164:167], v[20:23]
  ds_read_b128 a[64:67], v2 offset:24576
  v_mfma_f32_16x16x32_bf16 v[20:23], a[16:19], v[160:163], v[20:23]
  ds_read_b128 a[68:71], v2 offset:25600
  v_mfma_f32_16x16x32_bf16 v[24:27], a[128:131], v[160:163], v[116:119]
  v_exp_f32 v16, v16
  v_mfma_f32_16x16x32_bf16 v[24:27], a[132:135], v[164:167], v[24:27]
  ds_read_b128 a[72:75], v2 offset:26624
  ds_read_b128 a[76:79], v2 offset:27648
  v_mfma_f32_16x16x32_bf16 v[24:27], a[136:139], v[168:171], v[24:27]
  v_exp_f32 v17, v17
  v_mfma_f32_16x16x32_bf16 v[24:27], a[140:143], v[172:175], v[24:27]
  ds_read_b128 a[92:95], v2 offset:31744
  ds_read_b128 a[88:91], v2 offset:30720
  v_mfma_f32_16x16x32_bf16 v[28:31], a[156:159], v[172:175], v[116:119]
  ds_read_b128 a[84:87], v2 offset:29696
  v_cvt_pk_bf16_f32 v80, v16, v17
  v_mfma_f32_16x16x32_bf16 v[28:31], a[152:155], v[168:171], v[28:31]
  v_exp_f32 v18, v18
  v_mfma_f32_16x16x32_bf16 v[28:31], a[148:151], v[164:167], v[28:31]
  s_waitcnt lgkmcnt(14)
  ds_read_b128 a[80:83], v2 offset:28672
  s_waitcnt lgkmcnt(14)
  ds_read_b128 a[16:19], v2 offset:34816
  v_mfma_f32_16x16x32_bf16 v[28:31], a[144:147], v[160:163], v[28:31]
  v_exp_f32 v19, v19
  v_mfma_f32_16x16x32_bf16 v[32:35], a[0:3], v[144:147], v[208:211]
  v_exp_f32 v20, v20
  v_mfma_f32_16x16x32_bf16 v[32:35], a[4:7], v[148:151], v[32:35]
  s_waitcnt lgkmcnt(14)
  ds_read_b128 a[0:3], v2 offset:32768
  v_cvt_pk_bf16_f32 v81, v18, v19
  v_mfma_f32_16x16x32_bf16 v[32:35], a[8:11], v[152:155], v[32:35]
  s_waitcnt lgkmcnt(14)
  ds_read_b128 a[4:7], v2 offset:40960
  s_waitcnt lgkmcnt(14)
  ds_read_b128 a[20:23], v2 offset:43008
  v_mfma_f32_16x16x32_bf16 v[32:35], a[12:15], v[156:159], v[32:35]
  s_waitcnt lgkmcnt(14)
  ds_read_b128 a[8:11], v2 offset:33792
  s_waitcnt lgkmcnt(14)
  ds_read_b128 a[28:31], v2 offset:44032
  v_mfma_f32_16x16x32_bf16 v[48:51], a[32:35], v[160:163], v[116:119]
  v_exp_f32 v21, v21
  v_mfma_f32_16x16x32_bf16 v[48:51], a[36:39], v[164:167], v[48:51]
  s_waitcnt lgkmcnt(14)
  ds_read_b128 a[12:15], v2 offset:41984
  v_cvt_pk_bf16_f32 v82, v20, v21
  v_mfma_f32_16x16x32_bf16 v[48:51], a[40:43], v[168:171], v[48:51]
  s_waitcnt lgkmcnt(14)
  ds_read_b128 a[24:27], v2 offset:35840
  s_waitcnt vmcnt(2)
  v_cmp_gt_u32 vcc, 8, v11
  v_mfma_f32_16x16x32_bf16 v[48:51], a[44:47], v[172:175], v[48:51]
  v_exp_f32 v22, v22
  v_mfma_f32_16x16x32_bf16 v[52:55], a[60:63], v[172:175], v[116:119]
  s_waitcnt lgkmcnt(15)
  v_exp_f32 v23, v23
  v_mfma_f32_16x16x32_bf16 v[52:55], a[56:59], v[168:171], v[52:55]
  s_waitcnt lgkmcnt(14)
  ds_read_b128 a[128:131], v2 offset:36864
  v_cvt_pk_bf16_f32 v83, v22, v23
  v_mfma_f32_16x16x32_bf16 v[52:55], a[52:55], v[164:167], v[52:55]
  s_cbranch_vccnz L_sl_s3h1
L_bk_s3h1:
  v_exp_f32 v24, v24
  v_mfma_f32_16x16x32_bf16 v[52:55], a[48:51], v[160:163], v[52:55]
  s_waitcnt lgkmcnt(14)
  ds_read_b128 a[132:135], v2 offset:45056
  s_waitcnt vmcnt(1)
  v_cmp_gt_u32 vcc, 40, v14
  v_mfma_f32_16x16x32_bf16 v[56:59], a[64:67], v[160:163], v[116:119]
  s_waitcnt lgkmcnt(15)
  v_exp_f32 v25, v25
  v_mfma_f32_16x16x32_bf16 v[56:59], a[68:71], v[164:167], v[56:59]
  v_exp_f32 v26, v26
  v_mfma_f32_16x16x32_bf16 v[56:59], a[72:75], v[168:171], v[56:59]
  s_waitcnt lgkmcnt(14)
  v_exp_f32 v27, v27
  v_mfma_f32_16x16x32_bf16 v[56:59], a[76:79], v[172:175], v[56:59]
  s_cbranch_vccnz L_sl_s51
L_bk_s51:
  s_mov_b32 m0, s96
  v_cvt_pk_bf16_f32 v84, v24, v25
  s_waitcnt lgkmcnt(13)
  v_mfma_f32_16x16x32_bf16 v[60:63], a[92:95], v[172:175], v[212:215]
  s_waitcnt lgkmcnt(12)
  v_exp_f32 v28, v28
  v_mfma_f32_16x16x32_bf16 v[60:63], a[88:91], v[168:171], v[60:63]
  s_waitcnt lgkmcnt(11)
  v_exp_f32 v29, v29
  v_mfma_f32_16x16x32_bf16 v[60:63], a[84:87], v[164:167], v[60:63]
  s_waitcnt lgkmcnt(10)
  v_exp_f32 v30, v30
  v_exp_f32 v31, v31
  v_mfma_f32_16x16x32_bf16 v[60:63], a[80:83], v[160:163], v[60:63]
  s_waitcnt vmcnt(11) lgkmcnt(0)
  buffer_load_dwordx4 v1, s[16:19], s44 offen offset:0 sc1 lds
  v_cvt_pk_bf16_f32 v85, v26, v27
  v_cvt_pk_bf16_f32 v86, v28, v29
  v_cvt_pk_bf16_f32 v87, v30, v31
  v_mfma_f32_16x16x32_bf16 a[160:163], a[0:3], v[80:83], a[160:163]
  s_barrier
  buffer_load_dwordx4 v1, s[16:19], s44 offen offset:1024 sc1 lds
  v_mfma_f32_16x16x32_bf16 a[160:163], a[4:7], v[84:87], a[160:163]
  ds_read_b128 a[140:143], v2 offset:46080
  ds_read_b128 a[136:139], v2 offset:37888
  v_mfma_f32_16x16x32_bf16 a[164:167], a[12:15], v[84:87], a[164:167]
  ds_read_b128 a[144:147], v2 offset:38912
  ds_read_b128 a[148:151], v2 offset:47104
  v_mfma_f32_16x16x32_bf16 a[164:167], a[8:11], v[80:83], a[164:167]
  buffer_load_dwordx4 v1, s[16:19], s44 offen offset:2048 sc1 lds
  v_mfma_f32_16x16x32_bf16 a[168:171], a[16:19], v[80:83], a[168:171]
  ds_read_b128 a[156:159], v2 offset:48128
  ds_read_b128 a[152:155], v2 offset:39936
  v_mfma_f32_16x16x32_bf16 a[168:171], a[20:23], v[84:87], a[168:171]
  v_exp_f32 v32, v32
  v_mfma_f32_16x16x32_bf16 a[172:175], a[28:31], v[84:87], a[172:175]
  v_exp_f32 v33, v33
  v_mfma_f32_16x16x32_bf16 a[172:175], a[24:27], v[80:83], a[172:175]
  buffer_load_dwordx4 v1, s[16:19], s44 offen offset:3072 sc1 lds
  v_mfma_f32_16x16x32_bf16 a[176:179], a[128:131], v[80:83], a[176:179]
  s_add_u32 m0, s96, 4096
  s_add_u32 s44, s44, 4096
  v_cvt_pk_bf16_f32 v88, v32, v33
  v_mfma_f32_16x16x32_bf16 a[176:179], a[132:135], v[84:87], a[176:179]
  s_waitcnt lgkmcnt(5)
  v_exp_f32 v34, v34
  v_mfma_f32_16x16x32_bf16 a[180:183], a[140:143], v[84:87], a[180:183]
  s_waitcnt lgkmcnt(4)
  buffer_load_dwordx4 v1, s[16:19], s44 offen offset:0 sc1 lds
  v_mfma_f32_16x16x32_bf16 a[180:183], a[136:139], v[80:83], a[180:183]
  s_waitcnt lgkmcnt(3)
  s_add_u32 s96, s96, 20480
  s_add_u32 s44, s44, 16384
  ds_read_b128 a[32:35], v2 offset:49152
  v_mfma_f32_16x16x32_bf16 a[184:187], a[144:147], v[80:83], a[184:187]
  s_waitcnt lgkmcnt(3)
  s_cmp_ge_u32 s96, s1
  s_cselect_b32 s96, s0, s96
  ds_read_b128 a[36:39], v2 offset:57344
  v_mfma_f32_16x16x32_bf16 a[184:187], a[148:151], v[84:87], a[184:187]
  s_waitcnt lgkmcnt(3)
  v_exp_f32 v35, v35
  v_mfma_f32_16x16x32_bf16 a[188:191], a[156:159], v[84:87], a[188:191]
  s_waitcnt lgkmcnt(2)
  buffer_load_dwordx4 v[64:67], v1, s[40:43], s46 offen offset:0 sc1
  v_mfma_f32_16x16x32_bf16 a[188:191], a[152:155], v[80:83], a[188:191]
  ds_read_b128 a[44:47], v2 offset:58368
  v_cvt_pk_bf16_f32 v89, v34, v35
  v_mfma_f32_16x16x32_bf16 v[132:135], v[216:219], v[80:83], v[132:135]
  ds_read_b128 a[40:43], v2 offset:50176
  ds_read_b128 a[48:51], v2 offset:51200
  v_mfma_f32_16x16x32_bf16 v[132:135], v[216:219], v[84:87], v[132:135]
  buffer_load_dwordx4 v[68:71], v1, s[40:43], s46 offen offset:1024 sc1
  v_mfma_f32_16x16x32_bf16 a[96:99], a[0:3], v[88:91], a[96:99]
  s_add_u32 s46, s46, 2048
  v_exp_f32 v48, v48
  v_mfma_f32_16x16x32_bf16 a[100:103], a[8:11], v[88:91], a[100:103]
  v_exp_f32 v49, v49
  v_mfma_f32_16x16x32_bf16 a[104:107], a[16:19], v[88:91], a[104:107]
  buffer_load_dwordx4 v[72:75], v1, s[40:43], s47 offen offset:0 sc1
  v_mfma_f32_16x16x32_bf16 a[108:111], a[24:27], v[88:91], a[108:111]
  v_exp_f32 v50, v50
  v_mfma_f32_16x16x32_bf16 a[112:115], a[128:131], v[88:91], a[112:115]
  v_exp_f32 v51, v51
  v_mfma_f32_16x16x32_bf16 a[116:119], a[136:139], v[88:91], a[116:119]
  v_exp_f32 v52, v52
  v_mfma_f32_16x16x32_bf16 a[120:123], a[144:147], v[88:91], a[120:123]
  v_exp_f32 v53, v53
  v_exp_f32 v54, v54
  v_exp_f32 v55, v55
  v_mfma_f32_16x16x32_bf16 a[124:127], a[152:155], v[88:91], a[124:127]
  buffer_load_dwordx4 v[76:79], v1, s[40:43], s47 offen offset:1024 sc1
  ds_read_b128 a[52:55], v2 offset:59392
  v_cvt_pk_bf16_f32 v96, v48, v49
  v_cvt_pk_bf16_f32 v97, v50, v51
  v_cvt_pk_bf16_f32 v98, v52, v53
  v_cvt_pk_bf16_f32 v99, v54, v55
  v_exp_f32 v56, v56
  v_exp_f32 v57, v57
  v_exp_f32 v58, v58
  v_exp_f32 v59, v59
  v_exp_f32 v60, v60
  v_exp_f32 v61, v61
  v_exp_f32 v62, v62
  v_exp_f32 v63, v63
  v_mfma_f32_16x16x32_bf16 v[128:131], v[216:219], v[88:91], v[128:131]
  s_add_u32 s47, s47, 2048
  s_mov_b32 m0, s96
  ds_read_b128 a[60:63], v2 offset:60416
  v_cvt_pk_bf16_f32 v100, v56, v57
  v_cvt_pk_bf16_f32 v101, v58, v59
  v_cvt_pk_bf16_f32 v102, v60, v61
  v_cvt_pk_bf16_f32 v103, v62, v63
  s_waitcnt lgkmcnt(6)
  v_mfma_f32_16x16x32_bf16 a[160:163], a[32:35], v[96:99], a[160:163]
  s_waitcnt lgkmcnt(5)
  ds_read_b128 a[56:59], v2 offset:52224
  ds_read_b128 a[64:67], v2 offset:53248
  v_mfma_f32_16x16x32_bf16 a[160:163], a[36:39], v[100:103], a[160:163]
  s_waitcnt lgkmcnt(6)
  buffer_load_dwordx4 v1, s[16:19], s44 offen offset:0 sc1 lds
  v_mfma_f32_16x16x32_bf16 a[164:167], a[44:47], v[100:103], a[164:167]
  s_waitcnt lgkmcnt(5)
  ds_read_b128 a[68:71], v2 offset:61440
  ds_read_b128 a[76:79], v2 offset:62464
  v_mfma_f32_16x16x32_bf16 a[164:167], a[40:43], v[96:99], a[164:167]
  s_waitcnt lgkmcnt(6)
  ds_read_b128 a[72:75], v2 offset:54272
  ds_read_b128 a[80:83], v2 offset:55296
  v_mfma_f32_16x16x32_bf16 a[168:171], a[48:51], v[96:99], a[168:171]
  s_waitcnt lgkmcnt(7)
  buffer_load_dwordx4 v1, s[16:19], s44 offen offset:1024 sc1 lds
  v_mfma_f32_16x16x32_bf16 a[168:171], a[52:55], v[100:103], a[168:171]
  s_waitcnt lgkmcnt(6)
  ds_read_b128 a[84:87], v2 offset:63488
  ds_read_b128 a[92:95], v2 offset:64512
  v_mfma_f32_16x16x32_bf16 a[172:175], a[60:63], v[100:103], a[172:175]
  s_waitcnt lgkmcnt(7)
  buffer_load_dwordx4 v1, s[16:19], s44 offen offset:2048 sc1 lds
  v_mfma_f32_16x16x32_bf16 a[172:175], a[56:59], v[96:99], a[172:175]
  s_waitcnt lgkmcnt(6)
  ds_read_b128 a[88:91], v2 offset:56320
  v_mfma_f32_16x16x32_bf16 a[176:179], a[64:67], v[96:99], a[176:179]
  s_waitcnt lgkmcnt(6)
  v_mfma_f32_16x16x32_bf16 a[176:179], a[68:71], v[100:103], a[176:179]
  s_waitcnt lgkmcnt(5)
  v_mfma_f32_16x16x32_bf16 a[180:183], a[76:79], v[100:103], a[180:183]
  s_waitcnt lgkmcnt(4)
  buffer_load_dwordx4 v1, s[16:19], s44 offen offset:3072 sc1 lds
  v_mfma_f32_16x16x32_bf16 a[180:183], a[72:75], v[96:99], a[180:183]
  s_waitcnt lgkmcnt(3)
  s_add_u32 m0, s96, 4096
  s_add_u32 s44, s44, 4096
  v_mfma_f32_16x16x32_bf16 a[184:187], a[80:83], v[96:99], a[184:187]
  s_waitcnt lgkmcnt(2)
  v_mfma_f32_16x16x32_bf16 a[184:187], a[84:87], v[100:103], a[184:187]
  s_waitcnt lgkmcnt(1)
  buffer_load_dwordx4 v1, s[16:19], s44 offen offset:0 sc1 lds
  v_mfma_f32_16x16x32_bf16 a[188:191], a[92:95], v[100:103], a[188:191]
  s_waitcnt lgkmcnt(0)
  s_add_u32 s96, s96, 20480
  s_add_u32 s44, s44, 16384
  v_mfma_f32_16x16x32_bf16 a[188:191], a[88:91], v[96:99], a[188:191]
  s_cmp_ge_u32 s96, s1
  s_cselect_b32 s96, s0, s96
  v_mfma_f32_16x16x32_bf16 v[132:135], v[216:219], v[96:99], v[132:135]
  v_mfma_f32_16x16x32_bf16 v[132:135], v[216:219], v[100:103], v[132:135]
  s_branch L_att_ee
L_att_e1:
  s_cmp_lg_u32 s3, 1
  s_cbranch_scc1 L_att_e2
  s_waitcnt vmcnt(16) lgkmcnt(0)
  s_barrier
  buffer_load_dword v11, off, s[8:11], s35 sc1
  buffer_load_dword v14, off, s[8:11], s53 sc1
  v_mfma_f32_16x16x32_bf16 v[16:19], a[0:3], v[160:163], v[116:119]
  ds_read_b128 a[32:35], v2 offset:16384
  ds_read_b128 a[36:39], v2 offset:17408
  v_mfma_f32_16x16x32_bf16 v[16:19], a[4:7], v[164:167], v[16:19]
  ds_read_b128 a[40:43], v2 offset:18432
  ds_read_b128 a[44:47], v2 offset:19456
  v_mfma_f32_16x16x32_bf16 v[16:19], a[8:11], v[168:171], v[16:19]
  ds_read_b128 a[60:63], v2 offset:23552
  v_mov_b32 v102, 0
  v_mfma_f32_16x16x32_bf16 v[16:19], a[12:15], v[172:175], v[16:19]
  buffer_atomic_add v13, v12, s[8:11], s97 offen sc1
  v_mfma_f32_16x16x32_bf16 v[20:23], a[28:31], v[172:175], v[116:119]
  ds_read_b128 a[56:59], v2 offset:22528
  ds_read_b128 a[52:55], v2 offset:21504
  v_mfma_f32_16x16x32_bf16 v[20:23], a[24:27], v[168:171], v[20:23]
  ds_read_b128 a[48:51], v2 offset:20480
  v_mov_b32 v103, 0
  v_mfma_f32_16x16x32_bf16 v[20:23], a[20:23], v[164:167], v[20:23]
  ds_read_b128 a[64:67], v2 offset:24576
  v_mfma_f32_16x16x32_bf16 v[20:23], a[16:19], v[160:163], v[20:23]
  ds_read_b128 a[68:71], v2 offset:25600
  v_mfma_f32_16x16x32_bf16 v[24:27], a[128:131], v[160:163], v[116:119]
  v_exp_f32 v16, v16
  v_mfma_f32_16x16x32_bf16 v[24:27], a[132:135], v[164:167], v[24:27]
  v_exp_f32 v17, v17
  v_mfma_f32_16x16x32_bf16 v[24:27], a[136:139], v[168:171], v[24:27]
  v_exp_f32 v18, v18
  v_mfma_f32_16x16x32_bf16 v[24:27], a[140:143], v[172:175], v[24:27]
  v_exp_f32 v19, v19
  v_mfma_f32_16x16x32_bf16 v[28:31], a[156:159], v[172:175], v[116:119]
  v_exp_f32 v20, v20
  v_mfma_f32_16x16x32_bf16 v[28:31], a[152:155], v[168:171], v[28:31]
  v_exp_f32 v21, v21
  v_mfma_f32_16x16x32_bf16 v[28:31], a[148:151], v[164:167], v[28:31]
  v_exp_f32 v22, v22
  v_mfma_f32_16x16x32_bf16 v[28:31], a[144:147], v[160:163], v[28:31]
  v_exp_f32 v23, v23
  v_mfma_f32_16x16x32_bf16 v[32:35], a[0:3], v[144:147], v[112:115]
  v_cvt_pk_bf16_f32 v80, v16, v17
  v_cvt_pk_bf16_f32 v81, v18, v19
  v_mfma_f32_16x16x32_bf16 v[32:35], a[4:7], v[148:151], v[32:35]
  v_cvt_pk_bf16_f32 v82, v20, v21
  v_cvt_pk_bf16_f32 v83, v22, v23
  v_mfma_f32_16x16x32_bf16 v[32:35], a[8:11], v[152:155], v[32:35]
  v_exp_f32 v24, v24
  v_mfma_f32_16x16x32_bf16 v[32:35], a[12:15], v[156:159], v[32:35]
  v_exp_f32 v25, v25
  v_mfma_f32_16x16x32_bf16 v[36:39], a[28:31], v[156:159], v[208:211]
  v_exp_f32 v26, v26
  v_mfma_f32_16x16x32_bf16 v[36:39], a[24:27], v[152:155], v[36:39]
  v_exp_f32 v27, v27
  v_mfma_f32_16x16x32_bf16 v[36:39], a[20:23], v[148:151], v[36:39]
  s_waitcnt vmcnt(2)
  v_cmp_gt_u32 vcc, 8, v11
  v_cvt_pk_bf16_f32 v84, v24, v25
  v_mfma_f32_16x16x32_bf16 v[36:39], a[16:19], v[144:147], v[36:39]
  s_waitcnt lgkmcnt(9)
  v_exp_f32 v28, v28
  v_mfma_f32_16x16x32_bf16 v[48:51], a[32:35], v[160:163], v[116:119]
  s_waitcnt lgkmcnt(8)
  v_exp_f32 v29, v29
  v_mfma_f32_16x16x32_bf16 v[48:51], a[36:39], v[164:167], v[48:51]
  s_waitcnt lgkmcnt(7)
  v_exp_f32 v30, v30
  v_mfma_f32_16x16x32_bf16 v[48:51], a[40:43], v[168:171], v[48:51]
  s_cbranch_vccnz L_sl_s3h2
L_bk_s3h2:
  v_exp_f32 v31, v31
  s_waitcnt lgkmcnt(6)
  v_mfma_f32_16x16x32_bf16 v[48:51], a[44:47], v[172:175], v[48:51]
  s_waitcnt lgkmcnt(5)
  ds_read_b128 a[72:75], v2 offset:26624
  s_waitcnt vmcnt(1)
  v_cmp_gt_u32 vcc, 40, v14
  v_mfma_f32_16x16x32_bf16 v[52:55], a[60:63], v[172:175], v[116:119]
  s_waitcnt lgkmcnt(5)
  ds_read_b128 a[76:79], v2 offset:27648
  v_cvt_pk_bf16_f32 v85, v26, v27
  v_mfma_f32_16x16x32_bf16 v[52:55], a[56:59], v[168:171], v[52:55]
  s_waitcnt lgkmcnt(5)
  ds_read_b128 a[0:3], v2 offset:32768
  v_cvt_pk_bf16_f32 v86, v28, v29
  v_mfma_f32_16x16x32_bf16 v[52:55], a[52:55], v[164:167], v[52:55]
  s_waitcnt lgkmcnt(5)
  ds_read_b128 a[4:7], v2 offset:40960
  v_cvt_pk_bf16_f32 v87, v30, v31
  v_mfma_f32_16x16x32_bf16 v[52:55], a[48:51], v[160:163], v[52:55]
  s_cbranch_vccnz L_sl_s52
L_bk_s52:
  s_mov_b32 m0, s96
  ds_read_b128 a[12:15], v2 offset:41984
  s_waitcnt lgkmcnt(6)
  v_mfma_f32_16x16x32_bf16 v[56:59], a[64:67], v[160:163], v[212:215]
  s_waitcnt lgkmcnt(5)
  ds_read_b128 a[8:11], v2 offset:33792
  ds_read_b128 a[16:19], v2 offset:34816
  v_mfma_f32_16x16x32_bf16 v[56:59], a[68:71], v[164:167], v[56:59]
  s_waitcnt lgkmcnt(6)
  buffer_load_dwordx4 v1, s[16:19], s44 offen offset:0 sc1 lds
  v_mfma_f32_16x16x32_bf16 v[56:59], a[72:75], v[168:171], v[56:59]
  s_waitcnt lgkmcnt(5)
  ds_read_b128 a[20:23], v2 offset:43008
  ds_read_b128 a[28:31], v2 offset:44032
  v_mfma_f32_16x16x32_bf16 v[56:59], a[76:79], v[172:175], v[56:59]
  s_waitcnt vmcnt(11) lgkmcnt(0)
  ds_read_b128 a[24:27], v2 offset:35840
  ds_read_b128 a[128:131], v2 offset:36864
  v_mfma_f32_16x16x32_bf16 a[160:163], a[0:3], v[80:83], a[160:163]
  s_barrier
  buffer_load_dwordx4 v1, s[16:19], s44 offen offset:1024 sc1 lds
  v_mfma_f32_16x16x32_bf16 a[160:163], a[4:7], v[84:87], a[160:163]
  ds_read_b128 a[132:135], v2 offset:45056
  ds_read_b128 a[140:143], v2 offset:46080
  v_mfma_f32_16x16x32_bf16 a[164:167], a[12:15], v[84:87], a[164:167]
  v_exp_f32 v32, v32
  v_mfma_f32_16x16x32_bf16 a[164:167], a[8:11], v[80:83], a[164:167]
  buffer_load_dwordx4 v1, s[16:19], s44 offen offset:2048 sc1 lds
  v_mfma_f32_16x16x32_bf16 a[168:171], a[16:19], v[80:83], a[168:171]
  ds_read_b128 a[136:139], v2 offset:37888
  ds_read_b128 a[144:147], v2 offset:38912
  v_mfma_f32_16x16x32_bf16 a[168:171], a[20:23], v[84:87], a[168:171]
  v_exp_f32 v33, v33
  v_mfma_f32_16x16x32_bf16 a[172:175], a[28:31], v[84:87], a[172:175]
  s_waitcnt lgkmcnt(5)
  ds_read_b128 a[148:151], v2 offset:47104
  v_cvt_pk_bf16_f32 v88, v32, v33
  v_mfma_f32_16x16x32_bf16 a[172:175], a[24:27], v[80:83], a[172:175]
  s_waitcnt lgkmcnt(5)
  ds_read_b128 a[156:159], v2 offset:48128
  ds_read_b128 a[152:155], v2 offset:39936
  v_mfma_f32_16x16x32_bf16 a[176:179], a[128:131], v[80:83], a[176:179]
  s_waitcnt lgkmcnt(6)
  buffer_load_dwordx4 v1, s[16:19], s44 offen offset:3072 sc1 lds
  s_add_u32 m0, s96, 4096
  v_mfma_f32_16x16x32_bf16 a[176:179], a[132:135], v[84:87], a[176:179]
  s_waitcnt lgkmcnt(5)
  s_add_u32 s44, s44, 4096
  v_exp_f32 v34, v34
  v_mfma_f32_16x16x32_bf16 a[180:183], a[140:143], v[84:87], a[180:183]
  s_waitcnt lgkmcnt(4)
  buffer_load_dwordx4 v1, s[16:19], s44 offen offset:0 sc1 lds
  v_mfma_f32_16x16x32_bf16 a[180:183], a[136:139], v[80:83], a[180:183]
  s_waitcnt lgkmcnt(3)
  s_add_u32 s96, s96, 20480
  s_add_u32 s44, s44, 16384
  ds_read_b128 a[32:35], v2 offset:49152
  v_mfma_f32_16x16x32_bf16 a[184:187], a[144:147], v[80:83], a[184:187]
  s_waitcnt lgkmcnt(3)
  s_cmp_ge_u32 s96, s1
  s_cselect_b32 s96, s0, s96
  ds_read_b128 a[36:39], v2 offset:57344
  v_mfma_f32_16x16x32_bf16 a[184:187], a[148:151], v[84:87], a[184:187]
  s_waitcnt lgkmcnt(3)
  v_exp_f32 v35, v35
  v_mfma_f32_16x16x32_bf16 a[188:191], a[156:159], v[84:87], a[188:191]
  s_waitcnt lgkmcnt(2)
  v_exp_f32 v36, v36
  v_mfma_f32_16x16x32_bf16 a[188:191], a[152:155], v[80:83], a[188:191]
  buffer_load_dwordx4 v[64:67], v1, s[40:43], s46 offen offset:0 sc1
  v_exp_f32 v37, v37
  v_exp_f32 v38, v38
  v_exp_f32 v39, v39
  v_mfma_f32_16x16x32_bf16 v[132:135], v[216:219], v[80:83], v[132:135]
  v_cvt_pk_bf16_f32 v89, v34, v35
  v_cvt_pk_bf16_f32 v90, v36, v37
  v_cvt_pk_bf16_f32 v91, v38, v39
  v_mfma_f32_16x16x32_bf16 v[132:135], v[216:219], v[84:87], v[132:135]
  buffer_load_dwordx4 v[68:71], v1, s[40:43], s46 offen offset:1024 sc1
  v_mfma_f32_16x16x32_bf16 a[96:99], a[0:3], v[88:91], a[96:99]
  s_add_u32 s46, s46, 2048
  v_exp_f32 v48, v48
  v_mfma_f32_16x16x32_bf16 a[100:103], a[8:11], v[88:91], a[100:103]
  v_exp_f32 v49, v49
  v_mfma_f32_16x16x32_bf16 a[104:107], a[16:19], v[88:91], a[104:107]
  buffer_load_dwordx4 v[72:75], v1, s[40:43], s47 offen offset:0 sc1
  v_mfma_f32_16x16x32_bf16 a[108:111], a[24:27], v[88:91], a[108:111]
  v_exp_f32 v50, v50
  v_mfma_f32_16x16x32_bf16 a[112:115], a[128:131], v[88:91], a[112:115]
  ds_read_b128 a[44:47], v2 offset:58368
  v_cvt_pk_bf16_f32 v96, v48, v49
  v_mfma_f32_16x16x32_bf16 a[116:119], a[136:139], v[88:91], a[116:119]
  ds_read_b128 a[40:43], v2 offset:50176
  ds_read_b128 a[48:51], v2 offset:51200
  v_mfma_f32_16x16x32_bf16 a[120:123], a[144:147], v[88:91], a[120:123]
  v_exp_f32 v51, v51
  v_exp_f32 v52, v52
  v_exp_f32 v53, v53
  v_exp_f32 v54, v54
  v_exp_f32 v55, v55
  v_mfma_f32_16x16x32_bf16 a[124:127], a[152:155], v[88:91], a[124:127]
  buffer_load_dwordx4 v[76:79], v1, s[40:43], s47 offen offset:1024 sc1
  ds_read_b128 a[52:55], v2 offset:59392
  v_cvt_pk_bf16_f32 v97, v50, v51
  v_cvt_pk_bf16_f32 v98, v52, v53
  v_cvt_pk_bf16_f32 v99, v54, v55
  v_exp_f32 v56, v56
  v_exp_f32 v57, v57
  v_exp_f32 v58, v58
  v_exp_f32 v59, v59
  v_mfma_f32_16x16x32_bf16 v[128:131], v[216:219], v[88:91], v[128:131]
  s_waitcnt lgkmcnt(5)
  s_add_u32 s47, s47, 2048
  s_mov_b32 m0, s96
  ds_read_b128 a[60:63], v2 offset:60416
  v_cvt_pk_bf16_f32 v100, v56, v57
  v_cvt_pk_bf16_f32 v101, v58, v59
  v_mfma_f32_16x16x32_bf16 a[160:163], a[32:35], v[96:99], a[160:163]
  s_waitcnt lgkmcnt(5)
  ds_read_b128 a[56:59], v2 offset:52224
  ds_read_b128 a[64:67], v2 offset:53248
  v_mfma_f32_16x16x32_bf16 a[160:163], a[36:39], v[100:103], a[160:163]
  s_waitcnt lgkmcnt(6)
  buffer_load_dwordx4 v1, s[16:19], s44 offen offset:0 sc1 lds
  v_mfma_f32_16x16x32_bf16 a[164:167], a[44:47], v[100:103], a[164:167]
  s_waitcnt lgkmcnt(5)
  ds_read_b128 a[68:71], v2 offset:61440
  ds_read_b128 a[76:79], v2 offset:62464
  v_mfma_f32_16x16x32_bf16 a[164:167], a[40:43], v[96:99], a[164:167]
  s_waitcnt lgkmcnt(6)
  buffer_load_dwordx4 v1, s[16:19], s44 offen offset:1024 sc1 lds
  v_mfma_f32_16x16x32_bf16 a[168:171], a[48:51], v[96:99], a[168:171]
  s_waitcnt lgkmcnt(5)
  ds_read_b128 a[72:75], v2 offset:54272
  ds_read_b128 a[80:83], v2 offset:55296
  v_mfma_f32_16x16x32_bf16 a[168:171], a[52:55], v[100:103], a[168:171]
  s_waitcnt lgkmcnt(6)
  ds_read_b128 a[84:87], v2 offset:63488
  ds_read_b128 a[92:95], v2 offset:64512
  v_mfma_f32_16x16x32_bf16 a[172:175], a[60:63], v[100:103], a[172:175]
  s_waitcnt lgkmcnt(7)
  buffer_load_dwordx4 v1, s[16:19], s44 offen offset:2048 sc1 lds
  v_mfma_f32_16x16x32_bf16 a[172:175], a[56:59], v[96:99], a[172:175]
  s_waitcnt lgkmcnt(6)
  ds_read_b128 a[88:91], v2 offset:56320
  v_mfma_f32_16x16x32_bf16 a[176:179], a[64:67], v[96:99], a[176:179]
  s_waitcnt lgkmcnt(6)
  v_mfma_f32_16x16x32_bf16 a[176:179], a[68:71], v[100:103], a[176:179]
  s_waitcnt lgkmcnt(5)
  v_mfma_f32_16x16x32_bf16 a[180:183], a[76:79], v[100:103], a[180:183]
  s_waitcnt lgkmcnt(4)
  buffer_load_dwordx4 v1, s[16:19], s44 offen offset:3072 sc1 lds
  v_mfma_f32_16x16x32_bf16 a[180:183], a[72:75], v[96:99], a[180:183]
  s_waitcnt lgkmcnt(3)
  s_add_u32 m0, s96, 4096
  s_add_u32 s44, s44, 4096
  v_mfma_f32_16x16x32_bf16 a[184:187], a[80:83], v[96:99], a[184:187]
  s_waitcnt lgkmcnt(2)
  v_mfma_f32_16x16x32_bf16 a[184:187], a[84:87], v[100:103], a[184:187]
  s_waitcnt lgkmcnt(1)
  buffer_load_dwordx4 v1, s[16:19], s44 offen offset:0 sc1 lds
  v_mfma_f32_16x16x32_bf16 a[188:191], a[92:95], v[100:103], a[188:191]
  s_waitcnt lgkmcnt(0)
  s_add_u32 s96, s96, 20480
  s_add_u32 s44, s44, 16384
  v_mfma_f32_16x16x32_bf16 a[188:191], a[88:91], v[96:99], a[188:191]
  s_cmp_ge_u32 s96, s1
  s_cselect_b32 s96, s0, s96
  v_mfma_f32_16x16x32_bf16 v[132:135], v[216:219], v[96:99], v[132:135]
  v_mfma_f32_16x16x32_bf16 v[132:135], v[216:219], v[100:103], v[132:135]
  s_branch L_att_ee
L_att_e2:
  s_cmp_lg_u32 s3, 2
  s_cbranch_scc1 L_att_e3
  s_waitcnt vmcnt(16) lgkmcnt(0)
  s_barrier
  buffer_load_dword v11, off, s[8:11], s35 sc1
  buffer_load_dword v14, off, s[8:11], s53 sc1
  v_mfma_f32_16x16x32_bf16 v[16:19], a[0:3], v[160:163], v[116:119]
  ds_read_b128 a[32:35], v2 offset:16384
  ds_read_b128 a[36:39], v2 offset:17408
  v_mfma_f32_16x16x32_bf16 v[16:19], a[4:7], v[164:167], v[16:19]
  ds_read_b128 a[40:43], v2 offset:18432
  ds_read_b128 a[44:47], v2 offset:19456
  v_mfma_f32_16x16x32_bf16 v[16:19], a[8:11], v[168:171], v[16:19]
  ds_read_b128 a[60:63], v2 offset:23552
  v_mov_b32 v94, 0
  v_mfma_f32_16x16x32_bf16 v[16:19], a[12:15], v[172:175], v[16:19]
  buffer_atomic_add v13, v12, s[8:11], s97 offen sc1
  v_mfma_f32_16x16x32_bf16 v[20:23], a[28:31], v[172:175], v[116:119]
  ds_read_b128 a[56:59], v2 offset:22528
  ds_read_b128 a[52:55], v2 offset:21504
  v_mfma_f32_16x16x32_bf16 v[20:23], a[24:27], v[168:171], v[20:23]
  ds_read_b128 a[48:51], v2 offset:20480
  v_mov_b32 v95, 0
  v_mfma_f32_16x16x32_bf16 v[20:23], a[20:23], v[164:167], v[20:23]
  v_mfma_f32_16x16x32_bf16 v[20:23], a[16:19], v[160:163], v[20:23]
  v_mfma_f32_16x16x32_bf16 v[24:27], a[128:131], v[160:163], v[116:119]
  v_exp_f32 v16, v16
  v_mfma_f32_16x16x32_bf16 v[24:27], a[132:135], v[164:167], v[24:27]
  v_exp_f32 v17, v17
  v_mfma_f32_16x16x32_bf16 v[24:27], a[136:139], v[168:171], v[24:27]
  v_exp_f32 v18, v18
  v_mfma_f32_16x16x32_bf16 v[24:27], a[140:143], v[172:175], v[24:27]
  v_exp_f32 v19, v19
  v_mfma_f32_16x16x32_bf16 v[28:31], a[156:159], v[172:175], v[116:119]
  v_exp_f32 v20, v20
  v_mfma_f32_16x16x32_bf16 v[28:31], a[152:155], v[168:171], v[28:31]
  v_exp_f32 v21, v21
  v_mfma_f32_16x16x32_bf16 v[28:31], a[148:151], v[164:167], v[28:31]
  v_exp_f32 v22, v22
  v_mfma_f32_16x16x32_bf16 v[28:31], a[144:147], v[160:163], v[28:31]
  v_exp_f32 v23, v23
  v_mfma_f32_16x16x32_bf16 v[32:35], a[0:3], v[144:147], v[112:115]
  v_cvt_pk_bf16_f32 v80, v16, v17
  v_cvt_pk_bf16_f32 v81, v18, v19
  v_mfma_f32_16x16x32_bf16 v[32:35], a[4:7], v[148:151], v[32:35]
  v_cvt_pk_bf16_f32 v82, v20, v21
  v_cvt_pk_bf16_f32 v83, v22, v23
  v_mfma_f32_16x16x32_bf16 v[32:35], a[8:11], v[152:155], v[32:35]
  v_exp_f32 v24, v24
  v_mfma_f32_16x16x32_bf16 v[32:35], a[12:15], v[156:159], v[32:35]
  v_exp_f32 v25, v25
  v_mfma_f32_16x16x32_bf16 v[36:39], a[28:31], v[156:159], v[112:115]
  v_exp_f32 v26, v26
  v_mfma_f32_16x16x32_bf16 v[36:39], a[24:27], v[152:155], v[36:39]
  v_exp_f32 v27, v27
  v_mfma_f32_16x16x32_bf16 v[36:39], a[20:23], v[148:151], v[36:39]
  s_waitcnt vmcnt(2)
  v_cmp_gt_u32 vcc, 8, v11
  v_cvt_pk_bf16_f32 v84, v24, v25
  v_mfma_f32_16x16x32_bf16 v[36:39], a[16:19], v[144:147], v[36:39]
  v_exp_f32 v28, v28
  v_mfma_f32_16x16x32_bf16 v[40:43], a[128:131], v[144:147], v[208:211]
  v_exp_f32 v29, v29
  v_mfma_f32_16x16x32_bf16 v[40:43], a[132:135], v[148:151], v[40:43]
  v_exp_f32 v30, v30
  v_mfma_f32_16x16x32_bf16 v[40:43], a[136:139], v[152:155], v[40:43]
  s_cbranch_vccnz L_sl_s3h3
L_bk_s3h3:
  v_exp_f32 v31, v31
  v_mfma_f32_16x16x32_bf16 v[40:43], a[140:143], v[156:159], v[40:43]
  s_waitcnt vmcnt(1) lgkmcnt(7)
  v_cmp_gt_u32 vcc, 40, v14
  v_cvt_pk_bf16_f32 v85, v26, v27
  v_mfma_f32_16x16x32_bf16 v[48:51], a[32:35], v[160:163], v[116:119]
  s_waitcnt lgkmcnt(6)
  v_cvt_pk_bf16_f32 v86, v28, v29
  v_cvt_pk_bf16_f32 v87, v30, v31
  v_mfma_f32_16x16x32_bf16 v[48:51], a[36:39], v[164:167], v[48:51]
  s_waitcnt lgkmcnt(5)
  ds_read_b128 a[0:3], v2 offset:32768
  ds_read_b128 a[4:7], v2 offset:40960
  v_mfma_f32_16x16x32_bf16 v[48:51], a[40:43], v[168:171], v[48:51]
  s_waitcnt lgkmcnt(6)
  ds_read_b128 a[12:15], v2 offset:41984
  ds_read_b128 a[8:11], v2 offset:33792
  v_mfma_f32_16x16x32_bf16 v[48:51], a[44:47], v[172:175], v[48:51]
  s_cbranch_vccnz L_sl_s53
L_bk_s53:
  s_mov_b32 m0, s96
  ds_read_b128 a[16:19], v2 offset:34816
  s_waitcnt lgkmcnt(8)
  v_mfma_f32_16x16x32_bf16 v[52:55], a[60:63], v[172:175], v[212:215]
  s_waitcnt lgkmcnt(7)
  v_exp_f32 v32, v32
  v_mfma_f32_16x16x32_bf16 v[52:55], a[56:59], v[168:171], v[52:55]
  s_waitcnt lgkmcnt(6)
  buffer_load_dwordx4 v1, s[16:19], s44 offen offset:0 sc1 lds
  v_mfma_f32_16x16x32_bf16 v[52:55], a[52:55], v[164:167], v[52:55]
  s_waitcnt lgkmcnt(5)
  ds_read_b128 a[20:23], v2 offset:43008
  ds_read_b128 a[28:31], v2 offset:44032
  v_mfma_f32_16x16x32_bf16 v[52:55], a[48:51], v[160:163], v[52:55]
  s_waitcnt vmcnt(11) lgkmcnt(0)
  ds_read_b128 a[24:27], v2 offset:35840
  ds_read_b128 a[128:131], v2 offset:36864
  v_mfma_f32_16x16x32_bf16 a[160:163], a[0:3], v[80:83], a[160:163]
  s_barrier
  buffer_load_dwordx4 v1, s[16:19], s44 offen offset:1024 sc1 lds
  v_mfma_f32_16x16x32_bf16 a[160:163], a[4:7], v[84:87], a[160:163]
  ds_read_b128 a[132:135], v2 offset:45056
  ds_read_b128 a[140:143], v2 offset:46080
  v_mfma_f32_16x16x32_bf16 a[164:167], a[12:15], v[84:87], a[164:167]
  v_exp_f32 v33, v33
  v_mfma_f32_16x16x32_bf16 a[164:167], a[8:11], v[80:83], a[164:167]
  buffer_load_dwordx4 v1, s[16:19], s44 offen offset:2048 sc1 lds
  v_mfma_f32_16x16x32_bf16 a[168:171], a[16:19], v[80:83], a[168:171]
  ds_read_b128 a[136:139], v2 offset:37888
  v_cvt_pk_bf16_f32 v88, v32, v33
  v_mfma_f32_16x16x32_bf16 a[168:171], a[20:23], v[84:87], a[168:171]
  ds_read_b128 a[144:147], v2 offset:38912
  ds_read_b128 a[148:151], v2 offset:47104
  v_mfma_f32_16x16x32_bf16 a[172:175], a[28:31], v[84:87], a[172:175]
  s_waitcnt lgkmcnt(6)
  v_exp_f32 v34, v34
  v_mfma_f32_16x16x32_bf16 a[172:175], a[24:27], v[80:83], a[172:175]
  s_waitcnt lgkmcnt(5)
  ds_read_b128 a[156:159], v2 offset:48128
  ds_read_b128 a[152:155], v2 offset:39936
  v_mfma_f32_16x16x32_bf16 a[176:179], a[128:131], v[80:83], a[176:179]
  s_waitcnt lgkmcnt(6)
  buffer_load_dwordx4 v1, s[16:19], s44 offen offset:3072 sc1 lds
  s_add_u32 m0, s96, 4096
  v_mfma_f32_16x16x32_bf16 a[176:179], a[132:135], v[84:87], a[176:179]
  s_waitcnt lgkmcnt(5)
  s_add_u32 s44, s44, 4096
  v_exp_f32 v35, v35
  v_mfma_f32_16x16x32_bf16 a[180:183], a[140:143], v[84:87], a[180:183]
  s_waitcnt lgkmcnt(4)
  buffer_load_dwordx4 v1, s[16:19], s44 offen offset:0 sc1 lds
  v_mfma_f32_16x16x32_bf16 a[180:183], a[136:139], v[80:83], a[180:183]
  s_waitcnt lgkmcnt(3)
  s_add_u32 s96, s96, 20480
  s_add_u32 s44, s44, 16384
  v_cvt_pk_bf16_f32 v89, v34, v35
  v_mfma_f32_16x16x32_bf16 a[184:187], a[144:147], v[80:83], a[184:187]
  s_waitcnt lgkmcnt(2)
  s_cmp_ge_u32 s96, s1
  s_cselect_b32 s96, s0, s96
  ds_read_b128 a[32:35], v2 offset:49152
  v_mfma_f32_16x16x32_bf16 a[184:187], a[148:151], v[84:87], a[184:187]
  s_waitcnt lgkmcnt(2)
  v_exp_f32 v36, v36
  v_mfma_f32_16x16x32_bf16 a[188:191], a[156:159], v[84:87], a[188:191]
  s_waitcnt lgkmcnt(1)
  v_exp_f32 v37, v37
  v_mfma_f32_16x16x32_bf16 a[188:191], a[152:155], v[80:83], a[188:191]
  buffer_load_dwordx4 v[64:67], v1, s[40:43], s46 offen offset:0 sc1
  v_exp_f32 v38, v38
  v_exp_f32 v39, v39
  v_mfma_f32_16x16x32_bf16 v[132:135], v[216:219], v[80:83], v[132:135]
  v_cvt_pk_bf16_f32 v90, v36, v37
  v_cvt_pk_bf16_f32 v91, v38, v39
  v_exp_f32 v40, v40
  v_exp_f32 v41, v41
  v_exp_f32 v42, v42
  v_exp_f32 v43, v43
  v_mfma_f32_16x16x32_bf16 v[132:135], v[216:219], v[84:87], v[132:135]
  v_cvt_pk_bf16_f32 v92, v40, v41
  v_cvt_pk_bf16_f32 v93, v42, v43
  v_mfma_f32_16x16x32_bf16 a[96:99], a[0:3], v[88:91], a[96:99]
  buffer_load_dwordx4 v[68:71], v1, s[40:43], s46 offen offset:1024 sc1
  s_add_u32 s46, s46, 2048
  v_mfma_f32_16x16x32_bf16 a[96:99], a[4:7], v[92:95], a[96:99]
  v_exp_f32 v48, v48
  v_mfma_f32_16x16x32_bf16 a[100:103], a[12:15], v[92:95], a[100:103]
  buffer_load_dwordx4 v[72:75], v1, s[40:43], s47 offen offset:0 sc1
  v_mfma_f32_16x16x32_bf16 a[100:103], a[8:11], v[88:91], a[100:103]
  v_exp_f32 v49, v49
  v_mfma_f32_16x16x32_bf16 a[104:107], a[16:19], v[88:91], a[104:107]
  v_exp_f32 v50, v50
  v_mfma_f32_16x16x32_bf16 a[104:107], a[20:23], v[92:95], a[104:107]
  buffer_load_dwordx4 v[76:79], v1, s[40:43], s47 offen offset:1024 sc1
  v_mfma_f32_16x16x32_bf16 a[108:111], a[28:31], v[92:95], a[108:111]
  s_add_u32 s47, s47, 2048
  s_mov_b32 m0, s96
  v_cvt_pk_bf16_f32 v96, v48, v49
  v_mfma_f32_16x16x32_bf16 a[108:111], a[24:27], v[88:91], a[108:111]
  v_exp_f32 v51, v51
  v_mfma_f32_16x16x32_bf16 a[112:115], a[128:131], v[88:91], a[112:115]
  v_exp_f32 v52, v52
  v_mfma_f32_16x16x32_bf16 a[112:115], a[132:135], v[92:95], a[112:115]
  buffer_load_dwordx4 v1, s[16:19], s44 offen offset:0 sc1 lds
  v_mfma_f32_16x16x32_bf16 a[116:119], a[140:143], v[92:95], a[116:119]
  v_exp_f32 v53, v53
  v_mfma_f32_16x16x32_bf16 a[116:119], a[136:139], v[88:91], a[116:119]
  v_exp_f32 v54, v54
  v_mfma_f32_16x16x32_bf16 a[120:123], a[144:147], v[88:91], a[120:123]
  ds_read_b128 a[40:43], v2 offset:50176
  v_cvt_pk_bf16_f32 v97, v50, v51
  v_mfma_f32_16x16x32_bf16 a[120:123], a[148:151], v[92:95], a[120:123]
  ds_read_b128 a[48:51], v2 offset:51200
  v_cvt_pk_bf16_f32 v98, v52, v53
  v_mfma_f32_16x16x32_bf16 a[124:127], a[156:159], v[92:95], a[124:127]
  buffer_load_dwordx4 v1, s[16:19], s44 offen offset:1024 sc1 lds
  ds_read_b128 a[56:59], v2 offset:52224
  v_mfma_f32_16x16x32_bf16 a[124:127], a[152:155], v[88:91], a[124:127]
  ds_read_b128 a[64:67], v2 offset:53248
  v_exp_f32 v55, v55
  v_mfma_f32_16x16x32_bf16 v[128:131], v[216:219], v[88:91], v[128:131]
  ds_read_b128 a[72:75], v2 offset:54272
  v_cvt_pk_bf16_f32 v99, v54, v55
  v_mfma_f32_16x16x32_bf16 v[128:131], v[216:219], v[92:95], v[128:131]
  s_waitcnt lgkmcnt(5)
  buffer_load_dwordx4 v1, s[16:19], s44 offen offset:2048 sc1 lds
  ds_read_b128 a[80:83], v2 offset:55296
  v_mfma_f32_16x16x32_bf16 a[160:163], a[32:35], v[96:99], a[160:163]
  s_waitcnt lgkmcnt(5)
  ds_read_b128 a[88:91], v2 offset:56320
  v_mfma_f32_16x16x32_bf16 a[164:167], a[40:43], v[96:99], a[164:167]
  s_waitcnt lgkmcnt(5)
  buffer_load_dwordx4 v1, s[16:19], s44 offen offset:3072 sc1 lds
  v_mfma_f32_16x16x32_bf16 a[168:171], a[48:51], v[96:99], a[168:171]
  s_waitcnt lgkmcnt(4)
  s_add_u32 m0, s96, 4096
  s_add_u32 s44, s44, 4096
  v_mfma_f32_16x16x32_bf16 a[172:175], a[56:59], v[96:99], a[172:175]
  s_waitcnt lgkmcnt(3)
  v_mfma_f32_16x16x32_bf16 a[176:179], a[64:67], v[96:99], a[176:179]
  s_waitcnt lgkmcnt(2)
  buffer_load_dwordx4 v1, s[16:19], s44 offen offset:0 sc1 lds
  v_mfma_f32_16x16x32_bf16 a[180:183], a[72:75], v[96:99], a[180:183]
  s_waitcnt lgkmcnt(1)
  s_add_u32 s96, s96, 20480
  s_add_u32 s44, s44, 16384
  v_mfma_f32_16x16x32_bf16 a[184:187], a[80:83], v[96:99], a[184:187]
  s_waitcnt lgkmcnt(0)
  s_cmp_ge_u32 s96, s1
  s_cselect_b32 s96, s0, s96
  v_mfma_f32_16x16x32_bf16 a[188:191], a[88:91], v[96:99], a[188:191]
  v_mfma_f32_16x16x32_bf16 v[132:135], v[216:219], v[96:99], v[132:135]
  s_branch L_att_ee
L_att_e3:
  s_waitcnt vmcnt(16) lgkmcnt(0)
  s_barrier
  buffer_load_dword v11, off, s[8:11], s35 sc1
  buffer_load_dword v14, off, s[8:11], s53 sc1
  v_mfma_f32_16x16x32_bf16 v[16:19], a[0:3], v[160:163], v[116:119]
  ds_read_b128 a[32:35], v2 offset:16384
  ds_read_b128 a[36:39], v2 offset:17408
  v_mfma_f32_16x16x32_bf16 v[16:19], a[4:7], v[164:167], v[16:19]
  ds_read_b128 a[40:43], v2 offset:18432
  ds_read_b128 a[44:47], v2 offset:19456
  v_mfma_f32_16x16x32_bf16 v[16:19], a[8:11], v[168:171], v[16:19]
  v_mov_b32 v98, 0
  v_mov_b32 v99, 0
  v_mfma_f32_16x16x32_bf16 v[16:19], a[12:15], v[172:175], v[16:19]
  buffer_atomic_add v13, v12, s[8:11], s97 offen sc1
  v_mfma_f32_16x16x32_bf16 v[20:23], a[28:31], v[172:175], v[116:119]
  v_mfma_f32_16x16x32_bf16 v[20:23], a[24:27], v[168:171], v[20:23]
  v_mfma_f32_16x16x32_bf16 v[20:23], a[20:23], v[164:167], v[20:23]
  v_mfma_f32_16x16x32_bf16 v[20:23], a[16:19], v[160:163], v[20:23]
  v_mfma_f32_16x16x32_bf16 v[24:27], a[128:131], v[160:163], v[116:119]
  s_nop 1
  v_exp_f32 v16, v16
  v_mfma_f32_16x16x32_bf16 v[24:27], a[132:135], v[164:167], v[24:27]
  v_exp_f32 v17, v17
  v_mfma_f32_16x16x32_bf16 v[24:27], a[136:139], v[168:171], v[24:27]
  v_exp_f32 v18, v18
  v_mfma_f32_16x16x32_bf16 v[24:27], a[140:143], v[172:175], v[24:27]
  v_exp_f32 v19, v19
  v_mfma_f32_16x16x32_bf16 v[28:31], a[156:159], v[172:175], v[116:119]
  v_exp_f32 v20, v20
  v_mfma_f32_16x16x32_bf16 v[28:31], a[152:155], v[168:171], v[28:31]
  v_exp_f32 v21, v21
  v_mfma_f32_16x16x32_bf16 v[28:31], a[148:151], v[164:167], v[28:31]
  v_exp_f32 v22, v22
  v_mfma_f32_16x16x32_bf16 v[28:31], a[144:147], v[160:163], v[28:31]
  v_exp_f32 v23, v23
  v_mfma_f32_16x16x32_bf16 v[32:35], a[0:3], v[144:147], v[112:115]
  v_cvt_pk_bf16_f32 v80, v16, v17
  v_cvt_pk_bf16_f32 v81, v18, v19
  v_mfma_f32_16x16x32_bf16 v[32:35], a[4:7], v[148:151], v[32:35]
  v_cvt_pk_bf16_f32 v82, v20, v21
  v_cvt_pk_bf16_f32 v83, v22, v23
  v_mfma_f32_16x16x32_bf16 v[32:35], a[8:11], v[152:155], v[32:35]
  v_exp_f32 v24, v24
  v_mfma_f32_16x16x32_bf16 v[32:35], a[12:15], v[156:159], v[32:35]
  v_exp_f32 v25, v25
  v_mfma_f32_16x16x32_bf16 v[36:39], a[28:31], v[156:159], v[112:115]
  v_exp_f32 v26, v26
  v_mfma_f32_16x16x32_bf16 v[36:39], a[24:27], v[152:155], v[36:39]
  v_exp_f32 v27, v27
  v_mfma_f32_16x16x32_bf16 v[36:39], a[20:23], v[148:151], v[36:39]
  s_waitcnt vmcnt(2)
  v_cmp_gt_u32 vcc, 8, v11
  v_cvt_pk_bf16_f32 v84, v24, v25
  v_mfma_f32_16x16x32_bf16 v[36:39], a[16:19], v[144:147], v[36:39]
  v_exp_f32 v28, v28
  v_mfma_f32_16x16x32_bf16 v[40:43], a[128:131], v[144:147], v[112:115]
  v_exp_f32 v29, v29
  v_mfma_f32_16x16x32_bf16 v[40:43], a[132:135], v[148:151], v[40:43]
  v_exp_f32 v30, v30
  v_mfma_f32_16x16x32_bf16 v[40:43], a[136:139], v[152:155], v[40:43]
  s_cbranch_vccnz L_sl_s3h4
L_bk_s3h4:
  v_exp_f32 v31, v31
  v_mfma_f32_16x16x32_bf16 v[40:43], a[140:143], v[156:159], v[40:43]
  s_waitcnt vmcnt(1)
  v_cmp_gt_u32 vcc, 40, v14
  v_cvt_pk_bf16_f32 v85, v26, v27
  v_mfma_f32_16x16x32_bf16 v[44:47], a[156:159], v[156:159], v[208:211]
  v_cvt_pk_bf16_f32 v86, v28, v29
  v_cvt_pk_bf16_f32 v87, v30, v31
  v_mfma_f32_16x16x32_bf16 v[44:47], a[152:155], v[152:155], v[44:47]
  ds_read_b128 a[0:3], v2 offset:32768
  ds_read_b128 a[4:7], v2 offset:40960
  v_mfma_f32_16x16x32_bf16 v[44:47], a[148:151], v[148:151], v[44:47]
  ds_read_b128 a[12:15], v2 offset:41984
  ds_read_b128 a[8:11], v2 offset:33792
  v_mfma_f32_16x16x32_bf16 v[44:47], a[144:147], v[144:147], v[44:47]
  s_cbranch_vccnz L_sl_s54
L_bk_s54:
  s_mov_b32 m0, s96
  ds_read_b128 a[16:19], v2 offset:34816
  s_waitcnt lgkmcnt(8)
  v_mfma_f32_16x16x32_bf16 v[48:51], a[32:35], v[160:163], v[212:215]
  s_waitcnt lgkmcnt(7)
  v_exp_f32 v32, v32
  v_mfma_f32_16x16x32_bf16 v[48:51], a[36:39], v[164:167], v[48:51]
  s_waitcnt lgkmcnt(6)
  buffer_load_dwordx4 v1, s[16:19], s44 offen offset:0 sc1 lds
  v_mfma_f32_16x16x32_bf16 v[48:51], a[40:43], v[168:171], v[48:51]
  s_waitcnt lgkmcnt(5)
  ds_read_b128 a[20:23], v2 offset:43008
  ds_read_b128 a[28:31], v2 offset:44032
  v_mfma_f32_16x16x32_bf16 v[48:51], a[44:47], v[172:175], v[48:51]
  s_waitcnt vmcnt(11) lgkmcnt(0)
  ds_read_b128 a[24:27], v2 offset:35840
  ds_read_b128 a[128:131], v2 offset:36864
  v_mfma_f32_16x16x32_bf16 a[160:163], a[0:3], v[80:83], a[160:163]
  s_barrier
  buffer_load_dwordx4 v1, s[16:19], s44 offen offset:1024 sc1 lds
  v_mfma_f32_16x16x32_bf16 a[160:163], a[4:7], v[84:87], a[160:163]
  ds_read_b128 a[132:135], v2 offset:45056
  ds_read_b128 a[140:143], v2 offset:46080
  v_mfma_f32_16x16x32_bf16 a[164:167], a[12:15], v[84:87], a[164:167]
  v_exp_f32 v33, v33
  v_mfma_f32_16x16x32_bf16 a[164:167], a[8:11], v[80:83], a[164:167]
  buffer_load_dwordx4 v1, s[16:19], s44 offen offset:2048 sc1 lds
  v_mfma_f32_16x16x32_bf16 a[168:171], a[16:19], v[80:83], a[168:171]
  ds_read_b128 a[136:139], v2 offset:37888
  v_cvt_pk_bf16_f32 v88, v32, v33
  v_mfma_f32_16x16x32_bf16 a[168:171], a[20:23], v[84:87], a[168:171]
  ds_read_b128 a[144:147], v2 offset:38912
  ds_read_b128 a[148:151], v2 offset:47104
  v_mfma_f32_16x16x32_bf16 a[172:175], a[28:31], v[84:87], a[172:175]
  s_waitcnt lgkmcnt(6)
  v_exp_f32 v34, v34
  v_mfma_f32_16x16x32_bf16 a[172:175], a[24:27], v[80:83], a[172:175]
  s_waitcnt lgkmcnt(5)
  ds_read_b128 a[156:159], v2 offset:48128
  ds_read_b128 a[152:155], v2 offset:39936
  v_mfma_f32_16x16x32_bf16 a[176:179], a[128:131], v[80:83], a[176:179]
  s_waitcnt lgkmcnt(6)
  buffer_load_dwordx4 v1, s[16:19], s44 offen offset:3072 sc1 lds
  s_add_u32 m0, s96, 4096
  v_mfma_f32_16x16x32_bf16 a[176:179], a[132:135], v[84:87], a[176:179]
  s_waitcnt lgkmcnt(5)
  s_add_u32 s44, s44, 4096
  v_exp_f32 v35, v35
  v_mfma_f32_16x16x32_bf16 a[180:183], a[140:143], v[84:87], a[180:183]
  s_waitcnt lgkmcnt(4)
  buffer_load_dwordx4 v1, s[16:19], s44 offen offset:0 sc1 lds
  v_mfma_f32_16x16x32_bf16 a[180:183], a[136:139], v[80:83], a[180:183]
  s_waitcnt lgkmcnt(3)
  s_add_u32 s96, s96, 20480
  s_add_u32 s44, s44, 16384
  v_cvt_pk_bf16_f32 v89, v34, v35
  v_mfma_f32_16x16x32_bf16 a[184:187], a[144:147], v[80:83], a[184:187]
  s_waitcnt lgkmcnt(2)
  s_cmp_ge_u32 s96, s1
  s_cselect_b32 s96, s0, s96
  ds_read_b128 a[32:35], v2 offset:49152
  v_mfma_f32_16x16x32_bf16 a[184:187], a[148:151], v[84:87], a[184:187]
  s_waitcnt lgkmcnt(2)
  v_exp_f32 v36, v36
  v_mfma_f32_16x16x32_bf16 a[188:191], a[156:159], v[84:87], a[188:191]
  s_waitcnt lgkmcnt(1)
  v_exp_f32 v37, v37
  v_mfma_f32_16x16x32_bf16 a[188:191], a[152:155], v[80:83], a[188:191]
  buffer_load_dwordx4 v[64:67], v1, s[40:43], s46 offen offset:0 sc1
  v_exp_f32 v38, v38
  v_exp_f32 v39, v39
  v_mfma_f32_16x16x32_bf16 v[132:135], v[216:219], v[80:83], v[132:135]
  v_cvt_pk_bf16_f32 v90, v36, v37
  v_cvt_pk_bf16_f32 v91, v38, v39
  v_exp_f32 v40, v40
  v_exp_f32 v41, v41
  v_exp_f32 v42, v42
  v_exp_f32 v43, v43
  v_exp_f32 v44, v44
  v_exp_f32 v45, v45
  v_exp_f32 v46, v46
  v_exp_f32 v47, v47
  v_mfma_f32_16x16x32_bf16 v[132:135], v[216:219], v[84:87], v[132:135]
  v_cvt_pk_bf16_f32 v92, v40, v41
  v_cvt_pk_bf16_f32 v93, v42, v43
  v_cvt_pk_bf16_f32 v94, v44, v45
  v_cvt_pk_bf16_f32 v95, v46, v47
  v_mfma_f32_16x16x32_bf16 a[96:99], a[0:3], v[88:91], a[96:99]
  buffer_load_dwordx4 v[68:71], v1, s[40:43], s46 offen offset:1024 sc1
  s_add_u32 s46, s46, 2048
  v_mfma_f32_16x16x32_bf16 a[96:99], a[4:7], v[92:95], a[96:99]
  v_exp_f32 v48, v48
  v_mfma_f32_16x16x32_bf16 a[100:103], a[12:15], v[92:95], a[100:103]
  buffer_load_dwordx4 v[72:75], v1, s[40:43], s47 offen offset:0 sc1
  v_mfma_f32_16x16x32_bf16 a[100:103], a[8:11], v[88:91], a[100:103]
  v_exp_f32 v49, v49
  v_mfma_f32_16x16x32_bf16 a[104:107], a[16:19], v[88:91], a[104:107]
  v_exp_f32 v50, v50
  v_mfma_f32_16x16x32_bf16 a[104:107], a[20:23], v[92:95], a[104:107]
  buffer_load_dwordx4 v[76:79], v1, s[40:43], s47 offen offset:1024 sc1
  v_mfma_f32_16x16x32_bf16 a[108:111], a[28:31], v[92:95], a[108:111]
  s_add_u32 s47, s47, 2048
  s_mov_b32 m0, s96
  v_cvt_pk_bf16_f32 v96, v48, v49
  v_mfma_f32_16x16x32_bf16 a[108:111], a[24:27], v[88:91], a[108:111]
  v_exp_f32 v51, v51
  v_mfma_f32_16x16x32_bf16 a[112:115], a[128:131], v[88:91], a[112:115]
  ds_read_b128 a[40:43], v2 offset:50176
  v_cvt_pk_bf16_f32 v97, v50, v51
  v_mfma_f32_16x16x32_bf16 a[112:115], a[132:135], v[92:95], a[112:115]
  buffer_load_dwordx4 v1, s[16:19], s44 offen offset:0 sc1 lds
  v_mfma_f32_16x16x32_bf16 a[116:119], a[140:143], v[92:95], a[116:119]
  ds_read_b128 a[48:51], v2 offset:51200
  ds_read_b128 a[56:59], v2 offset:52224
  v_mfma_f32_16x16x32_bf16 a[116:119], a[136:139], v[88:91], a[116:119]
  ds_read_b128 a[64:67], v2 offset:53248
  ds_read_b128 a[72:75], v2 offset:54272
  v_mfma_f32_16x16x32_bf16 a[120:123], a[144:147], v[88:91], a[120:123]
  buffer_load_dwordx4 v1, s[16:19], s44 offen offset:1024 sc1 lds
  v_mfma_f32_16x16x32_bf16 a[120:123], a[148:151], v[92:95], a[120:123]
  ds_read_b128 a[80:83], v2 offset:55296
  ds_read_b128 a[88:91], v2 offset:56320
  v_mfma_f32_16x16x32_bf16 a[124:127], a[156:159], v[92:95], a[124:127]
  v_mfma_f32_16x16x32_bf16 a[124:127], a[152:155], v[88:91], a[124:127]
  buffer_load_dwordx4 v1, s[16:19], s44 offen offset:2048 sc1 lds
  v_mfma_f32_16x16x32_bf16 v[128:131], v[216:219], v[88:91], v[128:131]
  v_mfma_f32_16x16x32_bf16 v[128:131], v[216:219], v[92:95], v[128:131]
  s_waitcnt lgkmcnt(7)
  v_mfma_f32_16x16x32_bf16 a[160:163], a[32:35], v[96:99], a[160:163]
  s_waitcnt lgkmcnt(6)
  v_mfma_f32_16x16x32_bf16 a[164:167], a[40:43], v[96:99], a[164:167]
  s_waitcnt lgkmcnt(5)
  buffer_load_dwordx4 v1, s[16:19], s44 offen offset:3072 sc1 lds
  v_mfma_f32_16x16x32_bf16 a[168:171], a[48:51], v[96:99], a[168:171]
  s_waitcnt lgkmcnt(4)
  s_add_u32 m0, s96, 4096
  s_add_u32 s44, s44, 4096
  v_mfma_f32_16x16x32_bf16 a[172:175], a[56:59], v[96:99], a[172:175]
  s_waitcnt lgkmcnt(3)
  v_mfma_f32_16x16x32_bf16 a[176:179], a[64:67], v[96:99], a[176:179]
  s_waitcnt lgkmcnt(2)
  buffer_load_dwordx4 v1, s[16:19], s44 offen offset:0 sc1 lds
  v_mfma_f32_16x16x32_bf16 a[180:183], a[72:75], v[96:99], a[180:183]
  s_waitcnt lgkmcnt(1)
  s_add_u32 s96, s96, 20480
  s_add_u32 s44, s44, 16384
  v_mfma_f32_16x16x32_bf16 a[184:187], a[80:83], v[96:99], a[184:187]
  s_waitcnt lgkmcnt(0)
  s_cmp_ge_u32 s96, s1
  s_cselect_b32 s96, s0, s96
  v_mfma_f32_16x16x32_bf16 a[188:191], a[88:91], v[96:99], a[188:191]
  v_mfma_f32_16x16x32_bf16 v[132:135], v[216:219], v[96:99], v[132:135]
L_att_ee:
  v_mov_b32 v221, 0x5d800000
  v_cmp_nlt_f32 vcc, 0x21800000, v128
  v_cmp_ngt_f32 s[28:29], v221, v128
  v_rcp_f32 v128, v128
  s_or_b64 s[62:63], s[62:63], vcc
  s_or_b64 s[62:63], s[62:63], s[28:29]
  s_nop 1
  v_cmp_nlt_f32 vcc, 0x21800000, v132
  v_cmp_ngt_f32 s[28:29], v221, v132
  v_rcp_f32 v132, v132
  s_or_b64 s[62:63], s[62:63], vcc
  s_or_b64 s[62:63], s[62:63], s[28:29]
  s_cmp_lg_u64 s[62:63], 0
  s_cselect_b32 s28, 1, 0
  s_lshl_b32 s29, s3, 2
  s_add_u32 s29, s29, 163824
  v_mov_b32 v7, s29
  v_mov_b32 v8, s28
  ds_write_b32 v7, v8
  v_mov_b32 v7, 163824
  s_lshl_b32 s29, s7, 12
  s_add_u32 s29, s29, 14336
  s_add_u32 s30, s48, s29
  v_accvgpr_read_b32 v220, a96
  buffer_load_dwordx4 v[120:123], v1, s[40:43], s46 offen offset:0 sc1
  v_accvgpr_read_b32 v221, a97
  v_accvgpr_read_b32 v222, a98
  v_accvgpr_read_b32 v223, a99
  v_accvgpr_read_b32 v224, a100
  buffer_load_dwordx4 v[124:127], v1, s[40:43], s46 offen offset:1024 sc1
  v_accvgpr_read_b32 v225, a101
  v_accvgpr_read_b32 v226, a102
  v_accvgpr_read_b32 v227, a103
  v_pk_mul_f32 v[220:221], v[220:221], v[128:129] op_sel_hi:[1,0]
  v_pk_mul_f32 v[222:223], v[222:223], v[128:129] op_sel_hi:[1,0]
  v_pk_mul_f32 v[224:225], v[224:225], v[128:129] op_sel_hi:[1,0]
  v_pk_mul_f32 v[226:227], v[226:227], v[128:129] op_sel_hi:[1,0]
  v_cvt_pk_bf16_f32 v228, v220, v221
  v_cvt_pk_bf16_f32 v229, v222, v223
  v_cvt_pk_bf16_f32 v230, v224, v225
  v_cvt_pk_bf16_f32 v231, v226, v227
  buffer_store_dwordx4 v[228:231], v1, s[8:11], s30 offen offset:0 sc1
  v_accvgpr_read_b32 v232, a104
  s_add_u32 s46, s46, 2048
  buffer_load_dwordx4 v[136:139], v1, s[40:43], s47 offen offset:0 sc1
  v_accvgpr_read_b32 v233, a105
  v_accvgpr_read_b32 v234, a106
  v_accvgpr_read_b32 v235, a107
  v_accvgpr_read_b32 v236, a108
  buffer_load_dwordx4 v[140:143], v1, s[40:43], s47 offen offset:1024 sc1
  v_accvgpr_read_b32 v237, a109
  v_accvgpr_read_b32 v238, a110
  v_accvgpr_read_b32 v239, a111
  v_pk_mul_f32 v[232:233], v[232:233], v[128:129] op_sel_hi:[1,0]
  v_pk_mul_f32 v[234:235], v[234:235], v[128:129] op_sel_hi:[1,0]
  v_pk_mul_f32 v[236:237], v[236:237], v[128:129] op_sel_hi:[1,0]
  v_pk_mul_f32 v[238:239], v[238:239], v[128:129] op_sel_hi:[1,0]
  v_cvt_pk_bf16_f32 v240, v232, v233
  v_cvt_pk_bf16_f32 v241, v234, v235
  v_cvt_pk_bf16_f32 v242, v236, v237
  v_cvt_pk_bf16_f32 v243, v238, v239
  buffer_store_dwordx4 v[240:243], v1, s[8:11], s30 offen offset:1024 sc1
  v_accvgpr_read_b32 v220, a112
  s_add_u32 s47, s47, 2048
  v_accvgpr_read_b32 v221, a113
  v_accvgpr_read_b32 v222, a114
  v_accvgpr_read_b32 v223, a115
  v_accvgpr_read_b32 v224, a116
  v_accvgpr_read_b32 v225, a117
  v_accvgpr_read_b32 v226, a118
  v_accvgpr_read_b32 v227, a119
  v_pk_mul_f32 v[220:221], v[220:221], v[128:129] op_sel_hi:[1,0]
  v_pk_mul_f32 v[222:223], v[222:223], v[128:129] op_sel_hi:[1,0]
  v_pk_mul_f32 v[224:225], v[224:225], v[128:129] op_sel_hi:[1,0]
  v_pk_mul_f32 v[226:227], v[226:227], v[128:129] op_sel_hi:[1,0]
  v_cvt_pk_bf16_f32 v228, v220, v221
  v_cvt_pk_bf16_f32 v229, v222, v223
  v_cvt_pk_bf16_f32 v230, v224, v225
  v_cvt_pk_bf16_f32 v231, v226, v227
  buffer_store_dwordx4 v[228:231], v1, s[8:11], s30 offen offset:2048 sc1
  v_accvgpr_read_b32 v232, a120
  v_accvgpr_read_b32 v233, a121
  v_accvgpr_read_b32 v234, a122
  v_accvgpr_read_b32 v235, a123
  v_accvgpr_read_b32 v236, a124
  v_accvgpr_read_b32 v237, a125
  v_accvgpr_read_b32 v238, a126
  v_accvgpr_read_b32 v239, a127
  v_pk_mul_f32 v[232:233], v[232:233], v[128:129] op_sel_hi:[1,0]
  v_pk_mul_f32 v[234:235], v[234:235], v[128:129] op_sel_hi:[1,0]
  v_pk_mul_f32 v[236:237], v[236:237], v[128:129] op_sel_hi:[1,0]
  v_pk_mul_f32 v[238:239], v[238:239], v[128:129] op_sel_hi:[1,0]
  v_cvt_pk_bf16_f32 v240, v232, v233
  v_cvt_pk_bf16_f32 v241, v234, v235
  v_cvt_pk_bf16_f32 v242, v236, v237
  v_cvt_pk_bf16_f32 v243, v238, v239
  buffer_store_dwordx4 v[240:243], v1, s[8:11], s30 offen offset:3072 sc1
  s_add_u32 s30, s49, s29
  v_accvgpr_read_b32 v220, a160
  v_accvgpr_read_b32 v221, a161
  v_accvgpr_read_b32 v222, a162
  v_accvgpr_read_b32 v223, a163
  v_accvgpr_read_b32 v224, a164
  v_accvgpr_read_b32 v225, a165
  v_accvgpr_read_b32 v226, a166
  v_accvgpr_read_b32 v227, a167
  v_pk_mul_f32 v[220:221], v[220:221], v[132:133] op_sel_hi:[1,0]
  v_pk_mul_f32 v[222:223], v[222:223], v[132:133] op_sel_hi:[1,0]
  v_pk_mul_f32 v[224:225], v[224:225], v[132:133] op_sel_hi:[1,0]
  v_pk_mul_f32 v[226:227], v[226:227], v[132:133] op_sel_hi:[1,0]
  v_cvt_pk_bf16_f32 v228, v220, v221
  v_cvt_pk_bf16_f32 v229, v222, v223
  v_cvt_pk_bf16_f32 v230, v224, v225
  v_cvt_pk_bf16_f32 v231, v226, v227
  buffer_store_dwordx4 v[228:231], v1, s[8:11], s30 offen offset:0 sc1
  v_accvgpr_read_b32 v232, a168
  v_accvgpr_read_b32 v233, a169
  v_accvgpr_read_b32 v234, a170
  v_accvgpr_read_b32 v235, a171
  v_accvgpr_read_b32 v236, a172
  v_accvgpr_read_b32 v237, a173
  v_accvgpr_read_b32 v238, a174
  v_accvgpr_read_b32 v239, a175
  v_pk_mul_f32 v[232:233], v[232:233], v[132:133] op_sel_hi:[1,0]
  v_pk_mul_f32 v[234:235], v[234:235], v[132:133] op_sel_hi:[1,0]
  v_pk_mul_f32 v[236:237], v[236:237], v[132:133] op_sel_hi:[1,0]
  v_pk_mul_f32 v[238:239], v[238:239], v[132:133] op_sel_hi:[1,0]
  v_cvt_pk_bf16_f32 v240, v232, v233
  v_cvt_pk_bf16_f32 v241, v234, v235
  v_cvt_pk_bf16_f32 v242, v236, v237
  v_cvt_pk_bf16_f32 v243, v238, v239
  buffer_store_dwordx4 v[240:243], v1, s[8:11], s30 offen offset:1024 sc1
  v_accvgpr_read_b32 v220, a176
  v_accvgpr_read_b32 v221, a177
  v_accvgpr_read_b32 v222, a178
  v_accvgpr_read_b32 v223, a179
  v_accvgpr_read_b32 v224, a180
  v_accvgpr_read_b32 v225, a181
  v_accvgpr_read_b32 v226, a182
  v_accvgpr_read_b32 v227, a183
  v_pk_mul_f32 v[220:221], v[220:221], v[132:133] op_sel_hi:[1,0]
  v_pk_mul_f32 v[222:223], v[222:223], v[132:133] op_sel_hi:[1,0]
  v_pk_mul_f32 v[224:225], v[224:225], v[132:133] op_sel_hi:[1,0]
  v_pk_mul_f32 v[226:227], v[226:227], v[132:133] op_sel_hi:[1,0]
  v_cvt_pk_bf16_f32 v228, v220, v221
  v_cvt_pk_bf16_f32 v229, v222, v223
  v_cvt_pk_bf16_f32 v230, v224, v225
  v_cvt_pk_bf16_f32 v231, v226, v227
  buffer_store_dwordx4 v[228:231], v1, s[8:11], s30 offen offset:2048 sc1
  v_accvgpr_read_b32 v232, a184
  v_accvgpr_read_b32 v233, a185
  v_accvgpr_read_b32 v234, a186
  v_accvgpr_read_b32 v235, a187
  v_accvgpr_read_b32 v236, a188
  v_accvgpr_read_b32 v237, a189
  v_accvgpr_read_b32 v238, a190
  v_accvgpr_read_b32 v239, a191
  v_pk_mul_f32 v[232:233], v[232:233], v[132:133] op_sel_hi:[1,0]
  v_pk_mul_f32 v[234:235], v[234:235], v[132:133] op_sel_hi:[1,0]
  v_pk_mul_f32 v[236:237], v[236:237], v[132:133] op_sel_hi:[1,0]
  v_pk_mul_f32 v[238:239], v[238:239], v[132:133] op_sel_hi:[1,0]
  v_cvt_pk_bf16_f32 v240, v232, v233
  v_cvt_pk_bf16_f32 v241, v234, v235
  v_cvt_pk_bf16_f32 v242, v236, v237
  v_cvt_pk_bf16_f32 v243, v238, v239
  buffer_store_dwordx4 v[240:243], v1, s[8:11], s30 offen offset:3072 sc1
  s_waitcnt vmcnt(21)
  s_waitcnt lgkmcnt(0)
  s_barrier
  ds_read_b128 v[8:11], v7
  s_waitcnt lgkmcnt(0)
  v_or3_b32 v8, v8, v9, v10
  v_or_b32 v8, v8, v11
  s_nop 0
  v_readfirstlane_b32 s28, v8
  s_nop 0
  s_cmp_gt_u32 s28, s38
  s_cbranch_scc1 L_att_redo
  ds_read_b128 a[0:3], v244 offset:0
  ds_read_b128 a[4:7], v244 offset:10240
  ds_read_b128 a[8:11], v244 offset:1024
  ds_read_b128 a[12:15], v244 offset:11264
  ds_read_b128 a[16:19], v244 offset:2048
  ds_read_b128 a[20:23], v244 offset:12288
  s_lshl_b32 s28, s6, 3
  s_add_u32 s28, s28, s5
  s_add_u32 s28, s28, 64
  s_lshl_b32 s35, s28, 7
  s_lshl_b32 s36, s28, 7
  s_cmp_eq_u32 s3, 0
  s_cselect_b32 s36, s36, 536870912
  s_mov_b32 s88, s82
  s_and_b32 s89, s83, 0xffff
  s_mov_b32 s90, 2621440
  s_mov_b32 s91, 0x20000
  v_mov_b32 v96, 0
  v_mov_b32 v97, 0
  v_mov_b32 v98, 0
  v_mov_b32 v99, 0
  s_nop 1
  v_mfma_f32_32x32x16_bf16 v[144:159], v[96:99], v[96:99], 0
  v_mfma_f32_32x32x16_bf16 v[160:175], v[96:99], v[96:99], 0
  v_mfma_f32_32x32x16_bf16 v[176:191], v[96:99], v[96:99], 0
  v_mfma_f32_32x32x16_bf16 v[192:207], v[96:99], v[96:99], 0
  v_mfma_f32_32x32x16_bf16 v[208:223], v[96:99], v[96:99], 0
  s_mov_b32 s32, 0
  s_add_u32 s34, s53, 128
  s_movk_i32 s37, 8496
.p2align 3
L_p4:
  s_waitcnt vmcnt(12) lgkmcnt(5)
  s_nop 1
  v_mfma_f32_16x16x32_bf16 v[144:147], a[0:3], v[64:67], v[144:147]
  s_waitcnt vmcnt(11) lgkmcnt(4)
  s_mov_b32 m0, s96
  ds_read_b128 a[24:27], v244 offset:3072
  v_mfma_f32_16x16x32_bf16 v[144:147], a[4:7], v[68:71], v[144:147]
  s_waitcnt vmcnt(9)
  v_mfma_f32_16x16x32_bf16 v[184:187], a[4:7], v[76:79], v[184:187]
  ds_read_b128 a[28:31], v244 offset:13312
  v_mfma_f32_16x16x32_bf16 v[184:187], a[0:3], v[72:75], v[184:187]
  s_waitcnt lgkmcnt(5)
  buffer_load_dwordx4 v1, s[16:19], s44 offen offset:0 sc1 lds
  v_mfma_f32_16x16x32_bf16 v[188:191], a[8:11], v[72:75], v[188:191]
  s_waitcnt lgkmcnt(4)
  ds_read_b128 a[32:35], v244 offset:4096
  v_mfma_f32_16x16x32_bf16 v[188:191], a[12:15], v[76:79], v[188:191]
  v_mfma_f32_16x16x32_bf16 v[148:151], a[12:15], v[68:71], v[148:151]
  ds_read_b128 a[36:39], v244 offset:14336
  v_mfma_f32_16x16x32_bf16 v[148:151], a[8:11], v[64:67], v[148:151]
  s_waitcnt lgkmcnt(5)
  buffer_load_dwordx4 v1, s[16:19], s44 offen offset:1024 sc1 lds
  v_mfma_f32_16x16x32_bf16 v[152:155], a[16:19], v[64:67], v[152:155]
  s_waitcnt lgkmcnt(4)
  ds_read_b128 a[0:3], v244 offset:5120
  v_mfma_f32_16x16x32_bf16 v[152:155], a[20:23], v[68:71], v[152:155]
  v_mfma_f32_16x16x32_bf16 v[192:195], a[20:23], v[76:79], v[192:195]
  ds_read_b128 a[4:7], v244 offset:15360
  v_mfma_f32_16x16x32_bf16 v[192:195], a[16:19], v[72:75], v[192:195]
  s_waitcnt lgkmcnt(5)
  buffer_load_dwordx4 v1, s[16:19], s44 offen offset:2048 sc1 lds
  v_mfma_f32_16x16x32_bf16 v[196:199], a[24:27], v[72:75], v[196:199]
  s_waitcnt lgkmcnt(4)
  ds_read_b128 a[8:11], v244 offset:6144
  v_mfma_f32_16x16x32_bf16 v[196:199], a[28:31], v[76:79], v[196:199]
  v_mfma_f32_16x16x32_bf16 v[156:159], a[28:31], v[68:71], v[156:159]
  ds_read_b128 a[12:15], v244 offset:16384
  v_mfma_f32_16x16x32_bf16 v[156:159], a[24:27], v[64:67], v[156:159]
  s_waitcnt lgkmcnt(5)
  buffer_load_dwordx4 v1, s[16:19], s44 offen offset:3072 sc1 lds
  s_add_u32 m0, s96, 4096
  v_mfma_f32_16x16x32_bf16 v[160:163], a[32:35], v[64:67], v[160:163]
  s_waitcnt lgkmcnt(4)
  s_add_u32 s44, s44, 4096
  ds_read_b128 a[16:19], v244 offset:7168
  v_mfma_f32_16x16x32_bf16 v[160:163], a[36:39], v[68:71], v[160:163]
  v_mfma_f32_16x16x32_bf16 v[200:203], a[36:39], v[76:79], v[200:203]
  s_cmp_lt_u32 s32, 21
  s_cselect_b32 s42, 268435456, 0
  ds_read_b128 a[20:23], v244 offset:17408
  v_mfma_f32_16x16x32_bf16 v[200:203], a[32:35], v[72:75], v[200:203]
  s_waitcnt lgkmcnt(5)
  buffer_load_dwordx4 v1, s[16:19], s44 offen offset:0 sc1 lds
  s_add_u32 s96, s96, 20480
  v_mfma_f32_16x16x32_bf16 v[204:207], a[0:3], v[72:75], v[204:207]
  s_waitcnt lgkmcnt(4)
  s_add_u32 s44, s44, 16384
  ds_read_b128 a[24:27], v244 offset:8192
  v_mfma_f32_16x16x32_bf16 v[204:207], a[4:7], v[76:79], v[204:207]
  s_cmp_ge_u32 s96, s1
  s_cselect_b32 s96, s0, s96
  v_mfma_f32_16x16x32_bf16 v[164:167], a[4:7], v[68:71], v[164:167]
  s_bitcmp1_b32 s37, s32
  s_cbranch_scc1 L_c3
L_c3b:
  ds_read_b128 a[28:31], v244 offset:18432
  v_mfma_f32_16x16x32_bf16 v[164:167], a[0:3], v[64:67], v[164:167]
  s_waitcnt lgkmcnt(5)
  buffer_load_dwordx4 v[16:19], v1, s[40:43], s46 offen offset:0 sc1
  v_mfma_f32_16x16x32_bf16 v[168:171], a[8:11], v[64:67], v[168:171]
  s_waitcnt lgkmcnt(4)
  ds_read_b128 a[32:35], v244 offset:9216
  v_mfma_f32_16x16x32_bf16 v[168:171], a[12:15], v[68:71], v[168:171]
  v_mfma_f32_16x16x32_bf16 v[208:211], a[12:15], v[76:79], v[208:211]
  s_waitcnt vmcnt(10)
  ds_read_b128 a[36:39], v244 offset:19456
  v_mfma_f32_16x16x32_bf16 v[208:211], a[8:11], v[72:75], v[208:211]
  s_barrier
  buffer_load_dwordx4 v[20:23], v1, s[40:43], s46 offen offset:1024 sc1
  s_waitcnt lgkmcnt(5)
  v_mfma_f32_16x16x32_bf16 v[212:215], a[16:19], v[72:75], v[212:215]
  s_waitcnt lgkmcnt(4)
  s_add_u32 s46, s46, 2048
  ds_read_b128 a[0:3], v244 offset:20480
  v_mfma_f32_16x16x32_bf16 v[212:215], a[20:23], v[76:79], v[212:215]
  v_mfma_f32_16x16x32_bf16 v[172:175], a[20:23], v[68:71], v[172:175]
  ds_read_b128 a[4:7], v244 offset:30720
  v_mfma_f32_16x16x32_bf16 v[172:175], a[16:19], v[64:67], v[172:175]
  s_waitcnt lgkmcnt(5)
  buffer_load_dwordx4 v[24:27], v1, s[40:43], s47 offen offset:0 sc1
  v_mfma_f32_16x16x32_bf16 v[176:179], a[24:27], v[64:67], v[176:179]
  s_waitcnt lgkmcnt(4)
  ds_read_b128 a[8:11], v244 offset:21504
  v_mfma_f32_16x16x32_bf16 v[176:179], a[28:31], v[68:71], v[176:179]
  v_mfma_f32_16x16x32_bf16 v[216:219], a[28:31], v[76:79], v[216:219]
  ds_read_b128 a[12:15], v244 offset:31744
  v_mfma_f32_16x16x32_bf16 v[216:219], a[24:27], v[72:75], v[216:219]
  s_waitcnt lgkmcnt(5)
  buffer_load_dwordx4 v[28:31], v1, s[40:43], s47 offen offset:1024 sc1
  v_mfma_f32_16x16x32_bf16 v[220:223], a[32:35], v[72:75], v[220:223]
  s_waitcnt lgkmcnt(4)
  s_add_u32 s47, s47, 2048
  ds_read_b128 a[16:19], v244 offset:22528
  v_mfma_f32_16x16x32_bf16 v[220:223], a[36:39], v[76:79], v[220:223]
  s_add_u32 s32, s32, 1
  v_mfma_f32_16x16x32_bf16 v[180:183], a[36:39], v[68:71], v[180:183]
  ds_read_b128 a[20:23], v244 offset:32768
  v_mfma_f32_16x16x32_bf16 v[180:183], a[32:35], v[64:67], v[180:183]
  s_waitcnt vmcnt(12) lgkmcnt(5)
  v_mfma_f32_16x16x32_bf16 v[144:147], a[0:3], v[120:123], v[144:147]
  s_waitcnt vmcnt(11) lgkmcnt(4)
  s_mov_b32 m0, s96
  ds_read_b128 a[24:27], v244 offset:23552
  v_mfma_f32_16x16x32_bf16 v[144:147], a[4:7], v[124:127], v[144:147]
  s_waitcnt vmcnt(9)
  v_mfma_f32_16x16x32_bf16 v[184:187], a[4:7], v[140:143], v[184:187]
  ds_read_b128 a[28:31], v244 offset:33792
  v_mfma_f32_16x16x32_bf16 v[184:187], a[0:3], v[136:139], v[184:187]
  s_waitcnt lgkmcnt(5)
  buffer_load_dwordx4 v1, s[16:19], s44 offen offset:0 sc1 lds
  v_mfma_f32_16x16x32_bf16 v[188:191], a[8:11], v[136:139], v[188:191]
  s_waitcnt lgkmcnt(4)
  ds_read_b128 a[32:35], v244 offset:24576
  v_mfma_f32_16x16x32_bf16 v[188:191], a[12:15], v[140:143], v[188:191]
  v_mfma_f32_16x16x32_bf16 v[148:151], a[12:15], v[124:127], v[148:151]
  ds_read_b128 a[36:39], v244 offset:34816
  v_mfma_f32_16x16x32_bf16 v[148:151], a[8:11], v[120:123], v[148:151]
  s_waitcnt lgkmcnt(5)
  buffer_load_dwordx4 v1, s[16:19], s44 offen offset:1024 sc1 lds
  v_mfma_f32_16x16x32_bf16 v[152:155], a[16:19], v[120:123], v[152:155]
  s_waitcnt lgkmcnt(4)
  ds_read_b128 a[0:3], v244 offset:25600
  v_mfma_f32_16x16x32_bf16 v[152:155], a[20:23], v[124:127], v[152:155]
  v_mfma_f32_16x16x32_bf16 v[192:195], a[20:23], v[140:143], v[192:195]
  ds_read_b128 a[4:7], v244 offset:35840
  v_mfma_f32_16x16x32_bf16 v[192:195], a[16:19], v[136:139], v[192:195]
  s_waitcnt lgkmcnt(5)
  buffer_load_dwordx4 v1, s[16:19], s44 offen offset:2048 sc1 lds
  v_mfma_f32_16x16x32_bf16 v[196:199], a[24:27], v[136:139], v[196:199]
  s_waitcnt lgkmcnt(4)
  ds_read_b128 a[8:11], v244 offset:26624
  v_mfma_f32_16x16x32_bf16 v[196:199], a[28:31], v[140:143], v[196:199]
  v_mfma_f32_16x16x32_bf16 v[156:159], a[28:31], v[124:127], v[156:159]
  ds_read_b128 a[12:15], v244 offset:36864
  v_mfma_f32_16x16x32_bf16 v[156:159], a[24:27], v[120:123], v[156:159]
  s_waitcnt lgkmcnt(5)
  buffer_load_dwordx4 v1, s[16:19], s44 offen offset:3072 sc1 lds
  s_add_u32 m0, s96, 4096
  v_mfma_f32_16x16x32_bf16 v[160:163], a[32:35], v[120:123], v[160:163]
  s_waitcnt lgkmcnt(4)
  s_add_u32 s44, s44, 4096
  ds_read_b128 a[16:19], v244 offset:27648
  v_mfma_f32_16x16x32_bf16 v[160:163], a[36:39], v[124:127], v[160:163]
  v_mfma_f32_16x16x32_bf16 v[200:203], a[36:39], v[140:143], v[200:203]
  s_cmp_lt_u32 s32, 21
  s_cselect_b32 s42, 268435456, 0
  ds_read_b128 a[20:23], v244 offset:37888
  v_mfma_f32_16x16x32_bf16 v[200:203], a[32:35], v[136:139], v[200:203]
  s_waitcnt lgkmcnt(5)
  buffer_load_dwordx4 v1, s[16:19], s44 offen offset:0 sc1 lds
  s_add_u32 s96, s96, 20480
  v_mfma_f32_16x16x32_bf16 v[204:207], a[0:3], v[136:139], v[204:207]
  s_waitcnt lgkmcnt(4)
  s_add_u32 s44, s44, 16384
  ds_read_b128 a[24:27], v244 offset:28672
  v_mfma_f32_16x16x32_bf16 v[204:207], a[4:7], v[140:143], v[204:207]
  s_bitcmp1_b32 s37, s32
  s_cbranch_scc1 L_c0
L_c0b:
  v_mfma_f32_16x16x32_bf16 v[164:167], a[4:7], v[124:127], v[164:167]
  s_cmp_ge_u32 s96, s1
  s_cselect_b32 s96, s0, s96
  ds_read_b128 a[28:31], v244 offset:38912
  v_mfma_f32_16x16x32_bf16 v[164:167], a[0:3], v[120:123], v[164:167]
  s_waitcnt lgkmcnt(5)
  buffer_load_dwordx4 v[32:35], v1, s[40:43], s46 offen offset:0 sc1
  v_mfma_f32_16x16x32_bf16 v[168:171], a[8:11], v[120:123], v[168:171]
  s_waitcnt lgkmcnt(4)
  ds_read_b128 a[32:35], v244 offset:29696
  v_mfma_f32_16x16x32_bf16 v[168:171], a[12:15], v[124:127], v[168:171]
  v_mfma_f32_16x16x32_bf16 v[208:211], a[12:15], v[140:143], v[208:211]
  s_waitcnt vmcnt(10)
  ds_read_b128 a[36:39], v244 offset:39936
  v_mfma_f32_16x16x32_bf16 v[208:211], a[8:11], v[136:139], v[208:211]
  s_barrier
  buffer_load_dwordx4 v[36:39], v1, s[40:43], s46 offen offset:1024 sc1
  s_waitcnt lgkmcnt(5)
  v_mfma_f32_16x16x32_bf16 v[212:215], a[16:19], v[136:139], v[212:215]
  s_cmp_eq_u32 s32, 1
  s_cbranch_scc1 L_c2
L_c2b:
  ds_read_b128 a[0:3], v245 offset:0
  s_waitcnt lgkmcnt(5)
  v_mfma_f32_16x16x32_bf16 v[212:215], a[20:23], v[140:143], v[212:215]
  s_add_u32 s46, s46, 2048
  v_mfma_f32_16x16x32_bf16 v[172:175], a[20:23], v[124:127], v[172:175]
  ds_read_b128 a[4:7], v245 offset:10240
  v_mfma_f32_16x16x32_bf16 v[172:175], a[16:19], v[120:123], v[172:175]
  s_waitcnt lgkmcnt(5)
  buffer_load_dwordx4 v[40:43], v1, s[40:43], s47 offen offset:0 sc1
  v_mfma_f32_16x16x32_bf16 v[176:179], a[24:27], v[120:123], v[176:179]
  s_waitcnt lgkmcnt(4)
  ds_read_b128 a[8:11], v245 offset:1024
  v_mfma_f32_16x16x32_bf16 v[176:179], a[28:31], v[124:127], v[176:179]
  v_mfma_f32_16x16x32_bf16 v[216:219], a[28:31], v[140:143], v[216:219]
  ds_read_b128 a[12:15], v245 offset:11264
  v_mfma_f32_16x16x32_bf16 v[216:219], a[24:27], v[136:139], v[216:219]
  s_waitcnt lgkmcnt(5)
  buffer_load_dwordx4 v[44:47], v1, s[40:43], s47 offen offset:1024 sc1
  v_mfma_f32_16x16x32_bf16 v[220:223], a[32:35], v[136:139], v[220:223]
  s_waitcnt lgkmcnt(4)
  s_add_u32 s47, s47, 2048
  ds_read_b128 a[16:19], v245 offset:2048
  v_mfma_f32_16x16x32_bf16 v[220:223], a[36:39], v[140:143], v[220:223]
  s_add_u32 s32, s32, 1
  v_mfma_f32_16x16x32_bf16 v[180:183], a[36:39], v[124:127], v[180:183]
  ds_read_b128 a[20:23], v245 offset:12288
  v_mfma_f32_16x16x32_bf16 v[180:183], a[32:35], v[120:123], v[180:183]
  s_cmp_eq_u32 s32, 22
  s_cbranch_scc1 L_p4_x
  s_waitcnt vmcnt(12) lgkmcnt(5)
  v_mfma_f32_16x16x32_bf16 v[144:147], a[0:3], v[16:19], v[144:147]
  s_waitcnt vmcnt(11) lgkmcnt(4)
  s_mov_b32 m0, s96
  ds_read_b128 a[24:27], v245 offset:3072
  v_mfma_f32_16x16x32_bf16 v[144:147], a[4:7], v[20:23], v[144:147]
  s_waitcnt vmcnt(9)
  v_mfma_f32_16x16x32_bf16 v[184:187], a[4:7], v[28:31], v[184:187]
  ds_read_b128 a[28:31], v245 offset:13312
  v_mfma_f32_16x16x32_bf16 v[184:187], a[0:3], v[24:27], v[184:187]
  s_waitcnt lgkmcnt(5)
  buffer_load_dwordx4 v1, s[16:19], s44 offen offset:0 sc1 lds
  v_mfma_f32_16x16x32_bf16 v[188:191], a[8:11], v[24:27], v[188:191]
  s_waitcnt lgkmcnt(4)
  ds_read_b128 a[32:35], v245 offset:4096
  v_mfma_f32_16x16x32_bf16 v[188:191], a[12:15], v[28:31], v[188:191]
  v_mfma_f32_16x16x32_bf16 v[148:151], a[12:15], v[20:23], v[148:151]
  ds_read_b128 a[36:39], v245 offset:14336
  v_mfma_f32_16x16x32_bf16 v[148:151], a[8:11], v[16:19], v[148:151]
  s_waitcnt lgkmcnt(5)
  buffer_load_dwordx4 v1, s[16:19], s44 offen offset:1024 sc1 lds
  v_mfma_f32_16x16x32_bf16 v[152:155], a[16:19], v[16:19], v[152:155]
  s_waitcnt lgkmcnt(4)
  ds_read_b128 a[0:3], v245 offset:5120
  v_mfma_f32_16x16x32_bf16 v[152:155], a[20:23], v[20:23], v[152:155]
  v_mfma_f32_16x16x32_bf16 v[192:195], a[20:23], v[28:31], v[192:195]
  ds_read_b128 a[4:7], v245 offset:15360
  v_mfma_f32_16x16x32_bf16 v[192:195], a[16:19], v[24:27], v[192:195]
  s_waitcnt lgkmcnt(5)
  buffer_load_dwordx4 v1, s[16:19], s44 offen offset:2048 sc1 lds
  v_mfma_f32_16x16x32_bf16 v[196:199], a[24:27], v[24:27], v[196:199]
  s_waitcnt lgkmcnt(4)
  ds_read_b128 a[8:11], v245 offset:6144
  v_mfma_f32_16x16x32_bf16 v[196:199], a[28:31], v[28:31], v[196:199]
  v_mfma_f32_16x16x32_bf16 v[156:159], a[28:31], v[20:23], v[156:159]
  ds_read_b128 a[12:15], v245 offset:16384
  v_mfma_f32_16x16x32_bf16 v[156:159], a[24:27], v[16:19], v[156:159]
  s_waitcnt lgkmcnt(5)
  buffer_load_dwordx4 v1, s[16:19], s44 offen offset:3072 sc1 lds
  s_add_u32 m0, s96, 4096
  v_mfma_f32_16x16x32_bf16 v[160:163], a[32:35], v[16:19], v[160:163]
  s_waitcnt lgkmcnt(4)
  s_add_u32 s44, s44, 4096
  ds_read_b128 a[16:19], v245 offset:7168
  v_mfma_f32_16x16x32_bf16 v[160:163], a[36:39], v[20:23], v[160:163]
  v_mfma_f32_16x16x32_bf16 v[200:203], a[36:39], v[28:31], v[200:203]
  s_cmp_lt_u32 s32, 21
  s_cselect_b32 s42, 268435456, 0
  ds_read_b128 a[20:23], v245 offset:17408
  v_mfma_f32_16x16x32_bf16 v[200:203], a[32:35], v[24:27], v[200:203]
  s_waitcnt lgkmcnt(5)
  buffer_load_dwordx4 v1, s[16:19], s44 offen offset:0 sc1 lds
  s_add_u32 s96, s96, 20480
  v_mfma_f32_16x16x32_bf16 v[204:207], a[0:3], v[24:27], v[204:207]
  s_waitcnt lgkmcnt(4)
  s_add_u32 s44, s44, 16384
  ds_read_b128 a[24:27], v245 offset:8192
  v_mfma_f32_16x16x32_bf16 v[204:207], a[4:7], v[28:31], v[204:207]
  s_cmp_ge_u32 s96, s1
  s_cselect_b32 s96, s0, s96
  v_mfma_f32_16x16x32_bf16 v[164:167], a[4:7], v[20:23], v[164:167]
  ds_read_b128 a[28:31], v245 offset:18432
  v_mfma_f32_16x16x32_bf16 v[164:167], a[0:3], v[16:19], v[164:167]
  s_waitcnt lgkmcnt(5)
  buffer_load_dwordx4 v[64:67], v1, s[40:43], s46 offen offset:0 sc1
  v_mfma_f32_16x16x32_bf16 v[168:171], a[8:11], v[16:19], v[168:171]
  s_waitcnt lgkmcnt(4)
  ds_read_b128 a[32:35], v245 offset:9216
  v_mfma_f32_16x16x32_bf16 v[168:171], a[12:15], v[20:23], v[168:171]
  v_mfma_f32_16x16x32_bf16 v[208:211], a[12:15], v[28:31], v[208:211]
  s_waitcnt vmcnt(10)
  ds_read_b128 a[36:39], v245 offset:19456
  v_mfma_f32_16x16x32_bf16 v[208:211], a[8:11], v[24:27], v[208:211]
  s_barrier
  buffer_load_dwordx4 v[68:71], v1, s[40:43], s46 offen offset:1024 sc1
  s_waitcnt lgkmcnt(5)
  v_mfma_f32_16x16x32_bf16 v[212:215], a[16:19], v[24:27], v[212:215]
  s_waitcnt lgkmcnt(4)
  s_add_u32 s46, s46, 2048
  ds_read_b128 a[0:3], v245 offset:20480
  v_mfma_f32_16x16x32_bf16 v[212:215], a[20:23], v[28:31], v[212:215]
  v_mfma_f32_16x16x32_bf16 v[172:175], a[20:23], v[20:23], v[172:175]
  ds_read_b128 a[4:7], v245 offset:30720
  v_mfma_f32_16x16x32_bf16 v[172:175], a[16:19], v[16:19], v[172:175]
  s_waitcnt lgkmcnt(5)
  buffer_load_dwordx4 v[72:75], v1, s[40:43], s47 offen offset:0 sc1
  v_mfma_f32_16x16x32_bf16 v[176:179], a[24:27], v[16:19], v[176:179]
  s_waitcnt lgkmcnt(4)
  ds_read_b128 a[8:11], v245 offset:21504
  v_mfma_f32_16x16x32_bf16 v[176:179], a[28:31], v[20:23], v[176:179]
  v_mfma_f32_16x16x32_bf16 v[216:219], a[28:31], v[28:31], v[216:219]
  ds_read_b128 a[12:15], v245 offset:31744
  v_mfma_f32_16x16x32_bf16 v[216:219], a[24:27], v[24:27], v[216:219]
  s_waitcnt lgkmcnt(5)
  buffer_load_dwordx4 v[76:79], v1, s[40:43], s47 offen offset:1024 sc1
  v_mfma_f32_16x16x32_bf16 v[220:223], a[32:35], v[24:27], v[220:223]
  s_waitcnt lgkmcnt(4)
  s_add_u32 s47, s47, 2048
  ds_read_b128 a[16:19], v245 offset:22528
  v_mfma_f32_16x16x32_bf16 v[220:223], a[36:39], v[28:31], v[220:223]
  s_add_u32 s32, s32, 1
  v_mfma_f32_16x16x32_bf16 v[180:183], a[36:39], v[20:23], v[180:183]
  ds_read_b128 a[20:23], v245 offset:32768
  v_mfma_f32_16x16x32_bf16 v[180:183], a[32:35], v[16:19], v[180:183]
  s_waitcnt vmcnt(12) lgkmcnt(5)
  v_mfma_f32_16x16x32_bf16 v[144:147], a[0:3], v[32:35], v[144:147]
  s_waitcnt vmcnt(11) lgkmcnt(4)
  s_mov_b32 m0, s96
  ds_read_b128 a[24:27], v245 offset:23552
  v_mfma_f32_16x16x32_bf16 v[144:147], a[4:7], v[36:39], v[144:147]
  s_waitcnt vmcnt(9)
  v_mfma_f32_16x16x32_bf16 v[184:187], a[4:7], v[44:47], v[184:187]
  ds_read_b128 a[28:31], v245 offset:33792
  v_add_u32 v244, s55, v244
  v_mfma_f32_16x16x32_bf16 v[184:187], a[0:3], v[40:43], v[184:187]
  s_waitcnt lgkmcnt(5)
  buffer_load_dwordx4 v1, s[16:19], s44 offen offset:0 sc1 lds
  v_mfma_f32_16x16x32_bf16 v[188:191], a[8:11], v[40:43], v[188:191]
  s_waitcnt lgkmcnt(4)
  ds_read_b128 a[32:35], v245 offset:24576
  v_mfma_f32_16x16x32_bf16 v[188:191], a[12:15], v[44:47], v[188:191]
  v_mfma_f32_16x16x32_bf16 v[148:151], a[12:15], v[36:39], v[148:151]
  ds_read_b128 a[36:39], v245 offset:34816
  v_mfma_f32_16x16x32_bf16 v[148:151], a[8:11], v[32:35], v[148:151]
  s_waitcnt lgkmcnt(5)
  buffer_load_dwordx4 v1, s[16:19], s44 offen offset:1024 sc1 lds
  v_mfma_f32_16x16x32_bf16 v[152:155], a[16:19], v[32:35], v[152:155]
  s_waitcnt lgkmcnt(4)
  ds_read_b128 a[0:3], v245 offset:25600
  v_mfma_f32_16x16x32_bf16 v[152:155], a[20:23], v[36:39], v[152:155]
  v_mfma_f32_16x16x32_bf16 v[192:195], a[20:23], v[44:47], v[192:195]
  ds_read_b128 a[4:7], v245 offset:35840
  v_mfma_f32_16x16x32_bf16 v[192:195], a[16:19], v[40:43], v[192:195]
  s_waitcnt lgkmcnt(5)
  buffer_load_dwordx4 v1, s[16:19], s44 offen offset:2048 sc1 lds
  v_mfma_f32_16x16x32_bf16 v[196:199], a[24:27], v[40:43], v[196:199]
  s_waitcnt lgkmcnt(4)
  ds_read_b128 a[8:11], v245 offset:26624
  v_mfma_f32_16x16x32_bf16 v[196:199], a[28:31], v[44:47], v[196:199]
  v_mfma_f32_16x16x32_bf16 v[156:159], a[28:31], v[36:39], v[156:159]
  ds_read_b128 a[12:15], v245 offset:36864
  v_mfma_f32_16x16x32_bf16 v[156:159], a[24:27], v[32:35], v[156:159]
  s_waitcnt lgkmcnt(5)
  buffer_load_dwordx4 v1, s[16:19], s44 offen offset:3072 sc1 lds
  s_add_u32 m0, s96, 4096
  v_mfma_f32_16x16x32_bf16 v[160:163], a[32:35], v[32:35], v[160:163]
  s_waitcnt lgkmcnt(4)
  s_add_u32 s44, s44, 4096
  ds_read_b128 a[16:19], v245 offset:27648
  v_mfma_f32_16x16x32_bf16 v[160:163], a[36:39], v[36:39], v[160:163]
  v_mfma_f32_16x16x32_bf16 v[200:203], a[36:39], v[44:47], v[200:203]
  s_cmp_lt_u32 s32, 21
  s_cselect_b32 s42, 268435456, 0
  ds_read_b128 a[20:23], v245 offset:37888
  v_mfma_f32_16x16x32_bf16 v[200:203], a[32:35], v[40:43], v[200:203]
  s_waitcnt lgkmcnt(5)
  buffer_load_dwordx4 v1, s[16:19], s44 offen offset:0 sc1 lds
  s_add_u32 s96, s96, 20480
  v_mfma_f32_16x16x32_bf16 v[204:207], a[0:3], v[40:43], v[204:207]
  s_waitcnt lgkmcnt(4)
  s_add_u32 s44, s44, 16384
  ds_read_b128 a[24:27], v245 offset:28672
  v_mfma_f32_16x16x32_bf16 v[204:207], a[4:7], v[44:47], v[204:207]
  s_cmp_ge_u32 s96, s1
  s_cselect_b32 s96, s0, s96
  v_mfma_f32_16x16x32_bf16 v[164:167], a[4:7], v[36:39], v[164:167]
  ds_read_b128 a[28:31], v245 offset:38912
  v_mfma_f32_16x16x32_bf16 v[164:167], a[0:3], v[32:35], v[164:167]
  s_waitcnt lgkmcnt(5)
  buffer_load_dwordx4 v[120:123], v1, s[40:43], s46 offen offset:0 sc1
  v_mfma_f32_16x16x32_bf16 v[168:171], a[8:11], v[32:35], v[168:171]
  s_waitcnt lgkmcnt(4)
  ds_read_b128 a[32:35], v245 offset:29696
  v_mfma_f32_16x16x32_bf16 v[168:171], a[12:15], v[36:39], v[168:171]
  v_mfma_f32_16x16x32_bf16 v[208:211], a[12:15], v[44:47], v[208:211]
  s_waitcnt vmcnt(10)
  ds_read_b128 a[36:39], v245 offset:39936
  v_mfma_f32_16x16x32_bf16 v[208:211], a[8:11], v[40:43], v[208:211]
  s_barrier
  buffer_load_dwordx4 v[124:127], v1, s[40:43], s46 offen offset:1024 sc1
  s_waitcnt lgkmcnt(5)
  v_mfma_f32_16x16x32_bf16 v[212:215], a[16:19], v[40:43], v[212:215]
  s_waitcnt lgkmcnt(4)
  s_add_u32 s46, s46, 2048
  ds_read_b128 a[0:3], v244 offset:0
  v_mfma_f32_16x16x32_bf16 v[212:215], a[20:23], v[44:47], v[212:215]
  v_mfma_f32_16x16x32_bf16 v[172:175], a[20:23], v[36:39], v[172:175]
  ds_read_b128 a[4:7], v244 offset:10240
  v_add_u32 v245, s55, v245
  v_mfma_f32_16x16x32_bf16 v[172:175], a[16:19], v[32:35], v[172:175]
  s_waitcnt lgkmcnt(5)
  buffer_load_dwordx4 v[136:139], v1, s[40:43], s47 offen offset:0 sc1
  v_mfma_f32_16x16x32_bf16 v[176:179], a[24:27], v[32:35], v[176:179]
  s_waitcnt lgkmcnt(4)
  ds_read_b128 a[8:11], v244 offset:1024
  v_mfma_f32_16x16x32_bf16 v[176:179], a[28:31], v[36:39], v[176:179]
  v_mfma_f32_16x16x32_bf16 v[216:219], a[28:31], v[44:47], v[216:219]
  ds_read_b128 a[12:15], v244 offset:11264
  v_mfma_f32_16x16x32_bf16 v[216:219], a[24:27], v[40:43], v[216:219]
  s_waitcnt lgkmcnt(5)
  buffer_load_dwordx4 v[140:143], v1, s[40:43], s47 offen offset:1024 sc1
  v_mfma_f32_16x16x32_bf16 v[220:223], a[32:35], v[40:43], v[220:223]
  s_waitcnt lgkmcnt(4)
  s_add_u32 s47, s47, 2048
  ds_read_b128 a[16:19], v244 offset:2048
  v_mfma_f32_16x16x32_bf16 v[220:223], a[36:39], v[44:47], v[220:223]
  s_sub_u32 s55, 0, s55
  s_add_u32 s32, s32, 1
  v_mfma_f32_16x16x32_bf16 v[180:183], a[36:39], v[36:39], v[180:183]
  ds_read_b128 a[20:23], v244 offset:12288
  v_mfma_f32_16x16x32_bf16 v[180:183], a[32:35], v[32:35], v[180:183]
  s_branch L_p4
L_c3:
  s_cmp_eq_u32 s32, 8
  s_cbranch_scc1 L_c4
  buffer_load_dword v11, off, s[8:11], s35 sc1
  s_branch L_c3b
L_c4:
  buffer_load_dword v14, off, s[8:11], s34 sc1
  s_branch L_c3b
L_c2:
  buffer_atomic_add v13, v12, s[8:11], s36 offen sc1
  s_branch L_c2b
L_c0:
  s_cmp_eq_u32 s32, 13
  s_cbranch_scc1 L_c1
  s_waitcnt vmcnt(9)
  v_cmp_gt_u32 vcc, 8, v11
  s_nop 4
  s_cbranch_vccnz L_sl_s3c
L_bk_s3c:
  s_branch L_c0b
L_c1:
  v_cmp_gt_u32 vcc, 24, v14
  s_nop 4
  s_cbranch_vccnz L_sl_s5b
L_bk_s5b:
  s_branch L_c0b
L_p4_x:
  s_cmp_lg_u32 s6, 0
  s_cbranch_scc1 L_ex1
  s_waitcnt vmcnt(10) lgkmcnt(5)
  v_mfma_f32_16x16x32_bf16 v[184:187], a[0:3], v[24:27], v[184:187]
  s_waitcnt vmcnt(9) lgkmcnt(4)
  ds_read_b128 a[24:27], v245 offset:3072
  ds_read_b128 a[28:31], v245 offset:13312
  v_mfma_f32_16x16x32_bf16 v[184:187], a[4:7], v[28:31], v[184:187]
  ds_read_b128 a[32:35], v245 offset:4096
  ds_read_b128 a[36:39], v245 offset:14336
  v_mfma_f32_16x16x32_bf16 v[144:147], a[0:3], v[16:19], v[144:147]
  v_mfma_f32_16x16x32_bf16 v[144:147], a[4:7], v[20:23], v[144:147]
  s_waitcnt lgkmcnt(7)
  v_mfma_f32_16x16x32_bf16 v[188:191], a[8:11], v[24:27], v[188:191]
  s_waitcnt lgkmcnt(6)
  ds_read_b128 a[0:3], v245 offset:5120
  ds_read_b128 a[4:7], v245 offset:15360
  v_mfma_f32_16x16x32_bf16 v[188:191], a[12:15], v[28:31], v[188:191]
  v_mfma_f32_16x16x32_bf16 v[148:151], a[8:11], v[16:19], v[148:151]
  v_cvt_pk_bf16_f32 v48, v184, v185
  v_cvt_pk_bf16_f32 v49, v186, v187
  v_mfma_f32_16x16x32_bf16 v[148:151], a[12:15], v[20:23], v[148:151]
  s_waitcnt lgkmcnt(7)
  v_mfma_f32_16x16x32_bf16 v[192:195], a[16:19], v[24:27], v[192:195]
  s_waitcnt lgkmcnt(6)
  ds_read_b128 a[8:11], v245 offset:6144
  ds_read_b128 a[12:15], v245 offset:16384
  v_mfma_f32_16x16x32_bf16 v[192:195], a[20:23], v[28:31], v[192:195]
  v_mfma_f32_16x16x32_bf16 v[152:155], a[16:19], v[16:19], v[152:155]
  v_cvt_pk_bf16_f32 v50, v188, v189
  v_cvt_pk_bf16_f32 v51, v190, v191
  v_mfma_f32_16x16x32_bf16 v[152:155], a[20:23], v[20:23], v[152:155]
  s_waitcnt lgkmcnt(7)
  s_add_u32 s28, s59, 40960
  buffer_store_dwordx4 v[48:51], v1, s[8:11], s28 offen offset:0 sc1
  v_mfma_f32_16x16x32_bf16 v[196:199], a[24:27], v[24:27], v[196:199]
  s_waitcnt lgkmcnt(6)
  ds_read_b128 a[16:19], v245 offset:7168
  ds_read_b128 a[20:23], v245 offset:17408
  v_mfma_f32_16x16x32_bf16 v[196:199], a[28:31], v[28:31], v[196:199]
  v_mfma_f32_16x16x32_bf16 v[156:159], a[24:27], v[16:19], v[156:159]
  v_cvt_pk_bf16_f32 v52, v192, v193
  v_cvt_pk_bf16_f32 v53, v194, v195
  v_mfma_f32_16x16x32_bf16 v[156:159], a[28:31], v[20:23], v[156:159]
  s_waitcnt lgkmcnt(7)
  v_mfma_f32_16x16x32_bf16 v[200:203], a[32:35], v[24:27], v[200:203]
  s_waitcnt lgkmcnt(6)
  ds_read_b128 a[24:27], v245 offset:8192
  ds_read_b128 a[28:31], v245 offset:18432
  v_mfma_f32_16x16x32_bf16 v[200:203], a[36:39], v[28:31], v[200:203]
  v_mfma_f32_16x16x32_bf16 v[160:163], a[32:35], v[16:19], v[160:163]
  v_cvt_pk_bf16_f32 v54, v196, v197
  v_cvt_pk_bf16_f32 v55, v198, v199
  v_mfma_f32_16x16x32_bf16 v[160:163], a[36:39], v[20:23], v[160:163]
  s_waitcnt lgkmcnt(7)
  buffer_store_dwordx4 v[52:55], v1, s[8:11], s28 offen offset:1024 sc1
  v_mfma_f32_16x16x32_bf16 v[204:207], a[0:3], v[24:27], v[204:207]
  s_waitcnt lgkmcnt(6)
  ds_read_b128 a[32:35], v245 offset:9216
  ds_read_b128 a[36:39], v245 offset:19456
  v_mfma_f32_16x16x32_bf16 v[204:207], a[4:7], v[28:31], v[204:207]
  s_waitcnt lgkmcnt(7)
  v_mfma_f32_16x16x32_bf16 v[208:211], a[8:11], v[24:27], v[208:211]
  s_waitcnt lgkmcnt(6)
  v_cvt_pk_bf16_f32 v56, v200, v201
  v_cvt_pk_bf16_f32 v57, v202, v203
  v_mfma_f32_16x16x32_bf16 v[208:211], a[12:15], v[28:31], v[208:211]
  s_waitcnt lgkmcnt(5)
  buffer_store_dwordx2 v[56:57], v6, s[8:11], s28 offen offset:2048 sc1
  v_mfma_f32_16x16x32_bf16 v[212:215], a[16:19], v[24:27], v[212:215]
  s_waitcnt lgkmcnt(4)
  v_mfma_f32_16x16x32_bf16 v[212:215], a[20:23], v[28:31], v[212:215]
  s_waitcnt lgkmcnt(3)
  v_mfma_f32_16x16x32_bf16 v[216:219], a[24:27], v[24:27], v[216:219]
  s_waitcnt lgkmcnt(2)
  v_cvt_pk_bf16_f32 v80, v204, v205
  v_cvt_pk_bf16_f32 v81, v206, v207
  v_mfma_f32_16x16x32_bf16 v[216:219], a[28:31], v[28:31], v[216:219]
  s_waitcnt lgkmcnt(1)
  v_mfma_f32_16x16x32_bf16 v[220:223], a[32:35], v[24:27], v[220:223]
  s_waitcnt lgkmcnt(0)
  v_cvt_pk_bf16_f32 v82, v208, v209
  v_cvt_pk_bf16_f32 v83, v210, v211
  v_mfma_f32_16x16x32_bf16 v[220:223], a[36:39], v[28:31], v[220:223]
  s_add_u32 s28, s59, 122880
  buffer_store_dwordx4 v[80:83], v1, s[8:11], s28 offen offset:0 sc1
  v_mfma_f32_16x16x32_bf16 v[164:167], a[0:3], v[16:19], v[164:167]
  v_cvt_pk_bf16_f32 v84, v212, v213
  v_cvt_pk_bf16_f32 v85, v214, v215
  v_mfma_f32_16x16x32_bf16 v[164:167], a[4:7], v[20:23], v[164:167]
  v_mfma_f32_16x16x32_bf16 v[168:171], a[8:11], v[16:19], v[168:171]
  v_cvt_pk_bf16_f32 v86, v216, v217
  v_cvt_pk_bf16_f32 v87, v218, v219
  v_mfma_f32_16x16x32_bf16 v[168:171], a[12:15], v[20:23], v[168:171]
  buffer_store_dwordx4 v[84:87], v1, s[8:11], s28 offen offset:1024 sc1
  v_mfma_f32_16x16x32_bf16 v[172:175], a[16:19], v[16:19], v[172:175]
  v_cvt_pk_bf16_f32 v88, v220, v221
  v_cvt_pk_bf16_f32 v89, v222, v223
  v_mfma_f32_16x16x32_bf16 v[172:175], a[20:23], v[20:23], v[172:175]
  buffer_store_dwordx2 v[88:89], v6, s[8:11], s28 offen offset:2048 sc1
  v_mfma_f32_16x16x32_bf16 v[176:179], a[24:27], v[16:19], v[176:179]
  s_waitcnt vmcnt(9)
  v_cvt_pk_bf16_f32 v32, v164, v165
  v_cvt_pk_bf16_f32 v33, v166, v167
  v_mfma_f32_16x16x32_bf16 v[176:179], a[28:31], v[20:23], v[176:179]
  v_mfma_f32_16x16x32_bf16 v[180:183], a[32:35], v[16:19], v[180:183]
  v_cvt_pk_bf16_f32 v34, v168, v169
  v_cvt_pk_bf16_f32 v35, v170, v171
  v_mfma_f32_16x16x32_bf16 v[180:183], a[36:39], v[20:23], v[180:183]
  s_add_u32 s28, s59, 81920
  buffer_store_dwordx4 v[32:35], v1, s[8:11], s28 offen offset:0 sc1
  s_waitcnt vmcnt(9)
  v_cvt_pk_bf16_f32 v36, v172, v173
  v_cvt_pk_bf16_f32 v37, v174, v175
  v_cvt_pk_bf16_f32 v38, v176, v177
  v_cvt_pk_bf16_f32 v39, v178, v179
  buffer_store_dwordx4 v[36:39], v1, s[8:11], s28 offen offset:1024 sc1
  s_waitcnt vmcnt(9)
  v_cvt_pk_bf16_f32 v40, v180, v181
  v_cvt_pk_bf16_f32 v41, v182, v183
  buffer_store_dwordx2 v[40:41], v6, s[8:11], s28 offen offset:2048 sc1
  s_waitcnt vmcnt(0)
  s_barrier
  buffer_atomic_add v13, v12, s[8:11], s39 offen sc1
  buffer_load_dword v14, off, s[8:11], s61 sc1
  v_lshlrev_b32 v11, 16, v104
  v_add_f32 v236, v144, v11
  v_and_b32 v11, 0xffff0000, v104
  v_add_f32 v237, v145, v11
  v_lshlrev_b32 v11, 16, v105
  v_add_f32 v238, v146, v11
  v_and_b32 v11, 0xffff0000, v105
  v_add_f32 v239, v147, v11
  v_lshlrev_b32 v11, 16, v106
  v_add_f32 v240, v148, v11
  v_and_b32 v11, 0xffff0000, v106
  v_add_f32 v241, v149, v11
  v_lshlrev_b32 v11, 16, v107
  v_add_f32 v242, v150, v11
  v_and_b32 v11, 0xffff0000, v107
  v_add_f32 v243, v151, v11
  v_lshlrev_b32 v11, 16, v108
  v_add_f32 v244, v152, v11
  v_and_b32 v11, 0xffff0000, v108
  v_add_f32 v245, v153, v11
  v_lshlrev_b32 v11, 16, v109
  v_add_f32 v246, v154, v11
  v_and_b32 v11, 0xffff0000, v109
  v_add_f32 v247, v155, v11
  v_lshlrev_b32 v11, 16, v110
  v_add_f32 v248, v156, v11
  v_and_b32 v11, 0xffff0000, v110
  v_add_f32 v249, v157, v11
  v_lshlrev_b32 v11, 16, v111
  v_add_f32 v250, v158, v11
  v_and_b32 v11, 0xffff0000, v111
  v_add_f32 v251, v159, v11
  v_lshlrev_b32 v11, 16, v254
  v_add_f32 v252, v160, v11
  v_and_b32 v11, 0xffff0000, v254
  v_add_f32 v253, v161, v11
  v_lshlrev_b32 v11, 16, v255
  v_add_f32 v254, v162, v11
  v_and_b32 v11, 0xffff0000, v255
  v_add_f32 v255, v163, v11
  s_branch L_exs
L_ex1:
  s_cmp_lg_u32 s6, 1
  s_cbranch_scc1 L_ex2
  s_waitcnt vmcnt(12) lgkmcnt(5)
  v_mfma_f32_16x16x32_bf16 v[144:147], a[0:3], v[16:19], v[144:147]
  s_waitcnt vmcnt(11) lgkmcnt(4)
  ds_read_b128 a[24:27], v245 offset:3072
  ds_read_b128 a[28:31], v245 offset:13312
  v_mfma_f32_16x16x32_bf16 v[144:147], a[4:7], v[20:23], v[144:147]
  s_waitcnt vmcnt(10)
  ds_read_b128 a[32:35], v245 offset:4096
  ds_read_b128 a[36:39], v245 offset:14336
  v_mfma_f32_16x16x32_bf16 v[184:187], a[0:3], v[24:27], v[184:187]
  s_waitcnt vmcnt(9)
  v_mfma_f32_16x16x32_bf16 v[184:187], a[4:7], v[28:31], v[184:187]
  s_waitcnt lgkmcnt(7)
  v_mfma_f32_16x16x32_bf16 v[148:151], a[8:11], v[16:19], v[148:151]
  s_waitcnt lgkmcnt(6)
  ds_read_b128 a[0:3], v245 offset:5120
  ds_read_b128 a[4:7], v245 offset:15360
  v_mfma_f32_16x16x32_bf16 v[148:151], a[12:15], v[20:23], v[148:151]
  v_mfma_f32_16x16x32_bf16 v[188:191], a[8:11], v[24:27], v[188:191]
  v_cvt_pk_bf16_f32 v48, v144, v145
  v_cvt_pk_bf16_f32 v49, v146, v147
  v_mfma_f32_16x16x32_bf16 v[188:191], a[12:15], v[28:31], v[188:191]
  s_waitcnt lgkmcnt(7)
  v_mfma_f32_16x16x32_bf16 v[152:155], a[16:19], v[16:19], v[152:155]
  s_waitcnt lgkmcnt(6)
  ds_read_b128 a[8:11], v245 offset:6144
  ds_read_b128 a[12:15], v245 offset:16384
  v_mfma_f32_16x16x32_bf16 v[152:155], a[20:23], v[20:23], v[152:155]
  v_mfma_f32_16x16x32_bf16 v[192:195], a[16:19], v[24:27], v[192:195]
  v_cvt_pk_bf16_f32 v50, v148, v149
  v_cvt_pk_bf16_f32 v51, v150, v151
  v_mfma_f32_16x16x32_bf16 v[192:195], a[20:23], v[28:31], v[192:195]
  s_waitcnt lgkmcnt(7)
  s_add_u32 s28, s59, 0
  buffer_store_dwordx4 v[48:51], v1, s[8:11], s28 offen offset:0 sc1
  v_mfma_f32_16x16x32_bf16 v[156:159], a[24:27], v[16:19], v[156:159]
  s_waitcnt lgkmcnt(6)
  ds_read_b128 a[16:19], v245 offset:7168
  ds_read_b128 a[20:23], v245 offset:17408
  v_mfma_f32_16x16x32_bf16 v[156:159], a[28:31], v[20:23], v[156:159]
  v_mfma_f32_16x16x32_bf16 v[196:199], a[24:27], v[24:27], v[196:199]
  v_cvt_pk_bf16_f32 v52, v152, v153
  v_cvt_pk_bf16_f32 v53, v154, v155
  v_mfma_f32_16x16x32_bf16 v[196:199], a[28:31], v[28:31], v[196:199]
  s_waitcnt lgkmcnt(7)
  v_mfma_f32_16x16x32_bf16 v[160:163], a[32:35], v[16:19], v[160:163]
  s_waitcnt lgkmcnt(6)
  ds_read_b128 a[24:27], v245 offset:8192
  ds_read_b128 a[28:31], v245 offset:18432
  v_mfma_f32_16x16x32_bf16 v[160:163], a[36:39], v[20:23], v[160:163]
  v_mfma_f32_16x16x32_bf16 v[200:203], a[32:35], v[24:27], v[200:203]
  v_cvt_pk_bf16_f32 v54, v156, v157
  v_cvt_pk_bf16_f32 v55, v158, v159
  v_mfma_f32_16x16x32_bf16 v[200:203], a[36:39], v[28:31], v[200:203]
  s_waitcnt lgkmcnt(7)
  buffer_store_dwordx4 v[52:55], v1, s[8:11], s28 offen offset:1024 sc1
  v_mfma_f32_16x16x32_bf16 v[164:167], a[0:3], v[16:19], v[164:167]
  s_waitcnt lgkmcnt(6)
  ds_read_b128 a[32:35], v245 offset:9216
  ds_read_b128 a[36:39], v245 offset:19456
  v_mfma_f32_16x16x32_bf16 v[164:167], a[4:7], v[20:23], v[164:167]
  s_waitcnt lgkmcnt(7)
  v_mfma_f32_16x16x32_bf16 v[168:171], a[8:11], v[16:19], v[168:171]
  s_waitcnt lgkmcnt(6)
  v_cvt_pk_bf16_f32 v56, v160, v161
  v_cvt_pk_bf16_f32 v57, v162, v163
  v_mfma_f32_16x16x32_bf16 v[168:171], a[12:15], v[20:23], v[168:171]
  s_waitcnt lgkmcnt(5)
  buffer_store_dwordx2 v[56:57], v6, s[8:11], s28 offen offset:2048 sc1
  v_mfma_f32_16x16x32_bf16 v[172:175], a[16:19], v[16:19], v[172:175]
  s_waitcnt lgkmcnt(4)
  v_mfma_f32_16x16x32_bf16 v[172:175], a[20:23], v[20:23], v[172:175]
  s_waitcnt lgkmcnt(3)
  v_mfma_f32_16x16x32_bf16 v[176:179], a[24:27], v[16:19], v[176:179]
  s_waitcnt lgkmcnt(2)
  v_cvt_pk_bf16_f32 v80, v164, v165
  v_cvt_pk_bf16_f32 v81, v166, v167
  v_mfma_f32_16x16x32_bf16 v[176:179], a[28:31], v[20:23], v[176:179]
  s_waitcnt lgkmcnt(1)
  v_mfma_f32_16x16x32_bf16 v[180:183], a[32:35], v[16:19], v[180:183]
  s_waitcnt lgkmcnt(0)
  v_cvt_pk_bf16_f32 v82, v168, v169
  v_cvt_pk_bf16_f32 v83, v170, v171
  v_mfma_f32_16x16x32_bf16 v[180:183], a[36:39], v[20:23], v[180:183]
  s_add_u32 s28, s59, 81920
  buffer_store_dwordx4 v[80:83], v1, s[8:11], s28 offen offset:0 sc1
  v_mfma_f32_16x16x32_bf16 v[204:207], a[0:3], v[24:27], v[204:207]
  v_cvt_pk_bf16_f32 v84, v172, v173
  v_cvt_pk_bf16_f32 v85, v174, v175
  v_mfma_f32_16x16x32_bf16 v[204:207], a[4:7], v[28:31], v[204:207]
  v_mfma_f32_16x16x32_bf16 v[208:211], a[8:11], v[24:27], v[208:211]
  v_cvt_pk_bf16_f32 v86, v176, v177
  v_cvt_pk_bf16_f32 v87, v178, v179
  v_mfma_f32_16x16x32_bf16 v[208:211], a[12:15], v[28:31], v[208:211]
  buffer_store_dwordx4 v[84:87], v1, s[8:11], s28 offen offset:1024 sc1
  v_mfma_f32_16x16x32_bf16 v[212:215], a[16:19], v[24:27], v[212:215]
  v_cvt_pk_bf16_f32 v88, v180, v181
  v_cvt_pk_bf16_f32 v89, v182, v183
  v_mfma_f32_16x16x32_bf16 v[212:215], a[20:23], v[28:31], v[212:215]
  buffer_store_dwordx2 v[88:89], v6, s[8:11], s28 offen offset:2048 sc1
  v_mfma_f32_16x16x32_bf16 v[216:219], a[24:27], v[24:27], v[216:219]
  s_waitcnt vmcnt(9)
  v_cvt_pk_bf16_f32 v32, v204, v205
  v_cvt_pk_bf16_f32 v33, v206, v207
  v_mfma_f32_16x16x32_bf16 v[216:219], a[28:31], v[28:31], v[216:219]
  v_mfma_f32_16x16x32_bf16 v[220:223], a[32:35], v[24:27], v[220:223]
  v_cvt_pk_bf16_f32 v34, v208, v209
  v_cvt_pk_bf16_f32 v35, v210, v211
  v_mfma_f32_16x16x32_bf16 v[220:223], a[36:39], v[28:31], v[220:223]
  s_add_u32 s28, s59, 122880
  buffer_store_dwordx4 v[32:35], v1, s[8:11], s28 offen offset:0 sc1
  s_waitcnt vmcnt(9)
  v_cvt_pk_bf16_f32 v36, v212, v213
  v_cvt_pk_bf16_f32 v37, v214, v215
  v_cvt_pk_bf16_f32 v38, v216, v217
  v_cvt_pk_bf16_f32 v39, v218, v219
  buffer_store_dwordx4 v[36:39], v1, s[8:11], s28 offen offset:1024 sc1
  s_waitcnt vmcnt(9)
  v_cvt_pk_bf16_f32 v40, v220, v221
  v_cvt_pk_bf16_f32 v41, v222, v223
  buffer_store_dwordx2 v[40:41], v6, s[8:11], s28 offen offset:2048 sc1
  s_waitcnt vmcnt(0)
  s_barrier
  buffer_atomic_add v13, v12, s[8:11], s39 offen sc1
  buffer_load_dword v14, off, s[8:11], s61 sc1
  v_lshlrev_b32 v11, 16, v104
  v_add_f32 v236, v184, v11
  v_and_b32 v11, 0xffff0000, v104
  v_add_f32 v237, v185, v11
  v_lshlrev_b32 v11, 16, v105
  v_add_f32 v238, v186, v11
  v_and_b32 v11, 0xffff0000, v105
  v_add_f32 v239, v187, v11
  v_lshlrev_b32 v11, 16, v106
  v_add_f32 v240, v188, v11
  v_and_b32 v11, 0xffff0000, v106
  v_add_f32 v241, v189, v11
  v_lshlrev_b32 v11, 16, v107
  v_add_f32 v242, v190, v11
  v_and_b32 v11, 0xffff0000, v107
  v_add_f32 v243, v191, v11
  v_lshlrev_b32 v11, 16, v108
  v_add_f32 v244, v192, v11
  v_and_b32 v11, 0xffff0000, v108
  v_add_f32 v245, v193, v11
  v_lshlrev_b32 v11, 16, v109
  v_add_f32 v246, v194, v11
  v_and_b32 v11, 0xffff0000, v109
  v_add_f32 v247, v195, v11
  v_lshlrev_b32 v11, 16, v110
  v_add_f32 v248, v196, v11
  v_and_b32 v11, 0xffff0000, v110
  v_add_f32 v249, v197, v11
  v_lshlrev_b32 v11, 16, v111
  v_add_f32 v250, v198, v11
  v_and_b32 v11, 0xffff0000, v111
  v_add_f32 v251, v199, v11
  v_lshlrev_b32 v11, 16, v254
  v_add_f32 v252, v200, v11
  v_and_b32 v11, 0xffff0000, v254
  v_add_f32 v253, v201, v11
  v_lshlrev_b32 v11, 16, v255
  v_add_f32 v254, v202, v11
  v_and_b32 v11, 0xffff0000, v255
  v_add_f32 v255, v203, v11
  s_branch L_exs
L_ex2:
  s_cmp_lg_u32 s6, 2
  s_cbranch_scc1 L_ex3
  s_waitcnt vmcnt(10) lgkmcnt(5)
  v_mfma_f32_16x16x32_bf16 v[184:187], a[0:3], v[24:27], v[184:187]
  s_waitcnt vmcnt(9) lgkmcnt(4)
  ds_read_b128 a[24:27], v245 offset:3072
  ds_read_b128 a[28:31], v245 offset:13312
  v_mfma_f32_16x16x32_bf16 v[184:187], a[4:7], v[28:31], v[184:187]
  ds_read_b128 a[32:35], v245 offset:4096
  ds_read_b128 a[36:39], v245 offset:14336
  v_mfma_f32_16x16x32_bf16 v[144:147], a[0:3], v[16:19], v[144:147]
  v_mfma_f32_16x16x32_bf16 v[144:147], a[4:7], v[20:23], v[144:147]
  s_waitcnt lgkmcnt(7)
  v_mfma_f32_16x16x32_bf16 v[188:191], a[8:11], v[24:27], v[188:191]
  s_waitcnt lgkmcnt(6)
  ds_read_b128 a[0:3], v245 offset:5120
  ds_read_b128 a[4:7], v245 offset:15360
  v_mfma_f32_16x16x32_bf16 v[188:191], a[12:15], v[28:31], v[188:191]
  v_mfma_f32_16x16x32_bf16 v[148:151], a[8:11], v[16:19], v[148:151]
  v_cvt_pk_bf16_f32 v48, v184, v185
  v_cvt_pk_bf16_f32 v49, v186, v187
  v_mfma_f32_16x16x32_bf16 v[148:151], a[12:15], v[20:23], v[148:151]
  s_waitcnt lgkmcnt(7)
  v_mfma_f32_16x16x32_bf16 v[192:195], a[16:19], v[24:27], v[192:195]
  s_waitcnt lgkmcnt(6)
  v_cvt_pk_bf16_f32 v80, v144, v145
  v_cvt_pk_bf16_f32 v81, v146, v147
  v_mfma_f32_16x16x32_bf16 v[192:195], a[20:23], v[28:31], v[192:195]
  ds_read_b128 a[8:11], v245 offset:6144
  ds_read_b128 a[12:15], v245 offset:16384
  v_mfma_f32_16x16x32_bf16 v[152:155], a[16:19], v[16:19], v[152:155]
  v_cvt_pk_bf16_f32 v50, v188, v189
  v_cvt_pk_bf16_f32 v51, v190, v191
  v_mfma_f32_16x16x32_bf16 v[152:155], a[20:23], v[20:23], v[152:155]
  s_waitcnt lgkmcnt(7)
  s_add_u32 s28, s59, 40960
  buffer_store_dwordx4 v[48:51], v1, s[8:11], s28 offen offset:0 sc1
  v_mfma_f32_16x16x32_bf16 v[196:199], a[24:27], v[24:27], v[196:199]
  s_waitcnt lgkmcnt(6)
  v_cvt_pk_bf16_f32 v82, v148, v149
  v_cvt_pk_bf16_f32 v83, v150, v151
  v_mfma_f32_16x16x32_bf16 v[196:199], a[28:31], v[28:31], v[196:199]
  ds_read_b128 a[16:19], v245 offset:7168
  ds_read_b128 a[20:23], v245 offset:17408
  v_mfma_f32_16x16x32_bf16 v[156:159], a[24:27], v[16:19], v[156:159]
  v_cvt_pk_bf16_f32 v52, v192, v193
  v_cvt_pk_bf16_f32 v53, v194, v195
  v_mfma_f32_16x16x32_bf16 v[156:159], a[28:31], v[20:23], v[156:159]
  s_waitcnt lgkmcnt(7)
  v_mfma_f32_16x16x32_bf16 v[200:203], a[32:35], v[24:27], v[200:203]
  s_waitcnt lgkmcnt(6)
  ds_read_b128 a[24:27], v245 offset:8192
  ds_read_b128 a[28:31], v245 offset:18432
  v_mfma_f32_16x16x32_bf16 v[200:203], a[36:39], v[28:31], v[200:203]
  v_cvt_pk_bf16_f32 v84, v152, v153
  v_cvt_pk_bf16_f32 v85, v154, v155
  v_mfma_f32_16x16x32_bf16 v[160:163], a[32:35], v[16:19], v[160:163]
  v_cvt_pk_bf16_f32 v54, v196, v197
  v_cvt_pk_bf16_f32 v55, v198, v199
  v_mfma_f32_16x16x32_bf16 v[160:163], a[36:39], v[20:23], v[160:163]
  s_waitcnt lgkmcnt(7)
  buffer_store_dwordx4 v[52:55], v1, s[8:11], s28 offen offset:1024 sc1
  v_mfma_f32_16x16x32_bf16 v[204:207], a[0:3], v[24:27], v[204:207]
  s_waitcnt lgkmcnt(6)
  ds_read_b128 a[32:35], v245 offset:9216
  ds_read_b128 a[36:39], v245 offset:19456
  v_mfma_f32_16x16x32_bf16 v[204:207], a[4:7], v[28:31], v[204:207]
  s_waitcnt lgkmcnt(7)
  v_cvt_pk_bf16_f32 v86, v156, v157
  v_cvt_pk_bf16_f32 v87, v158, v159
  v_mfma_f32_16x16x32_bf16 v[208:211], a[8:11], v[24:27], v[208:211]
  s_waitcnt lgkmcnt(6)
  v_cvt_pk_bf16_f32 v56, v200, v201
  v_cvt_pk_bf16_f32 v57, v202, v203
  v_mfma_f32_16x16x32_bf16 v[208:211], a[12:15], v[28:31], v[208:211]
  s_waitcnt lgkmcnt(5)
  buffer_store_dwordx2 v[56:57], v6, s[8:11], s28 offen offset:2048 sc1
  v_mfma_f32_16x16x32_bf16 v[212:215], a[16:19], v[24:27], v[212:215]
  s_waitcnt lgkmcnt(4)
  s_add_u32 s28, s59, 0
  buffer_store_dwordx4 v[80:83], v1, s[8:11], s28 offen offset:0 sc1
  v_mfma_f32_16x16x32_bf16 v[212:215], a[20:23], v[28:31], v[212:215]
  s_waitcnt lgkmcnt(3)
  buffer_store_dwordx4 v[84:87], v1, s[8:11], s28 offen offset:1024 sc1
  v_mfma_f32_16x16x32_bf16 v[216:219], a[24:27], v[24:27], v[216:219]
  s_waitcnt lgkmcnt(2)
  v_cvt_pk_bf16_f32 v88, v160, v161
  v_cvt_pk_bf16_f32 v89, v162, v163
  v_mfma_f32_16x16x32_bf16 v[216:219], a[28:31], v[28:31], v[216:219]
  s_waitcnt lgkmcnt(1)
  buffer_store_dwordx2 v[88:89], v6, s[8:11], s28 offen offset:2048 sc1
  v_mfma_f32_16x16x32_bf16 v[220:223], a[32:35], v[24:27], v[220:223]
  s_waitcnt vmcnt(9) lgkmcnt(0)
  v_cvt_pk_bf16_f32 v32, v204, v205
  v_cvt_pk_bf16_f32 v33, v206, v207
  v_mfma_f32_16x16x32_bf16 v[220:223], a[36:39], v[28:31], v[220:223]
  v_cvt_pk_bf16_f32 v34, v208, v209
  v_cvt_pk_bf16_f32 v35, v210, v211
  v_mfma_f32_16x16x32_bf16 v[164:167], a[0:3], v[16:19], v[164:167]
  s_add_u32 s28, s59, 122880
  buffer_store_dwordx4 v[32:35], v1, s[8:11], s28 offen offset:0 sc1
  v_mfma_f32_16x16x32_bf16 v[164:167], a[4:7], v[20:23], v[164:167]
  s_waitcnt vmcnt(9)
  v_cvt_pk_bf16_f32 v36, v212, v213
  v_cvt_pk_bf16_f32 v37, v214, v215
  v_mfma_f32_16x16x32_bf16 v[168:171], a[8:11], v[16:19], v[168:171]
  v_cvt_pk_bf16_f32 v38, v216, v217
  v_cvt_pk_bf16_f32 v39, v218, v219
  v_mfma_f32_16x16x32_bf16 v[168:171], a[12:15], v[20:23], v[168:171]
  buffer_store_dwordx4 v[36:39], v1, s[8:11], s28 offen offset:1024 sc1
  v_mfma_f32_16x16x32_bf16 v[172:175], a[16:19], v[16:19], v[172:175]
  s_waitcnt vmcnt(9)
  v_cvt_pk_bf16_f32 v40, v220, v221
  v_cvt_pk_bf16_f32 v41, v222, v223
  v_mfma_f32_16x16x32_bf16 v[172:175], a[20:23], v[20:23], v[172:175]
  buffer_store_dwordx2 v[40:41], v6, s[8:11], s28 offen offset:2048 sc1
  v_mfma_f32_16x16x32_bf16 v[176:179], a[24:27], v[16:19], v[176:179]
  v_mfma_f32_16x16x32_bf16 v[176:179], a[28:31], v[20:23], v[176:179]
  v_mfma_f32_16x16x32_bf16 v[180:183], a[32:35], v[16:19], v[180:183]
  v_mfma_f32_16x16x32_bf16 v[180:183], a[36:39], v[20:23], v[180:183]
  s_waitcnt vmcnt(0)
  s_barrier
  buffer_atomic_add v13, v12, s[8:11], s39 offen sc1
  buffer_load_dword v14, off, s[8:11], s61 sc1
  v_lshlrev_b32 v11, 16, v104
  v_add_f32 v236, v164, v11
  v_and_b32 v11, 0xffff0000, v104
  v_add_f32 v237, v165, v11
  v_lshlrev_b32 v11, 16, v105
  v_add_f32 v238, v166, v11
  v_and_b32 v11, 0xffff0000, v105
  v_add_f32 v239, v167, v11
  v_lshlrev_b32 v11, 16, v106
  v_add_f32 v240, v168, v11
  v_and_b32 v11, 0xffff0000, v106
  v_add_f32 v241, v169, v11
  v_lshlrev_b32 v11, 16, v107
  v_add_f32 v242, v170, v11
  v_and_b32 v11, 0xffff0000, v107
  v_add_f32 v243, v171, v11
  v_lshlrev_b32 v11, 16, v108
  v_add_f32 v244, v172, v11
  v_and_b32 v11, 0xffff0000, v108
  v_add_f32 v245, v173, v11
  v_lshlrev_b32 v11, 16, v109
  v_add_f32 v246, v174, v11
  v_and_b32 v11, 0xffff0000, v109
  v_add_f32 v247, v175, v11
  v_lshlrev_b32 v11, 16, v110
  v_add_f32 v248, v176, v11
  v_and_b32 v11, 0xffff0000, v110
  v_add_f32 v249, v177, v11
  v_lshlrev_b32 v11, 16, v111
  v_add_f32 v250, v178, v11
  v_and_b32 v11, 0xffff0000, v111
  v_add_f32 v251, v179, v11
  v_lshlrev_b32 v11, 16, v254
  v_add_f32 v252, v180, v11
  v_and_b32 v11, 0xffff0000, v254
  v_add_f32 v253, v181, v11
  v_lshlrev_b32 v11, 16, v255
  v_add_f32 v254, v182, v11
  v_and_b32 v11, 0xffff0000, v255
  v_add_f32 v255, v183, v11
  s_branch L_exs
L_ex3:
  s_waitcnt vmcnt(12) lgkmcnt(5)
  v_mfma_f32_16x16x32_bf16 v[144:147], a[0:3], v[16:19], v[144:147]
  s_waitcnt vmcnt(11) lgkmcnt(4)
  ds_read_b128 a[24:27], v245 offset:3072
  ds_read_b128 a[28:31], v245 offset:13312
  v_mfma_f32_16x16x32_bf16 v[144:147], a[4:7], v[20:23], v[144:147]
  s_waitcnt vmcnt(10)
  ds_read_b128 a[32:35], v245 offset:4096
  ds_read_b128 a[36:39], v245 offset:14336
  v_mfma_f32_16x16x32_bf16 v[184:187], a[0:3], v[24:27], v[184:187]
  s_waitcnt vmcnt(9)
  v_mfma_f32_16x16x32_bf16 v[184:187], a[4:7], v[28:31], v[184:187]
  s_waitcnt lgkmcnt(7)
  v_mfma_f32_16x16x32_bf16 v[148:151], a[8:11], v[16:19], v[148:151]
  s_waitcnt lgkmcnt(6)
  ds_read_b128 a[0:3], v245 offset:5120
  ds_read_b128 a[4:7], v245 offset:15360
  v_mfma_f32_16x16x32_bf16 v[148:151], a[12:15], v[20:23], v[148:151]
  v_mfma_f32_16x16x32_bf16 v[188:191], a[8:11], v[24:27], v[188:191]
  v_cvt_pk_bf16_f32 v48, v144, v145
  v_cvt_pk_bf16_f32 v49, v146, v147
  v_mfma_f32_16x16x32_bf16 v[188:191], a[12:15], v[28:31], v[188:191]
  s_waitcnt lgkmcnt(7)
  v_mfma_f32_16x16x32_bf16 v[152:155], a[16:19], v[16:19], v[152:155]
  s_waitcnt lgkmcnt(6)
  v_cvt_pk_bf16_f32 v80, v184, v185
  v_cvt_pk_bf16_f32 v81, v186, v187
  v_mfma_f32_16x16x32_bf16 v[152:155], a[20:23], v[20:23], v[152:155]
  ds_read_b128 a[8:11], v245 offset:6144
  ds_read_b128 a[12:15], v245 offset:16384
  v_mfma_f32_16x16x32_bf16 v[192:195], a[16:19], v[24:27], v[192:195]
  v_cvt_pk_bf16_f32 v50, v148, v149
  v_cvt_pk_bf16_f32 v51, v150, v151
  v_mfma_f32_16x16x32_bf16 v[192:195], a[20:23], v[28:31], v[192:195]
  s_waitcnt lgkmcnt(7)
  s_add_u32 s28, s59, 0
  buffer_store_dwordx4 v[48:51], v1, s[8:11], s28 offen offset:0 sc1
  v_mfma_f32_16x16x32_bf16 v[156:159], a[24:27], v[16:19], v[156:159]
  s_waitcnt lgkmcnt(6)
  v_cvt_pk_bf16_f32 v82, v188, v189
  v_cvt_pk_bf16_f32 v83, v190, v191
  v_mfma_f32_16x16x32_bf16 v[156:159], a[28:31], v[20:23], v[156:159]
  ds_read_b128 a[16:19], v245 offset:7168
  ds_read_b128 a[20:23], v245 offset:17408
  v_mfma_f32_16x16x32_bf16 v[196:199], a[24:27], v[24:27], v[196:199]
  v_cvt_pk_bf16_f32 v52, v152, v153
  v_cvt_pk_bf16_f32 v53, v154, v155
  v_mfma_f32_16x16x32_bf16 v[196:199], a[28:31], v[28:31], v[196:199]
  s_waitcnt lgkmcnt(7)
  v_mfma_f32_16x16x32_bf16 v[160:163], a[32:35], v[16:19], v[160:163]
  s_waitcnt lgkmcnt(6)
  ds_read_b128 a[24:27], v245 offset:8192
  ds_read_b128 a[28:31], v245 offset:18432
  v_mfma_f32_16x16x32_bf16 v[160:163], a[36:39], v[20:23], v[160:163]
  v_cvt_pk_bf16_f32 v84, v192, v193
  v_cvt_pk_bf16_f32 v85, v194, v195
  v_mfma_f32_16x16x32_bf16 v[200:203], a[32:35], v[24:27], v[200:203]
  v_cvt_pk_bf16_f32 v54, v156, v157
  v_cvt_pk_bf16_f32 v55, v158, v159
  v_mfma_f32_16x16x32_bf16 v[200:203], a[36:39], v[28:31], v[200:203]
  s_waitcnt lgkmcnt(7)
  buffer_store_dwordx4 v[52:55], v1, s[8:11], s28 offen offset:1024 sc1
  v_mfma_f32_16x16x32_bf16 v[164:167], a[0:3], v[16:19], v[164:167]
  s_waitcnt lgkmcnt(6)
  ds_read_b128 a[32:35], v245 offset:9216
  ds_read_b128 a[36:39], v245 offset:19456
  v_mfma_f32_16x16x32_bf16 v[164:167], a[4:7], v[20:23], v[164:167]
  s_waitcnt lgkmcnt(7)
  v_cvt_pk_bf16_f32 v86, v196, v197
  v_cvt_pk_bf16_f32 v87, v198, v199
  v_mfma_f32_16x16x32_bf16 v[168:171], a[8:11], v[16:19], v[168:171]
  s_waitcnt lgkmcnt(6)
  v_cvt_pk_bf16_f32 v56, v160, v161
  v_cvt_pk_bf16_f32 v57, v162, v163
  v_mfma_f32_16x16x32_bf16 v[168:171], a[12:15], v[20:23], v[168:171]
  s_waitcnt lgkmcnt(5)
  buffer_store_dwordx2 v[56:57], v6, s[8:11], s28 offen offset:2048 sc1
  v_mfma_f32_16x16x32_bf16 v[172:175], a[16:19], v[16:19], v[172:175]
  s_waitcnt lgkmcnt(4)
  s_add_u32 s28, s59, 40960
  buffer_store_dwordx4 v[80:83], v1, s[8:11], s28 offen offset:0 sc1
  v_mfma_f32_16x16x32_bf16 v[172:175], a[20:23], v[20:23], v[172:175]
  s_waitcnt lgkmcnt(3)
  buffer_store_dwordx4 v[84:87], v1, s[8:11], s28 offen offset:1024 sc1
  v_mfma_f32_16x16x32_bf16 v[176:179], a[24:27], v[16:19], v[176:179]
  s_waitcnt lgkmcnt(2)
  v_cvt_pk_bf16_f32 v88, v200, v201
  v_cvt_pk_bf16_f32 v89, v202, v203
  v_mfma_f32_16x16x32_bf16 v[176:179], a[28:31], v[20:23], v[176:179]
  s_waitcnt lgkmcnt(1)
  buffer_store_dwordx2 v[88:89], v6, s[8:11], s28 offen offset:2048 sc1
  v_mfma_f32_16x16x32_bf16 v[180:183], a[32:35], v[16:19], v[180:183]
  s_waitcnt vmcnt(9) lgkmcnt(0)
  v_cvt_pk_bf16_f32 v32, v164, v165
  v_cvt_pk_bf16_f32 v33, v166, v167
  v_mfma_f32_16x16x32_bf16 v[180:183], a[36:39], v[20:23], v[180:183]
  v_cvt_pk_bf16_f32 v34, v168, v169
  v_cvt_pk_bf16_f32 v35, v170, v171
  v_mfma_f32_16x16x32_bf16 v[204:207], a[0:3], v[24:27], v[204:207]
  s_add_u32 s28, s59, 81920
  buffer_store_dwordx4 v[32:35], v1, s[8:11], s28 offen offset:0 sc1
  v_mfma_f32_16x16x32_bf16 v[204:207], a[4:7], v[28:31], v[204:207]
  s_waitcnt vmcnt(9)
  v_cvt_pk_bf16_f32 v36, v172, v173
  v_cvt_pk_bf16_f32 v37, v174, v175
  v_mfma_f32_16x16x32_bf16 v[208:211], a[8:11], v[24:27], v[208:211]
  v_cvt_pk_bf16_f32 v38, v176, v177
  v_cvt_pk_bf16_f32 v39, v178, v179
  v_mfma_f32_16x16x32_bf16 v[208:211], a[12:15], v[28:31], v[208:211]
  buffer_store_dwordx4 v[36:39], v1, s[8:11], s28 offen offset:1024 sc1
  v_mfma_f32_16x16x32_bf16 v[212:215], a[16:19], v[24:27], v[212:215]
  s_waitcnt vmcnt(9)
  v_cvt_pk_bf16_f32 v40, v180, v181
  v_cvt_pk_bf16_f32 v41, v182, v183
  v_mfma_f32_16x16x32_bf16 v[212:215], a[20:23], v[28:31], v[212:215]
  buffer_store_dwordx2 v[40:41], v6, s[8:11], s28 offen offset:2048 sc1
  v_mfma_f32_16x16x32_bf16 v[216:219], a[24:27], v[24:27], v[216:219]
  v_mfma_f32_16x16x32_bf16 v[216:219], a[28:31], v[28:31], v[216:219]
  v_mfma_f32_16x16x32_bf16 v[220:223], a[32:35], v[24:27], v[220:223]
  v_mfma_f32_16x16x32_bf16 v[220:223], a[36:39], v[28:31], v[220:223]
  s_waitcnt vmcnt(0)
  s_barrier
  buffer_atomic_add v13, v12, s[8:11], s39 offen sc1
  buffer_load_dword v14, off, s[8:11], s61 sc1
  v_lshlrev_b32 v11, 16, v104
  v_add_f32 v236, v204, v11
  v_and_b32 v11, 0xffff0000, v104
  v_add_f32 v237, v205, v11
  v_lshlrev_b32 v11, 16, v105
  v_add_f32 v238, v206, v11
  v_and_b32 v11, 0xffff0000, v105
  v_add_f32 v239, v207, v11
  v_lshlrev_b32 v11, 16, v106
  v_add_f32 v240, v208, v11
  v_and_b32 v11, 0xffff0000, v106
  v_add_f32 v241, v209, v11
  v_lshlrev_b32 v11, 16, v107
  v_add_f32 v242, v210, v11
  v_and_b32 v11, 0xffff0000, v107
  v_add_f32 v243, v211, v11
  v_lshlrev_b32 v11, 16, v108
  v_add_f32 v244, v212, v11
  v_and_b32 v11, 0xffff0000, v108
  v_add_f32 v245, v213, v11
  v_lshlrev_b32 v11, 16, v109
  v_add_f32 v246, v214, v11
  v_and_b32 v11, 0xffff0000, v109
  v_add_f32 v247, v215, v11
  v_lshlrev_b32 v11, 16, v110
  v_add_f32 v248, v216, v11
  v_and_b32 v11, 0xffff0000, v110
  v_add_f32 v249, v217, v11
  v_lshlrev_b32 v11, 16, v111
  v_add_f32 v250, v218, v11
  v_and_b32 v11, 0xffff0000, v111
  v_add_f32 v251, v219, v11
  v_lshlrev_b32 v11, 16, v254
  v_add_f32 v252, v220, v11
  v_and_b32 v11, 0xffff0000, v254
  v_add_f32 v253, v221, v11
  v_lshlrev_b32 v11, 16, v255
  v_add_f32 v254, v222, v11
  v_and_b32 v11, 0xffff0000, v255
  v_add_f32 v255, v223, v11
L_exs:
  s_mov_b32 s30, 40000
L_exp:
  s_waitcnt vmcnt(0)
  v_cmp_gt_u32 vcc, 4, v14
  s_sub_u32 s30, s30, 1
  s_cmp_eq_u32 s30, 0
  s_cbranch_scc1 L_exq
  s_nop 1
  s_cbranch_vccz L_exq
  buffer_load_dword v14, off, s[8:11], s61 sc1
  s_branch L_exp
L_exq:
  buffer_load_dwordx4 v[48:51], v1, s[8:11], s56 offen sc1
  buffer_load_dwordx4 v[52:55], v1, s[8:11], s56 offen offset:1024 sc1
  buffer_load_dwordx2 v[56:57], v6, s[8:11], s56 offen offset:2048 sc1
  buffer_load_dwordx4 v[80:83], v1, s[8:11], s57 offen sc1
  buffer_load_dwordx4 v[84:87], v1, s[8:11], s57 offen offset:1024 sc1
  buffer_load_dwordx2 v[88:89], v6, s[8:11], s57 offen offset:2048 sc1
  buffer_load_dwordx4 v[224:227], v1, s[8:11], s58 offen sc1
  buffer_load_dwordx4 v[228:231], v1, s[8:11], s58 offen offset:1024 sc1
  buffer_load_dwordx2 v[232:233], v6, s[8:11], s58 offen offset:2048 sc1
  s_waitcnt vmcnt(8)
  v_lshlrev_b32 v14, 16, v48
  v_and_b32 v11, 0xffff0000, v48
  v_add_f32 v236, v236, v14
  v_add_f32 v237, v237, v11
  v_lshlrev_b32 v14, 16, v49
  v_and_b32 v11, 0xffff0000, v49
  v_add_f32 v238, v238, v14
  v_add_f32 v239, v239, v11
  v_lshlrev_b32 v14, 16, v50
  v_and_b32 v11, 0xffff0000, v50
  v_add_f32 v240, v240, v14
  v_add_f32 v241, v241, v11
  v_lshlrev_b32 v14, 16, v51
  v_and_b32 v11, 0xffff0000, v51
  v_add_f32 v242, v242, v14
  v_add_f32 v243, v243, v11
  s_waitcnt vmcnt(7)
  v_lshlrev_b32 v14, 16, v52
  v_and_b32 v11, 0xffff0000, v52
  v_add_f32 v244, v244, v14
  v_add_f32 v245, v245, v11
  v_lshlrev_b32 v14, 16, v53
  v_and_b32 v11, 0xffff0000, v53
  v_add_f32 v246, v246, v14
  v_add_f32 v247, v247, v11
  v_lshlrev_b32 v14, 16, v54
  v_and_b32 v11, 0xffff0000, v54
  v_add_f32 v248, v248, v14
  v_add_f32 v249, v249, v11
  v_lshlrev_b32 v14, 16, v55
  v_and_b32 v11, 0xffff0000, v55
  v_add_f32 v250, v250, v14
  v_add_f32 v251, v251, v11
  s_waitcnt vmcnt(6)
  v_lshlrev_b32 v14, 16, v56
  v_and_b32 v11, 0xffff0000, v56
  v_add_f32 v252, v252, v14
  v_add_f32 v253, v253, v11
  v_lshlrev_b32 v14, 16, v57
  v_and_b32 v11, 0xffff0000, v57
  v_add_f32 v254, v254, v14
  v_add_f32 v255, v255, v11
  s_waitcnt vmcnt(5)
  v_lshlrev_b32 v14, 16, v80
  v_and_b32 v11, 0xffff0000, v80
  v_add_f32 v236, v236, v14
  v_add_f32 v237, v237, v11
  v_lshlrev_b32 v14, 16, v81
  v_and_b32 v11, 0xffff0000, v81
  v_add_f32 v238, v238, v14
  v_add_f32 v239, v239, v11
  v_lshlrev_b32 v14, 16, v82
  v_and_b32 v11, 0xffff0000, v82
  v_add_f32 v240, v240, v14
  v_add_f32 v241, v241, v11
  v_lshlrev_b32 v14, 16, v83
  v_and_b32 v11, 0xffff0000, v83
  v_add_f32 v242, v242, v14
  v_add_f32 v243, v243, v11
  s_waitcnt vmcnt(4)
  v_lshlrev_b32 v14, 16, v84
  v_and_b32 v11, 0xffff0000, v84
  v_add_f32 v244, v244, v14
  v_add_f32 v245, v245, v11
  v_lshlrev_b32 v14, 16, v85
  v_and_b32 v11, 0xffff0000, v85
  v_add_f32 v246, v246, v14
  v_add_f32 v247, v247, v11
  v_lshlrev_b32 v14, 16, v86
  v_and_b32 v11, 0xffff0000, v86
  v_add_f32 v248, v248, v14
  v_add_f32 v249, v249, v11
  v_lshlrev_b32 v14, 16, v87
  v_and_b32 v11, 0xffff0000, v87
  v_add_f32 v250, v250, v14
  v_add_f32 v251, v251, v11
  s_waitcnt vmcnt(3)
  v_lshlrev_b32 v14, 16, v88
  v_and_b32 v11, 0xffff0000, v88
  v_add_f32 v252, v252, v14
  v_add_f32 v253, v253, v11
  v_lshlrev_b32 v14, 16, v89
  v_and_b32 v11, 0xffff0000, v89
  v_add_f32 v254, v254, v14
  v_add_f32 v255, v255, v11
  s_waitcnt vmcnt(2)
  v_lshlrev_b32 v14, 16, v224
  v_and_b32 v11, 0xffff0000, v224
  v_add_f32 v236, v236, v14
  v_add_f32 v237, v237, v11
  v_lshlrev_b32 v14, 16, v225
  v_and_b32 v11, 0xffff0000, v225
  v_add_f32 v238, v238, v14
  v_add_f32 v239, v239, v11
  v_cvt_pk_bf16_f32 v112, v236, v237
  v_cvt_pk_bf16_f32 v113, v238, v239
  buffer_store_dwordx2 v[112:113], v5, s[88:91], s60 offen offset:0
  v_lshlrev_b32 v14, 16, v226
  v_and_b32 v11, 0xffff0000, v226
  v_add_f32 v240, v240, v14
  v_add_f32 v241, v241, v11
  v_lshlrev_b32 v14, 16, v227
  v_and_b32 v11, 0xffff0000, v227
  v_add_f32 v242, v242, v14
  v_add_f32 v243, v243, v11
  v_cvt_pk_bf16_f32 v114, v240, v241
  v_cvt_pk_bf16_f32 v115, v242, v243
  buffer_store_dwordx2 v[114:115], v5, s[88:91], s60 offen offset:32
  s_waitcnt vmcnt(3)
  v_lshlrev_b32 v14, 16, v228
  v_and_b32 v11, 0xffff0000, v228
  v_add_f32 v244, v244, v14
  v_add_f32 v245, v245, v11
  v_lshlrev_b32 v14, 16, v229
  v_and_b32 v11, 0xffff0000, v229
  v_add_f32 v246, v246, v14
  v_add_f32 v247, v247, v11
  v_cvt_pk_bf16_f32 v116, v244, v245
  v_cvt_pk_bf16_f32 v117, v246, v247
  buffer_store_dwordx2 v[116:117], v5, s[88:91], s60 offen offset:64
  v_lshlrev_b32 v14, 16, v230
  v_and_b32 v11, 0xffff0000, v230
  v_add_f32 v248, v248, v14
  v_add_f32 v249, v249, v11
  v_lshlrev_b32 v14, 16, v231
  v_and_b32 v11, 0xffff0000, v231
  v_add_f32 v250, v250, v14
  v_add_f32 v251, v251, v11
  v_cvt_pk_bf16_f32 v118, v248, v249
  v_cvt_pk_bf16_f32 v119, v250, v251
  buffer_store_dwordx2 v[118:119], v5, s[88:91], s60 offen offset:96
  s_waitcnt vmcnt(4)
  v_lshlrev_b32 v14, 16, v232
  v_and_b32 v11, 0xffff0000, v232
  v_add_f32 v252, v252, v14
  v_add_f32 v253, v253, v11
  v_lshlrev_b32 v14, 16, v233
  v_and_b32 v11, 0xffff0000, v233
  v_add_f32 v254, v254, v14
  v_add_f32 v255, v255, v11
  v_cvt_pk_bf16_f32 v120, v252, v253
  v_cvt_pk_bf16_f32 v121, v254, v255
  buffer_store_dwordx2 v[120:121], v5, s[88:91], s60 offen offset:128
  s_endpgm
L_s1_k:
  buffer_atomic_add v13, v12, s[24:27], s95 offen sc1
  s_branch L_s1b_k
L_sl_s1k:
  s_mov_b32 s30, 40000
L_sl_s1k_l:
  s_sleep 2
  buffer_load_dword v11, v14, s[24:27], 0 offen sc1
  s_sub_u32 s30, s30, 1
  s_waitcnt vmcnt(0)
  v_cmp_gt_u32 vcc, 4, v11
  s_cmp_eq_u32 s30, 0
  s_cbranch_scc1 L_bk_s1k
  s_nop 2
  s_cbranch_vccnz L_sl_s1k_l
  s_branch L_bk_s1k
L_s1_v:
  buffer_atomic_add v13, v12, s[24:27], s95 offen sc1
  s_branch L_s1b_v
L_sl_s1v:
  s_mov_b32 s30, 40000
L_sl_s1v_l:
  s_sleep 2
  buffer_load_dword v11, v14, s[24:27], 0 offen sc1
  s_sub_u32 s30, s30, 1
  s_waitcnt vmcnt(0)
  v_cmp_gt_u32 vcc, 4, v11
  s_cmp_eq_u32 s30, 0
  s_cbranch_scc1 L_bk_s1v
  s_nop 2
  s_cbranch_vccnz L_sl_s1v_l
  s_branch L_bk_s1v
L_sl_s2:
  s_mov_b32 s30, 40000
L_sl_s2_l:
  s_sleep 2
  buffer_load_dword v14, off, s[8:11], s35 sc1
  s_sub_u32 s30, s30, 1
  s_waitcnt vmcnt(0)
  v_cmp_gt_u32 vcc, 8, v14
  s_cmp_eq_u32 s30, 0
  s_cbranch_scc1 L_bk_s2
  s_nop 2
  s_cbranch_vccnz L_sl_s2_l
  s_branch L_bk_s2
L_att_z:
  s_waitcnt vmcnt(1)
  s_branch L_att_e
L_sl_s3h1:
  s_mov_b32 s30, 40000
L_sl_s3h1_l:
  s_sleep 2
  buffer_load_dword v11, off, s[8:11], s35 sc1
  s_sub_u32 s30, s30, 1
  s_waitcnt vmcnt(0)
  v_cmp_gt_u32 vcc, 8, v11
  s_cmp_eq_u32 s30, 0
  s_cbranch_scc1 L_bk_s3h1
  s_nop 2
  s_cbranch_vccnz L_sl_s3h1_l
  s_branch L_bk_s3h1
L_sl_s51:
  s_mov_b32 s30, 40000
L_sl_s51_l:
  s_sleep 2
  buffer_load_dword v14, off, s[8:11], s53 sc1
  s_sub_u32 s30, s30, 1
  s_waitcnt vmcnt(0)
  v_cmp_gt_u32 vcc, 40, v14
  s_cmp_eq_u32 s30, 0
  s_cbranch_scc1 L_bk_s51
  s_nop 2
  s_cbranch_vccnz L_sl_s51_l
  s_branch L_bk_s51
L_sl_s3h2:
  s_mov_b32 s30, 40000
L_sl_s3h2_l:
  s_sleep 2
  buffer_load_dword v11, off, s[8:11], s35 sc1
  s_sub_u32 s30, s30, 1
  s_waitcnt vmcnt(0)
  v_cmp_gt_u32 vcc, 8, v11
  s_cmp_eq_u32 s30, 0
  s_cbranch_scc1 L_bk_s3h2
  s_nop 2
  s_cbranch_vccnz L_sl_s3h2_l
  s_branch L_bk_s3h2
L_sl_s52:
  s_mov_b32 s30, 40000
L_sl_s52_l:
  s_sleep 2
  buffer_load_dword v14, off, s[8:11], s53 sc1
  s_sub_u32 s30, s30, 1
  s_waitcnt vmcnt(0)
  v_cmp_gt_u32 vcc, 40, v14
  s_cmp_eq_u32 s30, 0
  s_cbranch_scc1 L_bk_s52
  s_nop 2
  s_cbranch_vccnz L_sl_s52_l
  s_branch L_bk_s52
L_sl_s3h3:
  s_mov_b32 s30, 40000
L_sl_s3h3_l:
  s_sleep 2
  buffer_load_dword v11, off, s[8:11], s35 sc1
  s_sub_u32 s30, s30, 1
  s_waitcnt vmcnt(0)
  v_cmp_gt_u32 vcc, 8, v11
  s_cmp_eq_u32 s30, 0
  s_cbranch_scc1 L_bk_s3h3
  s_nop 2
  s_cbranch_vccnz L_sl_s3h3_l
  s_branch L_bk_s3h3
L_sl_s53:
  s_mov_b32 s30, 40000
L_sl_s53_l:
  s_sleep 2
  buffer_load_dword v14, off, s[8:11], s53 sc1
  s_sub_u32 s30, s30, 1
  s_waitcnt vmcnt(0)
  v_cmp_gt_u32 vcc, 40, v14
  s_cmp_eq_u32 s30, 0
  s_cbranch_scc1 L_bk_s53
  s_nop 2
  s_cbranch_vccnz L_sl_s53_l
  s_branch L_bk_s53
L_sl_s3h4:
  s_mov_b32 s30, 40000
L_sl_s3h4_l:
  s_sleep 2
  buffer_load_dword v11, off, s[8:11], s35 sc1
  s_sub_u32 s30, s30, 1
  s_waitcnt vmcnt(0)
  v_cmp_gt_u32 vcc, 8, v11
  s_cmp_eq_u32 s30, 0
  s_cbranch_scc1 L_bk_s3h4
  s_nop 2
  s_cbranch_vccnz L_sl_s3h4_l
  s_branch L_bk_s3h4
L_sl_s54:
  s_mov_b32 s30, 40000
L_sl_s54_l:
  s_sleep 2
  buffer_load_dword v14, off, s[8:11], s53 sc1
  s_sub_u32 s30, s30, 1
  s_waitcnt vmcnt(0)
  v_cmp_gt_u32 vcc, 40, v14
  s_cmp_eq_u32 s30, 0
  s_cbranch_scc1 L_bk_s54
  s_nop 2
  s_cbranch_vccnz L_sl_s54_l
  s_branch L_bk_s54
L_att_redo:
  s_mov_b32 s38, 1
  s_mov_b32 s18, 0
  s_mov_b32 s97, 536870912
  s_sub_u32 s28, 15, s5
  s_lshl_b32 s28, s28, 3
  s_add_u32 s28, s28, s3
  s_mul_i32 s28, s28, 16
  s_add_u32 s20, s28, 0
  s_sub_u32 s28, 15, s5
  s_lshl_b32 s28, s28, 3
  s_add_u32 s28, s28, 7
  s_sub_u32 s28, s28, s3
  s_mul_i32 s28, s28, 16
  s_add_u32 s21, s28, 0
  s_mov_b32 s28, s5
  s_lshl_b32 s28, s28, 3
  s_add_u32 s28, s28, s3
  s_mul_i32 s28, s28, 16
  s_add_u32 s22, s28, 0
  s_mov_b32 s28, s5
  s_lshl_b32 s28, s28, 3
  s_add_u32 s28, s28, 7
  s_sub_u32 s28, s28, s3
  s_mul_i32 s28, s28, 16
  s_add_u32 s23, s28, 0
  v_and_b32 v8, 15, v0
  v_bfe_u32 v7, v0, 4, 2
  v_lshlrev_b32 v7, 2, v7
  v_add_u32 v80, s20, v8
  v_mov_b32 v84, 0xf149f2ca
  v_add_u32 v81, s21, v8
  v_mov_b32 v85, 0xf149f2ca
  v_add_u32 v82, s22, v8
  v_mov_b32 v86, 0xf149f2ca
  v_add_u32 v83, s23, v8
  v_mov_b32 v87, 0xf149f2ca
  s_sub_u32 s35, 16, s5
  s_lshl_b32 s35, s35, 3
  s_mov_b32 s39, 0
L_att_max:
  s_lshr_b32 s28, s39, 3
  s_lshl_b32 s28, s28, 16
  s_and_b32 s29, s39, 7
  s_lshl_b32 s29, s29, 12
  s_add_u32 s28, s28, s29
  buffer_load_dwordx4 a[0:3], v1, s[12:15], s28 offen offset:0 sc1
  buffer_load_dwordx4 a[4:7], v1, s[12:15], s28 offen offset:1024 sc1
  buffer_load_dwordx4 a[8:11], v1, s[12:15], s28 offen offset:2048 sc1
  buffer_load_dwordx4 a[12:15], v1, s[12:15], s28 offen offset:3072 sc1
  s_waitcnt vmcnt(0)
  v_mfma_f32_16x16x32_bf16 v[16:19], a[0:3], v[144:147], 0
  v_mfma_f32_16x16x32_bf16 v[16:19], a[4:7], v[148:151], v[16:19]
  v_mfma_f32_16x16x32_bf16 v[16:19], a[8:11], v[152:155], v[16:19]
  v_mfma_f32_16x16x32_bf16 v[16:19], a[12:15], v[156:159], v[16:19]
  v_mfma_f32_16x16x32_bf16 v[20:23], a[0:3], v[160:163], 0
  v_mfma_f32_16x16x32_bf16 v[20:23], a[4:7], v[164:167], v[20:23]
  v_mfma_f32_16x16x32_bf16 v[20:23], a[8:11], v[168:171], v[20:23]
  v_mfma_f32_16x16x32_bf16 v[20:23], a[12:15], v[172:175], v[20:23]
  v_mfma_f32_16x16x32_bf16 v[24:27], a[0:3], v[176:179], 0
  v_mfma_f32_16x16x32_bf16 v[24:27], a[4:7], v[180:183], v[24:27]
  v_mfma_f32_16x16x32_bf16 v[24:27], a[8:11], v[184:187], v[24:27]
  v_mfma_f32_16x16x32_bf16 v[24:27], a[12:15], v[188:191], v[24:27]
  v_mfma_f32_16x16x32_bf16 v[28:31], a[0:3], v[192:195], 0
  v_mfma_f32_16x16x32_bf16 v[28:31], a[4:7], v[196:199], v[28:31]
  v_mfma_f32_16x16x32_bf16 v[28:31], a[8:11], v[200:203], v[28:31]
  v_mfma_f32_16x16x32_bf16 v[28:31], a[12:15], v[204:207], v[28:31]
  v_add_u32 v14, 0, v7
  v_cmp_le_u32 vcc, v14, v80
  v_max_f32 v10, v84, v16
  s_nop 0
  v_cndmask_b32 v84, v84, v10, vcc
  v_cmp_le_u32 vcc, v14, v81
  v_max_f32 v10, v85, v20
  s_nop 0
  v_cndmask_b32 v85, v85, v10, vcc
  v_cmp_le_u32 vcc, v14, v82
  v_max_f32 v10, v86, v24
  s_nop 0
  v_cndmask_b32 v86, v86, v10, vcc
  v_cmp_le_u32 vcc, v14, v83
  v_max_f32 v10, v87, v28
  s_nop 0
  v_cndmask_b32 v87, v87, v10, vcc
  v_add_u32 v14, 1, v7
  v_cmp_le_u32 vcc, v14, v80
  v_max_f32 v10, v84, v17
  s_nop 0
  v_cndmask_b32 v84, v84, v10, vcc
  v_cmp_le_u32 vcc, v14, v81
  v_max_f32 v10, v85, v21
  s_nop 0
  v_cndmask_b32 v85, v85, v10, vcc
  v_cmp_le_u32 vcc, v14, v82
  v_max_f32 v10, v86, v25
  s_nop 0
  v_cndmask_b32 v86, v86, v10, vcc
  v_cmp_le_u32 vcc, v14, v83
  v_max_f32 v10, v87, v29
  s_nop 0
  v_cndmask_b32 v87, v87, v10, vcc
  v_add_u32 v14, 2, v7
  v_cmp_le_u32 vcc, v14, v80
  v_max_f32 v10, v84, v18
  s_nop 0
  v_cndmask_b32 v84, v84, v10, vcc
  v_cmp_le_u32 vcc, v14, v81
  v_max_f32 v10, v85, v22
  s_nop 0
  v_cndmask_b32 v85, v85, v10, vcc
  v_cmp_le_u32 vcc, v14, v82
  v_max_f32 v10, v86, v26
  s_nop 0
  v_cndmask_b32 v86, v86, v10, vcc
  v_cmp_le_u32 vcc, v14, v83
  v_max_f32 v10, v87, v30
  s_nop 0
  v_cndmask_b32 v87, v87, v10, vcc
  v_add_u32 v14, 3, v7
  v_cmp_le_u32 vcc, v14, v80
  v_max_f32 v10, v84, v19
  s_nop 0
  v_cndmask_b32 v84, v84, v10, vcc
  v_cmp_le_u32 vcc, v14, v81
  v_max_f32 v10, v85, v23
  s_nop 0
  v_cndmask_b32 v85, v85, v10, vcc
  v_cmp_le_u32 vcc, v14, v82
  v_max_f32 v10, v86, v27
  s_nop 0
  v_cndmask_b32 v86, v86, v10, vcc
  v_cmp_le_u32 vcc, v14, v83
  v_max_f32 v10, v87, v31
  s_nop 0
  v_cndmask_b32 v87, v87, v10, vcc
  v_add_u32 v7, 16, v7
  s_add_u32 s39, s39, 1
  s_cmp_lt_u32 s39, s35
  s_cbranch_scc1 L_att_max
  v_mov_b32 v220, v84
  v_mov_b32 v221, v85
  v_mov_b32 v222, v86
  v_mov_b32 v223, v87
  v_permlane16_swap_b32 v84, v220
  v_permlane16_swap_b32 v85, v221
  v_permlane16_swap_b32 v86, v222
  v_permlane16_swap_b32 v87, v223
  v_max_f32 v84, v84, v220
  v_max_f32 v85, v85, v221
  v_max_f32 v86, v86, v222
  v_max_f32 v87, v87, v223
  v_mov_b32 v220, v84
  v_mov_b32 v221, v85
  v_mov_b32 v222, v86
  v_mov_b32 v223, v87
  v_permlane32_swap_b32 v84, v220
  v_permlane32_swap_b32 v85, v221
  v_permlane32_swap_b32 v86, v222
  v_permlane32_swap_b32 v87, v223
  v_max_f32 v84, v84, v220
  v_max_f32 v85, v85, v221
  v_max_f32 v86, v86, v222
  v_max_f32 v87, v87, v223
  v_sub_f32 v112, 0, v84
  v_sub_f32 v113, 0, v84
  v_sub_f32 v114, 0, v84
  v_sub_f32 v115, 0, v84
  v_sub_f32 v116, 0, v85
  v_sub_f32 v117, 0, v85
  v_sub_f32 v118, 0, v85
  v_sub_f32 v119, 0, v85
  v_sub_f32 v120, 0, v86
  v_sub_f32 v121, 0, v86
  v_sub_f32 v122, 0, v86
  v_sub_f32 v123, 0, v86
  v_sub_f32 v124, 0, v87
  v_sub_f32 v125, 0, v87
  v_sub_f32 v126, 0, v87
  v_sub_f32 v127, 0, v87
  s_sub_u32 s28, 15, s5
  s_bitcmp1_b32 s7, 0
  s_cselect_b32 s29, s28, s5
  s_lshl_b32 s29, s29, 3
  s_lshl_b32 s30, s3, 1
  s_add_u32 s29, s29, s30
  s_mul_i32 s29, s29, 188416
  s_mul_i32 s30, s6, 47104
  s_add_u32 s29, s29, s30
  s_add_u32 s46, s29, 38797312
  s_add_u32 s47, s46, 188416
  s_mul_i32 s44, s3, 5120
  s_mul_i32 s0, s3, 5120
  s_add_u32 s1, s0, 163840
  s_bitcmp1_b32 s28, 0
  s_cselect_b32 s29, 0, 81920
  s_add_u32 s96, s0, s29
  s_mov_b32 s42, 268435456
  s_mov_b32 s20, 536870912
  s_mov_b32 s21, 536870912
  s_mov_b32 s22, 536870912
  s_mov_b32 s23, 536870912
  s_mov_b32 s24, 536870912
  s_mov_b32 s25, 536870912
  s_mov_b32 s26, 536870912
  s_mov_b32 s27, 536870912
  v_accvgpr_write_b32 a96, 0
  v_accvgpr_write_b32 a97, 0
  v_accvgpr_write_b32 a98, 0
  v_accvgpr_write_b32 a99, 0
  v_accvgpr_write_b32 a100, 0
  v_accvgpr_write_b32 a101, 0
  v_accvgpr_write_b32 a102, 0
  v_accvgpr_write_b32 a103, 0
  v_accvgpr_write_b32 a104, 0
  v_accvgpr_write_b32 a105, 0
  v_accvgpr_write_b32 a106, 0
  v_accvgpr_write_b32 a107, 0
  v_accvgpr_write_b32 a108, 0
  v_accvgpr_write_b32 a109, 0
  v_accvgpr_write_b32 a110, 0
  v_accvgpr_write_b32 a111, 0
  v_accvgpr_write_b32 a112, 0
  v_accvgpr_write_b32 a113, 0
  v_accvgpr_write_b32 a114, 0
  v_accvgpr_write_b32 a115, 0
  v_accvgpr_write_b32 a116, 0
  v_accvgpr_write_b32 a117, 0
  v_accvgpr_write_b32 a118, 0
  v_accvgpr_write_b32 a119, 0
  v_accvgpr_write_b32 a120, 0
  v_accvgpr_write_b32 a121, 0
  v_accvgpr_write_b32 a122, 0
  v_accvgpr_write_b32 a123, 0
  v_accvgpr_write_b32 a124, 0
  v_accvgpr_write_b32 a125, 0
  v_accvgpr_write_b32 a126, 0
  v_accvgpr_write_b32 a127, 0
  v_accvgpr_write_b32 a160, 0
  v_accvgpr_write_b32 a161, 0
  v_accvgpr_write_b32 a162, 0
  v_accvgpr_write_b32 a163, 0
  v_accvgpr_write_b32 a164, 0
  v_accvgpr_write_b32 a165, 0
  v_accvgpr_write_b32 a166, 0
  v_accvgpr_write_b32 a167, 0
  v_accvgpr_write_b32 a168, 0
  v_accvgpr_write_b32 a169, 0
  v_accvgpr_write_b32 a170, 0
  v_accvgpr_write_b32 a171, 0
  v_accvgpr_write_b32 a172, 0
  v_accvgpr_write_b32 a173, 0
  v_accvgpr_write_b32 a174, 0
  v_accvgpr_write_b32 a175, 0
  v_accvgpr_write_b32 a176, 0
  v_accvgpr_write_b32 a177, 0
  v_accvgpr_write_b32 a178, 0
  v_accvgpr_write_b32 a179, 0
  v_accvgpr_write_b32 a180, 0
  v_accvgpr_write_b32 a181, 0
  v_accvgpr_write_b32 a182, 0
  v_accvgpr_write_b32 a183, 0
  v_accvgpr_write_b32 a184, 0
  v_accvgpr_write_b32 a185, 0
  v_accvgpr_write_b32 a186, 0
  v_accvgpr_write_b32 a187, 0
  v_accvgpr_write_b32 a188, 0
  v_accvgpr_write_b32 a189, 0
  v_accvgpr_write_b32 a190, 0
  v_accvgpr_write_b32 a191, 0
  v_accvgpr_write_b32 a192, 0
  v_accvgpr_write_b32 a193, 0
  v_accvgpr_write_b32 a194, 0
  v_accvgpr_write_b32 a195, 0
  v_accvgpr_write_b32 a196, 0
  v_accvgpr_write_b32 a197, 0
  v_accvgpr_write_b32 a198, 0
  v_accvgpr_write_b32 a199, 0
  v_accvgpr_write_b32 a200, 0
  v_accvgpr_write_b32 a201, 0
  v_accvgpr_write_b32 a202, 0
  v_accvgpr_write_b32 a203, 0
  v_accvgpr_write_b32 a204, 0
  v_accvgpr_write_b32 a205, 0
  v_accvgpr_write_b32 a206, 0
  v_accvgpr_write_b32 a207, 0
  v_accvgpr_write_b32 a208, 0
  v_accvgpr_write_b32 a209, 0
  v_accvgpr_write_b32 a210, 0
  v_accvgpr_write_b32 a211, 0
  v_accvgpr_write_b32 a212, 0
  v_accvgpr_write_b32 a213, 0
  v_accvgpr_write_b32 a214, 0
  v_accvgpr_write_b32 a215, 0
  v_accvgpr_write_b32 a216, 0
  v_accvgpr_write_b32 a217, 0
  v_accvgpr_write_b32 a218, 0
  v_accvgpr_write_b32 a219, 0
  v_accvgpr_write_b32 a220, 0
  v_accvgpr_write_b32 a221, 0
  v_accvgpr_write_b32 a222, 0
  v_accvgpr_write_b32 a223, 0
  v_accvgpr_write_b32 a224, 0
  v_accvgpr_write_b32 a225, 0
  v_accvgpr_write_b32 a226, 0
  v_accvgpr_write_b32 a227, 0
  v_accvgpr_write_b32 a228, 0
  v_accvgpr_write_b32 a229, 0
  v_accvgpr_write_b32 a230, 0
  v_accvgpr_write_b32 a231, 0
  v_accvgpr_write_b32 a232, 0
  v_accvgpr_write_b32 a233, 0
  v_accvgpr_write_b32 a234, 0
  v_accvgpr_write_b32 a235, 0
  v_accvgpr_write_b32 a236, 0
  v_accvgpr_write_b32 a237, 0
  v_accvgpr_write_b32 a238, 0
  v_accvgpr_write_b32 a239, 0
  v_accvgpr_write_b32 a240, 0
  v_accvgpr_write_b32 a241, 0
  v_accvgpr_write_b32 a242, 0
  v_accvgpr_write_b32 a243, 0
  v_accvgpr_write_b32 a244, 0
  v_accvgpr_write_b32 a245, 0
  v_accvgpr_write_b32 a246, 0
  v_accvgpr_write_b32 a247, 0
  v_accvgpr_write_b32 a248, 0
  v_accvgpr_write_b32 a249, 0
  v_accvgpr_write_b32 a250, 0
  v_accvgpr_write_b32 a251, 0
  v_accvgpr_write_b32 a252, 0
  v_accvgpr_write_b32 a253, 0
  v_accvgpr_write_b32 a254, 0
  v_accvgpr_write_b32 a255, 0
  s_barrier
  s_add_u32 s28, s34, 0
  s_and_b32 m0, s28, 0x1ffff
  s_nop 0
  buffer_load_dwordx4 v1, s[12:15], s28 offen offset:0 sc1 lds
  buffer_load_dwordx4 v1, s[12:15], s28 offen offset:1024 sc1 lds
  buffer_load_dwordx4 v1, s[12:15], s28 offen offset:2048 sc1 lds
  buffer_load_dwordx4 v1, s[12:15], s28 offen offset:3072 sc1 lds
  s_add_u32 s28, s34, 32768
  s_and_b32 m0, s28, 0x1ffff
  s_nop 0
  buffer_load_dwordx4 v1, s[12:15], s28 offen offset:0 sc1 lds
  buffer_load_dwordx4 v1, s[12:15], s28 offen offset:1024 sc1 lds
  buffer_load_dwordx4 v1, s[12:15], s28 offen offset:2048 sc1 lds
  buffer_load_dwordx4 v1, s[12:15], s28 offen offset:3072 sc1 lds
  s_add_u32 s28, s34, 16384
  s_and_b32 m0, s28, 0x1ffff
  s_nop 0
  buffer_load_dwordx4 v1, s[12:15], s28 offen offset:0 sc1 lds
  buffer_load_dwordx4 v1, s[12:15], s28 offen offset:1024 sc1 lds
  buffer_load_dwordx4 v1, s[12:15], s28 offen offset:2048 sc1 lds
  buffer_load_dwordx4 v1, s[12:15], s28 offen offset:3072 sc1 lds
  s_add_u32 s28, s34, 49152
  s_and_b32 m0, s28, 0x1ffff
  s_nop 0
  buffer_load_dwordx4 v1, s[12:15], s28 offen offset:0 sc1 lds
  buffer_load_dwordx4 v1, s[12:15], s28 offen offset:1024 sc1 lds
  buffer_load_dwordx4 v1, s[12:15], s28 offen offset:2048 sc1 lds
  buffer_load_dwordx4 v1, s[12:15], s28 offen offset:3072 sc1 lds
  s_add_u32 s28, s34, 65536
  s_and_b32 m0, s28, 0x1ffff
  s_nop 0
  buffer_load_dwordx4 v1, s[12:15], s28 offen offset:0 sc1 lds
  buffer_load_dwordx4 v1, s[12:15], s28 offen offset:1024 sc1 lds
  buffer_load_dwordx4 v1, s[12:15], s28 offen offset:2048 sc1 lds
  buffer_load_dwordx4 v1, s[12:15], s28 offen offset:3072 sc1 lds
  s_branch L_att
L_sl_s3c:
  s_mov_b32 s30, 40000
L_sl_s3c_l:
  s_sleep 2
  buffer_load_dword v11, off, s[8:11], s35 sc1
  s_sub_u32 s30, s30, 1
  s_waitcnt vmcnt(0)
  v_cmp_gt_u32 vcc, 8, v11
  s_cmp_eq_u32 s30, 0
  s_cbranch_scc1 L_bk_s3c
  s_nop 2
  s_cbranch_vccnz L_sl_s3c_l
  s_branch L_bk_s3c
L_sl_s5b:
  s_mov_b32 s30, 40000
L_sl_s5b_l:
  s_sleep 2
  buffer_load_dword v14, off, s[8:11], s34 sc1
  s_sub_u32 s30, s30, 1
  s_waitcnt vmcnt(0)
  v_cmp_gt_u32 vcc, 24, v14
  s_cmp_eq_u32 s30, 0
  s_cbranch_scc1 L_bk_s5b
  s_nop 2
  s_cbranch_vccnz L_sl_s5b_l
  s_branch L_bk_s5b
L_end:
  s_endpgm

.section .rodata,"a"
.p2align 6
.amdhsa_kernel parallel_sum__compressed_kv_cla__dense_activation_silu__prompt_kernel
  .amdhsa_next_free_vgpr 512
  .amdhsa_next_free_sgpr 102
  .amdhsa_accum_offset 256
  .amdhsa_group_segment_fixed_size 0
  .amdhsa_kernarg_size 96
  .amdhsa_user_sgpr_count 2
  .amdhsa_user_sgpr_kernarg_segment_ptr 1
  .amdhsa_system_sgpr_workgroup_id_x 1
.end_amdhsa_kernel
```
